```python
import torch

def _softmax(x, axis=-1):
    return torch.softmax(x, dim=axis)
def _gelu(x):
    return torch.nn.functional.gelu(x, approximate="tanh")
def _silu(x):
    return torch.nn.functional.silu(x)
def _sigmoid(x):
    return torch.sigmoid(x)
def _layernorm(x, axis=-1, eps=1e-5):
    m = x.mean(dim=axis, keepdim=True)
    v = x.var(dim=axis, keepdim=True, unbiased=False)
    return (x - m) / torch.sqrt(v + eps)
def _scatter_add(tgt, idx, src, axis=0):
    return tgt.clone().index_add_(axis, idx, src)
def _segment_sum(src, seg, n):
    out = torch.zeros((n,) + src.shape[1:], dtype=src.dtype)
    return out.index_add_(0, seg, src)
def _pad(x, pw):
    flat = tuple(v for pair in reversed(pw) for v in pair)
    return torch.nn.functional.pad(x, flat)

kernel_name = 'interleave_layers__mha_block_cached__dense_activation_silu__decode'

def setup_inputs():

    _w = (lambda a: (lambda t: t.to(torch.bfloat16) if t.is_floating_point() else t)(torch.as_tensor(a)))
    def _A_setup():
        B, Sq, D = 8, 1, 512
        H, Sk, Dh = 32, 4096, 128
        return {
            "x": _w((lambda *s: torch.randn(*s, dtype=torch.bfloat16) * 0.1)(B, Sq, D)),
            "k_cache": _w((lambda *s: torch.randn(*s, dtype=torch.bfloat16) * 0.8)(B, H, Sk, Dh)),
            "v_cache": _w((lambda *s: torch.randn(*s, dtype=torch.bfloat16) * 3.2)(B, H, Sk, Dh)),
            "wq": _w((lambda *s: torch.randn(*s, dtype=torch.bfloat16) * 0.8)(D, H * Dh) * (D ** -0.5)),
            "wo": _w((lambda *s: torch.randn(*s, dtype=torch.bfloat16) * 3.2)(H * Dh, D) * ((H * Dh) ** -0.5)),
        }
    _A_in = _A_setup()

    def _B_setup():
        B, S, D, F = 8, 1, 512, 1792
        return {
            "x": _w((lambda *s: torch.randn(*s, dtype=torch.bfloat16) * 0.1)(B, S, D)),
            "w1": _w((lambda *s: torch.randn(*s, dtype=torch.bfloat16) * 1.6)(D, F) * (D ** -0.5)),
            "w2": _w((lambda *s: torch.randn(*s, dtype=torch.bfloat16) * 0.4)(F, D) * (F ** -0.5)),
        }
    _B_in = _B_setup()

    return {
        "A_x": _A_in["x"],
        "A_k_cache": _A_in["k_cache"],
        "A_v_cache": _A_in["v_cache"],
        "A_wq": _A_in["wq"],
        "A_wo": _A_in["wo"],
        "B_x": _B_in["x"],
        "B_w1": _B_in["w1"],
        "B_w2": _B_in["w2"],
    }

def reference(A_x, A_k_cache, A_v_cache, A_wq, A_wo, B_x, B_w1, B_w2):
    def _A_ref(x, k_cache, v_cache, wq, wo):
        B, Sq, D = x.shape
        H, Dh = 32, 128
        q = (lambda x, *d: x.permute(*d))((x @ wq).reshape(B, Sq, H, Dh), 0, 2, 1, 3)
        scores = torch.einsum("bhqd,bhkd->bhqk", q, k_cache) * (Dh ** -0.5)
        p = _softmax(scores, axis=-1)
        o = torch.einsum("bhqk,bhkd->bhqd", p, v_cache)
        return (lambda x, *d: x.permute(*d))(o, 0, 2, 1, 3).reshape(B, Sq, H * Dh) @ wo

    def _B_ref(x, w1, w2):
        h = torch.einsum("bsd,df->bsf", x, w1)
        h = _silu(h)
        out = torch.einsum("bsf,fd->bsd", h, w2)
        return out

    x = A_x
    x = x + _A_ref(_layernorm(x, axis=-1), A_k_cache, A_v_cache, A_wq, A_wo)
    x = x + _B_ref(_layernorm(x, axis=-1), B_w1, B_w2)
    x = x + _A_ref(_layernorm(x, axis=-1), A_k_cache, A_v_cache, A_wq, A_wo)
    x = x + _B_ref(_layernorm(x, axis=-1), B_w1, B_w2)
    return x
```

```asm
; @launch grid=(256,1,1) block=(256,1,1) lds=155776
.amdgcn_target "amdgcn-amd-amdhsa--gfx950"
.text
.globl interleave_layers__mha_block_cached__dense_activation_silu__decode_kernel
.p2align 8
.type interleave_layers__mha_block_cached__dense_activation_silu__decode_kernel,@function
interleave_layers__mha_block_cached__dense_activation_silu__decode_kernel:
s_cmp_ge_u32 s2, 256
s_cbranch_scc1 L_end
s_load_dwordx16 s[64:79], s[0:1], 0
s_load_dwordx4 s[80:83], s[0:1], 64
s_load_dwordx2 s[84:85], s[0:1], 80
v_lshrrev_b32 v15, 6, v0
s_nop 0
v_readfirstlane_b32 s44, v15
v_and_b32 v0, 63, v0
s_and_b32 s46, s2, 31
s_lshr_b32 s47, s2, 5
s_waitcnt lgkmcnt(0)
s_lshl_b32 s54, s2, 20
s_lshr_b32 s55, s2, 12
s_add_u32 s4, s66, s54
s_addc_u32 s5, s67, s55
s_mov_b32 s6, 0x100000
s_mov_b32 s7, 0x20000
s_lshl_b32 s54, s2, 20
s_lshr_b32 s55, s2, 12
s_add_u32 s8, s68, s54
s_addc_u32 s9, s69, s55
s_mov_b32 s10, 0x100000
s_mov_b32 s11, 0x20000
s_lshl_b32 s54, s47, 10
s_lshr_b32 s55, s47, 22
s_add_u32 s36, s64, s54
s_addc_u32 s37, s65, s55
s_mov_b32 s38, 0x400
s_mov_b32 s39, 0x20000
s_lshl_b32 s54, s47, 10
s_lshr_b32 s55, s47, 22
s_add_u32 s40, s80, s54
s_addc_u32 s41, s81, s55
s_mov_b32 s42, 0x400
s_mov_b32 s43, 0x20000
s_lshl_b32 s54, s47, 18
s_lshr_b32 s55, s47, 14
s_add_u32 s28, s84, s54
s_addc_u32 s29, s85, s55
s_mov_b32 s30, 0x40000
s_mov_b32 s31, 0x20000
s_lshl_b32 s54, s46, 8
s_lshr_b32 s55, s46, 24
s_add_u32 s12, s70, s54
s_addc_u32 s13, s71, s55
s_mov_b32 s14, 0x0
s_mov_b32 s15, 0x20000
s_sub_u32 s14, 0x400000, s54
s_lshl_b32 s54, s46, 17
s_lshr_b32 s55, s46, 15
s_add_u32 s16, s72, s54
s_addc_u32 s17, s73, s55
s_mov_b32 s18, 0x20000
s_mov_b32 s19, 0x20000
s_min_u32 s56, s46, 13
s_lshl_b32 s54, s56, 8
s_lshr_b32 s55, s56, 24
s_add_u32 s20, s76, s54
s_addc_u32 s21, s77, s55
s_mov_b32 s22, 0x0
s_mov_b32 s23, 0x20000
s_sub_u32 s22, 0x1c0000, s54
s_lshl_b32 s54, s56, 17
s_lshr_b32 s55, s56, 15
s_add_u32 s24, s78, s54
s_addc_u32 s25, s79, s55
s_mov_b32 s26, 0x20000
s_mov_b32 s27, 0x20000
s_cmp_lt_u32 s46, 14
s_cselect_b32 s22, s22, 0
s_cselect_b32 s26, s26, 0
s_mov_b32 s32, s82
s_mov_b32 s33, s83
s_mov_b32 s34, 256
s_mov_b32 s35, 0x20000
s_lshl_b32 s56, s46, 11
s_lshl_b32 s54, s47, 25
s_lshr_b32 s55, s47, 7
s_add_u32 s72, s66, s54
s_addc_u32 s73, s67, s55
s_mov_b32 s74, 0x2000000
s_mov_b32 s75, 0x20000
s_add_u32 s76, s68, s54
s_addc_u32 s77, s69, s55
s_mov_b32 s78, 0x2000000
s_mov_b32 s79, 0x20000
s_mul_i32 s58, s44, 36864
s_mov_b32 s60, 0x11111111
s_mov_b32 s61, 0x11111111
s_mov_b32 s48, 0x22222222
s_mov_b32 s49, 0x22222222
s_mov_b32 s50, 0x44444444
s_mov_b32 s51, 0x44444444
s_mov_b32 s52, 0x88888888
s_mov_b32 s53, 0x88888888
v_and_b32 v120, 15, v0
v_lshrrev_b32 v121, 4, v0
v_mov_b32 v122, s44
v_and_b32 v123, 31, v0
v_lshlrev_b32 v124, 3, v123
v_lshl_add_u32 v125, v122, 8, v124
buffer_load_dwordx2 v[20:21], v125, s[36:39], 0 offen
v_lshlrev_b32 v6, 5, v120
v_lshl_add_u32 v6, v121, 4, v6
v_lshl_add_u32 v6, v122, 9, v6
v_add_u32 v11, 0x24000, v6
v_mov_b32 v15, 0x80000000
v_cmp_gt_u32 vcc, 32, v0
s_nop 1
v_cndmask_b32 v6, v15, v6, vcc
v_mov_b32 v96, -1
v_mov_b32 v97, -1
v_mov_b32 v98, -1
v_mov_b32 v99, -1
v_add_u32 v15, s56, v6
buffer_store_dwordx4 v[96:99], v15, s[28:31], 0 offen sc1
s_mov_b32 s45, 0x10000
buffer_store_dwordx4 v[96:99], v15, s[28:31], s45 offen sc1
s_mov_b32 s45, 0x20000
buffer_store_dwordx4 v[96:99], v15, s[28:31], s45 offen sc1
s_mov_b32 s45, 0x30000
buffer_store_dwordx4 v[96:99], v15, s[28:31], s45 offen sc1
v_lshl_add_u32 v124, v122, 7, v121
v_lshlrev_b32 v126, 4, v120
v_lshl_add_u32 v3, v124, 13, v126
v_lshrrev_b32 v1, 2, v120
v_lshlrev_b32 v1, 8, v1
v_and_b32 v15, 3, v120
v_lshl_add_u32 v15, v121, 2, v15
v_lshl_add_u32 v1, v15, 4, v1
v_lshl_add_u32 v1, v122, 18, v1
buffer_load_dwordx4 v[24:27], v3, s[12:15], 0 offen offset:0
s_add_u32 m0, s58, 0x0
s_nop 0
buffer_load_dwordx4 v1, s[4:7], 0 offen offset:0 nt lds
s_mov_b32 s45, 0x8000
buffer_load_dwordx4 v[28:31], v3, s[12:15], s45 offen offset:0
s_add_u32 m0, s58, 0x0
s_nop 0
buffer_load_dwordx4 v1, s[4:7], 0 offen offset:1024 nt lds
s_mov_b32 s45, 0x10000
buffer_load_dwordx4 v[32:35], v3, s[12:15], s45 offen offset:0
s_add_u32 m0, s58, 0x0
s_nop 0
buffer_load_dwordx4 v1, s[4:7], 0 offen offset:2048 nt lds
s_mov_b32 s45, 0x18000
buffer_load_dwordx4 v[36:39], v3, s[12:15], s45 offen offset:0
s_add_u32 m0, s58, 0x0
s_nop 0
buffer_load_dwordx4 v1, s[4:7], 0 offen offset:3072 nt lds
s_mov_b32 s45, 0x20000
buffer_load_dwordx4 v[40:43], v3, s[12:15], s45 offen offset:0
s_mov_b32 s45, 0x1000
s_add_u32 m0, s58, 0x1000
s_nop 0
buffer_load_dwordx4 v1, s[4:7], s45 offen offset:0 nt lds
s_mov_b32 s45, 0x28000
buffer_load_dwordx4 v[44:47], v3, s[12:15], s45 offen offset:0
s_mov_b32 s45, 0x1000
s_add_u32 m0, s58, 0x1000
s_nop 0
buffer_load_dwordx4 v1, s[4:7], s45 offen offset:1024 nt lds
s_mov_b32 s45, 0x30000
buffer_load_dwordx4 v[48:51], v3, s[12:15], s45 offen offset:0
s_mov_b32 s45, 0x1000
s_add_u32 m0, s58, 0x1000
s_nop 0
buffer_load_dwordx4 v1, s[4:7], s45 offen offset:2048 nt lds
s_mov_b32 s45, 0x38000
buffer_load_dwordx4 v[52:55], v3, s[12:15], s45 offen offset:0
s_mov_b32 s45, 0x1000
s_add_u32 m0, s58, 0x1000
s_nop 0
buffer_load_dwordx4 v1, s[4:7], s45 offen offset:3072 nt lds
s_mov_b32 s45, 0x40000
buffer_load_dwordx4 v[56:59], v3, s[12:15], s45 offen offset:0
s_mov_b32 s45, 0x2000
s_add_u32 m0, s58, 0x2000
s_nop 0
buffer_load_dwordx4 v1, s[4:7], s45 offen offset:0 nt lds
s_mov_b32 s45, 0x48000
buffer_load_dwordx4 v[60:63], v3, s[12:15], s45 offen offset:0
s_mov_b32 s45, 0x2000
s_add_u32 m0, s58, 0x2000
s_nop 0
buffer_load_dwordx4 v1, s[4:7], s45 offen offset:1024 nt lds
s_mov_b32 s45, 0x50000
buffer_load_dwordx4 v[64:67], v3, s[12:15], s45 offen offset:0
s_mov_b32 s45, 0x2000
s_add_u32 m0, s58, 0x2000
s_nop 0
buffer_load_dwordx4 v1, s[4:7], s45 offen offset:2048 nt lds
s_mov_b32 s45, 0x58000
buffer_load_dwordx4 v[68:71], v3, s[12:15], s45 offen offset:0
s_mov_b32 s45, 0x2000
s_add_u32 m0, s58, 0x2000
s_nop 0
buffer_load_dwordx4 v1, s[4:7], s45 offen offset:3072 nt lds
v_lshlrev_b32 v2, 4, v0
v_mov_b32 v8, v2
v_lshl_add_u32 v2, v122, 18, v2
v_add_u32 v8, s58, v8
s_mov_b32 s54, 3584
v_mul_lo_u32 v4, v124, s54
v_add_u32 v4, v4, v126
v_lshl_add_u32 v5, v121, 10, v126
v_lshl_add_u32 v5, v122, 8, v5
v_lshlrev_b32 v12, 4, v123
v_lshl_add_u32 v12, v122, 9, v12
v_lshrrev_b32 v15, 5, v0
v_lshl_add_u32 v7, v15, 11, v12
v_add_u32 v12, 0x24000, v12
v_lshlrev_b32 v9, 4, v120
v_lshl_add_u32 v9, v121, 2, v9
v_add_u32 v9, 0x24000, v9
v_lshl_add_u32 v10, v122, 9, v9
v_and_b32 v15, 3, v120
v_lshl_add_u32 v15, v121, 2, v15
v_lshlrev_b32 v13, 5, v15
v_add_u32 v13, 0x24000, v13
v_lshlrev_b32 v14, 5, v0
v_add_u32 v14, 0x24000, v14
v_mov_b32 v16, 0
v_mov_b32 v15, 0xffff
v_cmp_eq_u32 vcc, 0, v120
s_nop 1
v_cndmask_b32 v16, v16, v15, vcc
v_mov_b32 v15, 0xffff0000
v_cmp_eq_u32 vcc, 1, v120
s_nop 1
v_cndmask_b32 v16, v16, v15, vcc
v_mov_b32 v17, 0
v_mov_b32 v15, 0xffff
v_cmp_eq_u32 vcc, 2, v120
s_nop 1
v_cndmask_b32 v17, v17, v15, vcc
v_mov_b32 v15, 0xffff0000
v_cmp_eq_u32 vcc, 3, v120
s_nop 1
v_cndmask_b32 v17, v17, v15, vcc
v_mov_b32 v18, 0
v_mov_b32 v15, 0xffff
v_cmp_eq_u32 vcc, 4, v120
s_nop 1
v_cndmask_b32 v18, v18, v15, vcc
v_mov_b32 v15, 0xffff0000
v_cmp_eq_u32 vcc, 5, v120
s_nop 1
v_cndmask_b32 v18, v18, v15, vcc
v_mov_b32 v19, 0
v_mov_b32 v15, 0xffff
v_cmp_eq_u32 vcc, 6, v120
s_nop 1
v_cndmask_b32 v19, v19, v15, vcc
v_mov_b32 v15, 0xffff0000
v_cmp_eq_u32 vcc, 7, v120
s_nop 1
v_cndmask_b32 v19, v19, v15, vcc
v_mov_b32 v128, 0x26040
v_mov_b32 v130, 0
v_mov_b32 v131, 0
ds_write_b64 v128, v[130:131]
s_waitcnt vmcnt(28)
v_and_b32 v23, 0xffff0000, v21
v_lshlrev_b32 v22, 16, v21
v_and_b32 v21, 0xffff0000, v20
v_lshlrev_b32 v20, 16, v20
s_waitcnt vmcnt(24)
ds_write_b128 v12, v[20:23] offset:0
s_waitcnt lgkmcnt(0)
s_barrier
s_cmp_lg_u32 s44, 0
s_cbranch_scc1 L_sr1
s_mov_b64 exec, 1
v_mov_b32 v120, s47
v_lshlrev_b32 v120, 2, v120
v_mov_b32 v121, 1
buffer_atomic_add v121, v120, s[32:35], 0 offen
s_nop 1
s_mov_b64 exec, -1
L_sr1:
ds_read_b128 v[120:123], v14 offset:0
ds_read_b128 v[124:127], v14 offset:16
ds_read_b32 v132, v10 offset:0
ds_read_b32 v133, v10 offset:256
s_waitcnt lgkmcnt(2)
v_add_f32 v128, v120, v121
v_add_f32 v128, v128, v122
v_add_f32 v128, v128, v123
v_add_f32 v128, v128, v124
v_add_f32 v128, v128, v125
v_add_f32 v128, v128, v126
v_add_f32 v128, v128, v127
s_nop 1
v_add_f32_dpp v128, v128, v128 row_ror:8 row_mask:0xf bank_mask:0xf
s_nop 1
v_add_f32_dpp v128, v128, v128 row_ror:4 row_mask:0xf bank_mask:0xf
s_nop 1
v_add_f32_dpp v128, v128, v128 row_ror:2 row_mask:0xf bank_mask:0xf
s_nop 1
v_add_f32_dpp v128, v128, v128 row_ror:1 row_mask:0xf bank_mask:0xf
v_mov_b32 v129, v128
s_nop 1
v_permlane16_swap_b32 v128, v129
s_nop 0
v_add_f32 v128, v128, v129
v_mov_b32 v129, v128
s_nop 1
v_permlane32_swap_b32 v128, v129
s_nop 0
v_add_f32 v128, v128, v129
v_mul_f32 v128, 0x3b000000, v128
v_sub_f32 v120, v120, v128
v_sub_f32 v121, v121, v128
v_sub_f32 v122, v122, v128
v_sub_f32 v123, v123, v128
v_sub_f32 v124, v124, v128
v_sub_f32 v125, v125, v128
v_sub_f32 v126, v126, v128
v_sub_f32 v127, v127, v128
v_mul_f32 v130, v120, v120
v_fmac_f32 v130, v121, v121
v_fmac_f32 v130, v122, v122
v_fmac_f32 v130, v123, v123
v_fmac_f32 v130, v124, v124
v_fmac_f32 v130, v125, v125
v_fmac_f32 v130, v126, v126
v_fmac_f32 v130, v127, v127
s_nop 1
v_add_f32_dpp v130, v130, v130 row_ror:8 row_mask:0xf bank_mask:0xf
s_nop 1
v_add_f32_dpp v130, v130, v130 row_ror:4 row_mask:0xf bank_mask:0xf
s_nop 1
v_add_f32_dpp v130, v130, v130 row_ror:2 row_mask:0xf bank_mask:0xf
s_nop 1
v_add_f32_dpp v130, v130, v130 row_ror:1 row_mask:0xf bank_mask:0xf
v_mov_b32 v129, v130
s_nop 1
v_permlane16_swap_b32 v130, v129
s_nop 0
v_add_f32 v130, v130, v129
v_mov_b32 v129, v130
s_nop 1
v_permlane32_swap_b32 v130, v129
s_nop 0
v_add_f32 v130, v130, v129
v_mov_b32 v129, 0x3727c5ac
v_fmac_f32 v129, 0x3b000000, v130
v_rsq_f32 v130, v129
s_waitcnt lgkmcnt(0)
v_sub_f32 v132, v132, v128
v_mul_f32 v132, v132, v130
v_cvt_pk_bf16_f32 v88, v132, v132
v_sub_f32 v133, v133, v128
v_mul_f32 v133, v133, v130
v_cvt_pk_bf16_f32 v89, v133, v133
s_nop 1
v_and_b32_dpp v112, v88, v16 row_newbcast:0 row_mask:0xf bank_mask:0xf
v_and_b32_dpp v113, v88, v17 row_newbcast:0 row_mask:0xf bank_mask:0xf
v_and_b32_dpp v114, v88, v18 row_newbcast:0 row_mask:0xf bank_mask:0xf
v_and_b32_dpp v115, v88, v19 row_newbcast:0 row_mask:0xf bank_mask:0xf
v_and_b32_dpp v116, v88, v16 row_newbcast:1 row_mask:0xf bank_mask:0xf
v_and_b32_dpp v117, v88, v17 row_newbcast:1 row_mask:0xf bank_mask:0xf
v_and_b32_dpp v118, v88, v18 row_newbcast:1 row_mask:0xf bank_mask:0xf
v_and_b32_dpp v119, v88, v19 row_newbcast:1 row_mask:0xf bank_mask:0xf
s_waitcnt vmcnt(23)
v_mfma_f32_16x16x32_bf16 v[104:107], v[112:115], v[24:27], 0
s_mov_b32 s45, 0x60000
buffer_load_dwordx4 v[24:27], v3, s[12:15], s45 offen offset:0
s_mov_b32 s45, 0x3000
s_add_u32 m0, s58, 0x3000
s_nop 0
buffer_load_dwordx4 v1, s[4:7], s45 offen offset:0 nt lds
v_and_b32_dpp v112, v88, v16 row_newbcast:2 row_mask:0xf bank_mask:0xf
v_and_b32_dpp v113, v88, v17 row_newbcast:2 row_mask:0xf bank_mask:0xf
v_and_b32_dpp v114, v88, v18 row_newbcast:2 row_mask:0xf bank_mask:0xf
v_and_b32_dpp v115, v88, v19 row_newbcast:2 row_mask:0xf bank_mask:0xf
s_waitcnt vmcnt(23)
v_mfma_f32_16x16x32_bf16 v[104:107], v[116:119], v[28:31], v[104:107]
s_mov_b32 s45, 0x68000
buffer_load_dwordx4 v[28:31], v3, s[12:15], s45 offen offset:0
s_mov_b32 s45, 0x3000
s_add_u32 m0, s58, 0x3000
s_nop 0
buffer_load_dwordx4 v1, s[4:7], s45 offen offset:1024 nt lds
v_and_b32_dpp v116, v88, v16 row_newbcast:3 row_mask:0xf bank_mask:0xf
v_and_b32_dpp v117, v88, v17 row_newbcast:3 row_mask:0xf bank_mask:0xf
v_and_b32_dpp v118, v88, v18 row_newbcast:3 row_mask:0xf bank_mask:0xf
v_and_b32_dpp v119, v88, v19 row_newbcast:3 row_mask:0xf bank_mask:0xf
s_waitcnt vmcnt(23)
v_mfma_f32_16x16x32_bf16 v[104:107], v[112:115], v[32:35], v[104:107]
s_mov_b32 s45, 0x70000
buffer_load_dwordx4 v[32:35], v3, s[12:15], s45 offen offset:0
s_mov_b32 s45, 0x3000
s_add_u32 m0, s58, 0x3000
s_nop 0
buffer_load_dwordx4 v1, s[4:7], s45 offen offset:2048 nt lds
v_and_b32_dpp v112, v88, v16 row_newbcast:4 row_mask:0xf bank_mask:0xf
v_and_b32_dpp v113, v88, v17 row_newbcast:4 row_mask:0xf bank_mask:0xf
v_and_b32_dpp v114, v88, v18 row_newbcast:4 row_mask:0xf bank_mask:0xf
v_and_b32_dpp v115, v88, v19 row_newbcast:4 row_mask:0xf bank_mask:0xf
s_waitcnt vmcnt(23)
v_mfma_f32_16x16x32_bf16 v[104:107], v[116:119], v[36:39], v[104:107]
s_mov_b32 s45, 0x78000
buffer_load_dwordx4 v[36:39], v3, s[12:15], s45 offen offset:0
s_mov_b32 s45, 0x3000
s_add_u32 m0, s58, 0x3000
s_nop 0
buffer_load_dwordx4 v1, s[4:7], s45 offen offset:3072 nt lds
v_and_b32_dpp v116, v88, v16 row_newbcast:5 row_mask:0xf bank_mask:0xf
v_and_b32_dpp v117, v88, v17 row_newbcast:5 row_mask:0xf bank_mask:0xf
v_and_b32_dpp v118, v88, v18 row_newbcast:5 row_mask:0xf bank_mask:0xf
v_and_b32_dpp v119, v88, v19 row_newbcast:5 row_mask:0xf bank_mask:0xf
s_waitcnt vmcnt(23)
v_mfma_f32_16x16x32_bf16 v[104:107], v[112:115], v[40:43], v[104:107]
s_mov_b32 s45, 0x80000
buffer_load_dwordx4 v[40:43], v3, s[12:15], s45 offen offset:0
s_mov_b32 s45, 0x4000
s_add_u32 m0, s58, 0x4000
s_nop 0
buffer_load_dwordx4 v1, s[4:7], s45 offen offset:0 nt lds
v_and_b32_dpp v112, v88, v16 row_newbcast:6 row_mask:0xf bank_mask:0xf
v_and_b32_dpp v113, v88, v17 row_newbcast:6 row_mask:0xf bank_mask:0xf
v_and_b32_dpp v114, v88, v18 row_newbcast:6 row_mask:0xf bank_mask:0xf
v_and_b32_dpp v115, v88, v19 row_newbcast:6 row_mask:0xf bank_mask:0xf
s_waitcnt vmcnt(23)
v_mfma_f32_16x16x32_bf16 v[104:107], v[116:119], v[44:47], v[104:107]
s_mov_b32 s45, 0x88000
buffer_load_dwordx4 v[44:47], v3, s[12:15], s45 offen offset:0
s_mov_b32 s45, 0x4000
s_add_u32 m0, s58, 0x4000
s_nop 0
buffer_load_dwordx4 v1, s[4:7], s45 offen offset:1024 nt lds
v_and_b32_dpp v116, v88, v16 row_newbcast:7 row_mask:0xf bank_mask:0xf
v_and_b32_dpp v117, v88, v17 row_newbcast:7 row_mask:0xf bank_mask:0xf
v_and_b32_dpp v118, v88, v18 row_newbcast:7 row_mask:0xf bank_mask:0xf
v_and_b32_dpp v119, v88, v19 row_newbcast:7 row_mask:0xf bank_mask:0xf
s_waitcnt vmcnt(23)
v_mfma_f32_16x16x32_bf16 v[104:107], v[112:115], v[48:51], v[104:107]
s_mov_b32 s45, 0x90000
buffer_load_dwordx4 v[48:51], v3, s[12:15], s45 offen offset:0
s_mov_b32 s45, 0x4000
s_add_u32 m0, s58, 0x4000
s_nop 0
buffer_load_dwordx4 v1, s[4:7], s45 offen offset:2048 nt lds
v_and_b32_dpp v112, v88, v16 row_newbcast:8 row_mask:0xf bank_mask:0xf
v_and_b32_dpp v113, v88, v17 row_newbcast:8 row_mask:0xf bank_mask:0xf
v_and_b32_dpp v114, v88, v18 row_newbcast:8 row_mask:0xf bank_mask:0xf
v_and_b32_dpp v115, v88, v19 row_newbcast:8 row_mask:0xf bank_mask:0xf
s_waitcnt vmcnt(23)
v_mfma_f32_16x16x32_bf16 v[104:107], v[116:119], v[52:55], v[104:107]
s_mov_b32 s45, 0x98000
buffer_load_dwordx4 v[52:55], v3, s[12:15], s45 offen offset:0
s_mov_b32 s45, 0x4000
s_add_u32 m0, s58, 0x4000
s_nop 0
buffer_load_dwordx4 v1, s[4:7], s45 offen offset:3072 nt lds
v_and_b32_dpp v116, v88, v16 row_newbcast:9 row_mask:0xf bank_mask:0xf
v_and_b32_dpp v117, v88, v17 row_newbcast:9 row_mask:0xf bank_mask:0xf
v_and_b32_dpp v118, v88, v18 row_newbcast:9 row_mask:0xf bank_mask:0xf
v_and_b32_dpp v119, v88, v19 row_newbcast:9 row_mask:0xf bank_mask:0xf
s_waitcnt vmcnt(23)
v_mfma_f32_16x16x32_bf16 v[104:107], v[112:115], v[56:59], v[104:107]
s_mov_b32 s45, 0xa0000
buffer_load_dwordx4 v[56:59], v3, s[12:15], s45 offen offset:0
s_mov_b32 s45, 0x5000
s_add_u32 m0, s58, 0x5000
s_nop 0
buffer_load_dwordx4 v1, s[4:7], s45 offen offset:0 nt lds
v_and_b32_dpp v112, v88, v16 row_newbcast:10 row_mask:0xf bank_mask:0xf
v_and_b32_dpp v113, v88, v17 row_newbcast:10 row_mask:0xf bank_mask:0xf
v_and_b32_dpp v114, v88, v18 row_newbcast:10 row_mask:0xf bank_mask:0xf
v_and_b32_dpp v115, v88, v19 row_newbcast:10 row_mask:0xf bank_mask:0xf
s_waitcnt vmcnt(23)
v_mfma_f32_16x16x32_bf16 v[104:107], v[116:119], v[60:63], v[104:107]
s_mov_b32 s45, 0xa8000
buffer_load_dwordx4 v[60:63], v3, s[12:15], s45 offen offset:0
s_mov_b32 s45, 0x5000
s_add_u32 m0, s58, 0x5000
s_nop 0
buffer_load_dwordx4 v1, s[4:7], s45 offen offset:1024 nt lds
v_and_b32_dpp v116, v88, v16 row_newbcast:11 row_mask:0xf bank_mask:0xf
v_and_b32_dpp v117, v88, v17 row_newbcast:11 row_mask:0xf bank_mask:0xf
v_and_b32_dpp v118, v88, v18 row_newbcast:11 row_mask:0xf bank_mask:0xf
v_and_b32_dpp v119, v88, v19 row_newbcast:11 row_mask:0xf bank_mask:0xf
s_waitcnt vmcnt(23)
v_mfma_f32_16x16x32_bf16 v[104:107], v[112:115], v[64:67], v[104:107]
s_mov_b32 s45, 0xb0000
buffer_load_dwordx4 v[64:67], v3, s[12:15], s45 offen offset:0
s_mov_b32 s45, 0x5000
s_add_u32 m0, s58, 0x5000
s_nop 0
buffer_load_dwordx4 v1, s[4:7], s45 offen offset:2048 nt lds
v_and_b32_dpp v112, v88, v16 row_newbcast:12 row_mask:0xf bank_mask:0xf
v_and_b32_dpp v113, v88, v17 row_newbcast:12 row_mask:0xf bank_mask:0xf
v_and_b32_dpp v114, v88, v18 row_newbcast:12 row_mask:0xf bank_mask:0xf
v_and_b32_dpp v115, v88, v19 row_newbcast:12 row_mask:0xf bank_mask:0xf
s_waitcnt vmcnt(23)
v_mfma_f32_16x16x32_bf16 v[104:107], v[116:119], v[68:71], v[104:107]
s_mov_b32 s45, 0xb8000
buffer_load_dwordx4 v[68:71], v3, s[12:15], s45 offen offset:0
s_mov_b32 s45, 0x5000
s_add_u32 m0, s58, 0x5000
s_nop 0
buffer_load_dwordx4 v1, s[4:7], s45 offen offset:3072 nt lds
v_and_b32_dpp v116, v88, v16 row_newbcast:13 row_mask:0xf bank_mask:0xf
v_and_b32_dpp v117, v88, v17 row_newbcast:13 row_mask:0xf bank_mask:0xf
v_and_b32_dpp v118, v88, v18 row_newbcast:13 row_mask:0xf bank_mask:0xf
v_and_b32_dpp v119, v88, v19 row_newbcast:13 row_mask:0xf bank_mask:0xf
s_waitcnt vmcnt(23)
v_mfma_f32_16x16x32_bf16 v[104:107], v[112:115], v[24:27], v[104:107]
s_mov_b32 s45, 0xc0000
buffer_load_dwordx4 v[24:27], v3, s[12:15], s45 offen offset:0
s_mov_b32 s45, 0x6000
s_add_u32 m0, s58, 0x6000
s_nop 0
buffer_load_dwordx4 v1, s[4:7], s45 offen offset:0 nt lds
v_and_b32_dpp v112, v88, v16 row_newbcast:14 row_mask:0xf bank_mask:0xf
v_and_b32_dpp v113, v88, v17 row_newbcast:14 row_mask:0xf bank_mask:0xf
v_and_b32_dpp v114, v88, v18 row_newbcast:14 row_mask:0xf bank_mask:0xf
v_and_b32_dpp v115, v88, v19 row_newbcast:14 row_mask:0xf bank_mask:0xf
s_waitcnt vmcnt(23)
v_mfma_f32_16x16x32_bf16 v[104:107], v[116:119], v[28:31], v[104:107]
s_mov_b32 s45, 0xc8000
buffer_load_dwordx4 v[28:31], v3, s[12:15], s45 offen offset:0
s_mov_b32 s45, 0x6000
s_add_u32 m0, s58, 0x6000
s_nop 0
buffer_load_dwordx4 v1, s[4:7], s45 offen offset:1024 nt lds
v_and_b32_dpp v116, v88, v16 row_newbcast:15 row_mask:0xf bank_mask:0xf
v_and_b32_dpp v117, v88, v17 row_newbcast:15 row_mask:0xf bank_mask:0xf
v_and_b32_dpp v118, v88, v18 row_newbcast:15 row_mask:0xf bank_mask:0xf
v_and_b32_dpp v119, v88, v19 row_newbcast:15 row_mask:0xf bank_mask:0xf
s_waitcnt vmcnt(23)
v_mfma_f32_16x16x32_bf16 v[104:107], v[112:115], v[32:35], v[104:107]
s_mov_b32 s45, 0xd0000
buffer_load_dwordx4 v[32:35], v3, s[12:15], s45 offen offset:0
s_mov_b32 s45, 0x6000
s_add_u32 m0, s58, 0x6000
s_nop 0
buffer_load_dwordx4 v1, s[4:7], s45 offen offset:2048 nt lds
v_and_b32_dpp v112, v89, v16 row_newbcast:0 row_mask:0xf bank_mask:0xf
v_and_b32_dpp v113, v89, v17 row_newbcast:0 row_mask:0xf bank_mask:0xf
v_and_b32_dpp v114, v89, v18 row_newbcast:0 row_mask:0xf bank_mask:0xf
v_and_b32_dpp v115, v89, v19 row_newbcast:0 row_mask:0xf bank_mask:0xf
s_waitcnt vmcnt(23)
v_mfma_f32_16x16x32_bf16 v[104:107], v[116:119], v[36:39], v[104:107]
s_mov_b32 s45, 0xd8000
buffer_load_dwordx4 v[36:39], v3, s[12:15], s45 offen offset:0
s_mov_b32 s45, 0x6000
s_add_u32 m0, s58, 0x6000
s_nop 0
buffer_load_dwordx4 v1, s[4:7], s45 offen offset:3072 nt lds
v_and_b32_dpp v116, v89, v16 row_newbcast:1 row_mask:0xf bank_mask:0xf
v_and_b32_dpp v117, v89, v17 row_newbcast:1 row_mask:0xf bank_mask:0xf
v_and_b32_dpp v118, v89, v18 row_newbcast:1 row_mask:0xf bank_mask:0xf
v_and_b32_dpp v119, v89, v19 row_newbcast:1 row_mask:0xf bank_mask:0xf
s_waitcnt vmcnt(23)
v_mfma_f32_16x16x32_bf16 v[104:107], v[112:115], v[40:43], v[104:107]
s_mov_b32 s45, 0xe0000
buffer_load_dwordx4 v[40:43], v3, s[12:15], s45 offen offset:0
s_mov_b32 s45, 0x7000
s_add_u32 m0, s58, 0x7000
s_nop 0
buffer_load_dwordx4 v1, s[4:7], s45 offen offset:0 nt lds
v_and_b32_dpp v112, v89, v16 row_newbcast:2 row_mask:0xf bank_mask:0xf
v_and_b32_dpp v113, v89, v17 row_newbcast:2 row_mask:0xf bank_mask:0xf
v_and_b32_dpp v114, v89, v18 row_newbcast:2 row_mask:0xf bank_mask:0xf
v_and_b32_dpp v115, v89, v19 row_newbcast:2 row_mask:0xf bank_mask:0xf
s_waitcnt vmcnt(23)
v_mfma_f32_16x16x32_bf16 v[104:107], v[116:119], v[44:47], v[104:107]
s_mov_b32 s45, 0xe8000
buffer_load_dwordx4 v[44:47], v3, s[12:15], s45 offen offset:0
s_mov_b32 s45, 0x7000
s_add_u32 m0, s58, 0x7000
s_nop 0
buffer_load_dwordx4 v1, s[4:7], s45 offen offset:1024 nt lds
v_and_b32_dpp v116, v89, v16 row_newbcast:3 row_mask:0xf bank_mask:0xf
v_and_b32_dpp v117, v89, v17 row_newbcast:3 row_mask:0xf bank_mask:0xf
v_and_b32_dpp v118, v89, v18 row_newbcast:3 row_mask:0xf bank_mask:0xf
v_and_b32_dpp v119, v89, v19 row_newbcast:3 row_mask:0xf bank_mask:0xf
s_waitcnt vmcnt(23)
v_mfma_f32_16x16x32_bf16 v[104:107], v[112:115], v[48:51], v[104:107]
s_mov_b32 s45, 0xf0000
buffer_load_dwordx4 v[48:51], v3, s[12:15], s45 offen offset:0
s_mov_b32 s45, 0x7000
s_add_u32 m0, s58, 0x7000
s_nop 0
buffer_load_dwordx4 v1, s[4:7], s45 offen offset:2048 nt lds
v_and_b32_dpp v112, v89, v16 row_newbcast:4 row_mask:0xf bank_mask:0xf
v_and_b32_dpp v113, v89, v17 row_newbcast:4 row_mask:0xf bank_mask:0xf
v_and_b32_dpp v114, v89, v18 row_newbcast:4 row_mask:0xf bank_mask:0xf
v_and_b32_dpp v115, v89, v19 row_newbcast:4 row_mask:0xf bank_mask:0xf
s_waitcnt vmcnt(23)
v_mfma_f32_16x16x32_bf16 v[104:107], v[116:119], v[52:55], v[104:107]
s_mov_b32 s45, 0xf8000
buffer_load_dwordx4 v[52:55], v3, s[12:15], s45 offen offset:0
s_mov_b32 s45, 0x7000
s_add_u32 m0, s58, 0x7000
s_nop 0
buffer_load_dwordx4 v1, s[4:7], s45 offen offset:3072 nt lds
v_and_b32_dpp v116, v89, v16 row_newbcast:5 row_mask:0xf bank_mask:0xf
v_and_b32_dpp v117, v89, v17 row_newbcast:5 row_mask:0xf bank_mask:0xf
v_and_b32_dpp v118, v89, v18 row_newbcast:5 row_mask:0xf bank_mask:0xf
v_and_b32_dpp v119, v89, v19 row_newbcast:5 row_mask:0xf bank_mask:0xf
s_waitcnt vmcnt(23)
v_mfma_f32_16x16x32_bf16 v[104:107], v[112:115], v[56:59], v[104:107]
s_mov_b32 s45, 0x8000
s_add_u32 m0, s58, 0x8000
s_nop 0
buffer_load_dwordx4 v1, s[4:7], s45 offen offset:0 nt lds
v_and_b32_dpp v112, v89, v16 row_newbcast:6 row_mask:0xf bank_mask:0xf
v_and_b32_dpp v113, v89, v17 row_newbcast:6 row_mask:0xf bank_mask:0xf
v_and_b32_dpp v114, v89, v18 row_newbcast:6 row_mask:0xf bank_mask:0xf
v_and_b32_dpp v115, v89, v19 row_newbcast:6 row_mask:0xf bank_mask:0xf
s_waitcnt vmcnt(22)
v_mfma_f32_16x16x32_bf16 v[104:107], v[116:119], v[60:63], v[104:107]
s_add_u32 m0, s58, 0x8000
s_nop 0
buffer_load_dwordx4 v1, s[4:7], s45 offen offset:1024 nt lds
v_and_b32_dpp v116, v89, v16 row_newbcast:7 row_mask:0xf bank_mask:0xf
v_and_b32_dpp v117, v89, v17 row_newbcast:7 row_mask:0xf bank_mask:0xf
v_and_b32_dpp v118, v89, v18 row_newbcast:7 row_mask:0xf bank_mask:0xf
v_and_b32_dpp v119, v89, v19 row_newbcast:7 row_mask:0xf bank_mask:0xf
s_waitcnt vmcnt(21)
v_mfma_f32_16x16x32_bf16 v[104:107], v[112:115], v[64:67], v[104:107]
s_add_u32 m0, s58, 0x8000
s_nop 0
buffer_load_dwordx4 v1, s[4:7], s45 offen offset:2048 nt lds
v_and_b32_dpp v112, v89, v16 row_newbcast:8 row_mask:0xf bank_mask:0xf
v_and_b32_dpp v113, v89, v17 row_newbcast:8 row_mask:0xf bank_mask:0xf
v_and_b32_dpp v114, v89, v18 row_newbcast:8 row_mask:0xf bank_mask:0xf
v_and_b32_dpp v115, v89, v19 row_newbcast:8 row_mask:0xf bank_mask:0xf
s_waitcnt vmcnt(20)
v_mfma_f32_16x16x32_bf16 v[104:107], v[116:119], v[68:71], v[104:107]
s_add_u32 m0, s58, 0x8000
s_nop 0
buffer_load_dwordx4 v1, s[4:7], s45 offen offset:3072 nt lds
v_and_b32_dpp v116, v89, v16 row_newbcast:9 row_mask:0xf bank_mask:0xf
v_and_b32_dpp v117, v89, v17 row_newbcast:9 row_mask:0xf bank_mask:0xf
v_and_b32_dpp v118, v89, v18 row_newbcast:9 row_mask:0xf bank_mask:0xf
v_and_b32_dpp v119, v89, v19 row_newbcast:9 row_mask:0xf bank_mask:0xf
s_waitcnt vmcnt(19)
v_mfma_f32_16x16x32_bf16 v[104:107], v[112:115], v[24:27], v[104:107]
s_mov_b32 s45, 0x9000
buffer_load_dwordx4 a[0:3], v1, s[4:7], s45 offen offset:0 nt
v_and_b32_dpp v112, v89, v16 row_newbcast:10 row_mask:0xf bank_mask:0xf
v_and_b32_dpp v113, v89, v17 row_newbcast:10 row_mask:0xf bank_mask:0xf
v_and_b32_dpp v114, v89, v18 row_newbcast:10 row_mask:0xf bank_mask:0xf
v_and_b32_dpp v115, v89, v19 row_newbcast:10 row_mask:0xf bank_mask:0xf
s_waitcnt vmcnt(18)
v_mfma_f32_16x16x32_bf16 v[104:107], v[116:119], v[28:31], v[104:107]
buffer_load_dwordx4 a[4:7], v1, s[4:7], s45 offen offset:1024 nt
v_and_b32_dpp v116, v89, v16 row_newbcast:11 row_mask:0xf bank_mask:0xf
v_and_b32_dpp v117, v89, v17 row_newbcast:11 row_mask:0xf bank_mask:0xf
v_and_b32_dpp v118, v89, v18 row_newbcast:11 row_mask:0xf bank_mask:0xf
v_and_b32_dpp v119, v89, v19 row_newbcast:11 row_mask:0xf bank_mask:0xf
s_waitcnt vmcnt(17)
v_mfma_f32_16x16x32_bf16 v[104:107], v[112:115], v[32:35], v[104:107]
buffer_load_dwordx4 a[8:11], v1, s[4:7], s45 offen offset:2048 nt
v_and_b32_dpp v112, v89, v16 row_newbcast:12 row_mask:0xf bank_mask:0xf
v_and_b32_dpp v113, v89, v17 row_newbcast:12 row_mask:0xf bank_mask:0xf
v_and_b32_dpp v114, v89, v18 row_newbcast:12 row_mask:0xf bank_mask:0xf
v_and_b32_dpp v115, v89, v19 row_newbcast:12 row_mask:0xf bank_mask:0xf
s_waitcnt vmcnt(16)
v_mfma_f32_16x16x32_bf16 v[104:107], v[116:119], v[36:39], v[104:107]
buffer_load_dwordx4 a[12:15], v1, s[4:7], s45 offen offset:3072 nt
v_and_b32_dpp v116, v89, v16 row_newbcast:13 row_mask:0xf bank_mask:0xf
v_and_b32_dpp v117, v89, v17 row_newbcast:13 row_mask:0xf bank_mask:0xf
v_and_b32_dpp v118, v89, v18 row_newbcast:13 row_mask:0xf bank_mask:0xf
v_and_b32_dpp v119, v89, v19 row_newbcast:13 row_mask:0xf bank_mask:0xf
s_waitcnt vmcnt(15)
v_mfma_f32_16x16x32_bf16 v[104:107], v[112:115], v[40:43], v[104:107]
s_mov_b32 s45, 0xa000
buffer_load_dwordx4 a[16:19], v1, s[4:7], s45 offen offset:0 nt
v_and_b32_dpp v112, v89, v16 row_newbcast:14 row_mask:0xf bank_mask:0xf
v_and_b32_dpp v113, v89, v17 row_newbcast:14 row_mask:0xf bank_mask:0xf
v_and_b32_dpp v114, v89, v18 row_newbcast:14 row_mask:0xf bank_mask:0xf
v_and_b32_dpp v115, v89, v19 row_newbcast:14 row_mask:0xf bank_mask:0xf
s_waitcnt vmcnt(14)
v_mfma_f32_16x16x32_bf16 v[104:107], v[116:119], v[44:47], v[104:107]
buffer_load_dwordx4 a[20:23], v1, s[4:7], s45 offen offset:1024 nt
v_and_b32_dpp v116, v89, v16 row_newbcast:15 row_mask:0xf bank_mask:0xf
v_and_b32_dpp v117, v89, v17 row_newbcast:15 row_mask:0xf bank_mask:0xf
v_and_b32_dpp v118, v89, v18 row_newbcast:15 row_mask:0xf bank_mask:0xf
v_and_b32_dpp v119, v89, v19 row_newbcast:15 row_mask:0xf bank_mask:0xf
s_waitcnt vmcnt(13)
v_mfma_f32_16x16x32_bf16 v[104:107], v[112:115], v[48:51], v[104:107]
buffer_load_dwordx4 a[24:27], v1, s[4:7], s45 offen offset:2048 nt
s_nop 1
s_waitcnt vmcnt(12)
v_mfma_f32_16x16x32_bf16 v[104:107], v[116:119], v[52:55], v[104:107]
buffer_load_dwordx4 a[28:31], v1, s[4:7], s45 offen offset:3072 nt
s_nop 7
s_mov_b32 exec_hi, 0
ds_write_b128 v11, v[104:107] offset:2048
s_mov_b32 exec_hi, -1
s_waitcnt lgkmcnt(0)
s_barrier
ds_read_b128 v[120:123], v13 offset:2048
ds_read_b128 v[124:127], v13 offset:2064
ds_read_b128 v[128:131], v13 offset:2560
ds_read_b128 v[132:135], v13 offset:2576
s_waitcnt lgkmcnt(0)
v_add_f32 v120, v120, v128
v_add_f32 v121, v121, v129
v_add_f32 v122, v122, v130
v_add_f32 v123, v123, v131
v_add_f32 v124, v124, v132
v_add_f32 v125, v125, v133
v_add_f32 v126, v126, v134
v_add_f32 v127, v127, v135
ds_read_b128 v[128:131], v13 offset:3072
ds_read_b128 v[132:135], v13 offset:3088
s_waitcnt lgkmcnt(0)
v_add_f32 v120, v120, v128
v_add_f32 v121, v121, v129
v_add_f32 v122, v122, v130
v_add_f32 v123, v123, v131
v_add_f32 v124, v124, v132
v_add_f32 v125, v125, v133
v_add_f32 v126, v126, v134
v_add_f32 v127, v127, v135
ds_read_b128 v[128:131], v13 offset:3584
ds_read_b128 v[132:135], v13 offset:3600
s_waitcnt lgkmcnt(0)
v_add_f32 v120, v120, v128
v_add_f32 v121, v121, v129
v_add_f32 v122, v122, v130
v_add_f32 v123, v123, v131
v_add_f32 v124, v124, v132
v_add_f32 v125, v125, v133
v_add_f32 v126, v126, v134
v_add_f32 v127, v127, v135
v_cvt_pk_bf16_f32 v128, v120, v121
v_cvt_pk_bf16_f32 v129, v122, v123
v_cvt_pk_bf16_f32 v130, v124, v125
v_cvt_pk_bf16_f32 v131, v126, v127
v_lshrrev_b32 v120, 2, v0
v_and_b32 v120, 3, v120
v_cmp_eq_u32 vcc, 0, v120
s_nop 1
v_cndmask_b32 v72, 0, v128, vcc
v_cndmask_b32 v73, 0, v129, vcc
v_cndmask_b32 v74, 0, v130, vcc
v_cndmask_b32 v75, 0, v131, vcc
v_cmp_eq_u32 vcc, 1, v120
s_nop 1
v_cndmask_b32 v76, 0, v128, vcc
v_cndmask_b32 v77, 0, v129, vcc
v_cndmask_b32 v78, 0, v130, vcc
v_cndmask_b32 v79, 0, v131, vcc
v_cmp_eq_u32 vcc, 2, v120
s_nop 1
v_cndmask_b32 v80, 0, v128, vcc
v_cndmask_b32 v81, 0, v129, vcc
v_cndmask_b32 v82, 0, v130, vcc
v_cndmask_b32 v83, 0, v131, vcc
v_cmp_eq_u32 vcc, 3, v120
s_nop 1
v_cndmask_b32 v84, 0, v128, vcc
v_cndmask_b32 v85, 0, v129, vcc
v_cndmask_b32 v86, 0, v130, vcc
v_cndmask_b32 v87, 0, v131, vcc
s_nop 1
ds_read_b128 v[120:123], v8 offset:0
ds_read_b128 v[124:127], v8 offset:1024
ds_read_b128 v[128:131], v8 offset:2048
ds_read_b128 v[132:135], v8 offset:3072
s_waitcnt lgkmcnt(0)
v_mfma_f32_16x16x32_bf16 v[104:107], v[120:123], v[72:75], 0
v_mfma_f32_16x16x32_bf16 v[104:107], v[124:127], v[76:79], v[104:107]
v_mfma_f32_16x16x32_bf16 v[104:107], v[128:131], v[80:83], v[104:107]
v_mfma_f32_16x16x32_bf16 v[104:107], v[132:135], v[84:87], v[104:107]
ds_read_b128 v[120:123], v8 offset:4096
ds_read_b128 v[124:127], v8 offset:5120
ds_read_b128 v[128:131], v8 offset:6144
ds_read_b128 v[132:135], v8 offset:7168
s_waitcnt lgkmcnt(0)
v_mfma_f32_16x16x32_bf16 v[108:111], v[120:123], v[72:75], 0
v_mfma_f32_16x16x32_bf16 v[108:111], v[124:127], v[76:79], v[108:111]
v_mfma_f32_16x16x32_bf16 v[108:111], v[128:131], v[80:83], v[108:111]
v_mfma_f32_16x16x32_bf16 v[108:111], v[132:135], v[84:87], v[108:111]
ds_read_b128 v[120:123], v8 offset:8192
ds_read_b128 v[124:127], v8 offset:9216
ds_read_b128 v[128:131], v8 offset:10240
ds_read_b128 v[132:135], v8 offset:11264
s_nop 3
v_mov_b32_dpp v112, v104 quad_perm:[0,0,0,0] row_mask:0xf bank_mask:0xf
v_add_f32_dpp v112, v105, v112 quad_perm:[1,1,1,1] row_mask:0xf bank_mask:0xf
v_add_f32_dpp v112, v106, v112 quad_perm:[2,2,2,2] row_mask:0xf bank_mask:0xf
v_add_f32_dpp v112, v107, v112 quad_perm:[3,3,3,3] row_mask:0xf bank_mask:0xf
v_mov_b32 v88, v112
s_waitcnt lgkmcnt(0)
v_mfma_f32_16x16x32_bf16 v[104:107], v[120:123], v[72:75], 0
v_mfma_f32_16x16x32_bf16 v[104:107], v[124:127], v[76:79], v[104:107]
v_mfma_f32_16x16x32_bf16 v[104:107], v[128:131], v[80:83], v[104:107]
v_mfma_f32_16x16x32_bf16 v[104:107], v[132:135], v[84:87], v[104:107]
ds_read_b128 v[120:123], v8 offset:12288
ds_read_b128 v[124:127], v8 offset:13312
ds_read_b128 v[128:131], v8 offset:14336
ds_read_b128 v[132:135], v8 offset:15360
s_nop 3
v_mov_b32_dpp v112, v108 quad_perm:[0,0,0,0] row_mask:0xf bank_mask:0xf
v_add_f32_dpp v112, v109, v112 quad_perm:[1,1,1,1] row_mask:0xf bank_mask:0xf
v_add_f32_dpp v112, v110, v112 quad_perm:[2,2,2,2] row_mask:0xf bank_mask:0xf
v_add_f32_dpp v112, v111, v112 quad_perm:[3,3,3,3] row_mask:0xf bank_mask:0xf
v_cndmask_b32 v88, v88, v112, s[48:49]
s_waitcnt lgkmcnt(0)
v_mfma_f32_16x16x32_bf16 v[108:111], v[120:123], v[72:75], 0
v_mfma_f32_16x16x32_bf16 v[108:111], v[124:127], v[76:79], v[108:111]
v_mfma_f32_16x16x32_bf16 v[108:111], v[128:131], v[80:83], v[108:111]
v_mfma_f32_16x16x32_bf16 v[108:111], v[132:135], v[84:87], v[108:111]
ds_read_b128 v[120:123], v8 offset:16384
ds_read_b128 v[124:127], v8 offset:17408
ds_read_b128 v[128:131], v8 offset:18432
ds_read_b128 v[132:135], v8 offset:19456
s_nop 3
v_mov_b32_dpp v112, v104 quad_perm:[0,0,0,0] row_mask:0xf bank_mask:0xf
v_add_f32_dpp v112, v105, v112 quad_perm:[1,1,1,1] row_mask:0xf bank_mask:0xf
v_add_f32_dpp v112, v106, v112 quad_perm:[2,2,2,2] row_mask:0xf bank_mask:0xf
v_add_f32_dpp v112, v107, v112 quad_perm:[3,3,3,3] row_mask:0xf bank_mask:0xf
v_cndmask_b32 v88, v88, v112, s[50:51]
s_waitcnt lgkmcnt(0)
v_mfma_f32_16x16x32_bf16 v[104:107], v[120:123], v[72:75], 0
v_mfma_f32_16x16x32_bf16 v[104:107], v[124:127], v[76:79], v[104:107]
v_mfma_f32_16x16x32_bf16 v[104:107], v[128:131], v[80:83], v[104:107]
v_mfma_f32_16x16x32_bf16 v[104:107], v[132:135], v[84:87], v[104:107]
ds_read_b128 v[120:123], v8 offset:20480
ds_read_b128 v[124:127], v8 offset:21504
ds_read_b128 v[128:131], v8 offset:22528
ds_read_b128 v[132:135], v8 offset:23552
s_nop 3
v_mov_b32_dpp v112, v108 quad_perm:[0,0,0,0] row_mask:0xf bank_mask:0xf
v_add_f32_dpp v112, v109, v112 quad_perm:[1,1,1,1] row_mask:0xf bank_mask:0xf
v_add_f32_dpp v112, v110, v112 quad_perm:[2,2,2,2] row_mask:0xf bank_mask:0xf
v_add_f32_dpp v112, v111, v112 quad_perm:[3,3,3,3] row_mask:0xf bank_mask:0xf
v_cndmask_b32 v88, v88, v112, s[52:53]
s_waitcnt lgkmcnt(0)
v_mfma_f32_16x16x32_bf16 v[108:111], v[120:123], v[72:75], 0
v_mfma_f32_16x16x32_bf16 v[108:111], v[124:127], v[76:79], v[108:111]
v_mfma_f32_16x16x32_bf16 v[108:111], v[128:131], v[80:83], v[108:111]
v_mfma_f32_16x16x32_bf16 v[108:111], v[132:135], v[84:87], v[108:111]
ds_read_b128 v[120:123], v8 offset:24576
ds_read_b128 v[124:127], v8 offset:25600
ds_read_b128 v[128:131], v8 offset:26624
ds_read_b128 v[132:135], v8 offset:27648
s_nop 3
v_mov_b32_dpp v112, v104 quad_perm:[0,0,0,0] row_mask:0xf bank_mask:0xf
v_add_f32_dpp v112, v105, v112 quad_perm:[1,1,1,1] row_mask:0xf bank_mask:0xf
v_add_f32_dpp v112, v106, v112 quad_perm:[2,2,2,2] row_mask:0xf bank_mask:0xf
v_add_f32_dpp v112, v107, v112 quad_perm:[3,3,3,3] row_mask:0xf bank_mask:0xf
v_mov_b32 v89, v112
s_waitcnt lgkmcnt(0)
v_mfma_f32_16x16x32_bf16 v[104:107], v[120:123], v[72:75], 0
v_mfma_f32_16x16x32_bf16 v[104:107], v[124:127], v[76:79], v[104:107]
v_mfma_f32_16x16x32_bf16 v[104:107], v[128:131], v[80:83], v[104:107]
v_mfma_f32_16x16x32_bf16 v[104:107], v[132:135], v[84:87], v[104:107]
ds_read_b128 v[120:123], v8 offset:28672
ds_read_b128 v[124:127], v8 offset:29696
ds_read_b128 v[128:131], v8 offset:30720
s_waitcnt vmcnt(12)
ds_read_b128 v[132:135], v8 offset:31744
s_nop 3
v_mov_b32_dpp v112, v108 quad_perm:[0,0,0,0] row_mask:0xf bank_mask:0xf
v_add_f32_dpp v112, v109, v112 quad_perm:[1,1,1,1] row_mask:0xf bank_mask:0xf
v_add_f32_dpp v112, v110, v112 quad_perm:[2,2,2,2] row_mask:0xf bank_mask:0xf
v_add_f32_dpp v112, v111, v112 quad_perm:[3,3,3,3] row_mask:0xf bank_mask:0xf
v_cndmask_b32 v89, v89, v112, s[48:49]
s_waitcnt lgkmcnt(0)
v_mfma_f32_16x16x32_bf16 v[108:111], v[120:123], v[72:75], 0
v_mfma_f32_16x16x32_bf16 v[108:111], v[124:127], v[76:79], v[108:111]
v_mfma_f32_16x16x32_bf16 v[108:111], v[128:131], v[80:83], v[108:111]
v_mfma_f32_16x16x32_bf16 v[108:111], v[132:135], v[84:87], v[108:111]
s_waitcnt vmcnt(11)
ds_read_b128 v[120:123], v8 offset:32768
s_waitcnt vmcnt(10)
ds_read_b128 v[124:127], v8 offset:33792
s_waitcnt vmcnt(9)
ds_read_b128 v[128:131], v8 offset:34816
s_waitcnt vmcnt(8)
ds_read_b128 v[132:135], v8 offset:35840
s_nop 3
v_mov_b32_dpp v112, v104 quad_perm:[0,0,0,0] row_mask:0xf bank_mask:0xf
v_add_f32_dpp v112, v105, v112 quad_perm:[1,1,1,1] row_mask:0xf bank_mask:0xf
v_add_f32_dpp v112, v106, v112 quad_perm:[2,2,2,2] row_mask:0xf bank_mask:0xf
v_add_f32_dpp v112, v107, v112 quad_perm:[3,3,3,3] row_mask:0xf bank_mask:0xf
v_cndmask_b32 v89, v89, v112, s[50:51]
s_waitcnt lgkmcnt(0)
v_mfma_f32_16x16x32_bf16 v[104:107], v[120:123], v[72:75], 0
v_mfma_f32_16x16x32_bf16 v[104:107], v[124:127], v[76:79], v[104:107]
v_mfma_f32_16x16x32_bf16 v[104:107], v[128:131], v[80:83], v[104:107]
v_mfma_f32_16x16x32_bf16 v[104:107], v[132:135], v[84:87], v[104:107]
s_nop 3
v_mov_b32_dpp v112, v108 quad_perm:[0,0,0,0] row_mask:0xf bank_mask:0xf
v_add_f32_dpp v112, v109, v112 quad_perm:[1,1,1,1] row_mask:0xf bank_mask:0xf
v_add_f32_dpp v112, v110, v112 quad_perm:[2,2,2,2] row_mask:0xf bank_mask:0xf
v_add_f32_dpp v112, v111, v112 quad_perm:[3,3,3,3] row_mask:0xf bank_mask:0xf
v_cndmask_b32 v89, v89, v112, s[52:53]
s_mov_b32 s45, 0xb000
buffer_load_dwordx4 a[32:35], v1, s[4:7], s45 offen offset:0 nt
s_waitcnt vmcnt(8)
v_mfma_f32_16x16x32_bf16 v[108:111], a[0:3], v[72:75], 0
buffer_load_dwordx4 a[36:39], v1, s[4:7], s45 offen offset:1024 nt
s_waitcnt vmcnt(8)
v_mfma_f32_16x16x32_bf16 v[108:111], a[4:7], v[76:79], v[108:111]
buffer_load_dwordx4 a[40:43], v1, s[4:7], s45 offen offset:2048 nt
s_waitcnt vmcnt(8)
v_mfma_f32_16x16x32_bf16 v[108:111], a[8:11], v[80:83], v[108:111]
buffer_load_dwordx4 a[44:47], v1, s[4:7], s45 offen offset:3072 nt
s_waitcnt vmcnt(8)
v_mfma_f32_16x16x32_bf16 v[108:111], a[12:15], v[84:87], v[108:111]
s_nop 3
v_mov_b32_dpp v112, v104 quad_perm:[0,0,0,0] row_mask:0xf bank_mask:0xf
v_add_f32_dpp v112, v105, v112 quad_perm:[1,1,1,1] row_mask:0xf bank_mask:0xf
v_add_f32_dpp v112, v106, v112 quad_perm:[2,2,2,2] row_mask:0xf bank_mask:0xf
v_add_f32_dpp v112, v107, v112 quad_perm:[3,3,3,3] row_mask:0xf bank_mask:0xf
v_mov_b32 v90, v112
s_mov_b32 s45, 0xc000
buffer_load_dwordx4 a[48:51], v1, s[4:7], s45 offen offset:0 nt
s_waitcnt vmcnt(8)
v_mfma_f32_16x16x32_bf16 v[104:107], a[16:19], v[72:75], 0
buffer_load_dwordx4 a[52:55], v1, s[4:7], s45 offen offset:1024 nt
s_waitcnt vmcnt(8)
v_mfma_f32_16x16x32_bf16 v[104:107], a[20:23], v[76:79], v[104:107]
buffer_load_dwordx4 a[56:59], v1, s[4:7], s45 offen offset:2048 nt
s_waitcnt vmcnt(8)
v_mfma_f32_16x16x32_bf16 v[104:107], a[24:27], v[80:83], v[104:107]
buffer_load_dwordx4 a[60:63], v1, s[4:7], s45 offen offset:3072 nt
s_waitcnt vmcnt(8)
v_mfma_f32_16x16x32_bf16 v[104:107], a[28:31], v[84:87], v[104:107]
s_nop 3
v_mov_b32_dpp v112, v108 quad_perm:[0,0,0,0] row_mask:0xf bank_mask:0xf
v_add_f32_dpp v112, v109, v112 quad_perm:[1,1,1,1] row_mask:0xf bank_mask:0xf
v_add_f32_dpp v112, v110, v112 quad_perm:[2,2,2,2] row_mask:0xf bank_mask:0xf
v_add_f32_dpp v112, v111, v112 quad_perm:[3,3,3,3] row_mask:0xf bank_mask:0xf
v_cndmask_b32 v90, v90, v112, s[48:49]
s_mov_b32 s45, 0xd000
buffer_load_dwordx4 a[64:67], v1, s[4:7], s45 offen offset:0 nt
s_waitcnt vmcnt(8)
v_mfma_f32_16x16x32_bf16 v[108:111], a[32:35], v[72:75], 0
buffer_load_dwordx4 a[68:71], v1, s[4:7], s45 offen offset:1024 nt
s_waitcnt vmcnt(8)
v_mfma_f32_16x16x32_bf16 v[108:111], a[36:39], v[76:79], v[108:111]
buffer_load_dwordx4 a[72:75], v1, s[4:7], s45 offen offset:2048 nt
s_waitcnt vmcnt(8)
v_mfma_f32_16x16x32_bf16 v[108:111], a[40:43], v[80:83], v[108:111]
buffer_load_dwordx4 a[76:79], v1, s[4:7], s45 offen offset:3072 nt
s_waitcnt vmcnt(8)
v_mfma_f32_16x16x32_bf16 v[108:111], a[44:47], v[84:87], v[108:111]
s_nop 3
v_mov_b32_dpp v112, v104 quad_perm:[0,0,0,0] row_mask:0xf bank_mask:0xf
v_add_f32_dpp v112, v105, v112 quad_perm:[1,1,1,1] row_mask:0xf bank_mask:0xf
v_add_f32_dpp v112, v106, v112 quad_perm:[2,2,2,2] row_mask:0xf bank_mask:0xf
v_add_f32_dpp v112, v107, v112 quad_perm:[3,3,3,3] row_mask:0xf bank_mask:0xf
v_cndmask_b32 v90, v90, v112, s[50:51]
s_mov_b32 s45, 0xe000
buffer_load_dwordx4 a[80:83], v1, s[4:7], s45 offen offset:0 nt
s_waitcnt vmcnt(8)
v_mfma_f32_16x16x32_bf16 v[104:107], a[48:51], v[72:75], 0
buffer_load_dwordx4 a[84:87], v1, s[4:7], s45 offen offset:1024 nt
s_waitcnt vmcnt(8)
v_mfma_f32_16x16x32_bf16 v[104:107], a[52:55], v[76:79], v[104:107]
buffer_load_dwordx4 a[88:91], v1, s[4:7], s45 offen offset:2048 nt
s_waitcnt vmcnt(8)
v_mfma_f32_16x16x32_bf16 v[104:107], a[56:59], v[80:83], v[104:107]
buffer_load_dwordx4 a[92:95], v1, s[4:7], s45 offen offset:3072 nt
s_waitcnt vmcnt(8)
v_mfma_f32_16x16x32_bf16 v[104:107], a[60:63], v[84:87], v[104:107]
s_nop 3
v_mov_b32_dpp v112, v108 quad_perm:[0,0,0,0] row_mask:0xf bank_mask:0xf
v_add_f32_dpp v112, v109, v112 quad_perm:[1,1,1,1] row_mask:0xf bank_mask:0xf
v_add_f32_dpp v112, v110, v112 quad_perm:[2,2,2,2] row_mask:0xf bank_mask:0xf
v_add_f32_dpp v112, v111, v112 quad_perm:[3,3,3,3] row_mask:0xf bank_mask:0xf
v_cndmask_b32 v90, v90, v112, s[52:53]
s_mov_b32 s45, 0xf000
buffer_load_dwordx4 a[96:99], v1, s[4:7], s45 offen offset:0 nt
s_waitcnt vmcnt(8)
v_mfma_f32_16x16x32_bf16 v[108:111], a[64:67], v[72:75], 0
buffer_load_dwordx4 a[100:103], v1, s[4:7], s45 offen offset:1024 nt
s_waitcnt vmcnt(8)
v_mfma_f32_16x16x32_bf16 v[108:111], a[68:71], v[76:79], v[108:111]
buffer_load_dwordx4 a[104:107], v1, s[4:7], s45 offen offset:2048 nt
s_waitcnt vmcnt(8)
v_mfma_f32_16x16x32_bf16 v[108:111], a[72:75], v[80:83], v[108:111]
buffer_load_dwordx4 a[108:111], v1, s[4:7], s45 offen offset:3072 nt
s_waitcnt vmcnt(8)
v_mfma_f32_16x16x32_bf16 v[108:111], a[76:79], v[84:87], v[108:111]
s_nop 3
v_mov_b32_dpp v112, v104 quad_perm:[0,0,0,0] row_mask:0xf bank_mask:0xf
v_add_f32_dpp v112, v105, v112 quad_perm:[1,1,1,1] row_mask:0xf bank_mask:0xf
v_add_f32_dpp v112, v106, v112 quad_perm:[2,2,2,2] row_mask:0xf bank_mask:0xf
v_add_f32_dpp v112, v107, v112 quad_perm:[3,3,3,3] row_mask:0xf bank_mask:0xf
v_mov_b32 v91, v112
s_mov_b32 s45, 0x10000
buffer_load_dwordx4 a[112:115], v1, s[4:7], s45 offen offset:0 nt
s_waitcnt vmcnt(8)
v_mfma_f32_16x16x32_bf16 v[104:107], a[80:83], v[72:75], 0
buffer_load_dwordx4 a[116:119], v1, s[4:7], s45 offen offset:1024 nt
s_waitcnt vmcnt(8)
v_mfma_f32_16x16x32_bf16 v[104:107], a[84:87], v[76:79], v[104:107]
buffer_load_dwordx4 a[120:123], v1, s[4:7], s45 offen offset:2048 nt
s_waitcnt vmcnt(8)
v_mfma_f32_16x16x32_bf16 v[104:107], a[88:91], v[80:83], v[104:107]
buffer_load_dwordx4 a[124:127], v1, s[4:7], s45 offen offset:3072 nt
s_waitcnt vmcnt(8)
v_mfma_f32_16x16x32_bf16 v[104:107], a[92:95], v[84:87], v[104:107]
s_nop 3
v_mov_b32_dpp v112, v108 quad_perm:[0,0,0,0] row_mask:0xf bank_mask:0xf
v_add_f32_dpp v112, v109, v112 quad_perm:[1,1,1,1] row_mask:0xf bank_mask:0xf
v_add_f32_dpp v112, v110, v112 quad_perm:[2,2,2,2] row_mask:0xf bank_mask:0xf
v_add_f32_dpp v112, v111, v112 quad_perm:[3,3,3,3] row_mask:0xf bank_mask:0xf
v_cndmask_b32 v91, v91, v112, s[48:49]
s_mov_b32 s45, 0x11000
buffer_load_dwordx4 a[128:131], v1, s[4:7], s45 offen offset:0 nt
s_waitcnt vmcnt(8)
v_mfma_f32_16x16x32_bf16 v[108:111], a[96:99], v[72:75], 0
buffer_load_dwordx4 a[132:135], v1, s[4:7], s45 offen offset:1024 nt
s_waitcnt vmcnt(8)
v_mfma_f32_16x16x32_bf16 v[108:111], a[100:103], v[76:79], v[108:111]
buffer_load_dwordx4 a[136:139], v1, s[4:7], s45 offen offset:2048 nt
s_waitcnt vmcnt(8)
v_mfma_f32_16x16x32_bf16 v[108:111], a[104:107], v[80:83], v[108:111]
buffer_load_dwordx4 a[140:143], v1, s[4:7], s45 offen offset:3072 nt
s_waitcnt vmcnt(8)
v_mfma_f32_16x16x32_bf16 v[108:111], a[108:111], v[84:87], v[108:111]
s_nop 3
v_mov_b32_dpp v112, v104 quad_perm:[0,0,0,0] row_mask:0xf bank_mask:0xf
v_add_f32_dpp v112, v105, v112 quad_perm:[1,1,1,1] row_mask:0xf bank_mask:0xf
v_add_f32_dpp v112, v106, v112 quad_perm:[2,2,2,2] row_mask:0xf bank_mask:0xf
v_add_f32_dpp v112, v107, v112 quad_perm:[3,3,3,3] row_mask:0xf bank_mask:0xf
v_cndmask_b32 v91, v91, v112, s[50:51]
s_mov_b32 s45, 0x12000
buffer_load_dwordx4 a[144:147], v1, s[4:7], s45 offen offset:0 nt
s_waitcnt vmcnt(8)
v_mfma_f32_16x16x32_bf16 v[104:107], a[112:115], v[72:75], 0
buffer_load_dwordx4 a[148:151], v1, s[4:7], s45 offen offset:1024 nt
s_waitcnt vmcnt(8)
v_mfma_f32_16x16x32_bf16 v[104:107], a[116:119], v[76:79], v[104:107]
buffer_load_dwordx4 a[152:155], v1, s[4:7], s45 offen offset:2048 nt
s_waitcnt vmcnt(8)
v_mfma_f32_16x16x32_bf16 v[104:107], a[120:123], v[80:83], v[104:107]
buffer_load_dwordx4 a[156:159], v1, s[4:7], s45 offen offset:3072 nt
s_waitcnt vmcnt(8)
v_mfma_f32_16x16x32_bf16 v[104:107], a[124:127], v[84:87], v[104:107]
s_nop 3
v_mov_b32_dpp v112, v108 quad_perm:[0,0,0,0] row_mask:0xf bank_mask:0xf
v_add_f32_dpp v112, v109, v112 quad_perm:[1,1,1,1] row_mask:0xf bank_mask:0xf
v_add_f32_dpp v112, v110, v112 quad_perm:[2,2,2,2] row_mask:0xf bank_mask:0xf
v_add_f32_dpp v112, v111, v112 quad_perm:[3,3,3,3] row_mask:0xf bank_mask:0xf
v_cndmask_b32 v91, v91, v112, s[52:53]
s_mov_b32 s45, 0x13000
buffer_load_dwordx4 a[160:163], v1, s[4:7], s45 offen offset:0 nt
s_waitcnt vmcnt(8)
v_mfma_f32_16x16x32_bf16 v[108:111], a[128:131], v[72:75], 0
buffer_load_dwordx4 a[164:167], v1, s[4:7], s45 offen offset:1024 nt
s_waitcnt vmcnt(8)
v_mfma_f32_16x16x32_bf16 v[108:111], a[132:135], v[76:79], v[108:111]
buffer_load_dwordx4 a[168:171], v1, s[4:7], s45 offen offset:2048 nt
s_waitcnt vmcnt(8)
v_mfma_f32_16x16x32_bf16 v[108:111], a[136:139], v[80:83], v[108:111]
buffer_load_dwordx4 a[172:175], v1, s[4:7], s45 offen offset:3072 nt
s_waitcnt vmcnt(8)
v_mfma_f32_16x16x32_bf16 v[108:111], a[140:143], v[84:87], v[108:111]
s_nop 3
v_mov_b32_dpp v112, v104 quad_perm:[0,0,0,0] row_mask:0xf bank_mask:0xf
v_add_f32_dpp v112, v105, v112 quad_perm:[1,1,1,1] row_mask:0xf bank_mask:0xf
v_add_f32_dpp v112, v106, v112 quad_perm:[2,2,2,2] row_mask:0xf bank_mask:0xf
v_add_f32_dpp v112, v107, v112 quad_perm:[3,3,3,3] row_mask:0xf bank_mask:0xf
v_mov_b32 v92, v112
s_mov_b32 s45, 0x14000
buffer_load_dwordx4 a[176:179], v1, s[4:7], s45 offen offset:0 nt
s_waitcnt vmcnt(8)
v_mfma_f32_16x16x32_bf16 v[104:107], a[144:147], v[72:75], 0
buffer_load_dwordx4 a[180:183], v1, s[4:7], s45 offen offset:1024 nt
s_waitcnt vmcnt(8)
v_mfma_f32_16x16x32_bf16 v[104:107], a[148:151], v[76:79], v[104:107]
buffer_load_dwordx4 a[184:187], v1, s[4:7], s45 offen offset:2048 nt
s_waitcnt vmcnt(8)
v_mfma_f32_16x16x32_bf16 v[104:107], a[152:155], v[80:83], v[104:107]
buffer_load_dwordx4 a[188:191], v1, s[4:7], s45 offen offset:3072 nt
s_waitcnt vmcnt(8)
v_mfma_f32_16x16x32_bf16 v[104:107], a[156:159], v[84:87], v[104:107]
s_nop 3
v_mov_b32_dpp v112, v108 quad_perm:[0,0,0,0] row_mask:0xf bank_mask:0xf
v_add_f32_dpp v112, v109, v112 quad_perm:[1,1,1,1] row_mask:0xf bank_mask:0xf
v_add_f32_dpp v112, v110, v112 quad_perm:[2,2,2,2] row_mask:0xf bank_mask:0xf
v_add_f32_dpp v112, v111, v112 quad_perm:[3,3,3,3] row_mask:0xf bank_mask:0xf
v_cndmask_b32 v92, v92, v112, s[48:49]
s_mov_b32 s45, 0x15000
buffer_load_dwordx4 a[192:195], v1, s[4:7], s45 offen offset:0 nt
s_waitcnt vmcnt(8)
v_mfma_f32_16x16x32_bf16 v[108:111], a[160:163], v[72:75], 0
buffer_load_dwordx4 a[196:199], v1, s[4:7], s45 offen offset:1024 nt
s_waitcnt vmcnt(8)
v_mfma_f32_16x16x32_bf16 v[108:111], a[164:167], v[76:79], v[108:111]
buffer_load_dwordx4 a[200:203], v1, s[4:7], s45 offen offset:2048 nt
s_waitcnt vmcnt(8)
v_mfma_f32_16x16x32_bf16 v[108:111], a[168:171], v[80:83], v[108:111]
buffer_load_dwordx4 a[204:207], v1, s[4:7], s45 offen offset:3072 nt
s_waitcnt vmcnt(8)
v_mfma_f32_16x16x32_bf16 v[108:111], a[172:175], v[84:87], v[108:111]
s_nop 3
v_mov_b32_dpp v112, v104 quad_perm:[0,0,0,0] row_mask:0xf bank_mask:0xf
v_add_f32_dpp v112, v105, v112 quad_perm:[1,1,1,1] row_mask:0xf bank_mask:0xf
v_add_f32_dpp v112, v106, v112 quad_perm:[2,2,2,2] row_mask:0xf bank_mask:0xf
v_add_f32_dpp v112, v107, v112 quad_perm:[3,3,3,3] row_mask:0xf bank_mask:0xf
v_cndmask_b32 v92, v92, v112, s[50:51]
s_mov_b32 s45, 0x16000
buffer_load_dwordx4 a[208:211], v1, s[4:7], s45 offen offset:0 nt
s_waitcnt vmcnt(8)
v_mfma_f32_16x16x32_bf16 v[104:107], a[176:179], v[72:75], 0
buffer_load_dwordx4 a[212:215], v1, s[4:7], s45 offen offset:1024 nt
s_waitcnt vmcnt(8)
v_mfma_f32_16x16x32_bf16 v[104:107], a[180:183], v[76:79], v[104:107]
buffer_load_dwordx4 a[216:219], v1, s[4:7], s45 offen offset:2048 nt
s_waitcnt vmcnt(8)
v_mfma_f32_16x16x32_bf16 v[104:107], a[184:187], v[80:83], v[104:107]
buffer_load_dwordx4 a[220:223], v1, s[4:7], s45 offen offset:3072 nt
s_waitcnt vmcnt(8)
v_mfma_f32_16x16x32_bf16 v[104:107], a[188:191], v[84:87], v[104:107]
s_nop 3
v_mov_b32_dpp v112, v108 quad_perm:[0,0,0,0] row_mask:0xf bank_mask:0xf
v_add_f32_dpp v112, v109, v112 quad_perm:[1,1,1,1] row_mask:0xf bank_mask:0xf
v_add_f32_dpp v112, v110, v112 quad_perm:[2,2,2,2] row_mask:0xf bank_mask:0xf
v_add_f32_dpp v112, v111, v112 quad_perm:[3,3,3,3] row_mask:0xf bank_mask:0xf
v_cndmask_b32 v92, v92, v112, s[52:53]
s_mov_b32 s45, 0x17000
buffer_load_dwordx4 a[224:227], v1, s[4:7], s45 offen offset:0 nt
s_waitcnt vmcnt(8)
v_mfma_f32_16x16x32_bf16 v[108:111], a[192:195], v[72:75], 0
buffer_load_dwordx4 a[228:231], v1, s[4:7], s45 offen offset:1024 nt
s_waitcnt vmcnt(8)
v_mfma_f32_16x16x32_bf16 v[108:111], a[196:199], v[76:79], v[108:111]
buffer_load_dwordx4 a[232:235], v1, s[4:7], s45 offen offset:2048 nt
s_waitcnt vmcnt(8)
v_mfma_f32_16x16x32_bf16 v[108:111], a[200:203], v[80:83], v[108:111]
buffer_load_dwordx4 a[236:239], v1, s[4:7], s45 offen offset:3072 nt
s_waitcnt vmcnt(8)
v_mfma_f32_16x16x32_bf16 v[108:111], a[204:207], v[84:87], v[108:111]
s_nop 3
v_mov_b32_dpp v112, v104 quad_perm:[0,0,0,0] row_mask:0xf bank_mask:0xf
v_add_f32_dpp v112, v105, v112 quad_perm:[1,1,1,1] row_mask:0xf bank_mask:0xf
v_add_f32_dpp v112, v106, v112 quad_perm:[2,2,2,2] row_mask:0xf bank_mask:0xf
v_add_f32_dpp v112, v107, v112 quad_perm:[3,3,3,3] row_mask:0xf bank_mask:0xf
v_mov_b32 v93, v112
s_mov_b32 s45, 0x18000
buffer_load_dwordx4 a[240:243], v1, s[4:7], s45 offen offset:0 nt
s_waitcnt vmcnt(8)
v_mfma_f32_16x16x32_bf16 v[104:107], a[208:211], v[72:75], 0
buffer_load_dwordx4 a[244:247], v1, s[4:7], s45 offen offset:1024 nt
s_waitcnt vmcnt(8)
v_mfma_f32_16x16x32_bf16 v[104:107], a[212:215], v[76:79], v[104:107]
buffer_load_dwordx4 a[248:251], v1, s[4:7], s45 offen offset:2048 nt
s_waitcnt vmcnt(8)
v_mfma_f32_16x16x32_bf16 v[104:107], a[216:219], v[80:83], v[104:107]
buffer_load_dwordx4 a[252:255], v1, s[4:7], s45 offen offset:3072 nt
s_waitcnt vmcnt(8)
v_mfma_f32_16x16x32_bf16 v[104:107], a[220:223], v[84:87], v[104:107]
s_nop 3
v_mov_b32_dpp v112, v108 quad_perm:[0,0,0,0] row_mask:0xf bank_mask:0xf
v_add_f32_dpp v112, v109, v112 quad_perm:[1,1,1,1] row_mask:0xf bank_mask:0xf
v_add_f32_dpp v112, v110, v112 quad_perm:[2,2,2,2] row_mask:0xf bank_mask:0xf
v_add_f32_dpp v112, v111, v112 quad_perm:[3,3,3,3] row_mask:0xf bank_mask:0xf
v_cndmask_b32 v93, v93, v112, s[48:49]
s_mov_b32 s45, 0x19000
buffer_load_dwordx4 v[136:139], v1, s[4:7], s45 offen offset:0 nt
s_waitcnt vmcnt(8)
v_mfma_f32_16x16x32_bf16 v[108:111], a[224:227], v[72:75], 0
buffer_load_dwordx4 v[140:143], v1, s[4:7], s45 offen offset:1024 nt
s_waitcnt vmcnt(8)
v_mfma_f32_16x16x32_bf16 v[108:111], a[228:231], v[76:79], v[108:111]
buffer_load_dwordx4 v[144:147], v1, s[4:7], s45 offen offset:2048 nt
s_waitcnt vmcnt(8)
v_mfma_f32_16x16x32_bf16 v[108:111], a[232:235], v[80:83], v[108:111]
buffer_load_dwordx4 v[148:151], v1, s[4:7], s45 offen offset:3072 nt
s_waitcnt vmcnt(8)
v_mfma_f32_16x16x32_bf16 v[108:111], a[236:239], v[84:87], v[108:111]
s_nop 3
v_mov_b32_dpp v112, v104 quad_perm:[0,0,0,0] row_mask:0xf bank_mask:0xf
v_add_f32_dpp v112, v105, v112 quad_perm:[1,1,1,1] row_mask:0xf bank_mask:0xf
v_add_f32_dpp v112, v106, v112 quad_perm:[2,2,2,2] row_mask:0xf bank_mask:0xf
v_add_f32_dpp v112, v107, v112 quad_perm:[3,3,3,3] row_mask:0xf bank_mask:0xf
v_cndmask_b32 v93, v93, v112, s[50:51]
s_mov_b32 s45, 0x1a000
buffer_load_dwordx4 v[152:155], v1, s[4:7], s45 offen offset:0 nt
s_waitcnt vmcnt(8)
v_mfma_f32_16x16x32_bf16 v[104:107], a[240:243], v[72:75], 0
buffer_load_dwordx4 v[156:159], v1, s[4:7], s45 offen offset:1024 nt
s_waitcnt vmcnt(8)
v_mfma_f32_16x16x32_bf16 v[104:107], a[244:247], v[76:79], v[104:107]
buffer_load_dwordx4 v[160:163], v1, s[4:7], s45 offen offset:2048 nt
s_waitcnt vmcnt(8)
v_mfma_f32_16x16x32_bf16 v[104:107], a[248:251], v[80:83], v[104:107]
buffer_load_dwordx4 v[164:167], v1, s[4:7], s45 offen offset:3072 nt
s_waitcnt vmcnt(8)
v_mfma_f32_16x16x32_bf16 v[104:107], a[252:255], v[84:87], v[104:107]
s_nop 3
v_mov_b32_dpp v112, v108 quad_perm:[0,0,0,0] row_mask:0xf bank_mask:0xf
v_add_f32_dpp v112, v109, v112 quad_perm:[1,1,1,1] row_mask:0xf bank_mask:0xf
v_add_f32_dpp v112, v110, v112 quad_perm:[2,2,2,2] row_mask:0xf bank_mask:0xf
v_add_f32_dpp v112, v111, v112 quad_perm:[3,3,3,3] row_mask:0xf bank_mask:0xf
v_cndmask_b32 v93, v93, v112, s[52:53]
s_mov_b32 s45, 0x1b000
buffer_load_dwordx4 v[168:171], v1, s[4:7], s45 offen offset:0 nt
s_waitcnt vmcnt(8)
v_mfma_f32_16x16x32_bf16 v[108:111], v[136:139], v[72:75], 0
buffer_load_dwordx4 v[172:175], v1, s[4:7], s45 offen offset:1024 nt
s_waitcnt vmcnt(8)
v_mfma_f32_16x16x32_bf16 v[108:111], v[140:143], v[76:79], v[108:111]
buffer_load_dwordx4 v[176:179], v1, s[4:7], s45 offen offset:2048 nt
s_waitcnt vmcnt(8)
v_mfma_f32_16x16x32_bf16 v[108:111], v[144:147], v[80:83], v[108:111]
buffer_load_dwordx4 v[180:183], v1, s[4:7], s45 offen offset:3072 nt
s_waitcnt vmcnt(8)
v_mfma_f32_16x16x32_bf16 v[108:111], v[148:151], v[84:87], v[108:111]
s_nop 3
v_mov_b32_dpp v112, v104 quad_perm:[0,0,0,0] row_mask:0xf bank_mask:0xf
v_add_f32_dpp v112, v105, v112 quad_perm:[1,1,1,1] row_mask:0xf bank_mask:0xf
v_add_f32_dpp v112, v106, v112 quad_perm:[2,2,2,2] row_mask:0xf bank_mask:0xf
v_add_f32_dpp v112, v107, v112 quad_perm:[3,3,3,3] row_mask:0xf bank_mask:0xf
v_mov_b32 v94, v112
s_mov_b32 s45, 0x1c000
buffer_load_dwordx4 v[184:187], v1, s[4:7], s45 offen offset:0 nt
s_waitcnt vmcnt(8)
v_mfma_f32_16x16x32_bf16 v[104:107], v[152:155], v[72:75], 0
buffer_load_dwordx4 v[188:191], v1, s[4:7], s45 offen offset:1024 nt
s_waitcnt vmcnt(8)
v_mfma_f32_16x16x32_bf16 v[104:107], v[156:159], v[76:79], v[104:107]
buffer_load_dwordx4 v[192:195], v1, s[4:7], s45 offen offset:2048 nt
s_waitcnt vmcnt(8)
v_mfma_f32_16x16x32_bf16 v[104:107], v[160:163], v[80:83], v[104:107]
buffer_load_dwordx4 v[196:199], v1, s[4:7], s45 offen offset:3072 nt
s_waitcnt vmcnt(8)
v_mfma_f32_16x16x32_bf16 v[104:107], v[164:167], v[84:87], v[104:107]
s_nop 3
v_mov_b32_dpp v112, v108 quad_perm:[0,0,0,0] row_mask:0xf bank_mask:0xf
v_add_f32_dpp v112, v109, v112 quad_perm:[1,1,1,1] row_mask:0xf bank_mask:0xf
v_add_f32_dpp v112, v110, v112 quad_perm:[2,2,2,2] row_mask:0xf bank_mask:0xf
v_add_f32_dpp v112, v111, v112 quad_perm:[3,3,3,3] row_mask:0xf bank_mask:0xf
v_cndmask_b32 v94, v94, v112, s[48:49]
s_mov_b32 s45, 0x1d000
buffer_load_dwordx4 v[200:203], v1, s[4:7], s45 offen offset:0 nt
s_waitcnt vmcnt(8)
v_mfma_f32_16x16x32_bf16 v[108:111], v[168:171], v[72:75], 0
buffer_load_dwordx4 v[204:207], v1, s[4:7], s45 offen offset:1024 nt
s_waitcnt vmcnt(8)
v_mfma_f32_16x16x32_bf16 v[108:111], v[172:175], v[76:79], v[108:111]
buffer_load_dwordx4 v[208:211], v1, s[4:7], s45 offen offset:2048 nt
s_waitcnt vmcnt(8)
v_mfma_f32_16x16x32_bf16 v[108:111], v[176:179], v[80:83], v[108:111]
buffer_load_dwordx4 v[212:215], v1, s[4:7], s45 offen offset:3072 nt
s_waitcnt vmcnt(8)
v_mfma_f32_16x16x32_bf16 v[108:111], v[180:183], v[84:87], v[108:111]
s_nop 3
v_mov_b32_dpp v112, v104 quad_perm:[0,0,0,0] row_mask:0xf bank_mask:0xf
v_add_f32_dpp v112, v105, v112 quad_perm:[1,1,1,1] row_mask:0xf bank_mask:0xf
v_add_f32_dpp v112, v106, v112 quad_perm:[2,2,2,2] row_mask:0xf bank_mask:0xf
v_add_f32_dpp v112, v107, v112 quad_perm:[3,3,3,3] row_mask:0xf bank_mask:0xf
v_cndmask_b32 v94, v94, v112, s[50:51]
s_mov_b32 s45, 0x1e000
buffer_load_dwordx4 v[216:219], v1, s[4:7], s45 offen offset:0 nt
s_waitcnt vmcnt(8)
v_mfma_f32_16x16x32_bf16 v[104:107], v[184:187], v[72:75], 0
buffer_load_dwordx4 v[220:223], v1, s[4:7], s45 offen offset:1024 nt
s_waitcnt vmcnt(8)
v_mfma_f32_16x16x32_bf16 v[104:107], v[188:191], v[76:79], v[104:107]
buffer_load_dwordx4 v[224:227], v1, s[4:7], s45 offen offset:2048 nt
s_waitcnt vmcnt(8)
v_mfma_f32_16x16x32_bf16 v[104:107], v[192:195], v[80:83], v[104:107]
buffer_load_dwordx4 v[228:231], v1, s[4:7], s45 offen offset:3072 nt
s_waitcnt vmcnt(8)
v_mfma_f32_16x16x32_bf16 v[104:107], v[196:199], v[84:87], v[104:107]
s_nop 3
v_mov_b32_dpp v112, v108 quad_perm:[0,0,0,0] row_mask:0xf bank_mask:0xf
v_add_f32_dpp v112, v109, v112 quad_perm:[1,1,1,1] row_mask:0xf bank_mask:0xf
v_add_f32_dpp v112, v110, v112 quad_perm:[2,2,2,2] row_mask:0xf bank_mask:0xf
v_add_f32_dpp v112, v111, v112 quad_perm:[3,3,3,3] row_mask:0xf bank_mask:0xf
v_cndmask_b32 v94, v94, v112, s[52:53]
s_mov_b32 s45, 0x1f000
buffer_load_dwordx4 v[232:235], v1, s[4:7], s45 offen offset:0 nt
s_waitcnt vmcnt(8)
v_mfma_f32_16x16x32_bf16 v[108:111], v[200:203], v[72:75], 0
buffer_load_dwordx4 v[236:239], v1, s[4:7], s45 offen offset:1024 nt
s_waitcnt vmcnt(8)
v_mfma_f32_16x16x32_bf16 v[108:111], v[204:207], v[76:79], v[108:111]
buffer_load_dwordx4 v[240:243], v1, s[4:7], s45 offen offset:2048 nt
s_waitcnt vmcnt(8)
v_mfma_f32_16x16x32_bf16 v[108:111], v[208:211], v[80:83], v[108:111]
buffer_load_dwordx4 v[244:247], v1, s[4:7], s45 offen offset:3072 nt
s_waitcnt vmcnt(8)
v_mfma_f32_16x16x32_bf16 v[108:111], v[212:215], v[84:87], v[108:111]
s_nop 3
v_mov_b32_dpp v112, v104 quad_perm:[0,0,0,0] row_mask:0xf bank_mask:0xf
v_add_f32_dpp v112, v105, v112 quad_perm:[1,1,1,1] row_mask:0xf bank_mask:0xf
v_add_f32_dpp v112, v106, v112 quad_perm:[2,2,2,2] row_mask:0xf bank_mask:0xf
v_add_f32_dpp v112, v107, v112 quad_perm:[3,3,3,3] row_mask:0xf bank_mask:0xf
v_mov_b32 v95, v112
s_mov_b32 s45, 0x20000
buffer_load_dwordx4 v[248:251], v1, s[4:7], s45 offen offset:0 nt
s_waitcnt vmcnt(8)
v_mfma_f32_16x16x32_bf16 v[104:107], v[216:219], v[72:75], 0
buffer_load_dwordx4 v[252:255], v1, s[4:7], s45 offen offset:1024 nt
buffer_load_dwordx4 v[56:59], v1, s[4:7], s45 offen offset:2048 nt
buffer_load_dwordx4 v[60:63], v1, s[4:7], s45 offen offset:3072 nt
s_mov_b32 s45, 0x21000
buffer_load_dwordx4 v[64:67], v1, s[4:7], s45 offen offset:0
buffer_load_dwordx4 v[68:71], v1, s[4:7], s45 offen offset:1024 nt
buffer_load_dwordx4 v[24:27], v1, s[4:7], s45 offen offset:2048 nt
buffer_load_dwordx4 v[28:31], v1, s[4:7], s45 offen offset:3072
s_mov_b32 s45, 0x22000
buffer_load_dwordx4 v[32:35], v1, s[4:7], s45 offen offset:0 nt
buffer_load_dwordx4 v[36:39], v1, s[4:7], s45 offen offset:1024 nt
buffer_load_dwordx4 v[40:43], v1, s[4:7], s45 offen offset:2048
buffer_load_dwordx4 v[44:47], v1, s[4:7], s45 offen offset:3072 nt
s_mov_b32 s45, 0x23000
buffer_load_dwordx4 v[48:51], v1, s[4:7], s45 offen offset:0 nt
buffer_load_dwordx4 v[52:55], v1, s[4:7], s45 offen offset:1024
s_waitcnt vmcnt(20)
v_mfma_f32_16x16x32_bf16 v[104:107], v[220:223], v[76:79], v[104:107]
s_waitcnt vmcnt(19)
v_mfma_f32_16x16x32_bf16 v[104:107], v[224:227], v[80:83], v[104:107]
s_waitcnt vmcnt(18)
v_mfma_f32_16x16x32_bf16 v[104:107], v[228:231], v[84:87], v[104:107]
s_nop 3
v_mov_b32_dpp v112, v108 quad_perm:[0,0,0,0] row_mask:0xf bank_mask:0xf
v_add_f32_dpp v112, v109, v112 quad_perm:[1,1,1,1] row_mask:0xf bank_mask:0xf
v_add_f32_dpp v112, v110, v112 quad_perm:[2,2,2,2] row_mask:0xf bank_mask:0xf
v_add_f32_dpp v112, v111, v112 quad_perm:[3,3,3,3] row_mask:0xf bank_mask:0xf
v_cndmask_b32 v95, v95, v112, s[48:49]
s_waitcnt vmcnt(17)
v_mfma_f32_16x16x32_bf16 v[108:111], v[232:235], v[72:75], 0
s_waitcnt vmcnt(16)
v_mfma_f32_16x16x32_bf16 v[108:111], v[236:239], v[76:79], v[108:111]
s_waitcnt vmcnt(15)
v_mfma_f32_16x16x32_bf16 v[108:111], v[240:243], v[80:83], v[108:111]
s_waitcnt vmcnt(14)
v_mfma_f32_16x16x32_bf16 v[108:111], v[244:247], v[84:87], v[108:111]
s_nop 3
v_mov_b32_dpp v112, v104 quad_perm:[0,0,0,0] row_mask:0xf bank_mask:0xf
v_add_f32_dpp v112, v105, v112 quad_perm:[1,1,1,1] row_mask:0xf bank_mask:0xf
v_add_f32_dpp v112, v106, v112 quad_perm:[2,2,2,2] row_mask:0xf bank_mask:0xf
v_add_f32_dpp v112, v107, v112 quad_perm:[3,3,3,3] row_mask:0xf bank_mask:0xf
v_cndmask_b32 v95, v95, v112, s[50:51]
s_waitcnt vmcnt(13)
v_mfma_f32_16x16x32_bf16 v[104:107], v[248:251], v[72:75], 0
s_waitcnt vmcnt(12)
v_mfma_f32_16x16x32_bf16 v[104:107], v[252:255], v[76:79], v[104:107]
s_waitcnt vmcnt(11)
v_mfma_f32_16x16x32_bf16 v[104:107], v[56:59], v[80:83], v[104:107]
s_bitcmp1_b32 s47, 2
s_cbranch_scc0 L_th1
s_waitcnt vmcnt(3)
L_th1:
s_waitcnt vmcnt(8)
buffer_load_dwordx4 v[56:59], v1, s[4:7], s45 offen offset:2048 nt
s_waitcnt vmcnt(11)
v_mfma_f32_16x16x32_bf16 v[104:107], v[60:63], v[84:87], v[104:107]
s_bitcmp1_b32 s47, 2
s_cbranch_scc0 L_th2
s_waitcnt vmcnt(3)
L_th2:
s_waitcnt vmcnt(8)
buffer_load_dwordx4 v[60:63], v1, s[4:7], s45 offen offset:3072 nt
s_nop 3
v_mov_b32_dpp v112, v108 quad_perm:[0,0,0,0] row_mask:0xf bank_mask:0xf
v_add_f32_dpp v112, v109, v112 quad_perm:[1,1,1,1] row_mask:0xf bank_mask:0xf
v_add_f32_dpp v112, v110, v112 quad_perm:[2,2,2,2] row_mask:0xf bank_mask:0xf
v_add_f32_dpp v112, v111, v112 quad_perm:[3,3,3,3] row_mask:0xf bank_mask:0xf
v_cndmask_b32 v95, v95, v112, s[52:53]
s_waitcnt vmcnt(11)
v_mfma_f32_16x16x32_bf16 v[108:111], v[64:67], v[72:75], 0
s_bitcmp1_b32 s47, 2
s_cbranch_scc0 L_th3
s_waitcnt vmcnt(3)
L_th3:
s_waitcnt vmcnt(8)
s_mov_b32 s45, 0x24000
buffer_load_dwordx4 v[64:67], v1, s[4:7], s45 offen offset:0
s_waitcnt vmcnt(11)
v_mfma_f32_16x16x32_bf16 v[108:111], v[68:71], v[76:79], v[108:111]
s_bitcmp1_b32 s47, 2
s_cbranch_scc0 L_th4
s_waitcnt vmcnt(3)
L_th4:
s_waitcnt vmcnt(8)
buffer_load_dwordx4 v[68:71], v1, s[4:7], s45 offen offset:1024 nt
s_waitcnt vmcnt(11)
v_mfma_f32_16x16x32_bf16 v[108:111], v[24:27], v[80:83], v[108:111]
s_bitcmp1_b32 s47, 2
s_cbranch_scc0 L_th5
s_waitcnt vmcnt(3)
L_th5:
s_waitcnt vmcnt(8)
buffer_load_dwordx4 v[24:27], v1, s[4:7], s45 offen offset:2048 nt
s_waitcnt vmcnt(11)
v_mfma_f32_16x16x32_bf16 v[108:111], v[28:31], v[84:87], v[108:111]
s_bitcmp1_b32 s47, 2
s_cbranch_scc0 L_th6
s_waitcnt vmcnt(3)
L_th6:
s_waitcnt vmcnt(8)
buffer_load_dwordx4 v[28:31], v1, s[4:7], s45 offen offset:3072
s_nop 3
v_mov_b32_dpp v112, v104 quad_perm:[0,0,0,0] row_mask:0xf bank_mask:0xf
v_add_f32_dpp v112, v105, v112 quad_perm:[1,1,1,1] row_mask:0xf bank_mask:0xf
v_add_f32_dpp v112, v106, v112 quad_perm:[2,2,2,2] row_mask:0xf bank_mask:0xf
v_add_f32_dpp v112, v107, v112 quad_perm:[3,3,3,3] row_mask:0xf bank_mask:0xf
v_mov_b32 v96, v112
s_waitcnt vmcnt(11)
v_mfma_f32_16x16x32_bf16 v[104:107], v[32:35], v[72:75], 0
s_bitcmp1_b32 s47, 2
s_cbranch_scc0 L_th7
s_waitcnt vmcnt(3)
L_th7:
s_waitcnt vmcnt(8)
s_mov_b32 s45, 0x25000
buffer_load_dwordx4 v[32:35], v1, s[4:7], s45 offen offset:0 nt
s_waitcnt vmcnt(11)
v_mfma_f32_16x16x32_bf16 v[104:107], v[36:39], v[76:79], v[104:107]
s_bitcmp1_b32 s47, 2
s_cbranch_scc0 L_th8
s_waitcnt vmcnt(3)
L_th8:
s_waitcnt vmcnt(8)
buffer_load_dwordx4 v[36:39], v1, s[4:7], s45 offen offset:1024 nt
s_waitcnt vmcnt(11)
v_mfma_f32_16x16x32_bf16 v[104:107], v[40:43], v[80:83], v[104:107]
s_bitcmp1_b32 s47, 2
s_cbranch_scc0 L_th9
s_waitcnt vmcnt(3)
L_th9:
s_waitcnt vmcnt(8)
buffer_load_dwordx4 v[40:43], v1, s[4:7], s45 offen offset:2048
s_waitcnt vmcnt(11)
v_mfma_f32_16x16x32_bf16 v[104:107], v[44:47], v[84:87], v[104:107]
s_bitcmp1_b32 s47, 2
s_cbranch_scc0 L_th10
s_waitcnt vmcnt(3)
L_th10:
s_waitcnt vmcnt(8)
buffer_load_dwordx4 v[44:47], v1, s[4:7], s45 offen offset:3072 nt
s_nop 3
v_mov_b32_dpp v112, v108 quad_perm:[0,0,0,0] row_mask:0xf bank_mask:0xf
v_add_f32_dpp v112, v109, v112 quad_perm:[1,1,1,1] row_mask:0xf bank_mask:0xf
v_add_f32_dpp v112, v110, v112 quad_perm:[2,2,2,2] row_mask:0xf bank_mask:0xf
v_add_f32_dpp v112, v111, v112 quad_perm:[3,3,3,3] row_mask:0xf bank_mask:0xf
v_cndmask_b32 v96, v96, v112, s[48:49]
s_waitcnt vmcnt(11)
v_mfma_f32_16x16x32_bf16 v[108:111], v[48:51], v[72:75], 0
s_bitcmp1_b32 s47, 2
s_cbranch_scc0 L_th11
s_waitcnt vmcnt(3)
L_th11:
s_waitcnt vmcnt(8)
s_mov_b32 s45, 0x26000
buffer_load_dwordx4 v[48:51], v1, s[4:7], s45 offen offset:0 nt
s_waitcnt vmcnt(11)
v_mfma_f32_16x16x32_bf16 v[108:111], v[52:55], v[76:79], v[108:111]
s_bitcmp1_b32 s47, 2
s_cbranch_scc0 L_th12
s_waitcnt vmcnt(3)
L_th12:
s_waitcnt vmcnt(8)
buffer_load_dwordx4 v[52:55], v1, s[4:7], s45 offen offset:1024
s_waitcnt vmcnt(11)
v_mfma_f32_16x16x32_bf16 v[108:111], v[56:59], v[80:83], v[108:111]
s_bitcmp1_b32 s47, 2
s_cbranch_scc0 L_th13
s_waitcnt vmcnt(3)
L_th13:
s_waitcnt vmcnt(8)
buffer_load_dwordx4 v[56:59], v1, s[4:7], s45 offen offset:2048 nt
s_waitcnt vmcnt(11)
v_mfma_f32_16x16x32_bf16 v[108:111], v[60:63], v[84:87], v[108:111]
s_bitcmp1_b32 s47, 2
s_cbranch_scc0 L_th14
s_waitcnt vmcnt(3)
L_th14:
s_waitcnt vmcnt(8)
buffer_load_dwordx4 v[60:63], v1, s[4:7], s45 offen offset:3072 nt
s_nop 3
v_mov_b32_dpp v112, v104 quad_perm:[0,0,0,0] row_mask:0xf bank_mask:0xf
v_add_f32_dpp v112, v105, v112 quad_perm:[1,1,1,1] row_mask:0xf bank_mask:0xf
v_add_f32_dpp v112, v106, v112 quad_perm:[2,2,2,2] row_mask:0xf bank_mask:0xf
v_add_f32_dpp v112, v107, v112 quad_perm:[3,3,3,3] row_mask:0xf bank_mask:0xf
v_cndmask_b32 v96, v96, v112, s[50:51]
s_waitcnt vmcnt(11)
v_mfma_f32_16x16x32_bf16 v[104:107], v[64:67], v[72:75], 0
s_bitcmp1_b32 s47, 2
s_cbranch_scc0 L_th15
s_waitcnt vmcnt(3)
L_th15:
s_waitcnt vmcnt(8)
s_mov_b32 s45, 0x27000
buffer_load_dwordx4 v[64:67], v1, s[4:7], s45 offen offset:0
s_waitcnt vmcnt(11)
v_mfma_f32_16x16x32_bf16 v[104:107], v[68:71], v[76:79], v[104:107]
s_bitcmp1_b32 s47, 2
s_cbranch_scc0 L_th16
s_waitcnt vmcnt(3)
L_th16:
s_waitcnt vmcnt(8)
buffer_load_dwordx4 v[68:71], v1, s[4:7], s45 offen offset:1024 nt
s_waitcnt vmcnt(11)
v_mfma_f32_16x16x32_bf16 v[104:107], v[24:27], v[80:83], v[104:107]
s_bitcmp1_b32 s47, 2
s_cbranch_scc0 L_th17
s_waitcnt vmcnt(3)
L_th17:
s_waitcnt vmcnt(8)
buffer_load_dwordx4 v[24:27], v1, s[4:7], s45 offen offset:2048 nt
s_waitcnt vmcnt(11)
v_mfma_f32_16x16x32_bf16 v[104:107], v[28:31], v[84:87], v[104:107]
s_bitcmp1_b32 s47, 2
s_cbranch_scc0 L_th18
s_waitcnt vmcnt(3)
L_th18:
s_waitcnt vmcnt(8)
buffer_load_dwordx4 v[28:31], v1, s[4:7], s45 offen offset:3072
s_nop 3
v_mov_b32_dpp v112, v108 quad_perm:[0,0,0,0] row_mask:0xf bank_mask:0xf
v_add_f32_dpp v112, v109, v112 quad_perm:[1,1,1,1] row_mask:0xf bank_mask:0xf
v_add_f32_dpp v112, v110, v112 quad_perm:[2,2,2,2] row_mask:0xf bank_mask:0xf
v_add_f32_dpp v112, v111, v112 quad_perm:[3,3,3,3] row_mask:0xf bank_mask:0xf
v_cndmask_b32 v96, v96, v112, s[52:53]
s_waitcnt vmcnt(11)
v_mfma_f32_16x16x32_bf16 v[108:111], v[32:35], v[72:75], 0
s_bitcmp1_b32 s47, 2
s_cbranch_scc0 L_th19
s_waitcnt vmcnt(3)
L_th19:
s_waitcnt vmcnt(8)
s_mov_b32 s45, 0x28000
buffer_load_dwordx4 v[32:35], v1, s[4:7], s45 offen offset:0 nt
s_waitcnt vmcnt(11)
v_mfma_f32_16x16x32_bf16 v[108:111], v[36:39], v[76:79], v[108:111]
s_bitcmp1_b32 s47, 2
s_cbranch_scc0 L_th20
s_waitcnt vmcnt(3)
L_th20:
s_waitcnt vmcnt(8)
buffer_load_dwordx4 v[36:39], v1, s[4:7], s45 offen offset:1024 nt
s_waitcnt vmcnt(11)
v_mfma_f32_16x16x32_bf16 v[108:111], v[40:43], v[80:83], v[108:111]
s_bitcmp1_b32 s47, 2
s_cbranch_scc0 L_th21
s_waitcnt vmcnt(3)
L_th21:
s_waitcnt vmcnt(8)
buffer_load_dwordx4 v[40:43], v1, s[4:7], s45 offen offset:2048
s_waitcnt vmcnt(11)
v_mfma_f32_16x16x32_bf16 v[108:111], v[44:47], v[84:87], v[108:111]
s_bitcmp1_b32 s47, 2
s_cbranch_scc0 L_th22
s_waitcnt vmcnt(3)
L_th22:
s_waitcnt vmcnt(8)
buffer_load_dwordx4 v[44:47], v1, s[4:7], s45 offen offset:3072 nt
s_nop 3
v_mov_b32_dpp v112, v104 quad_perm:[0,0,0,0] row_mask:0xf bank_mask:0xf
v_add_f32_dpp v112, v105, v112 quad_perm:[1,1,1,1] row_mask:0xf bank_mask:0xf
v_add_f32_dpp v112, v106, v112 quad_perm:[2,2,2,2] row_mask:0xf bank_mask:0xf
v_add_f32_dpp v112, v107, v112 quad_perm:[3,3,3,3] row_mask:0xf bank_mask:0xf
v_mov_b32 v97, v112
s_waitcnt vmcnt(11)
v_mfma_f32_16x16x32_bf16 v[104:107], v[48:51], v[72:75], 0
s_bitcmp1_b32 s47, 2
s_cbranch_scc0 L_th23
s_waitcnt vmcnt(3)
L_th23:
s_waitcnt vmcnt(8)
s_mov_b32 s45, 0x29000
buffer_load_dwordx4 v[48:51], v1, s[4:7], s45 offen offset:0 nt
s_waitcnt vmcnt(11)
v_mfma_f32_16x16x32_bf16 v[104:107], v[52:55], v[76:79], v[104:107]
s_bitcmp1_b32 s47, 2
s_cbranch_scc0 L_th24
s_waitcnt vmcnt(3)
L_th24:
s_waitcnt vmcnt(8)
buffer_load_dwordx4 v[52:55], v1, s[4:7], s45 offen offset:1024
s_waitcnt vmcnt(11)
v_mfma_f32_16x16x32_bf16 v[104:107], v[56:59], v[80:83], v[104:107]
s_bitcmp1_b32 s47, 2
s_cbranch_scc0 L_th25
s_waitcnt vmcnt(3)
L_th25:
s_waitcnt vmcnt(8)
buffer_load_dwordx4 v[56:59], v1, s[4:7], s45 offen offset:2048 nt
s_waitcnt vmcnt(11)
v_mfma_f32_16x16x32_bf16 v[104:107], v[60:63], v[84:87], v[104:107]
s_bitcmp1_b32 s47, 2
s_cbranch_scc0 L_th26
s_waitcnt vmcnt(3)
L_th26:
s_waitcnt vmcnt(8)
buffer_load_dwordx4 v[60:63], v1, s[4:7], s45 offen offset:3072 nt
s_nop 3
v_mov_b32_dpp v112, v108 quad_perm:[0,0,0,0] row_mask:0xf bank_mask:0xf
v_add_f32_dpp v112, v109, v112 quad_perm:[1,1,1,1] row_mask:0xf bank_mask:0xf
v_add_f32_dpp v112, v110, v112 quad_perm:[2,2,2,2] row_mask:0xf bank_mask:0xf
v_add_f32_dpp v112, v111, v112 quad_perm:[3,3,3,3] row_mask:0xf bank_mask:0xf
v_cndmask_b32 v97, v97, v112, s[48:49]
s_waitcnt vmcnt(11)
v_mfma_f32_16x16x32_bf16 v[108:111], v[64:67], v[72:75], 0
s_bitcmp1_b32 s47, 2
s_cbranch_scc0 L_th27
s_waitcnt vmcnt(3)
L_th27:
s_waitcnt vmcnt(8)
s_mov_b32 s45, 0x2a000
buffer_load_dwordx4 v[64:67], v1, s[4:7], s45 offen offset:0
s_waitcnt vmcnt(11)
v_mfma_f32_16x16x32_bf16 v[108:111], v[68:71], v[76:79], v[108:111]
s_bitcmp1_b32 s47, 2
s_cbranch_scc0 L_th28
s_waitcnt vmcnt(3)
L_th28:
s_waitcnt vmcnt(8)
buffer_load_dwordx4 v[68:71], v1, s[4:7], s45 offen offset:1024 nt
s_waitcnt vmcnt(11)
v_mfma_f32_16x16x32_bf16 v[108:111], v[24:27], v[80:83], v[108:111]
s_bitcmp1_b32 s47, 2
s_cbranch_scc0 L_th29
s_waitcnt vmcnt(3)
L_th29:
s_waitcnt vmcnt(8)
buffer_load_dwordx4 v[24:27], v1, s[4:7], s45 offen offset:2048 nt
s_waitcnt vmcnt(11)
v_mfma_f32_16x16x32_bf16 v[108:111], v[28:31], v[84:87], v[108:111]
s_bitcmp1_b32 s47, 2
s_cbranch_scc0 L_th30
s_waitcnt vmcnt(3)
L_th30:
s_waitcnt vmcnt(8)
buffer_load_dwordx4 v[28:31], v1, s[4:7], s45 offen offset:3072
s_nop 3
v_mov_b32_dpp v112, v104 quad_perm:[0,0,0,0] row_mask:0xf bank_mask:0xf
v_add_f32_dpp v112, v105, v112 quad_perm:[1,1,1,1] row_mask:0xf bank_mask:0xf
v_add_f32_dpp v112, v106, v112 quad_perm:[2,2,2,2] row_mask:0xf bank_mask:0xf
v_add_f32_dpp v112, v107, v112 quad_perm:[3,3,3,3] row_mask:0xf bank_mask:0xf
v_cndmask_b32 v97, v97, v112, s[50:51]
s_waitcnt vmcnt(11)
v_mfma_f32_16x16x32_bf16 v[104:107], v[32:35], v[72:75], 0
s_bitcmp1_b32 s47, 2
s_cbranch_scc0 L_th31
s_waitcnt vmcnt(3)
L_th31:
s_waitcnt vmcnt(8)
s_mov_b32 s45, 0x2b000
buffer_load_dwordx4 v[32:35], v1, s[4:7], s45 offen offset:0 nt
s_waitcnt vmcnt(11)
v_mfma_f32_16x16x32_bf16 v[104:107], v[36:39], v[76:79], v[104:107]
s_bitcmp1_b32 s47, 2
s_cbranch_scc0 L_th32
s_waitcnt vmcnt(3)
L_th32:
s_waitcnt vmcnt(8)
buffer_load_dwordx4 v[36:39], v1, s[4:7], s45 offen offset:1024 nt
s_waitcnt vmcnt(11)
v_mfma_f32_16x16x32_bf16 v[104:107], v[40:43], v[80:83], v[104:107]
s_bitcmp1_b32 s47, 2
s_cbranch_scc0 L_th33
s_waitcnt vmcnt(3)
L_th33:
s_waitcnt vmcnt(8)
buffer_load_dwordx4 v[40:43], v1, s[4:7], s45 offen offset:2048
s_waitcnt vmcnt(11)
v_mfma_f32_16x16x32_bf16 v[104:107], v[44:47], v[84:87], v[104:107]
s_bitcmp1_b32 s47, 2
s_cbranch_scc0 L_th34
s_waitcnt vmcnt(3)
L_th34:
s_waitcnt vmcnt(8)
buffer_load_dwordx4 v[44:47], v1, s[4:7], s45 offen offset:3072 nt
s_nop 3
v_mov_b32_dpp v112, v108 quad_perm:[0,0,0,0] row_mask:0xf bank_mask:0xf
v_add_f32_dpp v112, v109, v112 quad_perm:[1,1,1,1] row_mask:0xf bank_mask:0xf
v_add_f32_dpp v112, v110, v112 quad_perm:[2,2,2,2] row_mask:0xf bank_mask:0xf
v_add_f32_dpp v112, v111, v112 quad_perm:[3,3,3,3] row_mask:0xf bank_mask:0xf
v_cndmask_b32 v97, v97, v112, s[52:53]
s_waitcnt vmcnt(11)
v_mfma_f32_16x16x32_bf16 v[108:111], v[48:51], v[72:75], 0
s_bitcmp1_b32 s47, 2
s_cbranch_scc0 L_th35
s_waitcnt vmcnt(3)
L_th35:
s_waitcnt vmcnt(8)
s_mov_b32 s45, 0x2c000
buffer_load_dwordx4 v[48:51], v1, s[4:7], s45 offen offset:0 nt
s_waitcnt vmcnt(11)
v_mfma_f32_16x16x32_bf16 v[108:111], v[52:55], v[76:79], v[108:111]
s_bitcmp1_b32 s47, 2
s_cbranch_scc0 L_th36
s_waitcnt vmcnt(3)
L_th36:
s_waitcnt vmcnt(8)
buffer_load_dwordx4 v[52:55], v1, s[4:7], s45 offen offset:1024
s_waitcnt vmcnt(11)
v_mfma_f32_16x16x32_bf16 v[108:111], v[56:59], v[80:83], v[108:111]
s_bitcmp1_b32 s47, 2
s_cbranch_scc0 L_th37
s_waitcnt vmcnt(3)
L_th37:
s_waitcnt vmcnt(8)
buffer_load_dwordx4 v[56:59], v1, s[4:7], s45 offen offset:2048 nt
s_waitcnt vmcnt(11)
v_mfma_f32_16x16x32_bf16 v[108:111], v[60:63], v[84:87], v[108:111]
s_bitcmp1_b32 s47, 2
s_cbranch_scc0 L_th38
s_waitcnt vmcnt(3)
L_th38:
s_waitcnt vmcnt(8)
buffer_load_dwordx4 v[60:63], v1, s[4:7], s45 offen offset:3072 nt
s_nop 3
v_mov_b32_dpp v112, v104 quad_perm:[0,0,0,0] row_mask:0xf bank_mask:0xf
v_add_f32_dpp v112, v105, v112 quad_perm:[1,1,1,1] row_mask:0xf bank_mask:0xf
v_add_f32_dpp v112, v106, v112 quad_perm:[2,2,2,2] row_mask:0xf bank_mask:0xf
v_add_f32_dpp v112, v107, v112 quad_perm:[3,3,3,3] row_mask:0xf bank_mask:0xf
v_mov_b32 v98, v112
s_waitcnt vmcnt(11)
v_mfma_f32_16x16x32_bf16 v[104:107], v[64:67], v[72:75], 0
s_bitcmp1_b32 s47, 2
s_cbranch_scc0 L_th39
s_waitcnt vmcnt(3)
L_th39:
s_waitcnt vmcnt(8)
s_mov_b32 s45, 0x2d000
buffer_load_dwordx4 v[64:67], v1, s[4:7], s45 offen offset:0
s_waitcnt vmcnt(11)
v_mfma_f32_16x16x32_bf16 v[104:107], v[68:71], v[76:79], v[104:107]
s_bitcmp1_b32 s47, 2
s_cbranch_scc0 L_th40
s_waitcnt vmcnt(3)
L_th40:
s_waitcnt vmcnt(8)
buffer_load_dwordx4 v[68:71], v1, s[4:7], s45 offen offset:1024 nt
s_waitcnt vmcnt(11)
v_mfma_f32_16x16x32_bf16 v[104:107], v[24:27], v[80:83], v[104:107]
s_bitcmp1_b32 s47, 2
s_cbranch_scc0 L_th41
s_waitcnt vmcnt(3)
L_th41:
s_waitcnt vmcnt(8)
buffer_load_dwordx4 v[24:27], v1, s[4:7], s45 offen offset:2048 nt
s_waitcnt vmcnt(11)
v_mfma_f32_16x16x32_bf16 v[104:107], v[28:31], v[84:87], v[104:107]
s_bitcmp1_b32 s47, 2
s_cbranch_scc0 L_th42
s_waitcnt vmcnt(3)
L_th42:
s_waitcnt vmcnt(8)
buffer_load_dwordx4 v[28:31], v1, s[4:7], s45 offen offset:3072
s_nop 3
v_mov_b32_dpp v112, v108 quad_perm:[0,0,0,0] row_mask:0xf bank_mask:0xf
v_add_f32_dpp v112, v109, v112 quad_perm:[1,1,1,1] row_mask:0xf bank_mask:0xf
v_add_f32_dpp v112, v110, v112 quad_perm:[2,2,2,2] row_mask:0xf bank_mask:0xf
v_add_f32_dpp v112, v111, v112 quad_perm:[3,3,3,3] row_mask:0xf bank_mask:0xf
v_cndmask_b32 v98, v98, v112, s[48:49]
s_waitcnt vmcnt(11)
v_mfma_f32_16x16x32_bf16 v[108:111], v[32:35], v[72:75], 0
s_bitcmp1_b32 s47, 2
s_cbranch_scc0 L_th43
s_waitcnt vmcnt(3)
L_th43:
s_waitcnt vmcnt(8)
s_mov_b32 s45, 0x2e000
buffer_load_dwordx4 v[32:35], v1, s[4:7], s45 offen offset:0 nt
s_waitcnt vmcnt(11)
v_mfma_f32_16x16x32_bf16 v[108:111], v[36:39], v[76:79], v[108:111]
s_bitcmp1_b32 s47, 2
s_cbranch_scc0 L_th44
s_waitcnt vmcnt(3)
L_th44:
s_waitcnt vmcnt(8)
buffer_load_dwordx4 v[36:39], v1, s[4:7], s45 offen offset:1024 nt
s_waitcnt vmcnt(11)
v_mfma_f32_16x16x32_bf16 v[108:111], v[40:43], v[80:83], v[108:111]
s_bitcmp1_b32 s47, 2
s_cbranch_scc0 L_th45
s_waitcnt vmcnt(3)
L_th45:
s_waitcnt vmcnt(8)
buffer_load_dwordx4 v[40:43], v1, s[4:7], s45 offen offset:2048
s_waitcnt vmcnt(11)
v_mfma_f32_16x16x32_bf16 v[108:111], v[44:47], v[84:87], v[108:111]
s_bitcmp1_b32 s47, 2
s_cbranch_scc0 L_th46
s_waitcnt vmcnt(3)
L_th46:
s_waitcnt vmcnt(8)
buffer_load_dwordx4 v[44:47], v1, s[4:7], s45 offen offset:3072 nt
s_nop 3
v_mov_b32_dpp v112, v104 quad_perm:[0,0,0,0] row_mask:0xf bank_mask:0xf
v_add_f32_dpp v112, v105, v112 quad_perm:[1,1,1,1] row_mask:0xf bank_mask:0xf
v_add_f32_dpp v112, v106, v112 quad_perm:[2,2,2,2] row_mask:0xf bank_mask:0xf
v_add_f32_dpp v112, v107, v112 quad_perm:[3,3,3,3] row_mask:0xf bank_mask:0xf
v_cndmask_b32 v98, v98, v112, s[50:51]
s_waitcnt vmcnt(11)
v_mfma_f32_16x16x32_bf16 v[104:107], v[48:51], v[72:75], 0
s_bitcmp1_b32 s47, 2
s_cbranch_scc0 L_th47
s_waitcnt vmcnt(3)
L_th47:
s_waitcnt vmcnt(8)
s_mov_b32 s45, 0x2f000
buffer_load_dwordx4 v[48:51], v1, s[4:7], s45 offen offset:0 nt
s_waitcnt vmcnt(11)
v_mfma_f32_16x16x32_bf16 v[104:107], v[52:55], v[76:79], v[104:107]
s_bitcmp1_b32 s47, 2
s_cbranch_scc0 L_th48
s_waitcnt vmcnt(3)
L_th48:
s_waitcnt vmcnt(8)
buffer_load_dwordx4 v[52:55], v1, s[4:7], s45 offen offset:1024
s_waitcnt vmcnt(11)
v_mfma_f32_16x16x32_bf16 v[104:107], v[56:59], v[80:83], v[104:107]
s_bitcmp1_b32 s47, 2
s_cbranch_scc0 L_th49
s_waitcnt vmcnt(3)
L_th49:
s_waitcnt vmcnt(8)
buffer_load_dwordx4 v[56:59], v1, s[4:7], s45 offen offset:2048 nt
s_waitcnt vmcnt(11)
v_mfma_f32_16x16x32_bf16 v[104:107], v[60:63], v[84:87], v[104:107]
s_bitcmp1_b32 s47, 2
s_cbranch_scc0 L_th50
s_waitcnt vmcnt(3)
L_th50:
s_waitcnt vmcnt(8)
buffer_load_dwordx4 v[60:63], v1, s[4:7], s45 offen offset:3072 nt
s_nop 3
v_mov_b32_dpp v112, v108 quad_perm:[0,0,0,0] row_mask:0xf bank_mask:0xf
v_add_f32_dpp v112, v109, v112 quad_perm:[1,1,1,1] row_mask:0xf bank_mask:0xf
v_add_f32_dpp v112, v110, v112 quad_perm:[2,2,2,2] row_mask:0xf bank_mask:0xf
v_add_f32_dpp v112, v111, v112 quad_perm:[3,3,3,3] row_mask:0xf bank_mask:0xf
v_cndmask_b32 v98, v98, v112, s[52:53]
s_waitcnt vmcnt(11)
v_mfma_f32_16x16x32_bf16 v[108:111], v[64:67], v[72:75], 0
s_bitcmp1_b32 s47, 2
s_cbranch_scc0 L_th51
s_waitcnt vmcnt(3)
L_th51:
s_waitcnt vmcnt(8)
s_mov_b32 s45, 0x30000
buffer_load_dwordx4 v[64:67], v1, s[4:7], s45 offen offset:0
s_waitcnt vmcnt(11)
v_mfma_f32_16x16x32_bf16 v[108:111], v[68:71], v[76:79], v[108:111]
s_bitcmp1_b32 s47, 2
s_cbranch_scc0 L_th52
s_waitcnt vmcnt(3)
L_th52:
s_waitcnt vmcnt(8)
buffer_load_dwordx4 v[68:71], v1, s[4:7], s45 offen offset:1024 nt
s_waitcnt vmcnt(11)
v_mfma_f32_16x16x32_bf16 v[108:111], v[24:27], v[80:83], v[108:111]
s_bitcmp1_b32 s47, 2
s_cbranch_scc0 L_th53
s_waitcnt vmcnt(3)
L_th53:
s_waitcnt vmcnt(8)
buffer_load_dwordx4 v[24:27], v1, s[4:7], s45 offen offset:2048 nt
s_waitcnt vmcnt(11)
v_mfma_f32_16x16x32_bf16 v[108:111], v[28:31], v[84:87], v[108:111]
s_bitcmp1_b32 s47, 2
s_cbranch_scc0 L_th54
s_waitcnt vmcnt(3)
L_th54:
s_waitcnt vmcnt(8)
buffer_load_dwordx4 v[28:31], v1, s[4:7], s45 offen offset:3072
s_nop 3
v_mov_b32_dpp v112, v104 quad_perm:[0,0,0,0] row_mask:0xf bank_mask:0xf
v_add_f32_dpp v112, v105, v112 quad_perm:[1,1,1,1] row_mask:0xf bank_mask:0xf
v_add_f32_dpp v112, v106, v112 quad_perm:[2,2,2,2] row_mask:0xf bank_mask:0xf
v_add_f32_dpp v112, v107, v112 quad_perm:[3,3,3,3] row_mask:0xf bank_mask:0xf
v_mov_b32 v99, v112
s_waitcnt vmcnt(11)
v_mfma_f32_16x16x32_bf16 v[104:107], v[32:35], v[72:75], 0
s_bitcmp1_b32 s47, 2
s_cbranch_scc0 L_th55
s_waitcnt vmcnt(3)
L_th55:
s_waitcnt vmcnt(8)
s_mov_b32 s45, 0x31000
buffer_load_dwordx4 v[32:35], v1, s[4:7], s45 offen offset:0 nt
s_waitcnt vmcnt(11)
v_mfma_f32_16x16x32_bf16 v[104:107], v[36:39], v[76:79], v[104:107]
s_bitcmp1_b32 s47, 2
s_cbranch_scc0 L_th56
s_waitcnt vmcnt(3)
L_th56:
s_waitcnt vmcnt(8)
buffer_load_dwordx4 v[36:39], v1, s[4:7], s45 offen offset:1024 nt
s_waitcnt vmcnt(11)
v_mfma_f32_16x16x32_bf16 v[104:107], v[40:43], v[80:83], v[104:107]
s_bitcmp1_b32 s47, 2
s_cbranch_scc0 L_th57
s_waitcnt vmcnt(3)
L_th57:
s_waitcnt vmcnt(8)
buffer_load_dwordx4 v[40:43], v1, s[4:7], s45 offen offset:2048
s_waitcnt vmcnt(11)
v_mfma_f32_16x16x32_bf16 v[104:107], v[44:47], v[84:87], v[104:107]
s_bitcmp1_b32 s47, 2
s_cbranch_scc0 L_th58
s_waitcnt vmcnt(3)
L_th58:
s_waitcnt vmcnt(8)
buffer_load_dwordx4 v[44:47], v1, s[4:7], s45 offen offset:3072 nt
s_nop 3
v_mov_b32_dpp v112, v108 quad_perm:[0,0,0,0] row_mask:0xf bank_mask:0xf
v_add_f32_dpp v112, v109, v112 quad_perm:[1,1,1,1] row_mask:0xf bank_mask:0xf
v_add_f32_dpp v112, v110, v112 quad_perm:[2,2,2,2] row_mask:0xf bank_mask:0xf
v_add_f32_dpp v112, v111, v112 quad_perm:[3,3,3,3] row_mask:0xf bank_mask:0xf
v_cndmask_b32 v99, v99, v112, s[48:49]
s_waitcnt vmcnt(11)
v_mfma_f32_16x16x32_bf16 v[108:111], v[48:51], v[72:75], 0
s_bitcmp1_b32 s47, 2
s_cbranch_scc0 L_th59
s_waitcnt vmcnt(3)
L_th59:
s_waitcnt vmcnt(8)
s_mov_b32 s45, 0x32000
buffer_load_dwordx4 v[48:51], v1, s[4:7], s45 offen offset:0 nt
s_waitcnt vmcnt(11)
v_mfma_f32_16x16x32_bf16 v[108:111], v[52:55], v[76:79], v[108:111]
s_bitcmp1_b32 s47, 2
s_cbranch_scc0 L_th60
s_waitcnt vmcnt(3)
L_th60:
s_waitcnt vmcnt(8)
buffer_load_dwordx4 v[52:55], v1, s[4:7], s45 offen offset:1024
s_waitcnt vmcnt(11)
v_mfma_f32_16x16x32_bf16 v[108:111], v[56:59], v[80:83], v[108:111]
s_bitcmp1_b32 s47, 2
s_cbranch_scc0 L_th61
s_waitcnt vmcnt(3)
L_th61:
s_waitcnt vmcnt(8)
buffer_load_dwordx4 v[56:59], v1, s[4:7], s45 offen offset:2048 nt
s_waitcnt vmcnt(11)
v_mfma_f32_16x16x32_bf16 v[108:111], v[60:63], v[84:87], v[108:111]
s_bitcmp1_b32 s47, 2
s_cbranch_scc0 L_th62
s_waitcnt vmcnt(3)
L_th62:
s_waitcnt vmcnt(8)
buffer_load_dwordx4 v[60:63], v1, s[4:7], s45 offen offset:3072 nt
s_nop 3
v_mov_b32_dpp v112, v104 quad_perm:[0,0,0,0] row_mask:0xf bank_mask:0xf
v_add_f32_dpp v112, v105, v112 quad_perm:[1,1,1,1] row_mask:0xf bank_mask:0xf
v_add_f32_dpp v112, v106, v112 quad_perm:[2,2,2,2] row_mask:0xf bank_mask:0xf
v_add_f32_dpp v112, v107, v112 quad_perm:[3,3,3,3] row_mask:0xf bank_mask:0xf
v_cndmask_b32 v99, v99, v112, s[50:51]
s_waitcnt vmcnt(11)
v_mfma_f32_16x16x32_bf16 v[104:107], v[64:67], v[72:75], 0
s_bitcmp1_b32 s47, 2
s_cbranch_scc0 L_th63
s_waitcnt vmcnt(3)
L_th63:
s_waitcnt vmcnt(8)
s_mov_b32 s45, 0x33000
buffer_load_dwordx4 v[64:67], v1, s[4:7], s45 offen offset:0
s_waitcnt vmcnt(11)
v_mfma_f32_16x16x32_bf16 v[104:107], v[68:71], v[76:79], v[104:107]
s_bitcmp1_b32 s47, 2
s_cbranch_scc0 L_th64
s_waitcnt vmcnt(3)
L_th64:
s_waitcnt vmcnt(8)
buffer_load_dwordx4 v[68:71], v1, s[4:7], s45 offen offset:1024 nt
s_waitcnt vmcnt(11)
v_mfma_f32_16x16x32_bf16 v[104:107], v[24:27], v[80:83], v[104:107]
s_bitcmp1_b32 s47, 2
s_cbranch_scc0 L_th65
s_waitcnt vmcnt(3)
L_th65:
s_waitcnt vmcnt(8)
buffer_load_dwordx4 v[24:27], v1, s[4:7], s45 offen offset:2048 nt
s_waitcnt vmcnt(11)
v_mfma_f32_16x16x32_bf16 v[104:107], v[28:31], v[84:87], v[104:107]
s_bitcmp1_b32 s47, 2
s_cbranch_scc0 L_th66
s_waitcnt vmcnt(3)
L_th66:
s_waitcnt vmcnt(8)
buffer_load_dwordx4 v[28:31], v1, s[4:7], s45 offen offset:3072
s_nop 3
v_mov_b32_dpp v112, v108 quad_perm:[0,0,0,0] row_mask:0xf bank_mask:0xf
v_add_f32_dpp v112, v109, v112 quad_perm:[1,1,1,1] row_mask:0xf bank_mask:0xf
v_add_f32_dpp v112, v110, v112 quad_perm:[2,2,2,2] row_mask:0xf bank_mask:0xf
v_add_f32_dpp v112, v111, v112 quad_perm:[3,3,3,3] row_mask:0xf bank_mask:0xf
v_cndmask_b32 v99, v99, v112, s[52:53]
s_waitcnt vmcnt(11)
v_mfma_f32_16x16x32_bf16 v[108:111], v[32:35], v[72:75], 0
s_bitcmp1_b32 s47, 2
s_cbranch_scc0 L_th67
s_waitcnt vmcnt(3)
L_th67:
s_waitcnt vmcnt(8)
s_mov_b32 s45, 0x34000
buffer_load_dwordx4 v[32:35], v1, s[4:7], s45 offen offset:0 nt
s_waitcnt vmcnt(11)
v_mfma_f32_16x16x32_bf16 v[108:111], v[36:39], v[76:79], v[108:111]
s_bitcmp1_b32 s47, 2
s_cbranch_scc0 L_th68
s_waitcnt vmcnt(3)
L_th68:
s_waitcnt vmcnt(8)
buffer_load_dwordx4 v[36:39], v1, s[4:7], s45 offen offset:1024 nt
s_waitcnt vmcnt(11)
v_mfma_f32_16x16x32_bf16 v[108:111], v[40:43], v[80:83], v[108:111]
s_bitcmp1_b32 s47, 2
s_cbranch_scc0 L_th69
s_waitcnt vmcnt(3)
L_th69:
s_waitcnt vmcnt(8)
buffer_load_dwordx4 v[40:43], v1, s[4:7], s45 offen offset:2048
s_waitcnt vmcnt(11)
v_mfma_f32_16x16x32_bf16 v[108:111], v[44:47], v[84:87], v[108:111]
s_bitcmp1_b32 s47, 2
s_cbranch_scc0 L_th70
s_waitcnt vmcnt(3)
L_th70:
s_waitcnt vmcnt(8)
buffer_load_dwordx4 v[44:47], v1, s[4:7], s45 offen offset:3072 nt
s_nop 3
v_mov_b32_dpp v112, v104 quad_perm:[0,0,0,0] row_mask:0xf bank_mask:0xf
v_add_f32_dpp v112, v105, v112 quad_perm:[1,1,1,1] row_mask:0xf bank_mask:0xf
v_add_f32_dpp v112, v106, v112 quad_perm:[2,2,2,2] row_mask:0xf bank_mask:0xf
v_add_f32_dpp v112, v107, v112 quad_perm:[3,3,3,3] row_mask:0xf bank_mask:0xf
v_mov_b32 v100, v112
s_waitcnt vmcnt(11)
v_mfma_f32_16x16x32_bf16 v[104:107], v[48:51], v[72:75], 0
s_bitcmp1_b32 s47, 2
s_cbranch_scc0 L_th71
s_waitcnt vmcnt(3)
L_th71:
s_waitcnt vmcnt(8)
s_mov_b32 s45, 0x35000
buffer_load_dwordx4 v[48:51], v1, s[4:7], s45 offen offset:0 nt
s_waitcnt vmcnt(11)
v_mfma_f32_16x16x32_bf16 v[104:107], v[52:55], v[76:79], v[104:107]
s_bitcmp1_b32 s47, 2
s_cbranch_scc0 L_th72
s_waitcnt vmcnt(3)
L_th72:
s_waitcnt vmcnt(8)
buffer_load_dwordx4 v[52:55], v1, s[4:7], s45 offen offset:1024
s_waitcnt vmcnt(11)
v_mfma_f32_16x16x32_bf16 v[104:107], v[56:59], v[80:83], v[104:107]
s_bitcmp1_b32 s47, 2
s_cbranch_scc0 L_th73
s_waitcnt vmcnt(3)
L_th73:
s_waitcnt vmcnt(8)
buffer_load_dwordx4 v[56:59], v1, s[4:7], s45 offen offset:2048 nt
s_waitcnt vmcnt(11)
v_mfma_f32_16x16x32_bf16 v[104:107], v[60:63], v[84:87], v[104:107]
s_bitcmp1_b32 s47, 2
s_cbranch_scc0 L_th74
s_waitcnt vmcnt(3)
L_th74:
s_waitcnt vmcnt(8)
buffer_load_dwordx4 v[60:63], v1, s[4:7], s45 offen offset:3072 nt
s_nop 3
v_mov_b32_dpp v112, v108 quad_perm:[0,0,0,0] row_mask:0xf bank_mask:0xf
v_add_f32_dpp v112, v109, v112 quad_perm:[1,1,1,1] row_mask:0xf bank_mask:0xf
v_add_f32_dpp v112, v110, v112 quad_perm:[2,2,2,2] row_mask:0xf bank_mask:0xf
v_add_f32_dpp v112, v111, v112 quad_perm:[3,3,3,3] row_mask:0xf bank_mask:0xf
v_cndmask_b32 v100, v100, v112, s[48:49]
s_waitcnt vmcnt(11)
v_mfma_f32_16x16x32_bf16 v[108:111], v[64:67], v[72:75], 0
s_bitcmp1_b32 s47, 2
s_cbranch_scc0 L_th75
s_waitcnt vmcnt(3)
L_th75:
s_waitcnt vmcnt(8)
s_mov_b32 s45, 0x36000
buffer_load_dwordx4 v[64:67], v1, s[4:7], s45 offen offset:0
s_waitcnt vmcnt(11)
v_mfma_f32_16x16x32_bf16 v[108:111], v[68:71], v[76:79], v[108:111]
s_bitcmp1_b32 s47, 2
s_cbranch_scc0 L_th76
s_waitcnt vmcnt(3)
L_th76:
s_waitcnt vmcnt(8)
buffer_load_dwordx4 v[68:71], v1, s[4:7], s45 offen offset:1024 nt
s_waitcnt vmcnt(11)
v_mfma_f32_16x16x32_bf16 v[108:111], v[24:27], v[80:83], v[108:111]
s_bitcmp1_b32 s47, 2
s_cbranch_scc0 L_th77
s_waitcnt vmcnt(3)
L_th77:
s_waitcnt vmcnt(8)
buffer_load_dwordx4 v[24:27], v1, s[4:7], s45 offen offset:2048 nt
s_waitcnt vmcnt(11)
v_mfma_f32_16x16x32_bf16 v[108:111], v[28:31], v[84:87], v[108:111]
s_bitcmp1_b32 s47, 2
s_cbranch_scc0 L_th78
s_waitcnt vmcnt(3)
L_th78:
s_waitcnt vmcnt(8)
buffer_load_dwordx4 v[28:31], v1, s[4:7], s45 offen offset:3072
s_nop 3
v_mov_b32_dpp v112, v104 quad_perm:[0,0,0,0] row_mask:0xf bank_mask:0xf
v_add_f32_dpp v112, v105, v112 quad_perm:[1,1,1,1] row_mask:0xf bank_mask:0xf
v_add_f32_dpp v112, v106, v112 quad_perm:[2,2,2,2] row_mask:0xf bank_mask:0xf
v_add_f32_dpp v112, v107, v112 quad_perm:[3,3,3,3] row_mask:0xf bank_mask:0xf
v_cndmask_b32 v100, v100, v112, s[50:51]
s_waitcnt vmcnt(11)
v_mfma_f32_16x16x32_bf16 v[104:107], v[32:35], v[72:75], 0
s_bitcmp1_b32 s47, 2
s_cbranch_scc0 L_th79
s_waitcnt vmcnt(3)
L_th79:
s_waitcnt vmcnt(8)
s_mov_b32 s45, 0x37000
buffer_load_dwordx4 v[32:35], v1, s[4:7], s45 offen offset:0 nt
s_waitcnt vmcnt(11)
v_mfma_f32_16x16x32_bf16 v[104:107], v[36:39], v[76:79], v[104:107]
s_bitcmp1_b32 s47, 2
s_cbranch_scc0 L_th80
s_waitcnt vmcnt(3)
L_th80:
s_waitcnt vmcnt(8)
buffer_load_dwordx4 v[36:39], v1, s[4:7], s45 offen offset:1024 nt
s_waitcnt vmcnt(11)
v_mfma_f32_16x16x32_bf16 v[104:107], v[40:43], v[80:83], v[104:107]
s_bitcmp1_b32 s47, 2
s_cbranch_scc0 L_th81
s_waitcnt vmcnt(3)
L_th81:
s_waitcnt vmcnt(8)
buffer_load_dwordx4 v[40:43], v1, s[4:7], s45 offen offset:2048
s_waitcnt vmcnt(11)
v_mfma_f32_16x16x32_bf16 v[104:107], v[44:47], v[84:87], v[104:107]
s_bitcmp1_b32 s47, 2
s_cbranch_scc0 L_th82
s_waitcnt vmcnt(3)
L_th82:
s_waitcnt vmcnt(8)
buffer_load_dwordx4 v[44:47], v1, s[4:7], s45 offen offset:3072 nt
s_nop 3
v_mov_b32_dpp v112, v108 quad_perm:[0,0,0,0] row_mask:0xf bank_mask:0xf
v_add_f32_dpp v112, v109, v112 quad_perm:[1,1,1,1] row_mask:0xf bank_mask:0xf
v_add_f32_dpp v112, v110, v112 quad_perm:[2,2,2,2] row_mask:0xf bank_mask:0xf
v_add_f32_dpp v112, v111, v112 quad_perm:[3,3,3,3] row_mask:0xf bank_mask:0xf
v_cndmask_b32 v100, v100, v112, s[52:53]
s_waitcnt vmcnt(11)
v_mfma_f32_16x16x32_bf16 v[108:111], v[48:51], v[72:75], 0
s_bitcmp1_b32 s47, 2
s_cbranch_scc0 L_th83
s_waitcnt vmcnt(3)
L_th83:
s_waitcnt vmcnt(8)
s_mov_b32 s45, 0x38000
buffer_load_dwordx4 v[48:51], v1, s[4:7], s45 offen offset:0 nt
s_waitcnt vmcnt(11)
v_mfma_f32_16x16x32_bf16 v[108:111], v[52:55], v[76:79], v[108:111]
s_bitcmp1_b32 s47, 2
s_cbranch_scc0 L_th84
s_waitcnt vmcnt(3)
L_th84:
s_waitcnt vmcnt(8)
buffer_load_dwordx4 v[52:55], v1, s[4:7], s45 offen offset:1024
s_waitcnt vmcnt(11)
v_mfma_f32_16x16x32_bf16 v[108:111], v[56:59], v[80:83], v[108:111]
s_bitcmp1_b32 s47, 2
s_cbranch_scc0 L_th85
s_waitcnt vmcnt(3)
L_th85:
s_waitcnt vmcnt(8)
buffer_load_dwordx4 v[56:59], v1, s[4:7], s45 offen offset:2048 nt
s_waitcnt vmcnt(11)
v_mfma_f32_16x16x32_bf16 v[108:111], v[60:63], v[84:87], v[108:111]
s_bitcmp1_b32 s47, 2
s_cbranch_scc0 L_th86
s_waitcnt vmcnt(3)
L_th86:
s_waitcnt vmcnt(8)
buffer_load_dwordx4 v[60:63], v1, s[4:7], s45 offen offset:3072 nt
s_nop 3
v_mov_b32_dpp v112, v104 quad_perm:[0,0,0,0] row_mask:0xf bank_mask:0xf
v_add_f32_dpp v112, v105, v112 quad_perm:[1,1,1,1] row_mask:0xf bank_mask:0xf
v_add_f32_dpp v112, v106, v112 quad_perm:[2,2,2,2] row_mask:0xf bank_mask:0xf
v_add_f32_dpp v112, v107, v112 quad_perm:[3,3,3,3] row_mask:0xf bank_mask:0xf
v_mov_b32 v101, v112
s_waitcnt vmcnt(11)
v_mfma_f32_16x16x32_bf16 v[104:107], v[64:67], v[72:75], 0
s_bitcmp1_b32 s47, 2
s_cbranch_scc0 L_th87
s_waitcnt vmcnt(3)
L_th87:
s_waitcnt vmcnt(8)
s_mov_b32 s45, 0x39000
buffer_load_dwordx4 v[64:67], v1, s[4:7], s45 offen offset:0
s_waitcnt vmcnt(11)
v_mfma_f32_16x16x32_bf16 v[104:107], v[68:71], v[76:79], v[104:107]
s_bitcmp1_b32 s47, 2
s_cbranch_scc0 L_th88
s_waitcnt vmcnt(3)
L_th88:
s_waitcnt vmcnt(8)
buffer_load_dwordx4 v[68:71], v1, s[4:7], s45 offen offset:1024 nt
s_waitcnt vmcnt(11)
v_mfma_f32_16x16x32_bf16 v[104:107], v[24:27], v[80:83], v[104:107]
s_bitcmp1_b32 s47, 2
s_cbranch_scc0 L_th89
s_waitcnt vmcnt(3)
L_th89:
s_waitcnt vmcnt(8)
buffer_load_dwordx4 v[24:27], v1, s[4:7], s45 offen offset:2048 nt
s_waitcnt vmcnt(11)
v_mfma_f32_16x16x32_bf16 v[104:107], v[28:31], v[84:87], v[104:107]
s_bitcmp1_b32 s47, 2
s_cbranch_scc0 L_th90
s_waitcnt vmcnt(3)
L_th90:
s_waitcnt vmcnt(8)
buffer_load_dwordx4 v[28:31], v1, s[4:7], s45 offen offset:3072
s_nop 3
v_mov_b32_dpp v112, v108 quad_perm:[0,0,0,0] row_mask:0xf bank_mask:0xf
v_add_f32_dpp v112, v109, v112 quad_perm:[1,1,1,1] row_mask:0xf bank_mask:0xf
v_add_f32_dpp v112, v110, v112 quad_perm:[2,2,2,2] row_mask:0xf bank_mask:0xf
v_add_f32_dpp v112, v111, v112 quad_perm:[3,3,3,3] row_mask:0xf bank_mask:0xf
v_cndmask_b32 v101, v101, v112, s[48:49]
s_waitcnt vmcnt(11)
v_mfma_f32_16x16x32_bf16 v[108:111], v[32:35], v[72:75], 0
s_bitcmp1_b32 s47, 2
s_cbranch_scc0 L_th91
s_waitcnt vmcnt(3)
L_th91:
s_waitcnt vmcnt(8)
s_mov_b32 s45, 0x3a000
buffer_load_dwordx4 v[32:35], v1, s[4:7], s45 offen offset:0 nt
s_waitcnt vmcnt(11)
v_mfma_f32_16x16x32_bf16 v[108:111], v[36:39], v[76:79], v[108:111]
s_bitcmp1_b32 s47, 2
s_cbranch_scc0 L_th92
s_waitcnt vmcnt(3)
L_th92:
s_waitcnt vmcnt(8)
buffer_load_dwordx4 v[36:39], v1, s[4:7], s45 offen offset:1024 nt
s_waitcnt vmcnt(11)
v_mfma_f32_16x16x32_bf16 v[108:111], v[40:43], v[80:83], v[108:111]
s_bitcmp1_b32 s47, 2
s_cbranch_scc0 L_th93
s_waitcnt vmcnt(3)
L_th93:
s_waitcnt vmcnt(8)
buffer_load_dwordx4 v[40:43], v1, s[4:7], s45 offen offset:2048
s_waitcnt vmcnt(11)
v_mfma_f32_16x16x32_bf16 v[108:111], v[44:47], v[84:87], v[108:111]
s_bitcmp1_b32 s47, 2
s_cbranch_scc0 L_th94
s_waitcnt vmcnt(3)
L_th94:
s_waitcnt vmcnt(8)
buffer_load_dwordx4 v[44:47], v1, s[4:7], s45 offen offset:3072 nt
s_nop 3
v_mov_b32_dpp v112, v104 quad_perm:[0,0,0,0] row_mask:0xf bank_mask:0xf
v_add_f32_dpp v112, v105, v112 quad_perm:[1,1,1,1] row_mask:0xf bank_mask:0xf
v_add_f32_dpp v112, v106, v112 quad_perm:[2,2,2,2] row_mask:0xf bank_mask:0xf
v_add_f32_dpp v112, v107, v112 quad_perm:[3,3,3,3] row_mask:0xf bank_mask:0xf
v_cndmask_b32 v101, v101, v112, s[50:51]
s_waitcnt vmcnt(11)
v_mfma_f32_16x16x32_bf16 v[104:107], v[48:51], v[72:75], 0
s_bitcmp1_b32 s47, 2
s_cbranch_scc0 L_th95
s_waitcnt vmcnt(3)
L_th95:
s_waitcnt vmcnt(8)
s_mov_b32 s45, 0x3b000
buffer_load_dwordx4 v[48:51], v1, s[4:7], s45 offen offset:0 nt
s_waitcnt vmcnt(11)
v_mfma_f32_16x16x32_bf16 v[104:107], v[52:55], v[76:79], v[104:107]
s_bitcmp1_b32 s47, 2
s_cbranch_scc0 L_th96
s_waitcnt vmcnt(3)
L_th96:
s_waitcnt vmcnt(8)
buffer_load_dwordx4 v[52:55], v1, s[4:7], s45 offen offset:1024
s_waitcnt vmcnt(11)
v_mfma_f32_16x16x32_bf16 v[104:107], v[56:59], v[80:83], v[104:107]
s_bitcmp1_b32 s47, 2
s_cbranch_scc0 L_th97
s_waitcnt vmcnt(3)
L_th97:
s_waitcnt vmcnt(8)
buffer_load_dwordx4 v[56:59], v1, s[4:7], s45 offen offset:2048 nt
s_waitcnt vmcnt(11)
v_mfma_f32_16x16x32_bf16 v[104:107], v[60:63], v[84:87], v[104:107]
s_bitcmp1_b32 s47, 2
s_cbranch_scc0 L_th98
s_waitcnt vmcnt(3)
L_th98:
s_waitcnt vmcnt(8)
buffer_load_dwordx4 v[60:63], v1, s[4:7], s45 offen offset:3072 nt
s_nop 3
v_mov_b32_dpp v112, v108 quad_perm:[0,0,0,0] row_mask:0xf bank_mask:0xf
v_add_f32_dpp v112, v109, v112 quad_perm:[1,1,1,1] row_mask:0xf bank_mask:0xf
v_add_f32_dpp v112, v110, v112 quad_perm:[2,2,2,2] row_mask:0xf bank_mask:0xf
v_add_f32_dpp v112, v111, v112 quad_perm:[3,3,3,3] row_mask:0xf bank_mask:0xf
v_cndmask_b32 v101, v101, v112, s[52:53]
s_waitcnt vmcnt(11)
v_mfma_f32_16x16x32_bf16 v[108:111], v[64:67], v[72:75], 0
s_bitcmp1_b32 s47, 2
s_cbranch_scc0 L_th99
s_waitcnt vmcnt(3)
L_th99:
s_waitcnt vmcnt(8)
s_mov_b32 s45, 0x3c000
buffer_load_dwordx4 v[64:67], v1, s[4:7], s45 offen offset:0
s_waitcnt vmcnt(11)
v_mfma_f32_16x16x32_bf16 v[108:111], v[68:71], v[76:79], v[108:111]
s_bitcmp1_b32 s47, 2
s_cbranch_scc0 L_th100
s_waitcnt vmcnt(3)
L_th100:
s_waitcnt vmcnt(8)
buffer_load_dwordx4 v[68:71], v1, s[4:7], s45 offen offset:1024 nt
s_waitcnt vmcnt(11)
v_mfma_f32_16x16x32_bf16 v[108:111], v[24:27], v[80:83], v[108:111]
s_bitcmp1_b32 s47, 2
s_cbranch_scc0 L_th101
s_waitcnt vmcnt(3)
L_th101:
s_waitcnt vmcnt(8)
buffer_load_dwordx4 v[24:27], v1, s[4:7], s45 offen offset:2048 nt
s_waitcnt vmcnt(11)
v_mfma_f32_16x16x32_bf16 v[108:111], v[28:31], v[84:87], v[108:111]
s_bitcmp1_b32 s47, 2
s_cbranch_scc0 L_th102
s_waitcnt vmcnt(3)
L_th102:
s_waitcnt vmcnt(8)
buffer_load_dwordx4 v[28:31], v1, s[4:7], s45 offen offset:3072
s_nop 3
v_mov_b32_dpp v112, v104 quad_perm:[0,0,0,0] row_mask:0xf bank_mask:0xf
v_add_f32_dpp v112, v105, v112 quad_perm:[1,1,1,1] row_mask:0xf bank_mask:0xf
v_add_f32_dpp v112, v106, v112 quad_perm:[2,2,2,2] row_mask:0xf bank_mask:0xf
v_add_f32_dpp v112, v107, v112 quad_perm:[3,3,3,3] row_mask:0xf bank_mask:0xf
v_mov_b32 v102, v112
s_waitcnt vmcnt(11)
v_mfma_f32_16x16x32_bf16 v[104:107], v[32:35], v[72:75], 0
s_bitcmp1_b32 s47, 2
s_cbranch_scc0 L_th103
s_waitcnt vmcnt(3)
L_th103:
s_waitcnt vmcnt(8)
s_mov_b32 s45, 0x3d000
buffer_load_dwordx4 v[32:35], v1, s[4:7], s45 offen offset:0 nt
s_waitcnt vmcnt(11)
v_mfma_f32_16x16x32_bf16 v[104:107], v[36:39], v[76:79], v[104:107]
s_bitcmp1_b32 s47, 2
s_cbranch_scc0 L_th104
s_waitcnt vmcnt(3)
L_th104:
s_waitcnt vmcnt(8)
buffer_load_dwordx4 v[36:39], v1, s[4:7], s45 offen offset:1024 nt
s_waitcnt vmcnt(11)
v_mfma_f32_16x16x32_bf16 v[104:107], v[40:43], v[80:83], v[104:107]
s_bitcmp1_b32 s47, 2
s_cbranch_scc0 L_th105
s_waitcnt vmcnt(3)
L_th105:
s_waitcnt vmcnt(8)
buffer_load_dwordx4 v[40:43], v1, s[4:7], s45 offen offset:2048
s_waitcnt vmcnt(11)
v_mfma_f32_16x16x32_bf16 v[104:107], v[44:47], v[84:87], v[104:107]
s_bitcmp1_b32 s47, 2
s_cbranch_scc0 L_th106
s_waitcnt vmcnt(3)
L_th106:
s_waitcnt vmcnt(8)
buffer_load_dwordx4 v[44:47], v1, s[4:7], s45 offen offset:3072 nt
s_nop 3
v_mov_b32_dpp v112, v108 quad_perm:[0,0,0,0] row_mask:0xf bank_mask:0xf
v_add_f32_dpp v112, v109, v112 quad_perm:[1,1,1,1] row_mask:0xf bank_mask:0xf
v_add_f32_dpp v112, v110, v112 quad_perm:[2,2,2,2] row_mask:0xf bank_mask:0xf
v_add_f32_dpp v112, v111, v112 quad_perm:[3,3,3,3] row_mask:0xf bank_mask:0xf
v_cndmask_b32 v102, v102, v112, s[48:49]
s_waitcnt vmcnt(11)
v_mfma_f32_16x16x32_bf16 v[108:111], v[48:51], v[72:75], 0
s_bitcmp1_b32 s47, 2
s_cbranch_scc0 L_th107
s_waitcnt vmcnt(3)
L_th107:
s_waitcnt vmcnt(8)
s_mov_b32 s45, 0x3e000
buffer_load_dwordx4 v[48:51], v1, s[4:7], s45 offen offset:0 nt
s_waitcnt vmcnt(11)
v_mfma_f32_16x16x32_bf16 v[108:111], v[52:55], v[76:79], v[108:111]
s_bitcmp1_b32 s47, 2
s_cbranch_scc0 L_th108
s_waitcnt vmcnt(3)
L_th108:
s_waitcnt vmcnt(8)
buffer_load_dwordx4 v[52:55], v1, s[4:7], s45 offen offset:1024
s_waitcnt vmcnt(11)
v_mfma_f32_16x16x32_bf16 v[108:111], v[56:59], v[80:83], v[108:111]
s_bitcmp1_b32 s47, 2
s_cbranch_scc0 L_th109
s_waitcnt vmcnt(3)
L_th109:
s_waitcnt vmcnt(8)
buffer_load_dwordx4 v[56:59], v1, s[4:7], s45 offen offset:2048 nt
s_waitcnt vmcnt(11)
v_mfma_f32_16x16x32_bf16 v[108:111], v[60:63], v[84:87], v[108:111]
s_bitcmp1_b32 s47, 2
s_cbranch_scc0 L_th110
s_waitcnt vmcnt(3)
L_th110:
s_waitcnt vmcnt(8)
buffer_load_dwordx4 v[60:63], v1, s[4:7], s45 offen offset:3072 nt
s_nop 3
v_mov_b32_dpp v112, v104 quad_perm:[0,0,0,0] row_mask:0xf bank_mask:0xf
v_add_f32_dpp v112, v105, v112 quad_perm:[1,1,1,1] row_mask:0xf bank_mask:0xf
v_add_f32_dpp v112, v106, v112 quad_perm:[2,2,2,2] row_mask:0xf bank_mask:0xf
v_add_f32_dpp v112, v107, v112 quad_perm:[3,3,3,3] row_mask:0xf bank_mask:0xf
v_cndmask_b32 v102, v102, v112, s[50:51]
s_waitcnt vmcnt(11)
v_mfma_f32_16x16x32_bf16 v[104:107], v[64:67], v[72:75], 0
s_bitcmp1_b32 s47, 2
s_cbranch_scc0 L_th111
s_waitcnt vmcnt(3)
L_th111:
s_waitcnt vmcnt(8)
s_mov_b32 s45, 0x3f000
buffer_load_dwordx4 v[64:67], v1, s[4:7], s45 offen offset:0
s_waitcnt vmcnt(11)
v_mfma_f32_16x16x32_bf16 v[104:107], v[68:71], v[76:79], v[104:107]
s_bitcmp1_b32 s47, 2
s_cbranch_scc0 L_th112
s_waitcnt vmcnt(3)
L_th112:
s_waitcnt vmcnt(8)
buffer_load_dwordx4 v[68:71], v1, s[4:7], s45 offen offset:1024 nt
s_waitcnt vmcnt(11)
v_mfma_f32_16x16x32_bf16 v[104:107], v[24:27], v[80:83], v[104:107]
s_bitcmp1_b32 s47, 2
s_cbranch_scc0 L_th113
s_waitcnt vmcnt(3)
L_th113:
s_waitcnt vmcnt(8)
buffer_load_dwordx4 v[24:27], v1, s[4:7], s45 offen offset:2048 nt
s_waitcnt vmcnt(11)
v_mfma_f32_16x16x32_bf16 v[104:107], v[28:31], v[84:87], v[104:107]
s_bitcmp1_b32 s47, 2
s_cbranch_scc0 L_th114
s_waitcnt vmcnt(3)
L_th114:
s_waitcnt vmcnt(8)
buffer_load_dwordx4 v[28:31], v1, s[4:7], s45 offen offset:3072
s_nop 3
v_mov_b32_dpp v112, v108 quad_perm:[0,0,0,0] row_mask:0xf bank_mask:0xf
v_add_f32_dpp v112, v109, v112 quad_perm:[1,1,1,1] row_mask:0xf bank_mask:0xf
v_add_f32_dpp v112, v110, v112 quad_perm:[2,2,2,2] row_mask:0xf bank_mask:0xf
v_add_f32_dpp v112, v111, v112 quad_perm:[3,3,3,3] row_mask:0xf bank_mask:0xf
v_cndmask_b32 v102, v102, v112, s[52:53]
s_waitcnt vmcnt(11)
v_mfma_f32_16x16x32_bf16 v[108:111], v[32:35], v[72:75], 0
s_bitcmp1_b32 s47, 2
s_cbranch_scc0 L_th115
s_waitcnt vmcnt(3)
L_th115:
s_waitcnt vmcnt(8)
buffer_load_dwordx4 v[32:35], v2, s[8:11], 0 offen offset:0
s_waitcnt vmcnt(11)
v_mfma_f32_16x16x32_bf16 v[108:111], v[36:39], v[76:79], v[108:111]
s_bitcmp1_b32 s47, 2
s_cbranch_scc0 L_th116
s_waitcnt vmcnt(3)
L_th116:
s_waitcnt vmcnt(8)
buffer_load_dwordx4 v[36:39], v2, s[8:11], 0 offen offset:1024 nt
s_waitcnt vmcnt(11)
v_mfma_f32_16x16x32_bf16 v[108:111], v[40:43], v[80:83], v[108:111]
s_bitcmp1_b32 s47, 2
s_cbranch_scc0 L_th117
s_waitcnt vmcnt(3)
L_th117:
s_waitcnt vmcnt(8)
buffer_load_dwordx4 v[40:43], v2, s[8:11], 0 offen offset:2048 nt
s_waitcnt vmcnt(11)
v_mfma_f32_16x16x32_bf16 v[108:111], v[44:47], v[84:87], v[108:111]
s_bitcmp1_b32 s47, 2
s_cbranch_scc0 L_th118
s_waitcnt vmcnt(3)
L_th118:
s_waitcnt vmcnt(8)
buffer_load_dwordx4 v[44:47], v2, s[8:11], 0 offen offset:3072
s_nop 3
v_mov_b32_dpp v112, v104 quad_perm:[0,0,0,0] row_mask:0xf bank_mask:0xf
v_add_f32_dpp v112, v105, v112 quad_perm:[1,1,1,1] row_mask:0xf bank_mask:0xf
v_add_f32_dpp v112, v106, v112 quad_perm:[2,2,2,2] row_mask:0xf bank_mask:0xf
v_add_f32_dpp v112, v107, v112 quad_perm:[3,3,3,3] row_mask:0xf bank_mask:0xf
v_mov_b32 v103, v112
s_waitcnt vmcnt(11)
v_mfma_f32_16x16x32_bf16 v[104:107], v[48:51], v[72:75], 0
s_bitcmp1_b32 s47, 2
s_cbranch_scc0 L_th119
s_waitcnt vmcnt(3)
L_th119:
s_waitcnt vmcnt(8)
s_mov_b32 s45, 0x1000
buffer_load_dwordx4 v[48:51], v2, s[8:11], s45 offen offset:0 nt
s_waitcnt vmcnt(11)
v_mfma_f32_16x16x32_bf16 v[104:107], v[52:55], v[76:79], v[104:107]
s_bitcmp1_b32 s47, 2
s_cbranch_scc0 L_th120
s_waitcnt vmcnt(3)
L_th120:
s_waitcnt vmcnt(8)
buffer_load_dwordx4 v[52:55], v2, s[8:11], s45 offen offset:1024 nt
s_waitcnt vmcnt(11)
v_mfma_f32_16x16x32_bf16 v[104:107], v[56:59], v[80:83], v[104:107]
s_bitcmp1_b32 s47, 2
s_cbranch_scc0 L_th121
s_waitcnt vmcnt(3)
L_th121:
s_waitcnt vmcnt(8)
buffer_load_dwordx4 v[56:59], v2, s[8:11], s45 offen offset:2048
s_waitcnt vmcnt(11)
v_mfma_f32_16x16x32_bf16 v[104:107], v[60:63], v[84:87], v[104:107]
s_bitcmp1_b32 s47, 2
s_cbranch_scc0 L_th122
s_waitcnt vmcnt(3)
L_th122:
s_waitcnt vmcnt(8)
buffer_load_dwordx4 v[60:63], v2, s[8:11], s45 offen offset:3072 nt
s_nop 3
v_mov_b32_dpp v112, v108 quad_perm:[0,0,0,0] row_mask:0xf bank_mask:0xf
v_add_f32_dpp v112, v109, v112 quad_perm:[1,1,1,1] row_mask:0xf bank_mask:0xf
v_add_f32_dpp v112, v110, v112 quad_perm:[2,2,2,2] row_mask:0xf bank_mask:0xf
v_add_f32_dpp v112, v111, v112 quad_perm:[3,3,3,3] row_mask:0xf bank_mask:0xf
v_cndmask_b32 v103, v103, v112, s[48:49]
s_waitcnt vmcnt(11)
v_mfma_f32_16x16x32_bf16 v[108:111], v[64:67], v[72:75], 0
s_bitcmp1_b32 s47, 2
s_cbranch_scc0 L_th123
s_waitcnt vmcnt(3)
L_th123:
s_waitcnt vmcnt(8)
s_mov_b32 s45, 0x2000
buffer_load_dwordx4 v[64:67], v2, s[8:11], s45 offen offset:0 nt
s_waitcnt vmcnt(11)
v_mfma_f32_16x16x32_bf16 v[108:111], v[68:71], v[76:79], v[108:111]
s_bitcmp1_b32 s47, 2
s_cbranch_scc0 L_th124
s_waitcnt vmcnt(3)
L_th124:
s_waitcnt vmcnt(8)
buffer_load_dwordx4 v[68:71], v2, s[8:11], s45 offen offset:1024
s_waitcnt vmcnt(11)
v_mfma_f32_16x16x32_bf16 v[108:111], v[24:27], v[80:83], v[108:111]
s_bitcmp1_b32 s47, 2
s_cbranch_scc0 L_th125
s_waitcnt vmcnt(3)
L_th125:
s_waitcnt vmcnt(8)
buffer_load_dwordx4 v[24:27], v2, s[8:11], s45 offen offset:2048 nt
s_waitcnt vmcnt(11)
v_mfma_f32_16x16x32_bf16 v[108:111], v[28:31], v[84:87], v[108:111]
s_bitcmp1_b32 s47, 2
s_cbranch_scc0 L_th126
s_waitcnt vmcnt(3)
L_th126:
s_waitcnt vmcnt(8)
buffer_load_dwordx4 v[28:31], v2, s[8:11], s45 offen offset:3072 nt
s_nop 3
v_mov_b32_dpp v112, v104 quad_perm:[0,0,0,0] row_mask:0xf bank_mask:0xf
v_add_f32_dpp v112, v105, v112 quad_perm:[1,1,1,1] row_mask:0xf bank_mask:0xf
v_add_f32_dpp v112, v106, v112 quad_perm:[2,2,2,2] row_mask:0xf bank_mask:0xf
v_add_f32_dpp v112, v107, v112 quad_perm:[3,3,3,3] row_mask:0xf bank_mask:0xf
v_cndmask_b32 v103, v103, v112, s[50:51]
s_nop 7
v_mov_b32_dpp v112, v108 quad_perm:[0,0,0,0] row_mask:0xf bank_mask:0xf
v_add_f32_dpp v112, v109, v112 quad_perm:[1,1,1,1] row_mask:0xf bank_mask:0xf
v_add_f32_dpp v112, v110, v112 quad_perm:[2,2,2,2] row_mask:0xf bank_mask:0xf
v_add_f32_dpp v112, v111, v112 quad_perm:[3,3,3,3] row_mask:0xf bank_mask:0xf
v_cndmask_b32 v103, v103, v112, s[52:53]
v_max3_f32 v104, v88, v89, v90
v_max3_f32 v104, v104, v91, v92
v_max3_f32 v104, v104, v93, v94
v_max3_f32 v104, v104, v95, v96
v_max3_f32 v104, v104, v97, v98
v_max3_f32 v104, v104, v99, v100
v_max3_f32 v104, v104, v101, v102
v_max_f32 v104, v104, v103
s_nop 1
v_max_f32_dpp v104, v104, v104 row_ror:8 row_mask:0xf bank_mask:0xf
s_nop 1
v_max_f32_dpp v104, v104, v104 row_ror:4 row_mask:0xf bank_mask:0xf
s_nop 1
v_max_f32_dpp v104, v104, v104 row_ror:2 row_mask:0xf bank_mask:0xf
s_nop 1
v_max_f32_dpp v104, v104, v104 row_ror:1 row_mask:0xf bank_mask:0xf
v_mov_b32 v105, v104
s_nop 1
v_permlane16_swap_b32 v104, v105
s_nop 0
v_max_f32 v104, v104, v105
v_mov_b32 v105, v104
s_nop 1
v_permlane32_swap_b32 v104, v105
s_nop 0
v_max_f32 v104, v104, v105
s_mov_b32 s54, 0x3e0293ee
v_mul_f32 v105, s54, v104
v_fma_f32 v88, v88, s54, -v105
v_fma_f32 v89, v89, s54, -v105
v_fma_f32 v90, v90, s54, -v105
v_fma_f32 v91, v91, s54, -v105
v_fma_f32 v92, v92, s54, -v105
v_fma_f32 v93, v93, s54, -v105
v_fma_f32 v94, v94, s54, -v105
v_fma_f32 v95, v95, s54, -v105
v_fma_f32 v96, v96, s54, -v105
v_fma_f32 v97, v97, s54, -v105
v_fma_f32 v98, v98, s54, -v105
v_fma_f32 v99, v99, s54, -v105
v_fma_f32 v100, v100, s54, -v105
v_fma_f32 v101, v101, s54, -v105
v_fma_f32 v102, v102, s54, -v105
v_fma_f32 v103, v103, s54, -v105
v_exp_f32 v88, v88
v_exp_f32 v89, v89
v_exp_f32 v90, v90
v_exp_f32 v91, v91
v_exp_f32 v92, v92
v_exp_f32 v93, v93
v_exp_f32 v94, v94
v_exp_f32 v95, v95
v_exp_f32 v96, v96
v_exp_f32 v97, v97
v_exp_f32 v98, v98
v_exp_f32 v99, v99
v_exp_f32 v100, v100
v_exp_f32 v101, v101
v_exp_f32 v102, v102
v_exp_f32 v103, v103
s_nop 0
v_add_f32 v106, v88, v89
v_add_f32 v106, v106, v90
v_add_f32 v106, v106, v91
v_add_f32 v106, v106, v92
v_add_f32 v106, v106, v93
v_add_f32 v106, v106, v94
v_add_f32 v106, v106, v95
v_add_f32 v106, v106, v96
v_add_f32 v106, v106, v97
v_add_f32 v106, v106, v98
v_add_f32 v106, v106, v99
v_add_f32 v106, v106, v100
v_add_f32 v106, v106, v101
v_add_f32 v106, v106, v102
v_add_f32 v106, v106, v103
v_cvt_pk_bf16_f32 v88, v88, v88
v_cvt_pk_bf16_f32 v89, v89, v89
v_cvt_pk_bf16_f32 v90, v90, v90
v_cvt_pk_bf16_f32 v91, v91, v91
v_cvt_pk_bf16_f32 v92, v92, v92
v_cvt_pk_bf16_f32 v93, v93, v93
v_cvt_pk_bf16_f32 v94, v94, v94
v_cvt_pk_bf16_f32 v95, v95, v95
v_cvt_pk_bf16_f32 v96, v96, v96
v_cvt_pk_bf16_f32 v97, v97, v97
v_cvt_pk_bf16_f32 v98, v98, v98
v_cvt_pk_bf16_f32 v99, v99, v99
v_cvt_pk_bf16_f32 v100, v100, v100
v_cvt_pk_bf16_f32 v101, v101, v101
v_cvt_pk_bf16_f32 v102, v102, v102
v_cvt_pk_bf16_f32 v103, v103, v103
s_nop 1
v_add_f32_dpp v106, v106, v106 row_ror:8 row_mask:0xf bank_mask:0xf
s_nop 1
v_add_f32_dpp v106, v106, v106 row_ror:4 row_mask:0xf bank_mask:0xf
s_nop 1
v_add_f32_dpp v106, v106, v106 row_ror:2 row_mask:0xf bank_mask:0xf
s_nop 1
v_add_f32_dpp v106, v106, v106 row_ror:1 row_mask:0xf bank_mask:0xf
v_mov_b32 v105, v106
s_nop 1
v_permlane16_swap_b32 v106, v105
s_nop 0
v_add_f32 v106, v106, v105
v_mov_b32 v105, v106
s_nop 1
v_permlane32_swap_b32 v106, v105
s_nop 0
v_add_f32 v106, v106, v105
v_mul_f32 v15, s54, v104
v_mov_b32 v133, v106
v_mov_b32 v132, v15
s_nop 1
v_and_b32_dpp v112, v88, v16 row_newbcast:0 row_mask:0xf bank_mask:0xf
v_and_b32_dpp v113, v88, v17 row_newbcast:0 row_mask:0xf bank_mask:0xf
v_and_b32_dpp v114, v88, v18 row_newbcast:0 row_mask:0xf bank_mask:0xf
v_and_b32_dpp v115, v88, v19 row_newbcast:0 row_mask:0xf bank_mask:0xf
v_and_b32_dpp v116, v88, v16 row_newbcast:4 row_mask:0xf bank_mask:0xf
v_and_b32_dpp v117, v88, v17 row_newbcast:4 row_mask:0xf bank_mask:0xf
v_and_b32_dpp v118, v88, v18 row_newbcast:4 row_mask:0xf bank_mask:0xf
v_and_b32_dpp v119, v88, v19 row_newbcast:4 row_mask:0xf bank_mask:0xf
s_waitcnt vmcnt(11)
v_mfma_f32_16x16x32_bf16 v[108:111], v[112:115], v[32:35], 0
s_bitcmp1_b32 s47, 2
s_cbranch_scc0 L_th127
s_waitcnt vmcnt(3)
L_th127:
s_waitcnt vmcnt(8)
s_mov_b32 s45, 0x3000
buffer_load_dwordx4 v[32:35], v2, s[8:11], s45 offen offset:0
v_and_b32_dpp v112, v88, v16 row_newbcast:8 row_mask:0xf bank_mask:0xf
v_and_b32_dpp v113, v88, v17 row_newbcast:8 row_mask:0xf bank_mask:0xf
v_and_b32_dpp v114, v88, v18 row_newbcast:8 row_mask:0xf bank_mask:0xf
v_and_b32_dpp v115, v88, v19 row_newbcast:8 row_mask:0xf bank_mask:0xf
s_waitcnt vmcnt(11)
v_mfma_f32_16x16x32_bf16 v[108:111], v[116:119], v[36:39], v[108:111]
s_bitcmp1_b32 s47, 2
s_cbranch_scc0 L_th128
s_waitcnt vmcnt(3)
L_th128:
s_waitcnt vmcnt(8)
buffer_load_dwordx4 v[36:39], v2, s[8:11], s45 offen offset:1024 nt
v_and_b32_dpp v116, v88, v16 row_newbcast:12 row_mask:0xf bank_mask:0xf
v_and_b32_dpp v117, v88, v17 row_newbcast:12 row_mask:0xf bank_mask:0xf
v_and_b32_dpp v118, v88, v18 row_newbcast:12 row_mask:0xf bank_mask:0xf
v_and_b32_dpp v119, v88, v19 row_newbcast:12 row_mask:0xf bank_mask:0xf
s_waitcnt vmcnt(11)
v_mfma_f32_16x16x32_bf16 v[108:111], v[112:115], v[40:43], v[108:111]
s_bitcmp1_b32 s47, 2
s_cbranch_scc0 L_th129
s_waitcnt vmcnt(3)
L_th129:
s_waitcnt vmcnt(8)
buffer_load_dwordx4 v[40:43], v2, s[8:11], s45 offen offset:2048 nt
v_and_b32_dpp v112, v88, v16 row_newbcast:1 row_mask:0xf bank_mask:0xf
v_and_b32_dpp v113, v88, v17 row_newbcast:1 row_mask:0xf bank_mask:0xf
v_and_b32_dpp v114, v88, v18 row_newbcast:1 row_mask:0xf bank_mask:0xf
v_and_b32_dpp v115, v88, v19 row_newbcast:1 row_mask:0xf bank_mask:0xf
s_waitcnt vmcnt(11)
v_mfma_f32_16x16x32_bf16 v[108:111], v[116:119], v[44:47], v[108:111]
s_bitcmp1_b32 s47, 2
s_cbranch_scc0 L_th130
s_waitcnt vmcnt(3)
L_th130:
s_waitcnt vmcnt(8)
buffer_load_dwordx4 v[44:47], v2, s[8:11], s45 offen offset:3072
v_and_b32_dpp v116, v88, v16 row_newbcast:5 row_mask:0xf bank_mask:0xf
v_and_b32_dpp v117, v88, v17 row_newbcast:5 row_mask:0xf bank_mask:0xf
v_and_b32_dpp v118, v88, v18 row_newbcast:5 row_mask:0xf bank_mask:0xf
v_and_b32_dpp v119, v88, v19 row_newbcast:5 row_mask:0xf bank_mask:0xf
s_waitcnt vmcnt(11)
v_mfma_f32_16x16x32_bf16 v[108:111], v[112:115], v[48:51], v[108:111]
s_bitcmp1_b32 s47, 2
s_cbranch_scc0 L_th131
s_waitcnt vmcnt(3)
L_th131:
s_waitcnt vmcnt(8)
s_mov_b32 s45, 0x4000
buffer_load_dwordx4 v[48:51], v2, s[8:11], s45 offen offset:0 nt
v_and_b32_dpp v112, v88, v16 row_newbcast:9 row_mask:0xf bank_mask:0xf
v_and_b32_dpp v113, v88, v17 row_newbcast:9 row_mask:0xf bank_mask:0xf
v_and_b32_dpp v114, v88, v18 row_newbcast:9 row_mask:0xf bank_mask:0xf
v_and_b32_dpp v115, v88, v19 row_newbcast:9 row_mask:0xf bank_mask:0xf
s_waitcnt vmcnt(11)
v_mfma_f32_16x16x32_bf16 v[108:111], v[116:119], v[52:55], v[108:111]
s_bitcmp1_b32 s47, 2
s_cbranch_scc0 L_th132
s_waitcnt vmcnt(3)
L_th132:
s_waitcnt vmcnt(8)
buffer_load_dwordx4 v[52:55], v2, s[8:11], s45 offen offset:1024 nt
v_and_b32_dpp v116, v88, v16 row_newbcast:13 row_mask:0xf bank_mask:0xf
v_and_b32_dpp v117, v88, v17 row_newbcast:13 row_mask:0xf bank_mask:0xf
v_and_b32_dpp v118, v88, v18 row_newbcast:13 row_mask:0xf bank_mask:0xf
v_and_b32_dpp v119, v88, v19 row_newbcast:13 row_mask:0xf bank_mask:0xf
s_waitcnt vmcnt(11)
v_mfma_f32_16x16x32_bf16 v[108:111], v[112:115], v[56:59], v[108:111]
s_bitcmp1_b32 s47, 2
s_cbranch_scc0 L_th133
s_waitcnt vmcnt(3)
L_th133:
s_waitcnt vmcnt(8)
buffer_load_dwordx4 v[56:59], v2, s[8:11], s45 offen offset:2048
v_and_b32_dpp v112, v88, v16 row_newbcast:2 row_mask:0xf bank_mask:0xf
v_and_b32_dpp v113, v88, v17 row_newbcast:2 row_mask:0xf bank_mask:0xf
v_and_b32_dpp v114, v88, v18 row_newbcast:2 row_mask:0xf bank_mask:0xf
v_and_b32_dpp v115, v88, v19 row_newbcast:2 row_mask:0xf bank_mask:0xf
s_waitcnt vmcnt(11)
v_mfma_f32_16x16x32_bf16 v[108:111], v[116:119], v[60:63], v[108:111]
s_bitcmp1_b32 s47, 2
s_cbranch_scc0 L_th134
s_waitcnt vmcnt(3)
L_th134:
s_waitcnt vmcnt(8)
buffer_load_dwordx4 v[60:63], v2, s[8:11], s45 offen offset:3072 nt
v_and_b32_dpp v116, v88, v16 row_newbcast:6 row_mask:0xf bank_mask:0xf
v_and_b32_dpp v117, v88, v17 row_newbcast:6 row_mask:0xf bank_mask:0xf
v_and_b32_dpp v118, v88, v18 row_newbcast:6 row_mask:0xf bank_mask:0xf
v_and_b32_dpp v119, v88, v19 row_newbcast:6 row_mask:0xf bank_mask:0xf
s_waitcnt vmcnt(11)
v_mfma_f32_16x16x32_bf16 v[108:111], v[112:115], v[64:67], v[108:111]
s_bitcmp1_b32 s47, 2
s_cbranch_scc0 L_th135
s_waitcnt vmcnt(3)
L_th135:
s_waitcnt vmcnt(8)
s_mov_b32 s45, 0x5000
buffer_load_dwordx4 v[64:67], v2, s[8:11], s45 offen offset:0 nt
v_and_b32_dpp v112, v88, v16 row_newbcast:10 row_mask:0xf bank_mask:0xf
v_and_b32_dpp v113, v88, v17 row_newbcast:10 row_mask:0xf bank_mask:0xf
v_and_b32_dpp v114, v88, v18 row_newbcast:10 row_mask:0xf bank_mask:0xf
v_and_b32_dpp v115, v88, v19 row_newbcast:10 row_mask:0xf bank_mask:0xf
s_waitcnt vmcnt(11)
v_mfma_f32_16x16x32_bf16 v[108:111], v[116:119], v[68:71], v[108:111]
s_bitcmp1_b32 s47, 2
s_cbranch_scc0 L_th136
s_waitcnt vmcnt(3)
L_th136:
s_waitcnt vmcnt(8)
buffer_load_dwordx4 v[68:71], v2, s[8:11], s45 offen offset:1024
v_and_b32_dpp v116, v88, v16 row_newbcast:14 row_mask:0xf bank_mask:0xf
v_and_b32_dpp v117, v88, v17 row_newbcast:14 row_mask:0xf bank_mask:0xf
v_and_b32_dpp v118, v88, v18 row_newbcast:14 row_mask:0xf bank_mask:0xf
v_and_b32_dpp v119, v88, v19 row_newbcast:14 row_mask:0xf bank_mask:0xf
s_waitcnt vmcnt(11)
v_mfma_f32_16x16x32_bf16 v[108:111], v[112:115], v[24:27], v[108:111]
s_bitcmp1_b32 s47, 2
s_cbranch_scc0 L_th137
s_waitcnt vmcnt(3)
L_th137:
s_waitcnt vmcnt(8)
buffer_load_dwordx4 v[24:27], v2, s[8:11], s45 offen offset:2048 nt
v_and_b32_dpp v112, v88, v16 row_newbcast:3 row_mask:0xf bank_mask:0xf
v_and_b32_dpp v113, v88, v17 row_newbcast:3 row_mask:0xf bank_mask:0xf
v_and_b32_dpp v114, v88, v18 row_newbcast:3 row_mask:0xf bank_mask:0xf
v_and_b32_dpp v115, v88, v19 row_newbcast:3 row_mask:0xf bank_mask:0xf
s_waitcnt vmcnt(11)
v_mfma_f32_16x16x32_bf16 v[108:111], v[116:119], v[28:31], v[108:111]
s_bitcmp1_b32 s47, 2
s_cbranch_scc0 L_th138
s_waitcnt vmcnt(3)
L_th138:
s_waitcnt vmcnt(8)
buffer_load_dwordx4 v[28:31], v2, s[8:11], s45 offen offset:3072 nt
v_and_b32_dpp v116, v88, v16 row_newbcast:7 row_mask:0xf bank_mask:0xf
v_and_b32_dpp v117, v88, v17 row_newbcast:7 row_mask:0xf bank_mask:0xf
v_and_b32_dpp v118, v88, v18 row_newbcast:7 row_mask:0xf bank_mask:0xf
v_and_b32_dpp v119, v88, v19 row_newbcast:7 row_mask:0xf bank_mask:0xf
s_waitcnt vmcnt(11)
v_mfma_f32_16x16x32_bf16 v[108:111], v[112:115], v[32:35], v[108:111]
s_bitcmp1_b32 s47, 2
s_cbranch_scc0 L_th139
s_waitcnt vmcnt(3)
L_th139:
s_waitcnt vmcnt(8)
s_mov_b32 s45, 0x6000
buffer_load_dwordx4 v[32:35], v2, s[8:11], s45 offen offset:0
v_and_b32_dpp v112, v88, v16 row_newbcast:11 row_mask:0xf bank_mask:0xf
v_and_b32_dpp v113, v88, v17 row_newbcast:11 row_mask:0xf bank_mask:0xf
v_and_b32_dpp v114, v88, v18 row_newbcast:11 row_mask:0xf bank_mask:0xf
v_and_b32_dpp v115, v88, v19 row_newbcast:11 row_mask:0xf bank_mask:0xf
s_waitcnt vmcnt(11)
v_mfma_f32_16x16x32_bf16 v[108:111], v[116:119], v[36:39], v[108:111]
s_bitcmp1_b32 s47, 2
s_cbranch_scc0 L_th140
s_waitcnt vmcnt(3)
L_th140:
s_waitcnt vmcnt(8)
buffer_load_dwordx4 v[36:39], v2, s[8:11], s45 offen offset:1024 nt
v_and_b32_dpp v116, v88, v16 row_newbcast:15 row_mask:0xf bank_mask:0xf
v_and_b32_dpp v117, v88, v17 row_newbcast:15 row_mask:0xf bank_mask:0xf
v_and_b32_dpp v118, v88, v18 row_newbcast:15 row_mask:0xf bank_mask:0xf
v_and_b32_dpp v119, v88, v19 row_newbcast:15 row_mask:0xf bank_mask:0xf
s_waitcnt vmcnt(11)
v_mfma_f32_16x16x32_bf16 v[108:111], v[112:115], v[40:43], v[108:111]
s_bitcmp1_b32 s47, 2
s_cbranch_scc0 L_th141
s_waitcnt vmcnt(3)
L_th141:
s_waitcnt vmcnt(8)
buffer_load_dwordx4 v[40:43], v2, s[8:11], s45 offen offset:2048 nt
v_and_b32_dpp v112, v89, v16 row_newbcast:0 row_mask:0xf bank_mask:0xf
v_and_b32_dpp v113, v89, v17 row_newbcast:0 row_mask:0xf bank_mask:0xf
v_and_b32_dpp v114, v89, v18 row_newbcast:0 row_mask:0xf bank_mask:0xf
v_and_b32_dpp v115, v89, v19 row_newbcast:0 row_mask:0xf bank_mask:0xf
s_waitcnt vmcnt(11)
v_mfma_f32_16x16x32_bf16 v[108:111], v[116:119], v[44:47], v[108:111]
s_bitcmp1_b32 s47, 2
s_cbranch_scc0 L_th142
s_waitcnt vmcnt(3)
L_th142:
s_waitcnt vmcnt(8)
buffer_load_dwordx4 v[44:47], v2, s[8:11], s45 offen offset:3072
v_and_b32_dpp v116, v89, v16 row_newbcast:4 row_mask:0xf bank_mask:0xf
v_and_b32_dpp v117, v89, v17 row_newbcast:4 row_mask:0xf bank_mask:0xf
v_and_b32_dpp v118, v89, v18 row_newbcast:4 row_mask:0xf bank_mask:0xf
v_and_b32_dpp v119, v89, v19 row_newbcast:4 row_mask:0xf bank_mask:0xf
s_waitcnt vmcnt(11)
v_mfma_f32_16x16x32_bf16 v[108:111], v[112:115], v[48:51], v[108:111]
s_bitcmp1_b32 s47, 2
s_cbranch_scc0 L_th143
s_waitcnt vmcnt(3)
L_th143:
s_waitcnt vmcnt(8)
s_mov_b32 s45, 0x7000
buffer_load_dwordx4 v[48:51], v2, s[8:11], s45 offen offset:0 nt
v_and_b32_dpp v112, v89, v16 row_newbcast:8 row_mask:0xf bank_mask:0xf
v_and_b32_dpp v113, v89, v17 row_newbcast:8 row_mask:0xf bank_mask:0xf
v_and_b32_dpp v114, v89, v18 row_newbcast:8 row_mask:0xf bank_mask:0xf
v_and_b32_dpp v115, v89, v19 row_newbcast:8 row_mask:0xf bank_mask:0xf
s_waitcnt vmcnt(11)
v_mfma_f32_16x16x32_bf16 v[108:111], v[116:119], v[52:55], v[108:111]
s_bitcmp1_b32 s47, 2
s_cbranch_scc0 L_th144
s_waitcnt vmcnt(3)
L_th144:
s_waitcnt vmcnt(8)
buffer_load_dwordx4 v[52:55], v2, s[8:11], s45 offen offset:1024 nt
v_and_b32_dpp v116, v89, v16 row_newbcast:12 row_mask:0xf bank_mask:0xf
v_and_b32_dpp v117, v89, v17 row_newbcast:12 row_mask:0xf bank_mask:0xf
v_and_b32_dpp v118, v89, v18 row_newbcast:12 row_mask:0xf bank_mask:0xf
v_and_b32_dpp v119, v89, v19 row_newbcast:12 row_mask:0xf bank_mask:0xf
s_waitcnt vmcnt(11)
v_mfma_f32_16x16x32_bf16 v[108:111], v[112:115], v[56:59], v[108:111]
s_bitcmp1_b32 s47, 2
s_cbranch_scc0 L_th145
s_waitcnt vmcnt(3)
L_th145:
s_waitcnt vmcnt(8)
buffer_load_dwordx4 v[56:59], v2, s[8:11], s45 offen offset:2048
v_and_b32_dpp v112, v89, v16 row_newbcast:1 row_mask:0xf bank_mask:0xf
v_and_b32_dpp v113, v89, v17 row_newbcast:1 row_mask:0xf bank_mask:0xf
v_and_b32_dpp v114, v89, v18 row_newbcast:1 row_mask:0xf bank_mask:0xf
v_and_b32_dpp v115, v89, v19 row_newbcast:1 row_mask:0xf bank_mask:0xf
s_waitcnt vmcnt(11)
v_mfma_f32_16x16x32_bf16 v[108:111], v[116:119], v[60:63], v[108:111]
s_bitcmp1_b32 s47, 2
s_cbranch_scc0 L_th146
s_waitcnt vmcnt(3)
L_th146:
s_waitcnt vmcnt(8)
buffer_load_dwordx4 v[60:63], v2, s[8:11], s45 offen offset:3072 nt
v_and_b32_dpp v116, v89, v16 row_newbcast:5 row_mask:0xf bank_mask:0xf
v_and_b32_dpp v117, v89, v17 row_newbcast:5 row_mask:0xf bank_mask:0xf
v_and_b32_dpp v118, v89, v18 row_newbcast:5 row_mask:0xf bank_mask:0xf
v_and_b32_dpp v119, v89, v19 row_newbcast:5 row_mask:0xf bank_mask:0xf
s_waitcnt vmcnt(11)
v_mfma_f32_16x16x32_bf16 v[108:111], v[112:115], v[64:67], v[108:111]
s_bitcmp1_b32 s47, 2
s_cbranch_scc0 L_th147
s_waitcnt vmcnt(3)
L_th147:
s_waitcnt vmcnt(8)
s_mov_b32 s45, 0x8000
buffer_load_dwordx4 v[64:67], v2, s[8:11], s45 offen offset:0 nt
v_and_b32_dpp v112, v89, v16 row_newbcast:9 row_mask:0xf bank_mask:0xf
v_and_b32_dpp v113, v89, v17 row_newbcast:9 row_mask:0xf bank_mask:0xf
v_and_b32_dpp v114, v89, v18 row_newbcast:9 row_mask:0xf bank_mask:0xf
v_and_b32_dpp v115, v89, v19 row_newbcast:9 row_mask:0xf bank_mask:0xf
s_waitcnt vmcnt(11)
v_mfma_f32_16x16x32_bf16 v[108:111], v[116:119], v[68:71], v[108:111]
s_bitcmp1_b32 s47, 2
s_cbranch_scc0 L_th148
s_waitcnt vmcnt(3)
L_th148:
s_waitcnt vmcnt(8)
buffer_load_dwordx4 v[68:71], v2, s[8:11], s45 offen offset:1024
v_and_b32_dpp v116, v89, v16 row_newbcast:13 row_mask:0xf bank_mask:0xf
v_and_b32_dpp v117, v89, v17 row_newbcast:13 row_mask:0xf bank_mask:0xf
v_and_b32_dpp v118, v89, v18 row_newbcast:13 row_mask:0xf bank_mask:0xf
v_and_b32_dpp v119, v89, v19 row_newbcast:13 row_mask:0xf bank_mask:0xf
s_waitcnt vmcnt(11)
v_mfma_f32_16x16x32_bf16 v[108:111], v[112:115], v[24:27], v[108:111]
s_bitcmp1_b32 s47, 2
s_cbranch_scc0 L_th149
s_waitcnt vmcnt(3)
L_th149:
s_waitcnt vmcnt(8)
buffer_load_dwordx4 v[24:27], v2, s[8:11], s45 offen offset:2048 nt
v_and_b32_dpp v112, v89, v16 row_newbcast:2 row_mask:0xf bank_mask:0xf
v_and_b32_dpp v113, v89, v17 row_newbcast:2 row_mask:0xf bank_mask:0xf
v_and_b32_dpp v114, v89, v18 row_newbcast:2 row_mask:0xf bank_mask:0xf
v_and_b32_dpp v115, v89, v19 row_newbcast:2 row_mask:0xf bank_mask:0xf
s_waitcnt vmcnt(11)
v_mfma_f32_16x16x32_bf16 v[108:111], v[116:119], v[28:31], v[108:111]
s_bitcmp1_b32 s47, 2
s_cbranch_scc0 L_th150
s_waitcnt vmcnt(3)
L_th150:
s_waitcnt vmcnt(8)
buffer_load_dwordx4 v[28:31], v2, s[8:11], s45 offen offset:3072 nt
v_and_b32_dpp v116, v89, v16 row_newbcast:6 row_mask:0xf bank_mask:0xf
v_and_b32_dpp v117, v89, v17 row_newbcast:6 row_mask:0xf bank_mask:0xf
v_and_b32_dpp v118, v89, v18 row_newbcast:6 row_mask:0xf bank_mask:0xf
v_and_b32_dpp v119, v89, v19 row_newbcast:6 row_mask:0xf bank_mask:0xf
s_waitcnt vmcnt(11)
v_mfma_f32_16x16x32_bf16 v[108:111], v[112:115], v[32:35], v[108:111]
s_bitcmp1_b32 s47, 2
s_cbranch_scc0 L_th151
s_waitcnt vmcnt(3)
L_th151:
s_waitcnt vmcnt(8)
s_mov_b32 s45, 0x9000
buffer_load_dwordx4 v[32:35], v2, s[8:11], s45 offen offset:0
v_and_b32_dpp v112, v89, v16 row_newbcast:10 row_mask:0xf bank_mask:0xf
v_and_b32_dpp v113, v89, v17 row_newbcast:10 row_mask:0xf bank_mask:0xf
v_and_b32_dpp v114, v89, v18 row_newbcast:10 row_mask:0xf bank_mask:0xf
v_and_b32_dpp v115, v89, v19 row_newbcast:10 row_mask:0xf bank_mask:0xf
s_waitcnt vmcnt(11)
v_mfma_f32_16x16x32_bf16 v[108:111], v[116:119], v[36:39], v[108:111]
s_bitcmp1_b32 s47, 2
s_cbranch_scc0 L_th152
s_waitcnt vmcnt(3)
L_th152:
s_waitcnt vmcnt(8)
buffer_load_dwordx4 v[36:39], v2, s[8:11], s45 offen offset:1024 nt
v_and_b32_dpp v116, v89, v16 row_newbcast:14 row_mask:0xf bank_mask:0xf
v_and_b32_dpp v117, v89, v17 row_newbcast:14 row_mask:0xf bank_mask:0xf
v_and_b32_dpp v118, v89, v18 row_newbcast:14 row_mask:0xf bank_mask:0xf
v_and_b32_dpp v119, v89, v19 row_newbcast:14 row_mask:0xf bank_mask:0xf
s_waitcnt vmcnt(11)
v_mfma_f32_16x16x32_bf16 v[108:111], v[112:115], v[40:43], v[108:111]
s_bitcmp1_b32 s47, 2
s_cbranch_scc0 L_th153
s_waitcnt vmcnt(3)
L_th153:
s_waitcnt vmcnt(8)
buffer_load_dwordx4 v[40:43], v2, s[8:11], s45 offen offset:2048 nt
v_and_b32_dpp v112, v89, v16 row_newbcast:3 row_mask:0xf bank_mask:0xf
v_and_b32_dpp v113, v89, v17 row_newbcast:3 row_mask:0xf bank_mask:0xf
v_and_b32_dpp v114, v89, v18 row_newbcast:3 row_mask:0xf bank_mask:0xf
v_and_b32_dpp v115, v89, v19 row_newbcast:3 row_mask:0xf bank_mask:0xf
s_waitcnt vmcnt(11)
v_mfma_f32_16x16x32_bf16 v[108:111], v[116:119], v[44:47], v[108:111]
s_bitcmp1_b32 s47, 2
s_cbranch_scc0 L_th154
s_waitcnt vmcnt(3)
L_th154:
s_waitcnt vmcnt(8)
buffer_load_dwordx4 v[44:47], v2, s[8:11], s45 offen offset:3072
v_and_b32_dpp v116, v89, v16 row_newbcast:7 row_mask:0xf bank_mask:0xf
v_and_b32_dpp v117, v89, v17 row_newbcast:7 row_mask:0xf bank_mask:0xf
v_and_b32_dpp v118, v89, v18 row_newbcast:7 row_mask:0xf bank_mask:0xf
v_and_b32_dpp v119, v89, v19 row_newbcast:7 row_mask:0xf bank_mask:0xf
s_waitcnt vmcnt(11)
v_mfma_f32_16x16x32_bf16 v[108:111], v[112:115], v[48:51], v[108:111]
s_bitcmp1_b32 s47, 2
s_cbranch_scc0 L_th155
s_waitcnt vmcnt(3)
L_th155:
s_waitcnt vmcnt(8)
s_mov_b32 s45, 0xa000
buffer_load_dwordx4 v[48:51], v2, s[8:11], s45 offen offset:0 nt
v_and_b32_dpp v112, v89, v16 row_newbcast:11 row_mask:0xf bank_mask:0xf
v_and_b32_dpp v113, v89, v17 row_newbcast:11 row_mask:0xf bank_mask:0xf
v_and_b32_dpp v114, v89, v18 row_newbcast:11 row_mask:0xf bank_mask:0xf
v_and_b32_dpp v115, v89, v19 row_newbcast:11 row_mask:0xf bank_mask:0xf
s_waitcnt vmcnt(11)
v_mfma_f32_16x16x32_bf16 v[108:111], v[116:119], v[52:55], v[108:111]
s_bitcmp1_b32 s47, 2
s_cbranch_scc0 L_th156
s_waitcnt vmcnt(3)
L_th156:
s_waitcnt vmcnt(8)
buffer_load_dwordx4 v[52:55], v2, s[8:11], s45 offen offset:1024 nt
v_and_b32_dpp v116, v89, v16 row_newbcast:15 row_mask:0xf bank_mask:0xf
v_and_b32_dpp v117, v89, v17 row_newbcast:15 row_mask:0xf bank_mask:0xf
v_and_b32_dpp v118, v89, v18 row_newbcast:15 row_mask:0xf bank_mask:0xf
v_and_b32_dpp v119, v89, v19 row_newbcast:15 row_mask:0xf bank_mask:0xf
s_waitcnt vmcnt(11)
v_mfma_f32_16x16x32_bf16 v[108:111], v[112:115], v[56:59], v[108:111]
s_bitcmp1_b32 s47, 2
s_cbranch_scc0 L_th157
s_waitcnt vmcnt(3)
L_th157:
s_waitcnt vmcnt(8)
buffer_load_dwordx4 v[56:59], v2, s[8:11], s45 offen offset:2048
v_and_b32_dpp v112, v90, v16 row_newbcast:0 row_mask:0xf bank_mask:0xf
v_and_b32_dpp v113, v90, v17 row_newbcast:0 row_mask:0xf bank_mask:0xf
v_and_b32_dpp v114, v90, v18 row_newbcast:0 row_mask:0xf bank_mask:0xf
v_and_b32_dpp v115, v90, v19 row_newbcast:0 row_mask:0xf bank_mask:0xf
s_waitcnt vmcnt(11)
v_mfma_f32_16x16x32_bf16 v[108:111], v[116:119], v[60:63], v[108:111]
s_bitcmp1_b32 s47, 2
s_cbranch_scc0 L_th158
s_waitcnt vmcnt(3)
L_th158:
s_waitcnt vmcnt(8)
buffer_load_dwordx4 v[60:63], v2, s[8:11], s45 offen offset:3072 nt
v_and_b32_dpp v116, v90, v16 row_newbcast:4 row_mask:0xf bank_mask:0xf
v_and_b32_dpp v117, v90, v17 row_newbcast:4 row_mask:0xf bank_mask:0xf
v_and_b32_dpp v118, v90, v18 row_newbcast:4 row_mask:0xf bank_mask:0xf
v_and_b32_dpp v119, v90, v19 row_newbcast:4 row_mask:0xf bank_mask:0xf
s_waitcnt vmcnt(11)
v_mfma_f32_16x16x32_bf16 v[108:111], v[112:115], v[64:67], v[108:111]
s_bitcmp1_b32 s47, 2
s_cbranch_scc0 L_th159
s_waitcnt vmcnt(3)
L_th159:
s_waitcnt vmcnt(8)
s_mov_b32 s45, 0xb000
buffer_load_dwordx4 v[64:67], v2, s[8:11], s45 offen offset:0 nt
v_and_b32_dpp v112, v90, v16 row_newbcast:8 row_mask:0xf bank_mask:0xf
v_and_b32_dpp v113, v90, v17 row_newbcast:8 row_mask:0xf bank_mask:0xf
v_and_b32_dpp v114, v90, v18 row_newbcast:8 row_mask:0xf bank_mask:0xf
v_and_b32_dpp v115, v90, v19 row_newbcast:8 row_mask:0xf bank_mask:0xf
s_waitcnt vmcnt(11)
v_mfma_f32_16x16x32_bf16 v[108:111], v[116:119], v[68:71], v[108:111]
s_bitcmp1_b32 s47, 2
s_cbranch_scc0 L_th160
s_waitcnt vmcnt(3)
L_th160:
s_waitcnt vmcnt(8)
buffer_load_dwordx4 v[68:71], v2, s[8:11], s45 offen offset:1024
v_and_b32_dpp v116, v90, v16 row_newbcast:12 row_mask:0xf bank_mask:0xf
v_and_b32_dpp v117, v90, v17 row_newbcast:12 row_mask:0xf bank_mask:0xf
v_and_b32_dpp v118, v90, v18 row_newbcast:12 row_mask:0xf bank_mask:0xf
v_and_b32_dpp v119, v90, v19 row_newbcast:12 row_mask:0xf bank_mask:0xf
s_waitcnt vmcnt(11)
v_mfma_f32_16x16x32_bf16 v[108:111], v[112:115], v[24:27], v[108:111]
s_bitcmp1_b32 s47, 2
s_cbranch_scc0 L_th161
s_waitcnt vmcnt(3)
L_th161:
s_waitcnt vmcnt(8)
buffer_load_dwordx4 v[24:27], v2, s[8:11], s45 offen offset:2048 nt
v_and_b32_dpp v112, v90, v16 row_newbcast:1 row_mask:0xf bank_mask:0xf
v_and_b32_dpp v113, v90, v17 row_newbcast:1 row_mask:0xf bank_mask:0xf
v_and_b32_dpp v114, v90, v18 row_newbcast:1 row_mask:0xf bank_mask:0xf
v_and_b32_dpp v115, v90, v19 row_newbcast:1 row_mask:0xf bank_mask:0xf
s_waitcnt vmcnt(11)
v_mfma_f32_16x16x32_bf16 v[108:111], v[116:119], v[28:31], v[108:111]
s_bitcmp1_b32 s47, 2
s_cbranch_scc0 L_th162
s_waitcnt vmcnt(3)
L_th162:
s_waitcnt vmcnt(8)
buffer_load_dwordx4 v[28:31], v2, s[8:11], s45 offen offset:3072 nt
v_and_b32_dpp v116, v90, v16 row_newbcast:5 row_mask:0xf bank_mask:0xf
v_and_b32_dpp v117, v90, v17 row_newbcast:5 row_mask:0xf bank_mask:0xf
v_and_b32_dpp v118, v90, v18 row_newbcast:5 row_mask:0xf bank_mask:0xf
v_and_b32_dpp v119, v90, v19 row_newbcast:5 row_mask:0xf bank_mask:0xf
s_waitcnt vmcnt(11)
v_mfma_f32_16x16x32_bf16 v[108:111], v[112:115], v[32:35], v[108:111]
s_bitcmp1_b32 s47, 2
s_cbranch_scc0 L_th163
s_waitcnt vmcnt(3)
L_th163:
s_waitcnt vmcnt(8)
s_mov_b32 s45, 0xc000
buffer_load_dwordx4 v[32:35], v2, s[8:11], s45 offen offset:0
v_and_b32_dpp v112, v90, v16 row_newbcast:9 row_mask:0xf bank_mask:0xf
v_and_b32_dpp v113, v90, v17 row_newbcast:9 row_mask:0xf bank_mask:0xf
v_and_b32_dpp v114, v90, v18 row_newbcast:9 row_mask:0xf bank_mask:0xf
v_and_b32_dpp v115, v90, v19 row_newbcast:9 row_mask:0xf bank_mask:0xf
s_waitcnt vmcnt(11)
v_mfma_f32_16x16x32_bf16 v[108:111], v[116:119], v[36:39], v[108:111]
s_bitcmp1_b32 s47, 2
s_cbranch_scc0 L_th164
s_waitcnt vmcnt(3)
L_th164:
s_waitcnt vmcnt(8)
buffer_load_dwordx4 v[36:39], v2, s[8:11], s45 offen offset:1024 nt
v_and_b32_dpp v116, v90, v16 row_newbcast:13 row_mask:0xf bank_mask:0xf
v_and_b32_dpp v117, v90, v17 row_newbcast:13 row_mask:0xf bank_mask:0xf
v_and_b32_dpp v118, v90, v18 row_newbcast:13 row_mask:0xf bank_mask:0xf
v_and_b32_dpp v119, v90, v19 row_newbcast:13 row_mask:0xf bank_mask:0xf
s_waitcnt vmcnt(11)
v_mfma_f32_16x16x32_bf16 v[108:111], v[112:115], v[40:43], v[108:111]
s_bitcmp1_b32 s47, 2
s_cbranch_scc0 L_th165
s_waitcnt vmcnt(3)
L_th165:
s_waitcnt vmcnt(8)
buffer_load_dwordx4 v[40:43], v2, s[8:11], s45 offen offset:2048 nt
v_and_b32_dpp v112, v90, v16 row_newbcast:2 row_mask:0xf bank_mask:0xf
v_and_b32_dpp v113, v90, v17 row_newbcast:2 row_mask:0xf bank_mask:0xf
v_and_b32_dpp v114, v90, v18 row_newbcast:2 row_mask:0xf bank_mask:0xf
v_and_b32_dpp v115, v90, v19 row_newbcast:2 row_mask:0xf bank_mask:0xf
s_waitcnt vmcnt(11)
v_mfma_f32_16x16x32_bf16 v[108:111], v[116:119], v[44:47], v[108:111]
s_bitcmp1_b32 s47, 2
s_cbranch_scc0 L_th166
s_waitcnt vmcnt(3)
L_th166:
s_waitcnt vmcnt(8)
buffer_load_dwordx4 v[44:47], v2, s[8:11], s45 offen offset:3072
v_and_b32_dpp v116, v90, v16 row_newbcast:6 row_mask:0xf bank_mask:0xf
v_and_b32_dpp v117, v90, v17 row_newbcast:6 row_mask:0xf bank_mask:0xf
v_and_b32_dpp v118, v90, v18 row_newbcast:6 row_mask:0xf bank_mask:0xf
v_and_b32_dpp v119, v90, v19 row_newbcast:6 row_mask:0xf bank_mask:0xf
s_waitcnt vmcnt(11)
v_mfma_f32_16x16x32_bf16 v[108:111], v[112:115], v[48:51], v[108:111]
s_bitcmp1_b32 s47, 2
s_cbranch_scc0 L_th167
s_waitcnt vmcnt(3)
L_th167:
s_waitcnt vmcnt(8)
s_mov_b32 s45, 0xd000
buffer_load_dwordx4 v[48:51], v2, s[8:11], s45 offen offset:0 nt
v_and_b32_dpp v112, v90, v16 row_newbcast:10 row_mask:0xf bank_mask:0xf
v_and_b32_dpp v113, v90, v17 row_newbcast:10 row_mask:0xf bank_mask:0xf
v_and_b32_dpp v114, v90, v18 row_newbcast:10 row_mask:0xf bank_mask:0xf
v_and_b32_dpp v115, v90, v19 row_newbcast:10 row_mask:0xf bank_mask:0xf
s_waitcnt vmcnt(11)
v_mfma_f32_16x16x32_bf16 v[108:111], v[116:119], v[52:55], v[108:111]
s_bitcmp1_b32 s47, 2
s_cbranch_scc0 L_th168
s_waitcnt vmcnt(3)
L_th168:
s_waitcnt vmcnt(8)
buffer_load_dwordx4 v[52:55], v2, s[8:11], s45 offen offset:1024 nt
v_and_b32_dpp v116, v90, v16 row_newbcast:14 row_mask:0xf bank_mask:0xf
v_and_b32_dpp v117, v90, v17 row_newbcast:14 row_mask:0xf bank_mask:0xf
v_and_b32_dpp v118, v90, v18 row_newbcast:14 row_mask:0xf bank_mask:0xf
v_and_b32_dpp v119, v90, v19 row_newbcast:14 row_mask:0xf bank_mask:0xf
s_waitcnt vmcnt(11)
v_mfma_f32_16x16x32_bf16 v[108:111], v[112:115], v[56:59], v[108:111]
s_bitcmp1_b32 s47, 2
s_cbranch_scc0 L_th169
s_waitcnt vmcnt(3)
L_th169:
s_waitcnt vmcnt(8)
buffer_load_dwordx4 v[56:59], v2, s[8:11], s45 offen offset:2048
v_and_b32_dpp v112, v90, v16 row_newbcast:3 row_mask:0xf bank_mask:0xf
v_and_b32_dpp v113, v90, v17 row_newbcast:3 row_mask:0xf bank_mask:0xf
v_and_b32_dpp v114, v90, v18 row_newbcast:3 row_mask:0xf bank_mask:0xf
v_and_b32_dpp v115, v90, v19 row_newbcast:3 row_mask:0xf bank_mask:0xf
s_waitcnt vmcnt(11)
v_mfma_f32_16x16x32_bf16 v[108:111], v[116:119], v[60:63], v[108:111]
s_bitcmp1_b32 s47, 2
s_cbranch_scc0 L_th170
s_waitcnt vmcnt(3)
L_th170:
s_waitcnt vmcnt(8)
buffer_load_dwordx4 v[60:63], v2, s[8:11], s45 offen offset:3072 nt
v_and_b32_dpp v116, v90, v16 row_newbcast:7 row_mask:0xf bank_mask:0xf
v_and_b32_dpp v117, v90, v17 row_newbcast:7 row_mask:0xf bank_mask:0xf
v_and_b32_dpp v118, v90, v18 row_newbcast:7 row_mask:0xf bank_mask:0xf
v_and_b32_dpp v119, v90, v19 row_newbcast:7 row_mask:0xf bank_mask:0xf
s_waitcnt vmcnt(11)
v_mfma_f32_16x16x32_bf16 v[108:111], v[112:115], v[64:67], v[108:111]
s_bitcmp1_b32 s47, 2
s_cbranch_scc0 L_th171
s_waitcnt vmcnt(3)
L_th171:
s_waitcnt vmcnt(8)
s_mov_b32 s45, 0xe000
buffer_load_dwordx4 v[64:67], v2, s[8:11], s45 offen offset:0 nt
v_and_b32_dpp v112, v90, v16 row_newbcast:11 row_mask:0xf bank_mask:0xf
v_and_b32_dpp v113, v90, v17 row_newbcast:11 row_mask:0xf bank_mask:0xf
v_and_b32_dpp v114, v90, v18 row_newbcast:11 row_mask:0xf bank_mask:0xf
v_and_b32_dpp v115, v90, v19 row_newbcast:11 row_mask:0xf bank_mask:0xf
s_waitcnt vmcnt(11)
v_mfma_f32_16x16x32_bf16 v[108:111], v[116:119], v[68:71], v[108:111]
s_bitcmp1_b32 s47, 2
s_cbranch_scc0 L_th172
s_waitcnt vmcnt(3)
L_th172:
s_waitcnt vmcnt(8)
buffer_load_dwordx4 v[68:71], v2, s[8:11], s45 offen offset:1024
v_and_b32_dpp v116, v90, v16 row_newbcast:15 row_mask:0xf bank_mask:0xf
v_and_b32_dpp v117, v90, v17 row_newbcast:15 row_mask:0xf bank_mask:0xf
v_and_b32_dpp v118, v90, v18 row_newbcast:15 row_mask:0xf bank_mask:0xf
v_and_b32_dpp v119, v90, v19 row_newbcast:15 row_mask:0xf bank_mask:0xf
s_waitcnt vmcnt(11)
v_mfma_f32_16x16x32_bf16 v[108:111], v[112:115], v[24:27], v[108:111]
s_bitcmp1_b32 s47, 2
s_cbranch_scc0 L_th173
s_waitcnt vmcnt(3)
L_th173:
s_waitcnt vmcnt(8)
buffer_load_dwordx4 v[24:27], v2, s[8:11], s45 offen offset:2048 nt
v_and_b32_dpp v112, v91, v16 row_newbcast:0 row_mask:0xf bank_mask:0xf
v_and_b32_dpp v113, v91, v17 row_newbcast:0 row_mask:0xf bank_mask:0xf
v_and_b32_dpp v114, v91, v18 row_newbcast:0 row_mask:0xf bank_mask:0xf
v_and_b32_dpp v115, v91, v19 row_newbcast:0 row_mask:0xf bank_mask:0xf
s_waitcnt vmcnt(11)
v_mfma_f32_16x16x32_bf16 v[108:111], v[116:119], v[28:31], v[108:111]
s_bitcmp1_b32 s47, 2
s_cbranch_scc0 L_th174
s_waitcnt vmcnt(3)
L_th174:
s_waitcnt vmcnt(8)
buffer_load_dwordx4 v[28:31], v2, s[8:11], s45 offen offset:3072 nt
v_and_b32_dpp v116, v91, v16 row_newbcast:4 row_mask:0xf bank_mask:0xf
v_and_b32_dpp v117, v91, v17 row_newbcast:4 row_mask:0xf bank_mask:0xf
v_and_b32_dpp v118, v91, v18 row_newbcast:4 row_mask:0xf bank_mask:0xf
v_and_b32_dpp v119, v91, v19 row_newbcast:4 row_mask:0xf bank_mask:0xf
s_waitcnt vmcnt(11)
v_mfma_f32_16x16x32_bf16 v[108:111], v[112:115], v[32:35], v[108:111]
s_bitcmp1_b32 s47, 2
s_cbranch_scc0 L_th175
s_waitcnt vmcnt(3)
L_th175:
s_waitcnt vmcnt(8)
s_mov_b32 s45, 0xf000
buffer_load_dwordx4 v[32:35], v2, s[8:11], s45 offen offset:0
v_and_b32_dpp v112, v91, v16 row_newbcast:8 row_mask:0xf bank_mask:0xf
v_and_b32_dpp v113, v91, v17 row_newbcast:8 row_mask:0xf bank_mask:0xf
v_and_b32_dpp v114, v91, v18 row_newbcast:8 row_mask:0xf bank_mask:0xf
v_and_b32_dpp v115, v91, v19 row_newbcast:8 row_mask:0xf bank_mask:0xf
s_waitcnt vmcnt(11)
v_mfma_f32_16x16x32_bf16 v[108:111], v[116:119], v[36:39], v[108:111]
s_bitcmp1_b32 s47, 2
s_cbranch_scc0 L_th176
s_waitcnt vmcnt(3)
L_th176:
s_waitcnt vmcnt(8)
buffer_load_dwordx4 v[36:39], v2, s[8:11], s45 offen offset:1024 nt
v_and_b32_dpp v116, v91, v16 row_newbcast:12 row_mask:0xf bank_mask:0xf
v_and_b32_dpp v117, v91, v17 row_newbcast:12 row_mask:0xf bank_mask:0xf
v_and_b32_dpp v118, v91, v18 row_newbcast:12 row_mask:0xf bank_mask:0xf
v_and_b32_dpp v119, v91, v19 row_newbcast:12 row_mask:0xf bank_mask:0xf
s_waitcnt vmcnt(11)
v_mfma_f32_16x16x32_bf16 v[108:111], v[112:115], v[40:43], v[108:111]
s_bitcmp1_b32 s47, 2
s_cbranch_scc0 L_th177
s_waitcnt vmcnt(3)
L_th177:
s_waitcnt vmcnt(8)
buffer_load_dwordx4 v[40:43], v2, s[8:11], s45 offen offset:2048 nt
v_and_b32_dpp v112, v91, v16 row_newbcast:1 row_mask:0xf bank_mask:0xf
v_and_b32_dpp v113, v91, v17 row_newbcast:1 row_mask:0xf bank_mask:0xf
v_and_b32_dpp v114, v91, v18 row_newbcast:1 row_mask:0xf bank_mask:0xf
v_and_b32_dpp v115, v91, v19 row_newbcast:1 row_mask:0xf bank_mask:0xf
s_waitcnt vmcnt(11)
v_mfma_f32_16x16x32_bf16 v[108:111], v[116:119], v[44:47], v[108:111]
s_bitcmp1_b32 s47, 2
s_cbranch_scc0 L_th178
s_waitcnt vmcnt(3)
L_th178:
s_waitcnt vmcnt(8)
buffer_load_dwordx4 v[44:47], v2, s[8:11], s45 offen offset:3072
v_and_b32_dpp v116, v91, v16 row_newbcast:5 row_mask:0xf bank_mask:0xf
v_and_b32_dpp v117, v91, v17 row_newbcast:5 row_mask:0xf bank_mask:0xf
v_and_b32_dpp v118, v91, v18 row_newbcast:5 row_mask:0xf bank_mask:0xf
v_and_b32_dpp v119, v91, v19 row_newbcast:5 row_mask:0xf bank_mask:0xf
s_waitcnt vmcnt(11)
v_mfma_f32_16x16x32_bf16 v[108:111], v[112:115], v[48:51], v[108:111]
s_bitcmp1_b32 s47, 2
s_cbranch_scc0 L_th179
s_waitcnt vmcnt(3)
L_th179:
s_waitcnt vmcnt(8)
s_mov_b32 s45, 0x10000
buffer_load_dwordx4 v[48:51], v2, s[8:11], s45 offen offset:0 nt
v_and_b32_dpp v112, v91, v16 row_newbcast:9 row_mask:0xf bank_mask:0xf
v_and_b32_dpp v113, v91, v17 row_newbcast:9 row_mask:0xf bank_mask:0xf
v_and_b32_dpp v114, v91, v18 row_newbcast:9 row_mask:0xf bank_mask:0xf
v_and_b32_dpp v115, v91, v19 row_newbcast:9 row_mask:0xf bank_mask:0xf
s_waitcnt vmcnt(11)
v_mfma_f32_16x16x32_bf16 v[108:111], v[116:119], v[52:55], v[108:111]
s_bitcmp1_b32 s47, 2
s_cbranch_scc0 L_th180
s_waitcnt vmcnt(3)
L_th180:
s_waitcnt vmcnt(8)
buffer_load_dwordx4 v[52:55], v2, s[8:11], s45 offen offset:1024 nt
v_and_b32_dpp v116, v91, v16 row_newbcast:13 row_mask:0xf bank_mask:0xf
v_and_b32_dpp v117, v91, v17 row_newbcast:13 row_mask:0xf bank_mask:0xf
v_and_b32_dpp v118, v91, v18 row_newbcast:13 row_mask:0xf bank_mask:0xf
v_and_b32_dpp v119, v91, v19 row_newbcast:13 row_mask:0xf bank_mask:0xf
s_waitcnt vmcnt(11)
v_mfma_f32_16x16x32_bf16 v[108:111], v[112:115], v[56:59], v[108:111]
s_bitcmp1_b32 s47, 2
s_cbranch_scc0 L_th181
s_waitcnt vmcnt(3)
L_th181:
s_waitcnt vmcnt(8)
buffer_load_dwordx4 v[56:59], v2, s[8:11], s45 offen offset:2048
v_and_b32_dpp v112, v91, v16 row_newbcast:2 row_mask:0xf bank_mask:0xf
v_and_b32_dpp v113, v91, v17 row_newbcast:2 row_mask:0xf bank_mask:0xf
v_and_b32_dpp v114, v91, v18 row_newbcast:2 row_mask:0xf bank_mask:0xf
v_and_b32_dpp v115, v91, v19 row_newbcast:2 row_mask:0xf bank_mask:0xf
s_waitcnt vmcnt(11)
v_mfma_f32_16x16x32_bf16 v[108:111], v[116:119], v[60:63], v[108:111]
s_bitcmp1_b32 s47, 2
s_cbranch_scc0 L_th182
s_waitcnt vmcnt(3)
L_th182:
s_waitcnt vmcnt(8)
buffer_load_dwordx4 v[60:63], v2, s[8:11], s45 offen offset:3072 nt
v_and_b32_dpp v116, v91, v16 row_newbcast:6 row_mask:0xf bank_mask:0xf
v_and_b32_dpp v117, v91, v17 row_newbcast:6 row_mask:0xf bank_mask:0xf
v_and_b32_dpp v118, v91, v18 row_newbcast:6 row_mask:0xf bank_mask:0xf
v_and_b32_dpp v119, v91, v19 row_newbcast:6 row_mask:0xf bank_mask:0xf
s_waitcnt vmcnt(11)
v_mfma_f32_16x16x32_bf16 v[108:111], v[112:115], v[64:67], v[108:111]
s_bitcmp1_b32 s47, 2
s_cbranch_scc0 L_th183
s_waitcnt vmcnt(3)
L_th183:
s_waitcnt vmcnt(8)
s_mov_b32 s45, 0x11000
buffer_load_dwordx4 v[64:67], v2, s[8:11], s45 offen offset:0 nt
v_and_b32_dpp v112, v91, v16 row_newbcast:10 row_mask:0xf bank_mask:0xf
v_and_b32_dpp v113, v91, v17 row_newbcast:10 row_mask:0xf bank_mask:0xf
v_and_b32_dpp v114, v91, v18 row_newbcast:10 row_mask:0xf bank_mask:0xf
v_and_b32_dpp v115, v91, v19 row_newbcast:10 row_mask:0xf bank_mask:0xf
s_waitcnt vmcnt(11)
v_mfma_f32_16x16x32_bf16 v[108:111], v[116:119], v[68:71], v[108:111]
s_bitcmp1_b32 s47, 2
s_cbranch_scc0 L_th184
s_waitcnt vmcnt(3)
L_th184:
s_waitcnt vmcnt(8)
buffer_load_dwordx4 v[68:71], v2, s[8:11], s45 offen offset:1024
v_and_b32_dpp v116, v91, v16 row_newbcast:14 row_mask:0xf bank_mask:0xf
v_and_b32_dpp v117, v91, v17 row_newbcast:14 row_mask:0xf bank_mask:0xf
v_and_b32_dpp v118, v91, v18 row_newbcast:14 row_mask:0xf bank_mask:0xf
v_and_b32_dpp v119, v91, v19 row_newbcast:14 row_mask:0xf bank_mask:0xf
s_waitcnt vmcnt(11)
v_mfma_f32_16x16x32_bf16 v[108:111], v[112:115], v[24:27], v[108:111]
s_bitcmp1_b32 s47, 2
s_cbranch_scc0 L_th185
s_waitcnt vmcnt(3)
L_th185:
s_waitcnt vmcnt(8)
buffer_load_dwordx4 v[24:27], v2, s[8:11], s45 offen offset:2048 nt
v_and_b32_dpp v112, v91, v16 row_newbcast:3 row_mask:0xf bank_mask:0xf
v_and_b32_dpp v113, v91, v17 row_newbcast:3 row_mask:0xf bank_mask:0xf
v_and_b32_dpp v114, v91, v18 row_newbcast:3 row_mask:0xf bank_mask:0xf
v_and_b32_dpp v115, v91, v19 row_newbcast:3 row_mask:0xf bank_mask:0xf
s_waitcnt vmcnt(11)
v_mfma_f32_16x16x32_bf16 v[108:111], v[116:119], v[28:31], v[108:111]
s_bitcmp1_b32 s47, 2
s_cbranch_scc0 L_th186
s_waitcnt vmcnt(3)
L_th186:
s_waitcnt vmcnt(8)
buffer_load_dwordx4 v[28:31], v2, s[8:11], s45 offen offset:3072 nt
v_and_b32_dpp v116, v91, v16 row_newbcast:7 row_mask:0xf bank_mask:0xf
v_and_b32_dpp v117, v91, v17 row_newbcast:7 row_mask:0xf bank_mask:0xf
v_and_b32_dpp v118, v91, v18 row_newbcast:7 row_mask:0xf bank_mask:0xf
v_and_b32_dpp v119, v91, v19 row_newbcast:7 row_mask:0xf bank_mask:0xf
s_waitcnt vmcnt(11)
v_mfma_f32_16x16x32_bf16 v[108:111], v[112:115], v[32:35], v[108:111]
s_bitcmp1_b32 s47, 2
s_cbranch_scc0 L_th187
s_waitcnt vmcnt(3)
L_th187:
s_waitcnt vmcnt(8)
s_mov_b32 s45, 0x12000
buffer_load_dwordx4 v[32:35], v2, s[8:11], s45 offen offset:0
v_and_b32_dpp v112, v91, v16 row_newbcast:11 row_mask:0xf bank_mask:0xf
v_and_b32_dpp v113, v91, v17 row_newbcast:11 row_mask:0xf bank_mask:0xf
v_and_b32_dpp v114, v91, v18 row_newbcast:11 row_mask:0xf bank_mask:0xf
v_and_b32_dpp v115, v91, v19 row_newbcast:11 row_mask:0xf bank_mask:0xf
s_waitcnt vmcnt(11)
v_mfma_f32_16x16x32_bf16 v[108:111], v[116:119], v[36:39], v[108:111]
s_bitcmp1_b32 s47, 2
s_cbranch_scc0 L_th188
s_waitcnt vmcnt(3)
L_th188:
s_waitcnt vmcnt(8)
buffer_load_dwordx4 v[36:39], v2, s[8:11], s45 offen offset:1024 nt
v_and_b32_dpp v116, v91, v16 row_newbcast:15 row_mask:0xf bank_mask:0xf
v_and_b32_dpp v117, v91, v17 row_newbcast:15 row_mask:0xf bank_mask:0xf
v_and_b32_dpp v118, v91, v18 row_newbcast:15 row_mask:0xf bank_mask:0xf
v_and_b32_dpp v119, v91, v19 row_newbcast:15 row_mask:0xf bank_mask:0xf
s_waitcnt vmcnt(11)
v_mfma_f32_16x16x32_bf16 v[108:111], v[112:115], v[40:43], v[108:111]
s_bitcmp1_b32 s47, 2
s_cbranch_scc0 L_th189
s_waitcnt vmcnt(3)
L_th189:
s_waitcnt vmcnt(8)
buffer_load_dwordx4 v[40:43], v2, s[8:11], s45 offen offset:2048 nt
v_and_b32_dpp v112, v92, v16 row_newbcast:0 row_mask:0xf bank_mask:0xf
v_and_b32_dpp v113, v92, v17 row_newbcast:0 row_mask:0xf bank_mask:0xf
v_and_b32_dpp v114, v92, v18 row_newbcast:0 row_mask:0xf bank_mask:0xf
v_and_b32_dpp v115, v92, v19 row_newbcast:0 row_mask:0xf bank_mask:0xf
s_waitcnt vmcnt(11)
v_mfma_f32_16x16x32_bf16 v[108:111], v[116:119], v[44:47], v[108:111]
s_bitcmp1_b32 s47, 2
s_cbranch_scc0 L_th190
s_waitcnt vmcnt(3)
L_th190:
s_waitcnt vmcnt(8)
buffer_load_dwordx4 v[44:47], v2, s[8:11], s45 offen offset:3072
v_and_b32_dpp v116, v92, v16 row_newbcast:4 row_mask:0xf bank_mask:0xf
v_and_b32_dpp v117, v92, v17 row_newbcast:4 row_mask:0xf bank_mask:0xf
v_and_b32_dpp v118, v92, v18 row_newbcast:4 row_mask:0xf bank_mask:0xf
v_and_b32_dpp v119, v92, v19 row_newbcast:4 row_mask:0xf bank_mask:0xf
s_waitcnt vmcnt(11)
v_mfma_f32_16x16x32_bf16 v[108:111], v[112:115], v[48:51], v[108:111]
s_bitcmp1_b32 s47, 2
s_cbranch_scc0 L_th191
s_waitcnt vmcnt(3)
L_th191:
s_waitcnt vmcnt(8)
s_mov_b32 s45, 0x13000
buffer_load_dwordx4 v[48:51], v2, s[8:11], s45 offen offset:0 nt
v_and_b32_dpp v112, v92, v16 row_newbcast:8 row_mask:0xf bank_mask:0xf
v_and_b32_dpp v113, v92, v17 row_newbcast:8 row_mask:0xf bank_mask:0xf
v_and_b32_dpp v114, v92, v18 row_newbcast:8 row_mask:0xf bank_mask:0xf
v_and_b32_dpp v115, v92, v19 row_newbcast:8 row_mask:0xf bank_mask:0xf
s_waitcnt vmcnt(11)
v_mfma_f32_16x16x32_bf16 v[108:111], v[116:119], v[52:55], v[108:111]
s_bitcmp1_b32 s47, 2
s_cbranch_scc0 L_th192
s_waitcnt vmcnt(3)
L_th192:
s_waitcnt vmcnt(8)
buffer_load_dwordx4 v[52:55], v2, s[8:11], s45 offen offset:1024 nt
v_and_b32_dpp v116, v92, v16 row_newbcast:12 row_mask:0xf bank_mask:0xf
v_and_b32_dpp v117, v92, v17 row_newbcast:12 row_mask:0xf bank_mask:0xf
v_and_b32_dpp v118, v92, v18 row_newbcast:12 row_mask:0xf bank_mask:0xf
v_and_b32_dpp v119, v92, v19 row_newbcast:12 row_mask:0xf bank_mask:0xf
s_waitcnt vmcnt(11)
v_mfma_f32_16x16x32_bf16 v[108:111], v[112:115], v[56:59], v[108:111]
s_bitcmp1_b32 s47, 2
s_cbranch_scc0 L_th193
s_waitcnt vmcnt(3)
L_th193:
s_waitcnt vmcnt(8)
buffer_load_dwordx4 v[56:59], v2, s[8:11], s45 offen offset:2048
v_and_b32_dpp v112, v92, v16 row_newbcast:1 row_mask:0xf bank_mask:0xf
v_and_b32_dpp v113, v92, v17 row_newbcast:1 row_mask:0xf bank_mask:0xf
v_and_b32_dpp v114, v92, v18 row_newbcast:1 row_mask:0xf bank_mask:0xf
v_and_b32_dpp v115, v92, v19 row_newbcast:1 row_mask:0xf bank_mask:0xf
s_waitcnt vmcnt(11)
v_mfma_f32_16x16x32_bf16 v[108:111], v[116:119], v[60:63], v[108:111]
s_bitcmp1_b32 s47, 2
s_cbranch_scc0 L_th194
s_waitcnt vmcnt(3)
L_th194:
s_waitcnt vmcnt(8)
buffer_load_dwordx4 v[60:63], v2, s[8:11], s45 offen offset:3072 nt
v_and_b32_dpp v116, v92, v16 row_newbcast:5 row_mask:0xf bank_mask:0xf
v_and_b32_dpp v117, v92, v17 row_newbcast:5 row_mask:0xf bank_mask:0xf
v_and_b32_dpp v118, v92, v18 row_newbcast:5 row_mask:0xf bank_mask:0xf
v_and_b32_dpp v119, v92, v19 row_newbcast:5 row_mask:0xf bank_mask:0xf
s_waitcnt vmcnt(11)
v_mfma_f32_16x16x32_bf16 v[108:111], v[112:115], v[64:67], v[108:111]
s_bitcmp1_b32 s47, 2
s_cbranch_scc0 L_th195
s_waitcnt vmcnt(3)
L_th195:
s_waitcnt vmcnt(8)
s_mov_b32 s45, 0x14000
buffer_load_dwordx4 v[64:67], v2, s[8:11], s45 offen offset:0 nt
v_and_b32_dpp v112, v92, v16 row_newbcast:9 row_mask:0xf bank_mask:0xf
v_and_b32_dpp v113, v92, v17 row_newbcast:9 row_mask:0xf bank_mask:0xf
v_and_b32_dpp v114, v92, v18 row_newbcast:9 row_mask:0xf bank_mask:0xf
v_and_b32_dpp v115, v92, v19 row_newbcast:9 row_mask:0xf bank_mask:0xf
s_waitcnt vmcnt(11)
v_mfma_f32_16x16x32_bf16 v[108:111], v[116:119], v[68:71], v[108:111]
s_bitcmp1_b32 s47, 2
s_cbranch_scc0 L_th196
s_waitcnt vmcnt(3)
L_th196:
s_waitcnt vmcnt(8)
buffer_load_dwordx4 v[68:71], v2, s[8:11], s45 offen offset:1024
v_and_b32_dpp v116, v92, v16 row_newbcast:13 row_mask:0xf bank_mask:0xf
v_and_b32_dpp v117, v92, v17 row_newbcast:13 row_mask:0xf bank_mask:0xf
v_and_b32_dpp v118, v92, v18 row_newbcast:13 row_mask:0xf bank_mask:0xf
v_and_b32_dpp v119, v92, v19 row_newbcast:13 row_mask:0xf bank_mask:0xf
s_waitcnt vmcnt(11)
v_mfma_f32_16x16x32_bf16 v[108:111], v[112:115], v[24:27], v[108:111]
s_bitcmp1_b32 s47, 2
s_cbranch_scc0 L_th197
s_waitcnt vmcnt(3)
L_th197:
s_waitcnt vmcnt(8)
buffer_load_dwordx4 v[24:27], v2, s[8:11], s45 offen offset:2048 nt
v_and_b32_dpp v112, v92, v16 row_newbcast:2 row_mask:0xf bank_mask:0xf
v_and_b32_dpp v113, v92, v17 row_newbcast:2 row_mask:0xf bank_mask:0xf
v_and_b32_dpp v114, v92, v18 row_newbcast:2 row_mask:0xf bank_mask:0xf
v_and_b32_dpp v115, v92, v19 row_newbcast:2 row_mask:0xf bank_mask:0xf
s_waitcnt vmcnt(11)
v_mfma_f32_16x16x32_bf16 v[108:111], v[116:119], v[28:31], v[108:111]
s_bitcmp1_b32 s47, 2
s_cbranch_scc0 L_th198
s_waitcnt vmcnt(3)
L_th198:
s_waitcnt vmcnt(8)
buffer_load_dwordx4 v[28:31], v2, s[8:11], s45 offen offset:3072 nt
v_and_b32_dpp v116, v92, v16 row_newbcast:6 row_mask:0xf bank_mask:0xf
v_and_b32_dpp v117, v92, v17 row_newbcast:6 row_mask:0xf bank_mask:0xf
v_and_b32_dpp v118, v92, v18 row_newbcast:6 row_mask:0xf bank_mask:0xf
v_and_b32_dpp v119, v92, v19 row_newbcast:6 row_mask:0xf bank_mask:0xf
s_waitcnt vmcnt(11)
v_mfma_f32_16x16x32_bf16 v[108:111], v[112:115], v[32:35], v[108:111]
s_bitcmp1_b32 s47, 2
s_cbranch_scc0 L_th199
s_waitcnt vmcnt(3)
L_th199:
s_waitcnt vmcnt(8)
s_mov_b32 s45, 0x15000
buffer_load_dwordx4 v[32:35], v2, s[8:11], s45 offen offset:0
v_and_b32_dpp v112, v92, v16 row_newbcast:10 row_mask:0xf bank_mask:0xf
v_and_b32_dpp v113, v92, v17 row_newbcast:10 row_mask:0xf bank_mask:0xf
v_and_b32_dpp v114, v92, v18 row_newbcast:10 row_mask:0xf bank_mask:0xf
v_and_b32_dpp v115, v92, v19 row_newbcast:10 row_mask:0xf bank_mask:0xf
s_waitcnt vmcnt(11)
v_mfma_f32_16x16x32_bf16 v[108:111], v[116:119], v[36:39], v[108:111]
s_bitcmp1_b32 s47, 2
s_cbranch_scc0 L_th200
s_waitcnt vmcnt(3)
L_th200:
s_waitcnt vmcnt(8)
buffer_load_dwordx4 v[36:39], v2, s[8:11], s45 offen offset:1024 nt
v_and_b32_dpp v116, v92, v16 row_newbcast:14 row_mask:0xf bank_mask:0xf
v_and_b32_dpp v117, v92, v17 row_newbcast:14 row_mask:0xf bank_mask:0xf
v_and_b32_dpp v118, v92, v18 row_newbcast:14 row_mask:0xf bank_mask:0xf
v_and_b32_dpp v119, v92, v19 row_newbcast:14 row_mask:0xf bank_mask:0xf
s_waitcnt vmcnt(11)
v_mfma_f32_16x16x32_bf16 v[108:111], v[112:115], v[40:43], v[108:111]
s_bitcmp1_b32 s47, 2
s_cbranch_scc0 L_th201
s_waitcnt vmcnt(3)
L_th201:
s_waitcnt vmcnt(8)
buffer_load_dwordx4 v[40:43], v2, s[8:11], s45 offen offset:2048 nt
v_and_b32_dpp v112, v92, v16 row_newbcast:3 row_mask:0xf bank_mask:0xf
v_and_b32_dpp v113, v92, v17 row_newbcast:3 row_mask:0xf bank_mask:0xf
v_and_b32_dpp v114, v92, v18 row_newbcast:3 row_mask:0xf bank_mask:0xf
v_and_b32_dpp v115, v92, v19 row_newbcast:3 row_mask:0xf bank_mask:0xf
s_waitcnt vmcnt(11)
v_mfma_f32_16x16x32_bf16 v[108:111], v[116:119], v[44:47], v[108:111]
s_bitcmp1_b32 s47, 2
s_cbranch_scc0 L_th202
s_waitcnt vmcnt(3)
L_th202:
s_waitcnt vmcnt(8)
buffer_load_dwordx4 v[44:47], v2, s[8:11], s45 offen offset:3072
v_and_b32_dpp v116, v92, v16 row_newbcast:7 row_mask:0xf bank_mask:0xf
v_and_b32_dpp v117, v92, v17 row_newbcast:7 row_mask:0xf bank_mask:0xf
v_and_b32_dpp v118, v92, v18 row_newbcast:7 row_mask:0xf bank_mask:0xf
v_and_b32_dpp v119, v92, v19 row_newbcast:7 row_mask:0xf bank_mask:0xf
s_waitcnt vmcnt(11)
v_mfma_f32_16x16x32_bf16 v[108:111], v[112:115], v[48:51], v[108:111]
s_bitcmp1_b32 s47, 2
s_cbranch_scc0 L_th203
s_waitcnt vmcnt(3)
L_th203:
s_waitcnt vmcnt(8)
s_mov_b32 s45, 0x16000
buffer_load_dwordx4 v[48:51], v2, s[8:11], s45 offen offset:0 nt
v_and_b32_dpp v112, v92, v16 row_newbcast:11 row_mask:0xf bank_mask:0xf
v_and_b32_dpp v113, v92, v17 row_newbcast:11 row_mask:0xf bank_mask:0xf
v_and_b32_dpp v114, v92, v18 row_newbcast:11 row_mask:0xf bank_mask:0xf
v_and_b32_dpp v115, v92, v19 row_newbcast:11 row_mask:0xf bank_mask:0xf
s_waitcnt vmcnt(11)
v_mfma_f32_16x16x32_bf16 v[108:111], v[116:119], v[52:55], v[108:111]
s_bitcmp1_b32 s47, 2
s_cbranch_scc0 L_th204
s_waitcnt vmcnt(3)
L_th204:
s_waitcnt vmcnt(8)
buffer_load_dwordx4 v[52:55], v2, s[8:11], s45 offen offset:1024 nt
v_and_b32_dpp v116, v92, v16 row_newbcast:15 row_mask:0xf bank_mask:0xf
v_and_b32_dpp v117, v92, v17 row_newbcast:15 row_mask:0xf bank_mask:0xf
v_and_b32_dpp v118, v92, v18 row_newbcast:15 row_mask:0xf bank_mask:0xf
v_and_b32_dpp v119, v92, v19 row_newbcast:15 row_mask:0xf bank_mask:0xf
s_waitcnt vmcnt(11)
v_mfma_f32_16x16x32_bf16 v[108:111], v[112:115], v[56:59], v[108:111]
s_bitcmp1_b32 s47, 2
s_cbranch_scc0 L_th205
s_waitcnt vmcnt(3)
L_th205:
s_waitcnt vmcnt(8)
buffer_load_dwordx4 v[56:59], v2, s[8:11], s45 offen offset:2048
v_and_b32_dpp v112, v93, v16 row_newbcast:0 row_mask:0xf bank_mask:0xf
v_and_b32_dpp v113, v93, v17 row_newbcast:0 row_mask:0xf bank_mask:0xf
v_and_b32_dpp v114, v93, v18 row_newbcast:0 row_mask:0xf bank_mask:0xf
v_and_b32_dpp v115, v93, v19 row_newbcast:0 row_mask:0xf bank_mask:0xf
s_waitcnt vmcnt(11)
v_mfma_f32_16x16x32_bf16 v[108:111], v[116:119], v[60:63], v[108:111]
s_bitcmp1_b32 s47, 2
s_cbranch_scc0 L_th206
s_waitcnt vmcnt(3)
L_th206:
s_waitcnt vmcnt(8)
buffer_load_dwordx4 v[60:63], v2, s[8:11], s45 offen offset:3072 nt
v_and_b32_dpp v116, v93, v16 row_newbcast:4 row_mask:0xf bank_mask:0xf
v_and_b32_dpp v117, v93, v17 row_newbcast:4 row_mask:0xf bank_mask:0xf
v_and_b32_dpp v118, v93, v18 row_newbcast:4 row_mask:0xf bank_mask:0xf
v_and_b32_dpp v119, v93, v19 row_newbcast:4 row_mask:0xf bank_mask:0xf
s_waitcnt vmcnt(11)
v_mfma_f32_16x16x32_bf16 v[108:111], v[112:115], v[64:67], v[108:111]
s_bitcmp1_b32 s47, 2
s_cbranch_scc0 L_th207
s_waitcnt vmcnt(3)
L_th207:
s_waitcnt vmcnt(8)
s_mov_b32 s45, 0x17000
buffer_load_dwordx4 v[64:67], v2, s[8:11], s45 offen offset:0 nt
v_and_b32_dpp v112, v93, v16 row_newbcast:8 row_mask:0xf bank_mask:0xf
v_and_b32_dpp v113, v93, v17 row_newbcast:8 row_mask:0xf bank_mask:0xf
v_and_b32_dpp v114, v93, v18 row_newbcast:8 row_mask:0xf bank_mask:0xf
v_and_b32_dpp v115, v93, v19 row_newbcast:8 row_mask:0xf bank_mask:0xf
s_waitcnt vmcnt(11)
v_mfma_f32_16x16x32_bf16 v[108:111], v[116:119], v[68:71], v[108:111]
s_bitcmp1_b32 s47, 2
s_cbranch_scc0 L_th208
s_waitcnt vmcnt(3)
L_th208:
s_waitcnt vmcnt(8)
buffer_load_dwordx4 v[68:71], v2, s[8:11], s45 offen offset:1024
v_and_b32_dpp v116, v93, v16 row_newbcast:12 row_mask:0xf bank_mask:0xf
v_and_b32_dpp v117, v93, v17 row_newbcast:12 row_mask:0xf bank_mask:0xf
v_and_b32_dpp v118, v93, v18 row_newbcast:12 row_mask:0xf bank_mask:0xf
v_and_b32_dpp v119, v93, v19 row_newbcast:12 row_mask:0xf bank_mask:0xf
s_waitcnt vmcnt(11)
v_mfma_f32_16x16x32_bf16 v[108:111], v[112:115], v[24:27], v[108:111]
s_bitcmp1_b32 s47, 2
s_cbranch_scc0 L_th209
s_waitcnt vmcnt(3)
L_th209:
s_waitcnt vmcnt(8)
buffer_load_dwordx4 v[24:27], v2, s[8:11], s45 offen offset:2048 nt
v_and_b32_dpp v112, v93, v16 row_newbcast:1 row_mask:0xf bank_mask:0xf
v_and_b32_dpp v113, v93, v17 row_newbcast:1 row_mask:0xf bank_mask:0xf
v_and_b32_dpp v114, v93, v18 row_newbcast:1 row_mask:0xf bank_mask:0xf
v_and_b32_dpp v115, v93, v19 row_newbcast:1 row_mask:0xf bank_mask:0xf
s_waitcnt vmcnt(11)
v_mfma_f32_16x16x32_bf16 v[108:111], v[116:119], v[28:31], v[108:111]
s_bitcmp1_b32 s47, 2
s_cbranch_scc0 L_th210
s_waitcnt vmcnt(3)
L_th210:
s_waitcnt vmcnt(8)
buffer_load_dwordx4 v[28:31], v2, s[8:11], s45 offen offset:3072 nt
v_and_b32_dpp v116, v93, v16 row_newbcast:5 row_mask:0xf bank_mask:0xf
v_and_b32_dpp v117, v93, v17 row_newbcast:5 row_mask:0xf bank_mask:0xf
v_and_b32_dpp v118, v93, v18 row_newbcast:5 row_mask:0xf bank_mask:0xf
v_and_b32_dpp v119, v93, v19 row_newbcast:5 row_mask:0xf bank_mask:0xf
s_waitcnt vmcnt(11)
v_mfma_f32_16x16x32_bf16 v[108:111], v[112:115], v[32:35], v[108:111]
s_bitcmp1_b32 s47, 2
s_cbranch_scc0 L_th211
s_waitcnt vmcnt(3)
L_th211:
s_waitcnt vmcnt(8)
s_mov_b32 s45, 0x18000
buffer_load_dwordx4 v[32:35], v2, s[8:11], s45 offen offset:0
v_and_b32_dpp v112, v93, v16 row_newbcast:9 row_mask:0xf bank_mask:0xf
v_and_b32_dpp v113, v93, v17 row_newbcast:9 row_mask:0xf bank_mask:0xf
v_and_b32_dpp v114, v93, v18 row_newbcast:9 row_mask:0xf bank_mask:0xf
v_and_b32_dpp v115, v93, v19 row_newbcast:9 row_mask:0xf bank_mask:0xf
s_waitcnt vmcnt(11)
v_mfma_f32_16x16x32_bf16 v[108:111], v[116:119], v[36:39], v[108:111]
s_bitcmp1_b32 s47, 2
s_cbranch_scc0 L_th212
s_waitcnt vmcnt(3)
L_th212:
s_waitcnt vmcnt(8)
buffer_load_dwordx4 v[36:39], v2, s[8:11], s45 offen offset:1024 nt
v_and_b32_dpp v116, v93, v16 row_newbcast:13 row_mask:0xf bank_mask:0xf
v_and_b32_dpp v117, v93, v17 row_newbcast:13 row_mask:0xf bank_mask:0xf
v_and_b32_dpp v118, v93, v18 row_newbcast:13 row_mask:0xf bank_mask:0xf
v_and_b32_dpp v119, v93, v19 row_newbcast:13 row_mask:0xf bank_mask:0xf
s_waitcnt vmcnt(11)
v_mfma_f32_16x16x32_bf16 v[108:111], v[112:115], v[40:43], v[108:111]
s_bitcmp1_b32 s47, 2
s_cbranch_scc0 L_th213
s_waitcnt vmcnt(3)
L_th213:
s_waitcnt vmcnt(8)
buffer_load_dwordx4 v[40:43], v2, s[8:11], s45 offen offset:2048 nt
v_and_b32_dpp v112, v93, v16 row_newbcast:2 row_mask:0xf bank_mask:0xf
v_and_b32_dpp v113, v93, v17 row_newbcast:2 row_mask:0xf bank_mask:0xf
v_and_b32_dpp v114, v93, v18 row_newbcast:2 row_mask:0xf bank_mask:0xf
v_and_b32_dpp v115, v93, v19 row_newbcast:2 row_mask:0xf bank_mask:0xf
s_waitcnt vmcnt(11)
v_mfma_f32_16x16x32_bf16 v[108:111], v[116:119], v[44:47], v[108:111]
s_bitcmp1_b32 s47, 2
s_cbranch_scc0 L_th214
s_waitcnt vmcnt(3)
L_th214:
s_waitcnt vmcnt(8)
buffer_load_dwordx4 v[44:47], v2, s[8:11], s45 offen offset:3072
v_and_b32_dpp v116, v93, v16 row_newbcast:6 row_mask:0xf bank_mask:0xf
v_and_b32_dpp v117, v93, v17 row_newbcast:6 row_mask:0xf bank_mask:0xf
v_and_b32_dpp v118, v93, v18 row_newbcast:6 row_mask:0xf bank_mask:0xf
v_and_b32_dpp v119, v93, v19 row_newbcast:6 row_mask:0xf bank_mask:0xf
s_waitcnt vmcnt(11)
v_mfma_f32_16x16x32_bf16 v[108:111], v[112:115], v[48:51], v[108:111]
s_bitcmp1_b32 s47, 2
s_cbranch_scc0 L_th215
s_waitcnt vmcnt(3)
L_th215:
s_waitcnt vmcnt(8)
s_mov_b32 s45, 0x19000
buffer_load_dwordx4 v[48:51], v2, s[8:11], s45 offen offset:0 nt
v_and_b32_dpp v112, v93, v16 row_newbcast:10 row_mask:0xf bank_mask:0xf
v_and_b32_dpp v113, v93, v17 row_newbcast:10 row_mask:0xf bank_mask:0xf
v_and_b32_dpp v114, v93, v18 row_newbcast:10 row_mask:0xf bank_mask:0xf
v_and_b32_dpp v115, v93, v19 row_newbcast:10 row_mask:0xf bank_mask:0xf
s_waitcnt vmcnt(11)
v_mfma_f32_16x16x32_bf16 v[108:111], v[116:119], v[52:55], v[108:111]
s_bitcmp1_b32 s47, 2
s_cbranch_scc0 L_th216
s_waitcnt vmcnt(3)
L_th216:
s_waitcnt vmcnt(8)
buffer_load_dwordx4 v[52:55], v2, s[8:11], s45 offen offset:1024 nt
v_and_b32_dpp v116, v93, v16 row_newbcast:14 row_mask:0xf bank_mask:0xf
v_and_b32_dpp v117, v93, v17 row_newbcast:14 row_mask:0xf bank_mask:0xf
v_and_b32_dpp v118, v93, v18 row_newbcast:14 row_mask:0xf bank_mask:0xf
v_and_b32_dpp v119, v93, v19 row_newbcast:14 row_mask:0xf bank_mask:0xf
s_waitcnt vmcnt(11)
v_mfma_f32_16x16x32_bf16 v[108:111], v[112:115], v[56:59], v[108:111]
s_bitcmp1_b32 s47, 2
s_cbranch_scc0 L_th217
s_waitcnt vmcnt(3)
L_th217:
s_waitcnt vmcnt(8)
buffer_load_dwordx4 v[56:59], v2, s[8:11], s45 offen offset:2048
v_and_b32_dpp v112, v93, v16 row_newbcast:3 row_mask:0xf bank_mask:0xf
v_and_b32_dpp v113, v93, v17 row_newbcast:3 row_mask:0xf bank_mask:0xf
v_and_b32_dpp v114, v93, v18 row_newbcast:3 row_mask:0xf bank_mask:0xf
v_and_b32_dpp v115, v93, v19 row_newbcast:3 row_mask:0xf bank_mask:0xf
s_waitcnt vmcnt(11)
v_mfma_f32_16x16x32_bf16 v[108:111], v[116:119], v[60:63], v[108:111]
s_bitcmp1_b32 s47, 2
s_cbranch_scc0 L_th218
s_waitcnt vmcnt(3)
L_th218:
s_waitcnt vmcnt(8)
buffer_load_dwordx4 v[60:63], v2, s[8:11], s45 offen offset:3072 nt
v_and_b32_dpp v116, v93, v16 row_newbcast:7 row_mask:0xf bank_mask:0xf
v_and_b32_dpp v117, v93, v17 row_newbcast:7 row_mask:0xf bank_mask:0xf
v_and_b32_dpp v118, v93, v18 row_newbcast:7 row_mask:0xf bank_mask:0xf
v_and_b32_dpp v119, v93, v19 row_newbcast:7 row_mask:0xf bank_mask:0xf
s_waitcnt vmcnt(11)
v_mfma_f32_16x16x32_bf16 v[108:111], v[112:115], v[64:67], v[108:111]
s_bitcmp1_b32 s47, 2
s_cbranch_scc0 L_th219
s_waitcnt vmcnt(3)
L_th219:
s_waitcnt vmcnt(8)
s_mov_b32 s45, 0x1a000
buffer_load_dwordx4 v[64:67], v2, s[8:11], s45 offen offset:0 nt
v_and_b32_dpp v112, v93, v16 row_newbcast:11 row_mask:0xf bank_mask:0xf
v_and_b32_dpp v113, v93, v17 row_newbcast:11 row_mask:0xf bank_mask:0xf
v_and_b32_dpp v114, v93, v18 row_newbcast:11 row_mask:0xf bank_mask:0xf
v_and_b32_dpp v115, v93, v19 row_newbcast:11 row_mask:0xf bank_mask:0xf
s_waitcnt vmcnt(11)
v_mfma_f32_16x16x32_bf16 v[108:111], v[116:119], v[68:71], v[108:111]
s_bitcmp1_b32 s47, 2
s_cbranch_scc0 L_th220
s_waitcnt vmcnt(3)
L_th220:
s_waitcnt vmcnt(8)
buffer_load_dwordx4 v[68:71], v2, s[8:11], s45 offen offset:1024
v_and_b32_dpp v116, v93, v16 row_newbcast:15 row_mask:0xf bank_mask:0xf
v_and_b32_dpp v117, v93, v17 row_newbcast:15 row_mask:0xf bank_mask:0xf
v_and_b32_dpp v118, v93, v18 row_newbcast:15 row_mask:0xf bank_mask:0xf
v_and_b32_dpp v119, v93, v19 row_newbcast:15 row_mask:0xf bank_mask:0xf
s_waitcnt vmcnt(11)
v_mfma_f32_16x16x32_bf16 v[108:111], v[112:115], v[24:27], v[108:111]
s_bitcmp1_b32 s47, 2
s_cbranch_scc0 L_th221
s_waitcnt vmcnt(3)
L_th221:
s_waitcnt vmcnt(8)
buffer_load_dwordx4 v[24:27], v2, s[8:11], s45 offen offset:2048 nt
v_and_b32_dpp v112, v94, v16 row_newbcast:0 row_mask:0xf bank_mask:0xf
v_and_b32_dpp v113, v94, v17 row_newbcast:0 row_mask:0xf bank_mask:0xf
v_and_b32_dpp v114, v94, v18 row_newbcast:0 row_mask:0xf bank_mask:0xf
v_and_b32_dpp v115, v94, v19 row_newbcast:0 row_mask:0xf bank_mask:0xf
s_waitcnt vmcnt(11)
v_mfma_f32_16x16x32_bf16 v[108:111], v[116:119], v[28:31], v[108:111]
s_bitcmp1_b32 s47, 2
s_cbranch_scc0 L_th222
s_waitcnt vmcnt(3)
L_th222:
s_waitcnt vmcnt(8)
buffer_load_dwordx4 v[28:31], v2, s[8:11], s45 offen offset:3072 nt
v_and_b32_dpp v116, v94, v16 row_newbcast:4 row_mask:0xf bank_mask:0xf
v_and_b32_dpp v117, v94, v17 row_newbcast:4 row_mask:0xf bank_mask:0xf
v_and_b32_dpp v118, v94, v18 row_newbcast:4 row_mask:0xf bank_mask:0xf
v_and_b32_dpp v119, v94, v19 row_newbcast:4 row_mask:0xf bank_mask:0xf
s_waitcnt vmcnt(11)
v_mfma_f32_16x16x32_bf16 v[108:111], v[112:115], v[32:35], v[108:111]
s_bitcmp1_b32 s47, 2
s_cbranch_scc0 L_th223
s_waitcnt vmcnt(3)
L_th223:
s_waitcnt vmcnt(8)
s_mov_b32 s45, 0x1b000
buffer_load_dwordx4 v[32:35], v2, s[8:11], s45 offen offset:0
v_and_b32_dpp v112, v94, v16 row_newbcast:8 row_mask:0xf bank_mask:0xf
v_and_b32_dpp v113, v94, v17 row_newbcast:8 row_mask:0xf bank_mask:0xf
v_and_b32_dpp v114, v94, v18 row_newbcast:8 row_mask:0xf bank_mask:0xf
v_and_b32_dpp v115, v94, v19 row_newbcast:8 row_mask:0xf bank_mask:0xf
s_waitcnt vmcnt(11)
v_mfma_f32_16x16x32_bf16 v[108:111], v[116:119], v[36:39], v[108:111]
s_bitcmp1_b32 s47, 2
s_cbranch_scc0 L_th224
s_waitcnt vmcnt(3)
L_th224:
s_waitcnt vmcnt(8)
buffer_load_dwordx4 v[36:39], v2, s[8:11], s45 offen offset:1024 nt
v_and_b32_dpp v116, v94, v16 row_newbcast:12 row_mask:0xf bank_mask:0xf
v_and_b32_dpp v117, v94, v17 row_newbcast:12 row_mask:0xf bank_mask:0xf
v_and_b32_dpp v118, v94, v18 row_newbcast:12 row_mask:0xf bank_mask:0xf
v_and_b32_dpp v119, v94, v19 row_newbcast:12 row_mask:0xf bank_mask:0xf
s_waitcnt vmcnt(11)
v_mfma_f32_16x16x32_bf16 v[108:111], v[112:115], v[40:43], v[108:111]
s_bitcmp1_b32 s47, 2
s_cbranch_scc0 L_th225
s_waitcnt vmcnt(3)
L_th225:
s_waitcnt vmcnt(8)
buffer_load_dwordx4 v[40:43], v2, s[8:11], s45 offen offset:2048 nt
v_and_b32_dpp v112, v94, v16 row_newbcast:1 row_mask:0xf bank_mask:0xf
v_and_b32_dpp v113, v94, v17 row_newbcast:1 row_mask:0xf bank_mask:0xf
v_and_b32_dpp v114, v94, v18 row_newbcast:1 row_mask:0xf bank_mask:0xf
v_and_b32_dpp v115, v94, v19 row_newbcast:1 row_mask:0xf bank_mask:0xf
s_waitcnt vmcnt(11)
v_mfma_f32_16x16x32_bf16 v[108:111], v[116:119], v[44:47], v[108:111]
s_bitcmp1_b32 s47, 2
s_cbranch_scc0 L_th226
s_waitcnt vmcnt(3)
L_th226:
s_waitcnt vmcnt(8)
buffer_load_dwordx4 v[44:47], v2, s[8:11], s45 offen offset:3072
v_and_b32_dpp v116, v94, v16 row_newbcast:5 row_mask:0xf bank_mask:0xf
v_and_b32_dpp v117, v94, v17 row_newbcast:5 row_mask:0xf bank_mask:0xf
v_and_b32_dpp v118, v94, v18 row_newbcast:5 row_mask:0xf bank_mask:0xf
v_and_b32_dpp v119, v94, v19 row_newbcast:5 row_mask:0xf bank_mask:0xf
s_waitcnt vmcnt(11)
v_mfma_f32_16x16x32_bf16 v[108:111], v[112:115], v[48:51], v[108:111]
s_bitcmp1_b32 s47, 2
s_cbranch_scc0 L_th227
s_waitcnt vmcnt(3)
L_th227:
s_waitcnt vmcnt(8)
s_mov_b32 s45, 0x1c000
buffer_load_dwordx4 v[48:51], v2, s[8:11], s45 offen offset:0 nt
v_and_b32_dpp v112, v94, v16 row_newbcast:9 row_mask:0xf bank_mask:0xf
v_and_b32_dpp v113, v94, v17 row_newbcast:9 row_mask:0xf bank_mask:0xf
v_and_b32_dpp v114, v94, v18 row_newbcast:9 row_mask:0xf bank_mask:0xf
v_and_b32_dpp v115, v94, v19 row_newbcast:9 row_mask:0xf bank_mask:0xf
s_waitcnt vmcnt(11)
v_mfma_f32_16x16x32_bf16 v[108:111], v[116:119], v[52:55], v[108:111]
s_bitcmp1_b32 s47, 2
s_cbranch_scc0 L_th228
s_waitcnt vmcnt(3)
L_th228:
s_waitcnt vmcnt(8)
buffer_load_dwordx4 v[52:55], v2, s[8:11], s45 offen offset:1024 nt
v_and_b32_dpp v116, v94, v16 row_newbcast:13 row_mask:0xf bank_mask:0xf
v_and_b32_dpp v117, v94, v17 row_newbcast:13 row_mask:0xf bank_mask:0xf
v_and_b32_dpp v118, v94, v18 row_newbcast:13 row_mask:0xf bank_mask:0xf
v_and_b32_dpp v119, v94, v19 row_newbcast:13 row_mask:0xf bank_mask:0xf
s_waitcnt vmcnt(11)
v_mfma_f32_16x16x32_bf16 v[108:111], v[112:115], v[56:59], v[108:111]
s_bitcmp1_b32 s47, 2
s_cbranch_scc0 L_th229
s_waitcnt vmcnt(3)
L_th229:
s_waitcnt vmcnt(8)
buffer_load_dwordx4 v[56:59], v2, s[8:11], s45 offen offset:2048
v_and_b32_dpp v112, v94, v16 row_newbcast:2 row_mask:0xf bank_mask:0xf
v_and_b32_dpp v113, v94, v17 row_newbcast:2 row_mask:0xf bank_mask:0xf
v_and_b32_dpp v114, v94, v18 row_newbcast:2 row_mask:0xf bank_mask:0xf
v_and_b32_dpp v115, v94, v19 row_newbcast:2 row_mask:0xf bank_mask:0xf
s_waitcnt vmcnt(11)
v_mfma_f32_16x16x32_bf16 v[108:111], v[116:119], v[60:63], v[108:111]
s_bitcmp1_b32 s47, 2
s_cbranch_scc0 L_th230
s_waitcnt vmcnt(3)
L_th230:
s_waitcnt vmcnt(8)
buffer_load_dwordx4 v[60:63], v2, s[8:11], s45 offen offset:3072 nt
v_and_b32_dpp v116, v94, v16 row_newbcast:6 row_mask:0xf bank_mask:0xf
v_and_b32_dpp v117, v94, v17 row_newbcast:6 row_mask:0xf bank_mask:0xf
v_and_b32_dpp v118, v94, v18 row_newbcast:6 row_mask:0xf bank_mask:0xf
v_and_b32_dpp v119, v94, v19 row_newbcast:6 row_mask:0xf bank_mask:0xf
s_waitcnt vmcnt(11)
v_mfma_f32_16x16x32_bf16 v[108:111], v[112:115], v[64:67], v[108:111]
s_bitcmp1_b32 s47, 2
s_cbranch_scc0 L_th231
s_waitcnt vmcnt(3)
L_th231:
s_waitcnt vmcnt(8)
s_mov_b32 s45, 0x1d000
buffer_load_dwordx4 v[64:67], v2, s[8:11], s45 offen offset:0 nt
v_and_b32_dpp v112, v94, v16 row_newbcast:10 row_mask:0xf bank_mask:0xf
v_and_b32_dpp v113, v94, v17 row_newbcast:10 row_mask:0xf bank_mask:0xf
v_and_b32_dpp v114, v94, v18 row_newbcast:10 row_mask:0xf bank_mask:0xf
v_and_b32_dpp v115, v94, v19 row_newbcast:10 row_mask:0xf bank_mask:0xf
s_waitcnt vmcnt(11)
v_mfma_f32_16x16x32_bf16 v[108:111], v[116:119], v[68:71], v[108:111]
s_bitcmp1_b32 s47, 2
s_cbranch_scc0 L_th232
s_waitcnt vmcnt(3)
L_th232:
s_waitcnt vmcnt(8)
buffer_load_dwordx4 v[68:71], v2, s[8:11], s45 offen offset:1024
v_and_b32_dpp v116, v94, v16 row_newbcast:14 row_mask:0xf bank_mask:0xf
v_and_b32_dpp v117, v94, v17 row_newbcast:14 row_mask:0xf bank_mask:0xf
v_and_b32_dpp v118, v94, v18 row_newbcast:14 row_mask:0xf bank_mask:0xf
v_and_b32_dpp v119, v94, v19 row_newbcast:14 row_mask:0xf bank_mask:0xf
s_waitcnt vmcnt(11)
v_mfma_f32_16x16x32_bf16 v[108:111], v[112:115], v[24:27], v[108:111]
s_bitcmp1_b32 s47, 2
s_cbranch_scc0 L_th233
s_waitcnt vmcnt(3)
L_th233:
s_waitcnt vmcnt(8)
buffer_load_dwordx4 v[24:27], v2, s[8:11], s45 offen offset:2048 nt
v_and_b32_dpp v112, v94, v16 row_newbcast:3 row_mask:0xf bank_mask:0xf
v_and_b32_dpp v113, v94, v17 row_newbcast:3 row_mask:0xf bank_mask:0xf
v_and_b32_dpp v114, v94, v18 row_newbcast:3 row_mask:0xf bank_mask:0xf
v_and_b32_dpp v115, v94, v19 row_newbcast:3 row_mask:0xf bank_mask:0xf
s_waitcnt vmcnt(11)
v_mfma_f32_16x16x32_bf16 v[108:111], v[116:119], v[28:31], v[108:111]
s_bitcmp1_b32 s47, 2
s_cbranch_scc0 L_th234
s_waitcnt vmcnt(3)
L_th234:
s_waitcnt vmcnt(8)
buffer_load_dwordx4 v[28:31], v2, s[8:11], s45 offen offset:3072 nt
v_and_b32_dpp v116, v94, v16 row_newbcast:7 row_mask:0xf bank_mask:0xf
v_and_b32_dpp v117, v94, v17 row_newbcast:7 row_mask:0xf bank_mask:0xf
v_and_b32_dpp v118, v94, v18 row_newbcast:7 row_mask:0xf bank_mask:0xf
v_and_b32_dpp v119, v94, v19 row_newbcast:7 row_mask:0xf bank_mask:0xf
s_waitcnt vmcnt(11)
v_mfma_f32_16x16x32_bf16 v[108:111], v[112:115], v[32:35], v[108:111]
s_bitcmp1_b32 s47, 2
s_cbranch_scc0 L_th235
s_waitcnt vmcnt(3)
L_th235:
s_waitcnt vmcnt(8)
s_mov_b32 s45, 0x1e000
buffer_load_dwordx4 v[32:35], v2, s[8:11], s45 offen offset:0
v_and_b32_dpp v112, v94, v16 row_newbcast:11 row_mask:0xf bank_mask:0xf
v_and_b32_dpp v113, v94, v17 row_newbcast:11 row_mask:0xf bank_mask:0xf
v_and_b32_dpp v114, v94, v18 row_newbcast:11 row_mask:0xf bank_mask:0xf
v_and_b32_dpp v115, v94, v19 row_newbcast:11 row_mask:0xf bank_mask:0xf
s_waitcnt vmcnt(11)
v_mfma_f32_16x16x32_bf16 v[108:111], v[116:119], v[36:39], v[108:111]
s_bitcmp1_b32 s47, 2
s_cbranch_scc0 L_th236
s_waitcnt vmcnt(3)
L_th236:
s_waitcnt vmcnt(8)
buffer_load_dwordx4 v[36:39], v2, s[8:11], s45 offen offset:1024 nt
v_and_b32_dpp v116, v94, v16 row_newbcast:15 row_mask:0xf bank_mask:0xf
v_and_b32_dpp v117, v94, v17 row_newbcast:15 row_mask:0xf bank_mask:0xf
v_and_b32_dpp v118, v94, v18 row_newbcast:15 row_mask:0xf bank_mask:0xf
v_and_b32_dpp v119, v94, v19 row_newbcast:15 row_mask:0xf bank_mask:0xf
s_waitcnt vmcnt(11)
v_mfma_f32_16x16x32_bf16 v[108:111], v[112:115], v[40:43], v[108:111]
s_bitcmp1_b32 s47, 2
s_cbranch_scc0 L_th237
s_waitcnt vmcnt(3)
L_th237:
s_waitcnt vmcnt(8)
buffer_load_dwordx4 v[40:43], v2, s[8:11], s45 offen offset:2048 nt
v_and_b32_dpp v112, v95, v16 row_newbcast:0 row_mask:0xf bank_mask:0xf
v_and_b32_dpp v113, v95, v17 row_newbcast:0 row_mask:0xf bank_mask:0xf
v_and_b32_dpp v114, v95, v18 row_newbcast:0 row_mask:0xf bank_mask:0xf
v_and_b32_dpp v115, v95, v19 row_newbcast:0 row_mask:0xf bank_mask:0xf
s_waitcnt vmcnt(11)
v_mfma_f32_16x16x32_bf16 v[108:111], v[116:119], v[44:47], v[108:111]
s_bitcmp1_b32 s47, 2
s_cbranch_scc0 L_th238
s_waitcnt vmcnt(3)
L_th238:
s_waitcnt vmcnt(8)
buffer_load_dwordx4 v[44:47], v2, s[8:11], s45 offen offset:3072
v_and_b32_dpp v116, v95, v16 row_newbcast:4 row_mask:0xf bank_mask:0xf
v_and_b32_dpp v117, v95, v17 row_newbcast:4 row_mask:0xf bank_mask:0xf
v_and_b32_dpp v118, v95, v18 row_newbcast:4 row_mask:0xf bank_mask:0xf
v_and_b32_dpp v119, v95, v19 row_newbcast:4 row_mask:0xf bank_mask:0xf
s_waitcnt vmcnt(11)
v_mfma_f32_16x16x32_bf16 v[108:111], v[112:115], v[48:51], v[108:111]
s_mov_b32 s45, 0x1f000
buffer_load_dwordx4 v[48:51], v2, s[8:11], s45 offen offset:0 nt
v_and_b32_dpp v112, v95, v16 row_newbcast:8 row_mask:0xf bank_mask:0xf
v_and_b32_dpp v113, v95, v17 row_newbcast:8 row_mask:0xf bank_mask:0xf
v_and_b32_dpp v114, v95, v18 row_newbcast:8 row_mask:0xf bank_mask:0xf
v_and_b32_dpp v115, v95, v19 row_newbcast:8 row_mask:0xf bank_mask:0xf
s_waitcnt vmcnt(11)
v_mfma_f32_16x16x32_bf16 v[108:111], v[116:119], v[52:55], v[108:111]
buffer_load_dwordx4 v[52:55], v2, s[8:11], s45 offen offset:1024 nt
v_and_b32_dpp v116, v95, v16 row_newbcast:12 row_mask:0xf bank_mask:0xf
v_and_b32_dpp v117, v95, v17 row_newbcast:12 row_mask:0xf bank_mask:0xf
v_and_b32_dpp v118, v95, v18 row_newbcast:12 row_mask:0xf bank_mask:0xf
v_and_b32_dpp v119, v95, v19 row_newbcast:12 row_mask:0xf bank_mask:0xf
s_waitcnt vmcnt(11)
v_mfma_f32_16x16x32_bf16 v[108:111], v[112:115], v[56:59], v[108:111]
buffer_load_dwordx4 v[56:59], v2, s[8:11], s45 offen offset:2048
v_and_b32_dpp v112, v95, v16 row_newbcast:1 row_mask:0xf bank_mask:0xf
v_and_b32_dpp v113, v95, v17 row_newbcast:1 row_mask:0xf bank_mask:0xf
v_and_b32_dpp v114, v95, v18 row_newbcast:1 row_mask:0xf bank_mask:0xf
v_and_b32_dpp v115, v95, v19 row_newbcast:1 row_mask:0xf bank_mask:0xf
s_waitcnt vmcnt(11)
v_mfma_f32_16x16x32_bf16 v[108:111], v[116:119], v[60:63], v[108:111]
buffer_load_dwordx4 v[60:63], v2, s[8:11], s45 offen offset:3072 nt
v_and_b32_dpp v116, v95, v16 row_newbcast:5 row_mask:0xf bank_mask:0xf
v_and_b32_dpp v117, v95, v17 row_newbcast:5 row_mask:0xf bank_mask:0xf
v_and_b32_dpp v118, v95, v18 row_newbcast:5 row_mask:0xf bank_mask:0xf
v_and_b32_dpp v119, v95, v19 row_newbcast:5 row_mask:0xf bank_mask:0xf
s_waitcnt vmcnt(11)
v_mfma_f32_16x16x32_bf16 v[108:111], v[112:115], v[64:67], v[108:111]
s_mov_b32 s45, 0x20000
buffer_load_dwordx4 v[64:67], v2, s[8:11], s45 offen offset:0 nt
v_and_b32_dpp v112, v95, v16 row_newbcast:9 row_mask:0xf bank_mask:0xf
v_and_b32_dpp v113, v95, v17 row_newbcast:9 row_mask:0xf bank_mask:0xf
v_and_b32_dpp v114, v95, v18 row_newbcast:9 row_mask:0xf bank_mask:0xf
v_and_b32_dpp v115, v95, v19 row_newbcast:9 row_mask:0xf bank_mask:0xf
s_waitcnt vmcnt(11)
v_mfma_f32_16x16x32_bf16 v[108:111], v[116:119], v[68:71], v[108:111]
buffer_load_dwordx4 v[68:71], v2, s[8:11], s45 offen offset:1024
v_and_b32_dpp v116, v95, v16 row_newbcast:13 row_mask:0xf bank_mask:0xf
v_and_b32_dpp v117, v95, v17 row_newbcast:13 row_mask:0xf bank_mask:0xf
v_and_b32_dpp v118, v95, v18 row_newbcast:13 row_mask:0xf bank_mask:0xf
v_and_b32_dpp v119, v95, v19 row_newbcast:13 row_mask:0xf bank_mask:0xf
s_waitcnt vmcnt(11)
v_mfma_f32_16x16x32_bf16 v[108:111], v[112:115], v[24:27], v[108:111]
buffer_load_dwordx4 v[24:27], v2, s[8:11], s45 offen offset:2048 nt
v_and_b32_dpp v112, v95, v16 row_newbcast:2 row_mask:0xf bank_mask:0xf
v_and_b32_dpp v113, v95, v17 row_newbcast:2 row_mask:0xf bank_mask:0xf
v_and_b32_dpp v114, v95, v18 row_newbcast:2 row_mask:0xf bank_mask:0xf
v_and_b32_dpp v115, v95, v19 row_newbcast:2 row_mask:0xf bank_mask:0xf
s_waitcnt vmcnt(11)
v_mfma_f32_16x16x32_bf16 v[108:111], v[116:119], v[28:31], v[108:111]
buffer_load_dwordx4 v[28:31], v2, s[8:11], s45 offen offset:3072 nt
v_and_b32_dpp v116, v95, v16 row_newbcast:6 row_mask:0xf bank_mask:0xf
v_and_b32_dpp v117, v95, v17 row_newbcast:6 row_mask:0xf bank_mask:0xf
v_and_b32_dpp v118, v95, v18 row_newbcast:6 row_mask:0xf bank_mask:0xf
v_and_b32_dpp v119, v95, v19 row_newbcast:6 row_mask:0xf bank_mask:0xf
s_waitcnt vmcnt(11)
v_mfma_f32_16x16x32_bf16 v[108:111], v[112:115], v[32:35], v[108:111]
s_mov_b32 s45, 0x21000
buffer_load_dwordx4 v[32:35], v2, s[8:11], s45 offen offset:0
v_and_b32_dpp v112, v95, v16 row_newbcast:10 row_mask:0xf bank_mask:0xf
v_and_b32_dpp v113, v95, v17 row_newbcast:10 row_mask:0xf bank_mask:0xf
v_and_b32_dpp v114, v95, v18 row_newbcast:10 row_mask:0xf bank_mask:0xf
v_and_b32_dpp v115, v95, v19 row_newbcast:10 row_mask:0xf bank_mask:0xf
s_waitcnt vmcnt(11)
v_mfma_f32_16x16x32_bf16 v[108:111], v[116:119], v[36:39], v[108:111]
buffer_load_dwordx4 v[36:39], v2, s[8:11], s45 offen offset:1024 nt
v_and_b32_dpp v116, v95, v16 row_newbcast:14 row_mask:0xf bank_mask:0xf
v_and_b32_dpp v117, v95, v17 row_newbcast:14 row_mask:0xf bank_mask:0xf
v_and_b32_dpp v118, v95, v18 row_newbcast:14 row_mask:0xf bank_mask:0xf
v_and_b32_dpp v119, v95, v19 row_newbcast:14 row_mask:0xf bank_mask:0xf
s_waitcnt vmcnt(11)
v_mfma_f32_16x16x32_bf16 v[108:111], v[112:115], v[40:43], v[108:111]
buffer_load_dwordx4 v[40:43], v2, s[8:11], s45 offen offset:2048 nt
v_and_b32_dpp v112, v95, v16 row_newbcast:3 row_mask:0xf bank_mask:0xf
v_and_b32_dpp v113, v95, v17 row_newbcast:3 row_mask:0xf bank_mask:0xf
v_and_b32_dpp v114, v95, v18 row_newbcast:3 row_mask:0xf bank_mask:0xf
v_and_b32_dpp v115, v95, v19 row_newbcast:3 row_mask:0xf bank_mask:0xf
s_waitcnt vmcnt(11)
v_mfma_f32_16x16x32_bf16 v[108:111], v[116:119], v[44:47], v[108:111]
buffer_load_dwordx4 v[44:47], v2, s[8:11], s45 offen offset:3072
v_and_b32_dpp v116, v95, v16 row_newbcast:7 row_mask:0xf bank_mask:0xf
v_and_b32_dpp v117, v95, v17 row_newbcast:7 row_mask:0xf bank_mask:0xf
v_and_b32_dpp v118, v95, v18 row_newbcast:7 row_mask:0xf bank_mask:0xf
v_and_b32_dpp v119, v95, v19 row_newbcast:7 row_mask:0xf bank_mask:0xf
s_waitcnt vmcnt(11)
v_mfma_f32_16x16x32_bf16 v[108:111], v[112:115], v[48:51], v[108:111]
s_mov_b32 s45, 0x22000
buffer_load_dwordx4 v[48:51], v2, s[8:11], s45 offen offset:0 nt
v_and_b32_dpp v112, v95, v16 row_newbcast:11 row_mask:0xf bank_mask:0xf
v_and_b32_dpp v113, v95, v17 row_newbcast:11 row_mask:0xf bank_mask:0xf
v_and_b32_dpp v114, v95, v18 row_newbcast:11 row_mask:0xf bank_mask:0xf
v_and_b32_dpp v115, v95, v19 row_newbcast:11 row_mask:0xf bank_mask:0xf
s_waitcnt vmcnt(11)
v_mfma_f32_16x16x32_bf16 v[108:111], v[116:119], v[52:55], v[108:111]
buffer_load_dwordx4 v[52:55], v2, s[8:11], s45 offen offset:1024 nt
v_and_b32_dpp v116, v95, v16 row_newbcast:15 row_mask:0xf bank_mask:0xf
v_and_b32_dpp v117, v95, v17 row_newbcast:15 row_mask:0xf bank_mask:0xf
v_and_b32_dpp v118, v95, v18 row_newbcast:15 row_mask:0xf bank_mask:0xf
v_and_b32_dpp v119, v95, v19 row_newbcast:15 row_mask:0xf bank_mask:0xf
s_waitcnt vmcnt(11)
v_mfma_f32_16x16x32_bf16 v[108:111], v[112:115], v[56:59], v[108:111]
buffer_load_dwordx4 v[56:59], v2, s[8:11], s45 offen offset:2048
v_and_b32_dpp v112, v96, v16 row_newbcast:0 row_mask:0xf bank_mask:0xf
v_and_b32_dpp v113, v96, v17 row_newbcast:0 row_mask:0xf bank_mask:0xf
v_and_b32_dpp v114, v96, v18 row_newbcast:0 row_mask:0xf bank_mask:0xf
v_and_b32_dpp v115, v96, v19 row_newbcast:0 row_mask:0xf bank_mask:0xf
s_waitcnt vmcnt(11)
v_mfma_f32_16x16x32_bf16 v[108:111], v[116:119], v[60:63], v[108:111]
buffer_load_dwordx4 v[60:63], v2, s[8:11], s45 offen offset:3072 nt
v_and_b32_dpp v116, v96, v16 row_newbcast:4 row_mask:0xf bank_mask:0xf
v_and_b32_dpp v117, v96, v17 row_newbcast:4 row_mask:0xf bank_mask:0xf
v_and_b32_dpp v118, v96, v18 row_newbcast:4 row_mask:0xf bank_mask:0xf
v_and_b32_dpp v119, v96, v19 row_newbcast:4 row_mask:0xf bank_mask:0xf
s_waitcnt vmcnt(11)
v_mfma_f32_16x16x32_bf16 v[108:111], v[112:115], v[64:67], v[108:111]
s_mov_b32 s45, 0x23000
buffer_load_dwordx4 v[64:67], v2, s[8:11], s45 offen offset:0 nt
v_and_b32_dpp v112, v96, v16 row_newbcast:8 row_mask:0xf bank_mask:0xf
v_and_b32_dpp v113, v96, v17 row_newbcast:8 row_mask:0xf bank_mask:0xf
v_and_b32_dpp v114, v96, v18 row_newbcast:8 row_mask:0xf bank_mask:0xf
v_and_b32_dpp v115, v96, v19 row_newbcast:8 row_mask:0xf bank_mask:0xf
s_waitcnt vmcnt(11)
v_mfma_f32_16x16x32_bf16 v[108:111], v[116:119], v[68:71], v[108:111]
buffer_load_dwordx4 v[68:71], v2, s[8:11], s45 offen offset:1024
v_and_b32_dpp v116, v96, v16 row_newbcast:12 row_mask:0xf bank_mask:0xf
v_and_b32_dpp v117, v96, v17 row_newbcast:12 row_mask:0xf bank_mask:0xf
v_and_b32_dpp v118, v96, v18 row_newbcast:12 row_mask:0xf bank_mask:0xf
v_and_b32_dpp v119, v96, v19 row_newbcast:12 row_mask:0xf bank_mask:0xf
s_waitcnt vmcnt(11)
v_mfma_f32_16x16x32_bf16 v[108:111], v[112:115], v[24:27], v[108:111]
buffer_load_dwordx4 v[24:27], v2, s[8:11], s45 offen offset:2048 nt
v_and_b32_dpp v112, v96, v16 row_newbcast:1 row_mask:0xf bank_mask:0xf
v_and_b32_dpp v113, v96, v17 row_newbcast:1 row_mask:0xf bank_mask:0xf
v_and_b32_dpp v114, v96, v18 row_newbcast:1 row_mask:0xf bank_mask:0xf
v_and_b32_dpp v115, v96, v19 row_newbcast:1 row_mask:0xf bank_mask:0xf
s_waitcnt vmcnt(11)
v_mfma_f32_16x16x32_bf16 v[108:111], v[116:119], v[28:31], v[108:111]
buffer_load_dwordx4 v[28:31], v2, s[8:11], s45 offen offset:3072 nt
v_and_b32_dpp v116, v96, v16 row_newbcast:5 row_mask:0xf bank_mask:0xf
v_and_b32_dpp v117, v96, v17 row_newbcast:5 row_mask:0xf bank_mask:0xf
v_and_b32_dpp v118, v96, v18 row_newbcast:5 row_mask:0xf bank_mask:0xf
v_and_b32_dpp v119, v96, v19 row_newbcast:5 row_mask:0xf bank_mask:0xf
s_waitcnt vmcnt(11)
v_mfma_f32_16x16x32_bf16 v[108:111], v[112:115], v[32:35], v[108:111]
s_mov_b32 s45, 0x24000
buffer_load_dwordx4 v[32:35], v2, s[8:11], s45 offen offset:0
v_and_b32_dpp v112, v96, v16 row_newbcast:9 row_mask:0xf bank_mask:0xf
v_and_b32_dpp v113, v96, v17 row_newbcast:9 row_mask:0xf bank_mask:0xf
v_and_b32_dpp v114, v96, v18 row_newbcast:9 row_mask:0xf bank_mask:0xf
v_and_b32_dpp v115, v96, v19 row_newbcast:9 row_mask:0xf bank_mask:0xf
s_waitcnt vmcnt(11)
v_mfma_f32_16x16x32_bf16 v[108:111], v[116:119], v[36:39], v[108:111]
buffer_load_dwordx4 v[36:39], v2, s[8:11], s45 offen offset:1024 nt
v_and_b32_dpp v116, v96, v16 row_newbcast:13 row_mask:0xf bank_mask:0xf
v_and_b32_dpp v117, v96, v17 row_newbcast:13 row_mask:0xf bank_mask:0xf
v_and_b32_dpp v118, v96, v18 row_newbcast:13 row_mask:0xf bank_mask:0xf
v_and_b32_dpp v119, v96, v19 row_newbcast:13 row_mask:0xf bank_mask:0xf
s_waitcnt vmcnt(11)
v_mfma_f32_16x16x32_bf16 v[108:111], v[112:115], v[40:43], v[108:111]
buffer_load_dwordx4 v[40:43], v2, s[8:11], s45 offen offset:2048 nt
v_and_b32_dpp v112, v96, v16 row_newbcast:2 row_mask:0xf bank_mask:0xf
v_and_b32_dpp v113, v96, v17 row_newbcast:2 row_mask:0xf bank_mask:0xf
v_and_b32_dpp v114, v96, v18 row_newbcast:2 row_mask:0xf bank_mask:0xf
v_and_b32_dpp v115, v96, v19 row_newbcast:2 row_mask:0xf bank_mask:0xf
s_waitcnt vmcnt(11)
v_mfma_f32_16x16x32_bf16 v[108:111], v[116:119], v[44:47], v[108:111]
buffer_load_dwordx4 v[44:47], v2, s[8:11], s45 offen offset:3072
v_and_b32_dpp v116, v96, v16 row_newbcast:6 row_mask:0xf bank_mask:0xf
v_and_b32_dpp v117, v96, v17 row_newbcast:6 row_mask:0xf bank_mask:0xf
v_and_b32_dpp v118, v96, v18 row_newbcast:6 row_mask:0xf bank_mask:0xf
v_and_b32_dpp v119, v96, v19 row_newbcast:6 row_mask:0xf bank_mask:0xf
s_waitcnt vmcnt(11)
v_mfma_f32_16x16x32_bf16 v[108:111], v[112:115], v[48:51], v[108:111]
s_mov_b32 s45, 0x25000
buffer_load_dwordx4 v[48:51], v2, s[8:11], s45 offen offset:0 nt
v_and_b32_dpp v112, v96, v16 row_newbcast:10 row_mask:0xf bank_mask:0xf
v_and_b32_dpp v113, v96, v17 row_newbcast:10 row_mask:0xf bank_mask:0xf
v_and_b32_dpp v114, v96, v18 row_newbcast:10 row_mask:0xf bank_mask:0xf
v_and_b32_dpp v115, v96, v19 row_newbcast:10 row_mask:0xf bank_mask:0xf
s_waitcnt vmcnt(11)
v_mfma_f32_16x16x32_bf16 v[108:111], v[116:119], v[52:55], v[108:111]
buffer_load_dwordx4 v[52:55], v2, s[8:11], s45 offen offset:1024 nt
v_and_b32_dpp v116, v96, v16 row_newbcast:14 row_mask:0xf bank_mask:0xf
v_and_b32_dpp v117, v96, v17 row_newbcast:14 row_mask:0xf bank_mask:0xf
v_and_b32_dpp v118, v96, v18 row_newbcast:14 row_mask:0xf bank_mask:0xf
v_and_b32_dpp v119, v96, v19 row_newbcast:14 row_mask:0xf bank_mask:0xf
s_waitcnt vmcnt(11)
v_mfma_f32_16x16x32_bf16 v[108:111], v[112:115], v[56:59], v[108:111]
buffer_load_dwordx4 v[56:59], v2, s[8:11], s45 offen offset:2048
v_and_b32_dpp v112, v96, v16 row_newbcast:3 row_mask:0xf bank_mask:0xf
v_and_b32_dpp v113, v96, v17 row_newbcast:3 row_mask:0xf bank_mask:0xf
v_and_b32_dpp v114, v96, v18 row_newbcast:3 row_mask:0xf bank_mask:0xf
v_and_b32_dpp v115, v96, v19 row_newbcast:3 row_mask:0xf bank_mask:0xf
s_waitcnt vmcnt(11)
v_mfma_f32_16x16x32_bf16 v[108:111], v[116:119], v[60:63], v[108:111]
buffer_load_dwordx4 v[60:63], v2, s[8:11], s45 offen offset:3072 nt
v_and_b32_dpp v116, v96, v16 row_newbcast:7 row_mask:0xf bank_mask:0xf
v_and_b32_dpp v117, v96, v17 row_newbcast:7 row_mask:0xf bank_mask:0xf
v_and_b32_dpp v118, v96, v18 row_newbcast:7 row_mask:0xf bank_mask:0xf
v_and_b32_dpp v119, v96, v19 row_newbcast:7 row_mask:0xf bank_mask:0xf
s_waitcnt vmcnt(11)
v_mfma_f32_16x16x32_bf16 v[108:111], v[112:115], v[64:67], v[108:111]
s_mov_b32 s45, 0x26000
buffer_load_dwordx4 v[64:67], v2, s[8:11], s45 offen offset:0 nt
v_and_b32_dpp v112, v96, v16 row_newbcast:11 row_mask:0xf bank_mask:0xf
v_and_b32_dpp v113, v96, v17 row_newbcast:11 row_mask:0xf bank_mask:0xf
v_and_b32_dpp v114, v96, v18 row_newbcast:11 row_mask:0xf bank_mask:0xf
v_and_b32_dpp v115, v96, v19 row_newbcast:11 row_mask:0xf bank_mask:0xf
s_waitcnt vmcnt(11)
v_mfma_f32_16x16x32_bf16 v[108:111], v[116:119], v[68:71], v[108:111]
buffer_load_dwordx4 v[68:71], v2, s[8:11], s45 offen offset:1024
v_and_b32_dpp v116, v96, v16 row_newbcast:15 row_mask:0xf bank_mask:0xf
v_and_b32_dpp v117, v96, v17 row_newbcast:15 row_mask:0xf bank_mask:0xf
v_and_b32_dpp v118, v96, v18 row_newbcast:15 row_mask:0xf bank_mask:0xf
v_and_b32_dpp v119, v96, v19 row_newbcast:15 row_mask:0xf bank_mask:0xf
s_waitcnt vmcnt(11)
v_mfma_f32_16x16x32_bf16 v[108:111], v[112:115], v[24:27], v[108:111]
buffer_load_dwordx4 v[24:27], v2, s[8:11], s45 offen offset:2048 nt
v_and_b32_dpp v112, v97, v16 row_newbcast:0 row_mask:0xf bank_mask:0xf
v_and_b32_dpp v113, v97, v17 row_newbcast:0 row_mask:0xf bank_mask:0xf
v_and_b32_dpp v114, v97, v18 row_newbcast:0 row_mask:0xf bank_mask:0xf
v_and_b32_dpp v115, v97, v19 row_newbcast:0 row_mask:0xf bank_mask:0xf
s_waitcnt vmcnt(11)
v_mfma_f32_16x16x32_bf16 v[108:111], v[116:119], v[28:31], v[108:111]
buffer_load_dwordx4 v[28:31], v2, s[8:11], s45 offen offset:3072 nt
v_and_b32_dpp v116, v97, v16 row_newbcast:4 row_mask:0xf bank_mask:0xf
v_and_b32_dpp v117, v97, v17 row_newbcast:4 row_mask:0xf bank_mask:0xf
v_and_b32_dpp v118, v97, v18 row_newbcast:4 row_mask:0xf bank_mask:0xf
v_and_b32_dpp v119, v97, v19 row_newbcast:4 row_mask:0xf bank_mask:0xf
s_waitcnt vmcnt(11)
v_mfma_f32_16x16x32_bf16 v[108:111], v[112:115], v[32:35], v[108:111]
s_mov_b32 s45, 0x27000
buffer_load_dwordx4 v[32:35], v2, s[8:11], s45 offen offset:0
v_and_b32_dpp v112, v97, v16 row_newbcast:8 row_mask:0xf bank_mask:0xf
v_and_b32_dpp v113, v97, v17 row_newbcast:8 row_mask:0xf bank_mask:0xf
v_and_b32_dpp v114, v97, v18 row_newbcast:8 row_mask:0xf bank_mask:0xf
v_and_b32_dpp v115, v97, v19 row_newbcast:8 row_mask:0xf bank_mask:0xf
s_waitcnt vmcnt(11)
v_mfma_f32_16x16x32_bf16 v[108:111], v[116:119], v[36:39], v[108:111]
buffer_load_dwordx4 v[36:39], v2, s[8:11], s45 offen offset:1024 nt
v_and_b32_dpp v116, v97, v16 row_newbcast:12 row_mask:0xf bank_mask:0xf
v_and_b32_dpp v117, v97, v17 row_newbcast:12 row_mask:0xf bank_mask:0xf
v_and_b32_dpp v118, v97, v18 row_newbcast:12 row_mask:0xf bank_mask:0xf
v_and_b32_dpp v119, v97, v19 row_newbcast:12 row_mask:0xf bank_mask:0xf
s_waitcnt vmcnt(11)
v_mfma_f32_16x16x32_bf16 v[108:111], v[112:115], v[40:43], v[108:111]
buffer_load_dwordx4 v[40:43], v2, s[8:11], s45 offen offset:2048 nt
v_and_b32_dpp v112, v97, v16 row_newbcast:1 row_mask:0xf bank_mask:0xf
v_and_b32_dpp v113, v97, v17 row_newbcast:1 row_mask:0xf bank_mask:0xf
v_and_b32_dpp v114, v97, v18 row_newbcast:1 row_mask:0xf bank_mask:0xf
v_and_b32_dpp v115, v97, v19 row_newbcast:1 row_mask:0xf bank_mask:0xf
s_waitcnt vmcnt(11)
v_mfma_f32_16x16x32_bf16 v[108:111], v[116:119], v[44:47], v[108:111]
buffer_load_dwordx4 v[44:47], v2, s[8:11], s45 offen offset:3072
v_and_b32_dpp v116, v97, v16 row_newbcast:5 row_mask:0xf bank_mask:0xf
v_and_b32_dpp v117, v97, v17 row_newbcast:5 row_mask:0xf bank_mask:0xf
v_and_b32_dpp v118, v97, v18 row_newbcast:5 row_mask:0xf bank_mask:0xf
v_and_b32_dpp v119, v97, v19 row_newbcast:5 row_mask:0xf bank_mask:0xf
s_waitcnt vmcnt(11)
v_mfma_f32_16x16x32_bf16 v[108:111], v[112:115], v[48:51], v[108:111]
s_mov_b32 s45, 0x28000
buffer_load_dwordx4 v[48:51], v2, s[8:11], s45 offen offset:0 nt
v_and_b32_dpp v112, v97, v16 row_newbcast:9 row_mask:0xf bank_mask:0xf
v_and_b32_dpp v113, v97, v17 row_newbcast:9 row_mask:0xf bank_mask:0xf
v_and_b32_dpp v114, v97, v18 row_newbcast:9 row_mask:0xf bank_mask:0xf
v_and_b32_dpp v115, v97, v19 row_newbcast:9 row_mask:0xf bank_mask:0xf
s_waitcnt vmcnt(11)
v_mfma_f32_16x16x32_bf16 v[108:111], v[116:119], v[52:55], v[108:111]
buffer_load_dwordx4 v[52:55], v2, s[8:11], s45 offen offset:1024 nt
v_and_b32_dpp v116, v97, v16 row_newbcast:13 row_mask:0xf bank_mask:0xf
v_and_b32_dpp v117, v97, v17 row_newbcast:13 row_mask:0xf bank_mask:0xf
v_and_b32_dpp v118, v97, v18 row_newbcast:13 row_mask:0xf bank_mask:0xf
v_and_b32_dpp v119, v97, v19 row_newbcast:13 row_mask:0xf bank_mask:0xf
s_waitcnt vmcnt(11)
v_mfma_f32_16x16x32_bf16 v[108:111], v[112:115], v[56:59], v[108:111]
buffer_load_dwordx4 v[56:59], v2, s[8:11], s45 offen offset:2048
v_and_b32_dpp v112, v97, v16 row_newbcast:2 row_mask:0xf bank_mask:0xf
v_and_b32_dpp v113, v97, v17 row_newbcast:2 row_mask:0xf bank_mask:0xf
v_and_b32_dpp v114, v97, v18 row_newbcast:2 row_mask:0xf bank_mask:0xf
v_and_b32_dpp v115, v97, v19 row_newbcast:2 row_mask:0xf bank_mask:0xf
s_waitcnt vmcnt(11)
v_mfma_f32_16x16x32_bf16 v[108:111], v[116:119], v[60:63], v[108:111]
buffer_load_dwordx4 v[60:63], v2, s[8:11], s45 offen offset:3072 nt
v_and_b32_dpp v116, v97, v16 row_newbcast:6 row_mask:0xf bank_mask:0xf
v_and_b32_dpp v117, v97, v17 row_newbcast:6 row_mask:0xf bank_mask:0xf
v_and_b32_dpp v118, v97, v18 row_newbcast:6 row_mask:0xf bank_mask:0xf
v_and_b32_dpp v119, v97, v19 row_newbcast:6 row_mask:0xf bank_mask:0xf
s_waitcnt vmcnt(11)
v_mfma_f32_16x16x32_bf16 v[108:111], v[112:115], v[64:67], v[108:111]
s_mov_b32 s45, 0x29000
buffer_load_dwordx4 v[64:67], v2, s[8:11], s45 offen offset:0 nt
v_and_b32_dpp v112, v97, v16 row_newbcast:10 row_mask:0xf bank_mask:0xf
v_and_b32_dpp v113, v97, v17 row_newbcast:10 row_mask:0xf bank_mask:0xf
v_and_b32_dpp v114, v97, v18 row_newbcast:10 row_mask:0xf bank_mask:0xf
v_and_b32_dpp v115, v97, v19 row_newbcast:10 row_mask:0xf bank_mask:0xf
s_waitcnt vmcnt(11)
v_mfma_f32_16x16x32_bf16 v[108:111], v[116:119], v[68:71], v[108:111]
buffer_load_dwordx4 v[68:71], v2, s[8:11], s45 offen offset:1024
v_and_b32_dpp v116, v97, v16 row_newbcast:14 row_mask:0xf bank_mask:0xf
v_and_b32_dpp v117, v97, v17 row_newbcast:14 row_mask:0xf bank_mask:0xf
v_and_b32_dpp v118, v97, v18 row_newbcast:14 row_mask:0xf bank_mask:0xf
v_and_b32_dpp v119, v97, v19 row_newbcast:14 row_mask:0xf bank_mask:0xf
s_waitcnt vmcnt(11)
v_mfma_f32_16x16x32_bf16 v[108:111], v[112:115], v[24:27], v[108:111]
buffer_load_dwordx4 v[24:27], v2, s[8:11], s45 offen offset:2048 nt
v_and_b32_dpp v112, v97, v16 row_newbcast:3 row_mask:0xf bank_mask:0xf
v_and_b32_dpp v113, v97, v17 row_newbcast:3 row_mask:0xf bank_mask:0xf
v_and_b32_dpp v114, v97, v18 row_newbcast:3 row_mask:0xf bank_mask:0xf
v_and_b32_dpp v115, v97, v19 row_newbcast:3 row_mask:0xf bank_mask:0xf
s_waitcnt vmcnt(11)
v_mfma_f32_16x16x32_bf16 v[108:111], v[116:119], v[28:31], v[108:111]
buffer_load_dwordx4 v[28:31], v2, s[8:11], s45 offen offset:3072 nt
v_and_b32_dpp v116, v97, v16 row_newbcast:7 row_mask:0xf bank_mask:0xf
v_and_b32_dpp v117, v97, v17 row_newbcast:7 row_mask:0xf bank_mask:0xf
v_and_b32_dpp v118, v97, v18 row_newbcast:7 row_mask:0xf bank_mask:0xf
v_and_b32_dpp v119, v97, v19 row_newbcast:7 row_mask:0xf bank_mask:0xf
s_waitcnt vmcnt(11)
v_mfma_f32_16x16x32_bf16 v[108:111], v[112:115], v[32:35], v[108:111]
s_mov_b32 s45, 0x2a000
buffer_load_dwordx4 v[32:35], v2, s[8:11], s45 offen offset:0
v_and_b32_dpp v112, v97, v16 row_newbcast:11 row_mask:0xf bank_mask:0xf
v_and_b32_dpp v113, v97, v17 row_newbcast:11 row_mask:0xf bank_mask:0xf
v_and_b32_dpp v114, v97, v18 row_newbcast:11 row_mask:0xf bank_mask:0xf
v_and_b32_dpp v115, v97, v19 row_newbcast:11 row_mask:0xf bank_mask:0xf
s_waitcnt vmcnt(11)
v_mfma_f32_16x16x32_bf16 v[108:111], v[116:119], v[36:39], v[108:111]
buffer_load_dwordx4 v[36:39], v2, s[8:11], s45 offen offset:1024 nt
v_and_b32_dpp v116, v97, v16 row_newbcast:15 row_mask:0xf bank_mask:0xf
v_and_b32_dpp v117, v97, v17 row_newbcast:15 row_mask:0xf bank_mask:0xf
v_and_b32_dpp v118, v97, v18 row_newbcast:15 row_mask:0xf bank_mask:0xf
v_and_b32_dpp v119, v97, v19 row_newbcast:15 row_mask:0xf bank_mask:0xf
s_waitcnt vmcnt(11)
v_mfma_f32_16x16x32_bf16 v[108:111], v[112:115], v[40:43], v[108:111]
buffer_load_dwordx4 v[40:43], v2, s[8:11], s45 offen offset:2048 nt
v_and_b32_dpp v112, v98, v16 row_newbcast:0 row_mask:0xf bank_mask:0xf
v_and_b32_dpp v113, v98, v17 row_newbcast:0 row_mask:0xf bank_mask:0xf
v_and_b32_dpp v114, v98, v18 row_newbcast:0 row_mask:0xf bank_mask:0xf
v_and_b32_dpp v115, v98, v19 row_newbcast:0 row_mask:0xf bank_mask:0xf
s_waitcnt vmcnt(11)
v_mfma_f32_16x16x32_bf16 v[108:111], v[116:119], v[44:47], v[108:111]
buffer_load_dwordx4 v[44:47], v2, s[8:11], s45 offen offset:3072
v_and_b32_dpp v116, v98, v16 row_newbcast:4 row_mask:0xf bank_mask:0xf
v_and_b32_dpp v117, v98, v17 row_newbcast:4 row_mask:0xf bank_mask:0xf
v_and_b32_dpp v118, v98, v18 row_newbcast:4 row_mask:0xf bank_mask:0xf
v_and_b32_dpp v119, v98, v19 row_newbcast:4 row_mask:0xf bank_mask:0xf
s_waitcnt vmcnt(11)
v_mfma_f32_16x16x32_bf16 v[108:111], v[112:115], v[48:51], v[108:111]
s_mov_b32 s45, 0x2b000
buffer_load_dwordx4 v[48:51], v2, s[8:11], s45 offen offset:0 nt
v_and_b32_dpp v112, v98, v16 row_newbcast:8 row_mask:0xf bank_mask:0xf
v_and_b32_dpp v113, v98, v17 row_newbcast:8 row_mask:0xf bank_mask:0xf
v_and_b32_dpp v114, v98, v18 row_newbcast:8 row_mask:0xf bank_mask:0xf
v_and_b32_dpp v115, v98, v19 row_newbcast:8 row_mask:0xf bank_mask:0xf
s_waitcnt vmcnt(11)
v_mfma_f32_16x16x32_bf16 v[108:111], v[116:119], v[52:55], v[108:111]
buffer_load_dwordx4 v[52:55], v2, s[8:11], s45 offen offset:1024 nt
v_and_b32_dpp v116, v98, v16 row_newbcast:12 row_mask:0xf bank_mask:0xf
v_and_b32_dpp v117, v98, v17 row_newbcast:12 row_mask:0xf bank_mask:0xf
v_and_b32_dpp v118, v98, v18 row_newbcast:12 row_mask:0xf bank_mask:0xf
v_and_b32_dpp v119, v98, v19 row_newbcast:12 row_mask:0xf bank_mask:0xf
s_waitcnt vmcnt(11)
v_mfma_f32_16x16x32_bf16 v[108:111], v[112:115], v[56:59], v[108:111]
buffer_load_dwordx4 v[56:59], v2, s[8:11], s45 offen offset:2048
v_and_b32_dpp v112, v98, v16 row_newbcast:1 row_mask:0xf bank_mask:0xf
v_and_b32_dpp v113, v98, v17 row_newbcast:1 row_mask:0xf bank_mask:0xf
v_and_b32_dpp v114, v98, v18 row_newbcast:1 row_mask:0xf bank_mask:0xf
v_and_b32_dpp v115, v98, v19 row_newbcast:1 row_mask:0xf bank_mask:0xf
s_waitcnt vmcnt(11)
v_mfma_f32_16x16x32_bf16 v[108:111], v[116:119], v[60:63], v[108:111]
buffer_load_dwordx4 v[60:63], v2, s[8:11], s45 offen offset:3072 nt
v_and_b32_dpp v116, v98, v16 row_newbcast:5 row_mask:0xf bank_mask:0xf
v_and_b32_dpp v117, v98, v17 row_newbcast:5 row_mask:0xf bank_mask:0xf
v_and_b32_dpp v118, v98, v18 row_newbcast:5 row_mask:0xf bank_mask:0xf
v_and_b32_dpp v119, v98, v19 row_newbcast:5 row_mask:0xf bank_mask:0xf
s_waitcnt vmcnt(11)
v_mfma_f32_16x16x32_bf16 v[108:111], v[112:115], v[64:67], v[108:111]
s_mov_b32 s45, 0x2c000
buffer_load_dwordx4 v[64:67], v2, s[8:11], s45 offen offset:0 nt
v_and_b32_dpp v112, v98, v16 row_newbcast:9 row_mask:0xf bank_mask:0xf
v_and_b32_dpp v113, v98, v17 row_newbcast:9 row_mask:0xf bank_mask:0xf
v_and_b32_dpp v114, v98, v18 row_newbcast:9 row_mask:0xf bank_mask:0xf
v_and_b32_dpp v115, v98, v19 row_newbcast:9 row_mask:0xf bank_mask:0xf
s_waitcnt vmcnt(11)
v_mfma_f32_16x16x32_bf16 v[108:111], v[116:119], v[68:71], v[108:111]
buffer_load_dwordx4 v[68:71], v2, s[8:11], s45 offen offset:1024
v_and_b32_dpp v116, v98, v16 row_newbcast:13 row_mask:0xf bank_mask:0xf
v_and_b32_dpp v117, v98, v17 row_newbcast:13 row_mask:0xf bank_mask:0xf
v_and_b32_dpp v118, v98, v18 row_newbcast:13 row_mask:0xf bank_mask:0xf
v_and_b32_dpp v119, v98, v19 row_newbcast:13 row_mask:0xf bank_mask:0xf
s_waitcnt vmcnt(11)
v_mfma_f32_16x16x32_bf16 v[108:111], v[112:115], v[24:27], v[108:111]
buffer_load_dwordx4 v[24:27], v2, s[8:11], s45 offen offset:2048 nt
v_and_b32_dpp v112, v98, v16 row_newbcast:2 row_mask:0xf bank_mask:0xf
v_and_b32_dpp v113, v98, v17 row_newbcast:2 row_mask:0xf bank_mask:0xf
v_and_b32_dpp v114, v98, v18 row_newbcast:2 row_mask:0xf bank_mask:0xf
v_and_b32_dpp v115, v98, v19 row_newbcast:2 row_mask:0xf bank_mask:0xf
s_waitcnt vmcnt(11)
v_mfma_f32_16x16x32_bf16 v[108:111], v[116:119], v[28:31], v[108:111]
buffer_load_dwordx4 v[28:31], v2, s[8:11], s45 offen offset:3072 nt
v_and_b32_dpp v116, v98, v16 row_newbcast:6 row_mask:0xf bank_mask:0xf
v_and_b32_dpp v117, v98, v17 row_newbcast:6 row_mask:0xf bank_mask:0xf
v_and_b32_dpp v118, v98, v18 row_newbcast:6 row_mask:0xf bank_mask:0xf
v_and_b32_dpp v119, v98, v19 row_newbcast:6 row_mask:0xf bank_mask:0xf
s_waitcnt vmcnt(11)
v_mfma_f32_16x16x32_bf16 v[108:111], v[112:115], v[32:35], v[108:111]
s_mov_b32 s45, 0x2d000
buffer_load_dwordx4 v[32:35], v2, s[8:11], s45 offen offset:0
v_and_b32_dpp v112, v98, v16 row_newbcast:10 row_mask:0xf bank_mask:0xf
v_and_b32_dpp v113, v98, v17 row_newbcast:10 row_mask:0xf bank_mask:0xf
v_and_b32_dpp v114, v98, v18 row_newbcast:10 row_mask:0xf bank_mask:0xf
v_and_b32_dpp v115, v98, v19 row_newbcast:10 row_mask:0xf bank_mask:0xf
s_waitcnt vmcnt(11)
v_mfma_f32_16x16x32_bf16 v[108:111], v[116:119], v[36:39], v[108:111]
buffer_load_dwordx4 v[36:39], v2, s[8:11], s45 offen offset:1024 nt
v_and_b32_dpp v116, v98, v16 row_newbcast:14 row_mask:0xf bank_mask:0xf
v_and_b32_dpp v117, v98, v17 row_newbcast:14 row_mask:0xf bank_mask:0xf
v_and_b32_dpp v118, v98, v18 row_newbcast:14 row_mask:0xf bank_mask:0xf
v_and_b32_dpp v119, v98, v19 row_newbcast:14 row_mask:0xf bank_mask:0xf
s_waitcnt vmcnt(11)
v_mfma_f32_16x16x32_bf16 v[108:111], v[112:115], v[40:43], v[108:111]
buffer_load_dwordx4 v[40:43], v2, s[8:11], s45 offen offset:2048 nt
v_and_b32_dpp v112, v98, v16 row_newbcast:3 row_mask:0xf bank_mask:0xf
v_and_b32_dpp v113, v98, v17 row_newbcast:3 row_mask:0xf bank_mask:0xf
v_and_b32_dpp v114, v98, v18 row_newbcast:3 row_mask:0xf bank_mask:0xf
v_and_b32_dpp v115, v98, v19 row_newbcast:3 row_mask:0xf bank_mask:0xf
s_waitcnt vmcnt(11)
v_mfma_f32_16x16x32_bf16 v[108:111], v[116:119], v[44:47], v[108:111]
buffer_load_dwordx4 v[44:47], v2, s[8:11], s45 offen offset:3072
v_and_b32_dpp v116, v98, v16 row_newbcast:7 row_mask:0xf bank_mask:0xf
v_and_b32_dpp v117, v98, v17 row_newbcast:7 row_mask:0xf bank_mask:0xf
v_and_b32_dpp v118, v98, v18 row_newbcast:7 row_mask:0xf bank_mask:0xf
v_and_b32_dpp v119, v98, v19 row_newbcast:7 row_mask:0xf bank_mask:0xf
s_waitcnt vmcnt(11)
v_mfma_f32_16x16x32_bf16 v[108:111], v[112:115], v[48:51], v[108:111]
s_mov_b32 s45, 0x2e000
buffer_load_dwordx4 v[48:51], v2, s[8:11], s45 offen offset:0 nt
v_and_b32_dpp v112, v98, v16 row_newbcast:11 row_mask:0xf bank_mask:0xf
v_and_b32_dpp v113, v98, v17 row_newbcast:11 row_mask:0xf bank_mask:0xf
v_and_b32_dpp v114, v98, v18 row_newbcast:11 row_mask:0xf bank_mask:0xf
v_and_b32_dpp v115, v98, v19 row_newbcast:11 row_mask:0xf bank_mask:0xf
s_waitcnt vmcnt(11)
v_mfma_f32_16x16x32_bf16 v[108:111], v[116:119], v[52:55], v[108:111]
buffer_load_dwordx4 v[52:55], v2, s[8:11], s45 offen offset:1024 nt
v_and_b32_dpp v116, v98, v16 row_newbcast:15 row_mask:0xf bank_mask:0xf
v_and_b32_dpp v117, v98, v17 row_newbcast:15 row_mask:0xf bank_mask:0xf
v_and_b32_dpp v118, v98, v18 row_newbcast:15 row_mask:0xf bank_mask:0xf
v_and_b32_dpp v119, v98, v19 row_newbcast:15 row_mask:0xf bank_mask:0xf
s_waitcnt vmcnt(11)
v_mfma_f32_16x16x32_bf16 v[108:111], v[112:115], v[56:59], v[108:111]
buffer_load_dwordx4 v[56:59], v2, s[8:11], s45 offen offset:2048
v_and_b32_dpp v112, v99, v16 row_newbcast:0 row_mask:0xf bank_mask:0xf
v_and_b32_dpp v113, v99, v17 row_newbcast:0 row_mask:0xf bank_mask:0xf
v_and_b32_dpp v114, v99, v18 row_newbcast:0 row_mask:0xf bank_mask:0xf
v_and_b32_dpp v115, v99, v19 row_newbcast:0 row_mask:0xf bank_mask:0xf
s_waitcnt vmcnt(11)
v_mfma_f32_16x16x32_bf16 v[108:111], v[116:119], v[60:63], v[108:111]
buffer_load_dwordx4 v[60:63], v2, s[8:11], s45 offen offset:3072 nt
v_and_b32_dpp v116, v99, v16 row_newbcast:4 row_mask:0xf bank_mask:0xf
v_and_b32_dpp v117, v99, v17 row_newbcast:4 row_mask:0xf bank_mask:0xf
v_and_b32_dpp v118, v99, v18 row_newbcast:4 row_mask:0xf bank_mask:0xf
v_and_b32_dpp v119, v99, v19 row_newbcast:4 row_mask:0xf bank_mask:0xf
s_waitcnt vmcnt(11)
v_mfma_f32_16x16x32_bf16 v[108:111], v[112:115], v[64:67], v[108:111]
s_mov_b32 s45, 0x2f000
buffer_load_dwordx4 v[64:67], v2, s[8:11], s45 offen offset:0 nt
v_and_b32_dpp v112, v99, v16 row_newbcast:8 row_mask:0xf bank_mask:0xf
v_and_b32_dpp v113, v99, v17 row_newbcast:8 row_mask:0xf bank_mask:0xf
v_and_b32_dpp v114, v99, v18 row_newbcast:8 row_mask:0xf bank_mask:0xf
v_and_b32_dpp v115, v99, v19 row_newbcast:8 row_mask:0xf bank_mask:0xf
s_waitcnt vmcnt(11)
v_mfma_f32_16x16x32_bf16 v[108:111], v[116:119], v[68:71], v[108:111]
buffer_load_dwordx4 v[68:71], v2, s[8:11], s45 offen offset:1024
v_and_b32_dpp v116, v99, v16 row_newbcast:12 row_mask:0xf bank_mask:0xf
v_and_b32_dpp v117, v99, v17 row_newbcast:12 row_mask:0xf bank_mask:0xf
v_and_b32_dpp v118, v99, v18 row_newbcast:12 row_mask:0xf bank_mask:0xf
v_and_b32_dpp v119, v99, v19 row_newbcast:12 row_mask:0xf bank_mask:0xf
s_waitcnt vmcnt(11)
v_mfma_f32_16x16x32_bf16 v[108:111], v[112:115], v[24:27], v[108:111]
buffer_load_dwordx4 v[24:27], v2, s[8:11], s45 offen offset:2048 nt
v_and_b32_dpp v112, v99, v16 row_newbcast:1 row_mask:0xf bank_mask:0xf
v_and_b32_dpp v113, v99, v17 row_newbcast:1 row_mask:0xf bank_mask:0xf
v_and_b32_dpp v114, v99, v18 row_newbcast:1 row_mask:0xf bank_mask:0xf
v_and_b32_dpp v115, v99, v19 row_newbcast:1 row_mask:0xf bank_mask:0xf
s_waitcnt vmcnt(11)
v_mfma_f32_16x16x32_bf16 v[108:111], v[116:119], v[28:31], v[108:111]
buffer_load_dwordx4 v[28:31], v2, s[8:11], s45 offen offset:3072 nt
v_and_b32_dpp v116, v99, v16 row_newbcast:5 row_mask:0xf bank_mask:0xf
v_and_b32_dpp v117, v99, v17 row_newbcast:5 row_mask:0xf bank_mask:0xf
v_and_b32_dpp v118, v99, v18 row_newbcast:5 row_mask:0xf bank_mask:0xf
v_and_b32_dpp v119, v99, v19 row_newbcast:5 row_mask:0xf bank_mask:0xf
s_waitcnt vmcnt(11)
v_mfma_f32_16x16x32_bf16 v[108:111], v[112:115], v[32:35], v[108:111]
s_mov_b32 s45, 0x30000
buffer_load_dwordx4 v[32:35], v2, s[8:11], s45 offen offset:0
v_and_b32_dpp v112, v99, v16 row_newbcast:9 row_mask:0xf bank_mask:0xf
v_and_b32_dpp v113, v99, v17 row_newbcast:9 row_mask:0xf bank_mask:0xf
v_and_b32_dpp v114, v99, v18 row_newbcast:9 row_mask:0xf bank_mask:0xf
v_and_b32_dpp v115, v99, v19 row_newbcast:9 row_mask:0xf bank_mask:0xf
s_waitcnt vmcnt(11)
v_mfma_f32_16x16x32_bf16 v[108:111], v[116:119], v[36:39], v[108:111]
buffer_load_dwordx4 v[36:39], v2, s[8:11], s45 offen offset:1024 nt
v_and_b32_dpp v116, v99, v16 row_newbcast:13 row_mask:0xf bank_mask:0xf
v_and_b32_dpp v117, v99, v17 row_newbcast:13 row_mask:0xf bank_mask:0xf
v_and_b32_dpp v118, v99, v18 row_newbcast:13 row_mask:0xf bank_mask:0xf
v_and_b32_dpp v119, v99, v19 row_newbcast:13 row_mask:0xf bank_mask:0xf
s_waitcnt vmcnt(11)
v_mfma_f32_16x16x32_bf16 v[108:111], v[112:115], v[40:43], v[108:111]
buffer_load_dwordx4 v[40:43], v2, s[8:11], s45 offen offset:2048 nt
v_and_b32_dpp v112, v99, v16 row_newbcast:2 row_mask:0xf bank_mask:0xf
v_and_b32_dpp v113, v99, v17 row_newbcast:2 row_mask:0xf bank_mask:0xf
v_and_b32_dpp v114, v99, v18 row_newbcast:2 row_mask:0xf bank_mask:0xf
v_and_b32_dpp v115, v99, v19 row_newbcast:2 row_mask:0xf bank_mask:0xf
s_waitcnt vmcnt(11)
v_mfma_f32_16x16x32_bf16 v[108:111], v[116:119], v[44:47], v[108:111]
buffer_load_dwordx4 v[44:47], v2, s[8:11], s45 offen offset:3072
v_and_b32_dpp v116, v99, v16 row_newbcast:6 row_mask:0xf bank_mask:0xf
v_and_b32_dpp v117, v99, v17 row_newbcast:6 row_mask:0xf bank_mask:0xf
v_and_b32_dpp v118, v99, v18 row_newbcast:6 row_mask:0xf bank_mask:0xf
v_and_b32_dpp v119, v99, v19 row_newbcast:6 row_mask:0xf bank_mask:0xf
s_waitcnt vmcnt(11)
v_mfma_f32_16x16x32_bf16 v[108:111], v[112:115], v[48:51], v[108:111]
s_mov_b32 s45, 0x31000
buffer_load_dwordx4 v[48:51], v2, s[8:11], s45 offen offset:0 nt
v_and_b32_dpp v112, v99, v16 row_newbcast:10 row_mask:0xf bank_mask:0xf
v_and_b32_dpp v113, v99, v17 row_newbcast:10 row_mask:0xf bank_mask:0xf
v_and_b32_dpp v114, v99, v18 row_newbcast:10 row_mask:0xf bank_mask:0xf
v_and_b32_dpp v115, v99, v19 row_newbcast:10 row_mask:0xf bank_mask:0xf
s_waitcnt vmcnt(11)
v_mfma_f32_16x16x32_bf16 v[108:111], v[116:119], v[52:55], v[108:111]
buffer_load_dwordx4 v[52:55], v2, s[8:11], s45 offen offset:1024 nt
v_and_b32_dpp v116, v99, v16 row_newbcast:14 row_mask:0xf bank_mask:0xf
v_and_b32_dpp v117, v99, v17 row_newbcast:14 row_mask:0xf bank_mask:0xf
v_and_b32_dpp v118, v99, v18 row_newbcast:14 row_mask:0xf bank_mask:0xf
v_and_b32_dpp v119, v99, v19 row_newbcast:14 row_mask:0xf bank_mask:0xf
s_waitcnt vmcnt(11)
v_mfma_f32_16x16x32_bf16 v[108:111], v[112:115], v[56:59], v[108:111]
buffer_load_dwordx4 v[56:59], v2, s[8:11], s45 offen offset:2048
v_and_b32_dpp v112, v99, v16 row_newbcast:3 row_mask:0xf bank_mask:0xf
v_and_b32_dpp v113, v99, v17 row_newbcast:3 row_mask:0xf bank_mask:0xf
v_and_b32_dpp v114, v99, v18 row_newbcast:3 row_mask:0xf bank_mask:0xf
v_and_b32_dpp v115, v99, v19 row_newbcast:3 row_mask:0xf bank_mask:0xf
s_waitcnt vmcnt(11)
v_mfma_f32_16x16x32_bf16 v[108:111], v[116:119], v[60:63], v[108:111]
buffer_load_dwordx4 v[60:63], v2, s[8:11], s45 offen offset:3072 nt
v_and_b32_dpp v116, v99, v16 row_newbcast:7 row_mask:0xf bank_mask:0xf
v_and_b32_dpp v117, v99, v17 row_newbcast:7 row_mask:0xf bank_mask:0xf
v_and_b32_dpp v118, v99, v18 row_newbcast:7 row_mask:0xf bank_mask:0xf
v_and_b32_dpp v119, v99, v19 row_newbcast:7 row_mask:0xf bank_mask:0xf
s_waitcnt vmcnt(11)
v_mfma_f32_16x16x32_bf16 v[108:111], v[112:115], v[64:67], v[108:111]
s_mov_b32 s45, 0x32000
buffer_load_dwordx4 v[64:67], v2, s[8:11], s45 offen offset:0 nt
v_and_b32_dpp v112, v99, v16 row_newbcast:11 row_mask:0xf bank_mask:0xf
v_and_b32_dpp v113, v99, v17 row_newbcast:11 row_mask:0xf bank_mask:0xf
v_and_b32_dpp v114, v99, v18 row_newbcast:11 row_mask:0xf bank_mask:0xf
v_and_b32_dpp v115, v99, v19 row_newbcast:11 row_mask:0xf bank_mask:0xf
s_waitcnt vmcnt(11)
v_mfma_f32_16x16x32_bf16 v[108:111], v[116:119], v[68:71], v[108:111]
buffer_load_dwordx4 v[68:71], v2, s[8:11], s45 offen offset:1024
v_and_b32_dpp v116, v99, v16 row_newbcast:15 row_mask:0xf bank_mask:0xf
v_and_b32_dpp v117, v99, v17 row_newbcast:15 row_mask:0xf bank_mask:0xf
v_and_b32_dpp v118, v99, v18 row_newbcast:15 row_mask:0xf bank_mask:0xf
v_and_b32_dpp v119, v99, v19 row_newbcast:15 row_mask:0xf bank_mask:0xf
s_waitcnt vmcnt(11)
v_mfma_f32_16x16x32_bf16 v[108:111], v[112:115], v[24:27], v[108:111]
buffer_load_dwordx4 v[24:27], v2, s[8:11], s45 offen offset:2048 nt
v_and_b32_dpp v112, v100, v16 row_newbcast:0 row_mask:0xf bank_mask:0xf
v_and_b32_dpp v113, v100, v17 row_newbcast:0 row_mask:0xf bank_mask:0xf
v_and_b32_dpp v114, v100, v18 row_newbcast:0 row_mask:0xf bank_mask:0xf
v_and_b32_dpp v115, v100, v19 row_newbcast:0 row_mask:0xf bank_mask:0xf
s_waitcnt vmcnt(11)
v_mfma_f32_16x16x32_bf16 v[108:111], v[116:119], v[28:31], v[108:111]
buffer_load_dwordx4 v[28:31], v2, s[8:11], s45 offen offset:3072 nt
v_and_b32_dpp v116, v100, v16 row_newbcast:4 row_mask:0xf bank_mask:0xf
v_and_b32_dpp v117, v100, v17 row_newbcast:4 row_mask:0xf bank_mask:0xf
v_and_b32_dpp v118, v100, v18 row_newbcast:4 row_mask:0xf bank_mask:0xf
v_and_b32_dpp v119, v100, v19 row_newbcast:4 row_mask:0xf bank_mask:0xf
s_waitcnt vmcnt(11)
v_mfma_f32_16x16x32_bf16 v[108:111], v[112:115], v[32:35], v[108:111]
s_mov_b32 s45, 0x33000
buffer_load_dwordx4 v[32:35], v2, s[8:11], s45 offen offset:0
v_and_b32_dpp v112, v100, v16 row_newbcast:8 row_mask:0xf bank_mask:0xf
v_and_b32_dpp v113, v100, v17 row_newbcast:8 row_mask:0xf bank_mask:0xf
v_and_b32_dpp v114, v100, v18 row_newbcast:8 row_mask:0xf bank_mask:0xf
v_and_b32_dpp v115, v100, v19 row_newbcast:8 row_mask:0xf bank_mask:0xf
s_waitcnt vmcnt(11)
v_mfma_f32_16x16x32_bf16 v[108:111], v[116:119], v[36:39], v[108:111]
buffer_load_dwordx4 v[36:39], v2, s[8:11], s45 offen offset:1024 nt
v_and_b32_dpp v116, v100, v16 row_newbcast:12 row_mask:0xf bank_mask:0xf
v_and_b32_dpp v117, v100, v17 row_newbcast:12 row_mask:0xf bank_mask:0xf
v_and_b32_dpp v118, v100, v18 row_newbcast:12 row_mask:0xf bank_mask:0xf
v_and_b32_dpp v119, v100, v19 row_newbcast:12 row_mask:0xf bank_mask:0xf
s_waitcnt vmcnt(11)
v_mfma_f32_16x16x32_bf16 v[108:111], v[112:115], v[40:43], v[108:111]
buffer_load_dwordx4 v[40:43], v2, s[8:11], s45 offen offset:2048 nt
v_and_b32_dpp v112, v100, v16 row_newbcast:1 row_mask:0xf bank_mask:0xf
v_and_b32_dpp v113, v100, v17 row_newbcast:1 row_mask:0xf bank_mask:0xf
v_and_b32_dpp v114, v100, v18 row_newbcast:1 row_mask:0xf bank_mask:0xf
v_and_b32_dpp v115, v100, v19 row_newbcast:1 row_mask:0xf bank_mask:0xf
s_waitcnt vmcnt(11)
v_mfma_f32_16x16x32_bf16 v[108:111], v[116:119], v[44:47], v[108:111]
buffer_load_dwordx4 v[44:47], v2, s[8:11], s45 offen offset:3072
v_and_b32_dpp v116, v100, v16 row_newbcast:5 row_mask:0xf bank_mask:0xf
v_and_b32_dpp v117, v100, v17 row_newbcast:5 row_mask:0xf bank_mask:0xf
v_and_b32_dpp v118, v100, v18 row_newbcast:5 row_mask:0xf bank_mask:0xf
v_and_b32_dpp v119, v100, v19 row_newbcast:5 row_mask:0xf bank_mask:0xf
s_waitcnt vmcnt(11)
v_mfma_f32_16x16x32_bf16 v[108:111], v[112:115], v[48:51], v[108:111]
s_mov_b32 s45, 0x34000
buffer_load_dwordx4 v[48:51], v2, s[8:11], s45 offen offset:0 nt
v_and_b32_dpp v112, v100, v16 row_newbcast:9 row_mask:0xf bank_mask:0xf
v_and_b32_dpp v113, v100, v17 row_newbcast:9 row_mask:0xf bank_mask:0xf
v_and_b32_dpp v114, v100, v18 row_newbcast:9 row_mask:0xf bank_mask:0xf
v_and_b32_dpp v115, v100, v19 row_newbcast:9 row_mask:0xf bank_mask:0xf
s_waitcnt vmcnt(11)
v_mfma_f32_16x16x32_bf16 v[108:111], v[116:119], v[52:55], v[108:111]
buffer_load_dwordx4 v[52:55], v2, s[8:11], s45 offen offset:1024 nt
v_and_b32_dpp v116, v100, v16 row_newbcast:13 row_mask:0xf bank_mask:0xf
v_and_b32_dpp v117, v100, v17 row_newbcast:13 row_mask:0xf bank_mask:0xf
v_and_b32_dpp v118, v100, v18 row_newbcast:13 row_mask:0xf bank_mask:0xf
v_and_b32_dpp v119, v100, v19 row_newbcast:13 row_mask:0xf bank_mask:0xf
s_waitcnt vmcnt(11)
v_mfma_f32_16x16x32_bf16 v[108:111], v[112:115], v[56:59], v[108:111]
buffer_load_dwordx4 v[56:59], v2, s[8:11], s45 offen offset:2048
v_and_b32_dpp v112, v100, v16 row_newbcast:2 row_mask:0xf bank_mask:0xf
v_and_b32_dpp v113, v100, v17 row_newbcast:2 row_mask:0xf bank_mask:0xf
v_and_b32_dpp v114, v100, v18 row_newbcast:2 row_mask:0xf bank_mask:0xf
v_and_b32_dpp v115, v100, v19 row_newbcast:2 row_mask:0xf bank_mask:0xf
s_waitcnt vmcnt(11)
v_mfma_f32_16x16x32_bf16 v[108:111], v[116:119], v[60:63], v[108:111]
buffer_load_dwordx4 v[60:63], v2, s[8:11], s45 offen offset:3072 nt
v_and_b32_dpp v116, v100, v16 row_newbcast:6 row_mask:0xf bank_mask:0xf
v_and_b32_dpp v117, v100, v17 row_newbcast:6 row_mask:0xf bank_mask:0xf
v_and_b32_dpp v118, v100, v18 row_newbcast:6 row_mask:0xf bank_mask:0xf
v_and_b32_dpp v119, v100, v19 row_newbcast:6 row_mask:0xf bank_mask:0xf
s_waitcnt vmcnt(11)
v_mfma_f32_16x16x32_bf16 v[108:111], v[112:115], v[64:67], v[108:111]
s_mov_b32 s45, 0x35000
buffer_load_dwordx4 v[64:67], v2, s[8:11], s45 offen offset:0 nt
v_and_b32_dpp v112, v100, v16 row_newbcast:10 row_mask:0xf bank_mask:0xf
v_and_b32_dpp v113, v100, v17 row_newbcast:10 row_mask:0xf bank_mask:0xf
v_and_b32_dpp v114, v100, v18 row_newbcast:10 row_mask:0xf bank_mask:0xf
v_and_b32_dpp v115, v100, v19 row_newbcast:10 row_mask:0xf bank_mask:0xf
s_waitcnt vmcnt(11)
v_mfma_f32_16x16x32_bf16 v[108:111], v[116:119], v[68:71], v[108:111]
buffer_load_dwordx4 v[68:71], v2, s[8:11], s45 offen offset:1024
v_and_b32_dpp v116, v100, v16 row_newbcast:14 row_mask:0xf bank_mask:0xf
v_and_b32_dpp v117, v100, v17 row_newbcast:14 row_mask:0xf bank_mask:0xf
v_and_b32_dpp v118, v100, v18 row_newbcast:14 row_mask:0xf bank_mask:0xf
v_and_b32_dpp v119, v100, v19 row_newbcast:14 row_mask:0xf bank_mask:0xf
s_waitcnt vmcnt(11)
v_mfma_f32_16x16x32_bf16 v[108:111], v[112:115], v[24:27], v[108:111]
buffer_load_dwordx4 v[24:27], v2, s[8:11], s45 offen offset:2048 nt
v_and_b32_dpp v112, v100, v16 row_newbcast:3 row_mask:0xf bank_mask:0xf
v_and_b32_dpp v113, v100, v17 row_newbcast:3 row_mask:0xf bank_mask:0xf
v_and_b32_dpp v114, v100, v18 row_newbcast:3 row_mask:0xf bank_mask:0xf
v_and_b32_dpp v115, v100, v19 row_newbcast:3 row_mask:0xf bank_mask:0xf
s_waitcnt vmcnt(11)
v_mfma_f32_16x16x32_bf16 v[108:111], v[116:119], v[28:31], v[108:111]
buffer_load_dwordx4 v[28:31], v2, s[8:11], s45 offen offset:3072 nt
v_and_b32_dpp v116, v100, v16 row_newbcast:7 row_mask:0xf bank_mask:0xf
v_and_b32_dpp v117, v100, v17 row_newbcast:7 row_mask:0xf bank_mask:0xf
v_and_b32_dpp v118, v100, v18 row_newbcast:7 row_mask:0xf bank_mask:0xf
v_and_b32_dpp v119, v100, v19 row_newbcast:7 row_mask:0xf bank_mask:0xf
s_waitcnt vmcnt(11)
v_mfma_f32_16x16x32_bf16 v[108:111], v[112:115], v[32:35], v[108:111]
s_mov_b32 s45, 0x36000
buffer_load_dwordx4 v[32:35], v2, s[8:11], s45 offen offset:0
v_and_b32_dpp v112, v100, v16 row_newbcast:11 row_mask:0xf bank_mask:0xf
v_and_b32_dpp v113, v100, v17 row_newbcast:11 row_mask:0xf bank_mask:0xf
v_and_b32_dpp v114, v100, v18 row_newbcast:11 row_mask:0xf bank_mask:0xf
v_and_b32_dpp v115, v100, v19 row_newbcast:11 row_mask:0xf bank_mask:0xf
s_waitcnt vmcnt(11)
v_mfma_f32_16x16x32_bf16 v[108:111], v[116:119], v[36:39], v[108:111]
buffer_load_dwordx4 v[36:39], v2, s[8:11], s45 offen offset:1024 nt
v_and_b32_dpp v116, v100, v16 row_newbcast:15 row_mask:0xf bank_mask:0xf
v_and_b32_dpp v117, v100, v17 row_newbcast:15 row_mask:0xf bank_mask:0xf
v_and_b32_dpp v118, v100, v18 row_newbcast:15 row_mask:0xf bank_mask:0xf
v_and_b32_dpp v119, v100, v19 row_newbcast:15 row_mask:0xf bank_mask:0xf
s_waitcnt vmcnt(11)
v_mfma_f32_16x16x32_bf16 v[108:111], v[112:115], v[40:43], v[108:111]
buffer_load_dwordx4 v[40:43], v2, s[8:11], s45 offen offset:2048 nt
v_and_b32_dpp v112, v101, v16 row_newbcast:0 row_mask:0xf bank_mask:0xf
v_and_b32_dpp v113, v101, v17 row_newbcast:0 row_mask:0xf bank_mask:0xf
v_and_b32_dpp v114, v101, v18 row_newbcast:0 row_mask:0xf bank_mask:0xf
v_and_b32_dpp v115, v101, v19 row_newbcast:0 row_mask:0xf bank_mask:0xf
s_waitcnt vmcnt(11)
v_mfma_f32_16x16x32_bf16 v[108:111], v[116:119], v[44:47], v[108:111]
buffer_load_dwordx4 v[44:47], v2, s[8:11], s45 offen offset:3072
v_and_b32_dpp v116, v101, v16 row_newbcast:4 row_mask:0xf bank_mask:0xf
v_and_b32_dpp v117, v101, v17 row_newbcast:4 row_mask:0xf bank_mask:0xf
v_and_b32_dpp v118, v101, v18 row_newbcast:4 row_mask:0xf bank_mask:0xf
v_and_b32_dpp v119, v101, v19 row_newbcast:4 row_mask:0xf bank_mask:0xf
s_waitcnt vmcnt(11)
v_mfma_f32_16x16x32_bf16 v[108:111], v[112:115], v[48:51], v[108:111]
s_mov_b32 s45, 0x37000
buffer_load_dwordx4 v[48:51], v2, s[8:11], s45 offen offset:0 nt
v_and_b32_dpp v112, v101, v16 row_newbcast:8 row_mask:0xf bank_mask:0xf
v_and_b32_dpp v113, v101, v17 row_newbcast:8 row_mask:0xf bank_mask:0xf
v_and_b32_dpp v114, v101, v18 row_newbcast:8 row_mask:0xf bank_mask:0xf
v_and_b32_dpp v115, v101, v19 row_newbcast:8 row_mask:0xf bank_mask:0xf
s_waitcnt vmcnt(11)
v_mfma_f32_16x16x32_bf16 v[108:111], v[116:119], v[52:55], v[108:111]
buffer_load_dwordx4 v[52:55], v2, s[8:11], s45 offen offset:1024 nt
v_and_b32_dpp v116, v101, v16 row_newbcast:12 row_mask:0xf bank_mask:0xf
v_and_b32_dpp v117, v101, v17 row_newbcast:12 row_mask:0xf bank_mask:0xf
v_and_b32_dpp v118, v101, v18 row_newbcast:12 row_mask:0xf bank_mask:0xf
v_and_b32_dpp v119, v101, v19 row_newbcast:12 row_mask:0xf bank_mask:0xf
s_waitcnt vmcnt(11)
v_mfma_f32_16x16x32_bf16 v[108:111], v[112:115], v[56:59], v[108:111]
buffer_load_dwordx4 v[56:59], v2, s[8:11], s45 offen offset:2048
v_and_b32_dpp v112, v101, v16 row_newbcast:1 row_mask:0xf bank_mask:0xf
v_and_b32_dpp v113, v101, v17 row_newbcast:1 row_mask:0xf bank_mask:0xf
v_and_b32_dpp v114, v101, v18 row_newbcast:1 row_mask:0xf bank_mask:0xf
v_and_b32_dpp v115, v101, v19 row_newbcast:1 row_mask:0xf bank_mask:0xf
s_waitcnt vmcnt(11)
v_mfma_f32_16x16x32_bf16 v[108:111], v[116:119], v[60:63], v[108:111]
buffer_load_dwordx4 v[60:63], v2, s[8:11], s45 offen offset:3072 nt
v_and_b32_dpp v116, v101, v16 row_newbcast:5 row_mask:0xf bank_mask:0xf
v_and_b32_dpp v117, v101, v17 row_newbcast:5 row_mask:0xf bank_mask:0xf
v_and_b32_dpp v118, v101, v18 row_newbcast:5 row_mask:0xf bank_mask:0xf
v_and_b32_dpp v119, v101, v19 row_newbcast:5 row_mask:0xf bank_mask:0xf
s_waitcnt vmcnt(11)
v_mfma_f32_16x16x32_bf16 v[108:111], v[112:115], v[64:67], v[108:111]
s_mov_b32 s45, 0x38000
buffer_load_dwordx4 v[64:67], v2, s[8:11], s45 offen offset:0 nt
v_and_b32_dpp v112, v101, v16 row_newbcast:9 row_mask:0xf bank_mask:0xf
v_and_b32_dpp v113, v101, v17 row_newbcast:9 row_mask:0xf bank_mask:0xf
v_and_b32_dpp v114, v101, v18 row_newbcast:9 row_mask:0xf bank_mask:0xf
v_and_b32_dpp v115, v101, v19 row_newbcast:9 row_mask:0xf bank_mask:0xf
s_waitcnt vmcnt(11)
v_mfma_f32_16x16x32_bf16 v[108:111], v[116:119], v[68:71], v[108:111]
buffer_load_dwordx4 v[68:71], v2, s[8:11], s45 offen offset:1024
v_and_b32_dpp v116, v101, v16 row_newbcast:13 row_mask:0xf bank_mask:0xf
v_and_b32_dpp v117, v101, v17 row_newbcast:13 row_mask:0xf bank_mask:0xf
v_and_b32_dpp v118, v101, v18 row_newbcast:13 row_mask:0xf bank_mask:0xf
v_and_b32_dpp v119, v101, v19 row_newbcast:13 row_mask:0xf bank_mask:0xf
s_waitcnt vmcnt(11)
v_mfma_f32_16x16x32_bf16 v[108:111], v[112:115], v[24:27], v[108:111]
buffer_load_dwordx4 v[24:27], v2, s[8:11], s45 offen offset:2048 nt
v_and_b32_dpp v112, v101, v16 row_newbcast:2 row_mask:0xf bank_mask:0xf
v_and_b32_dpp v113, v101, v17 row_newbcast:2 row_mask:0xf bank_mask:0xf
v_and_b32_dpp v114, v101, v18 row_newbcast:2 row_mask:0xf bank_mask:0xf
v_and_b32_dpp v115, v101, v19 row_newbcast:2 row_mask:0xf bank_mask:0xf
s_waitcnt vmcnt(11)
v_mfma_f32_16x16x32_bf16 v[108:111], v[116:119], v[28:31], v[108:111]
buffer_load_dwordx4 v[28:31], v2, s[8:11], s45 offen offset:3072 nt
v_and_b32_dpp v116, v101, v16 row_newbcast:6 row_mask:0xf bank_mask:0xf
v_and_b32_dpp v117, v101, v17 row_newbcast:6 row_mask:0xf bank_mask:0xf
v_and_b32_dpp v118, v101, v18 row_newbcast:6 row_mask:0xf bank_mask:0xf
v_and_b32_dpp v119, v101, v19 row_newbcast:6 row_mask:0xf bank_mask:0xf
s_waitcnt vmcnt(11)
v_mfma_f32_16x16x32_bf16 v[108:111], v[112:115], v[32:35], v[108:111]
s_mov_b32 s45, 0x39000
buffer_load_dwordx4 v[32:35], v2, s[8:11], s45 offen offset:0
v_and_b32_dpp v112, v101, v16 row_newbcast:10 row_mask:0xf bank_mask:0xf
v_and_b32_dpp v113, v101, v17 row_newbcast:10 row_mask:0xf bank_mask:0xf
v_and_b32_dpp v114, v101, v18 row_newbcast:10 row_mask:0xf bank_mask:0xf
v_and_b32_dpp v115, v101, v19 row_newbcast:10 row_mask:0xf bank_mask:0xf
s_waitcnt vmcnt(11)
v_mfma_f32_16x16x32_bf16 v[108:111], v[116:119], v[36:39], v[108:111]
buffer_load_dwordx4 v[36:39], v2, s[8:11], s45 offen offset:1024 nt
v_and_b32_dpp v116, v101, v16 row_newbcast:14 row_mask:0xf bank_mask:0xf
v_and_b32_dpp v117, v101, v17 row_newbcast:14 row_mask:0xf bank_mask:0xf
v_and_b32_dpp v118, v101, v18 row_newbcast:14 row_mask:0xf bank_mask:0xf
v_and_b32_dpp v119, v101, v19 row_newbcast:14 row_mask:0xf bank_mask:0xf
s_waitcnt vmcnt(11)
v_mfma_f32_16x16x32_bf16 v[108:111], v[112:115], v[40:43], v[108:111]
buffer_load_dwordx4 v[40:43], v2, s[8:11], s45 offen offset:2048 nt
v_and_b32_dpp v112, v101, v16 row_newbcast:3 row_mask:0xf bank_mask:0xf
v_and_b32_dpp v113, v101, v17 row_newbcast:3 row_mask:0xf bank_mask:0xf
v_and_b32_dpp v114, v101, v18 row_newbcast:3 row_mask:0xf bank_mask:0xf
v_and_b32_dpp v115, v101, v19 row_newbcast:3 row_mask:0xf bank_mask:0xf
s_waitcnt vmcnt(11)
v_mfma_f32_16x16x32_bf16 v[108:111], v[116:119], v[44:47], v[108:111]
buffer_load_dwordx4 v[44:47], v2, s[8:11], s45 offen offset:3072
v_and_b32_dpp v116, v101, v16 row_newbcast:7 row_mask:0xf bank_mask:0xf
v_and_b32_dpp v117, v101, v17 row_newbcast:7 row_mask:0xf bank_mask:0xf
v_and_b32_dpp v118, v101, v18 row_newbcast:7 row_mask:0xf bank_mask:0xf
v_and_b32_dpp v119, v101, v19 row_newbcast:7 row_mask:0xf bank_mask:0xf
s_waitcnt vmcnt(11)
v_mfma_f32_16x16x32_bf16 v[108:111], v[112:115], v[48:51], v[108:111]
s_mov_b32 s45, 0x3a000
buffer_load_dwordx4 v[48:51], v2, s[8:11], s45 offen offset:0 nt
v_and_b32_dpp v112, v101, v16 row_newbcast:11 row_mask:0xf bank_mask:0xf
v_and_b32_dpp v113, v101, v17 row_newbcast:11 row_mask:0xf bank_mask:0xf
v_and_b32_dpp v114, v101, v18 row_newbcast:11 row_mask:0xf bank_mask:0xf
v_and_b32_dpp v115, v101, v19 row_newbcast:11 row_mask:0xf bank_mask:0xf
s_waitcnt vmcnt(11)
v_mfma_f32_16x16x32_bf16 v[108:111], v[116:119], v[52:55], v[108:111]
buffer_load_dwordx4 v[52:55], v2, s[8:11], s45 offen offset:1024 nt
v_and_b32_dpp v116, v101, v16 row_newbcast:15 row_mask:0xf bank_mask:0xf
v_and_b32_dpp v117, v101, v17 row_newbcast:15 row_mask:0xf bank_mask:0xf
v_and_b32_dpp v118, v101, v18 row_newbcast:15 row_mask:0xf bank_mask:0xf
v_and_b32_dpp v119, v101, v19 row_newbcast:15 row_mask:0xf bank_mask:0xf
s_waitcnt vmcnt(11)
v_mfma_f32_16x16x32_bf16 v[108:111], v[112:115], v[56:59], v[108:111]
buffer_load_dwordx4 v[56:59], v2, s[8:11], s45 offen offset:2048
v_and_b32_dpp v112, v102, v16 row_newbcast:0 row_mask:0xf bank_mask:0xf
v_and_b32_dpp v113, v102, v17 row_newbcast:0 row_mask:0xf bank_mask:0xf
v_and_b32_dpp v114, v102, v18 row_newbcast:0 row_mask:0xf bank_mask:0xf
v_and_b32_dpp v115, v102, v19 row_newbcast:0 row_mask:0xf bank_mask:0xf
s_waitcnt vmcnt(11)
v_mfma_f32_16x16x32_bf16 v[108:111], v[116:119], v[60:63], v[108:111]
buffer_load_dwordx4 v[60:63], v2, s[8:11], s45 offen offset:3072 nt
v_and_b32_dpp v116, v102, v16 row_newbcast:4 row_mask:0xf bank_mask:0xf
v_and_b32_dpp v117, v102, v17 row_newbcast:4 row_mask:0xf bank_mask:0xf
v_and_b32_dpp v118, v102, v18 row_newbcast:4 row_mask:0xf bank_mask:0xf
v_and_b32_dpp v119, v102, v19 row_newbcast:4 row_mask:0xf bank_mask:0xf
s_waitcnt vmcnt(11)
v_mfma_f32_16x16x32_bf16 v[108:111], v[112:115], v[64:67], v[108:111]
s_mov_b32 s45, 0x3b000
buffer_load_dwordx4 v[64:67], v2, s[8:11], s45 offen offset:0 nt
v_and_b32_dpp v112, v102, v16 row_newbcast:8 row_mask:0xf bank_mask:0xf
v_and_b32_dpp v113, v102, v17 row_newbcast:8 row_mask:0xf bank_mask:0xf
v_and_b32_dpp v114, v102, v18 row_newbcast:8 row_mask:0xf bank_mask:0xf
v_and_b32_dpp v115, v102, v19 row_newbcast:8 row_mask:0xf bank_mask:0xf
s_waitcnt vmcnt(11)
v_mfma_f32_16x16x32_bf16 v[108:111], v[116:119], v[68:71], v[108:111]
buffer_load_dwordx4 v[68:71], v2, s[8:11], s45 offen offset:1024
v_and_b32_dpp v116, v102, v16 row_newbcast:12 row_mask:0xf bank_mask:0xf
v_and_b32_dpp v117, v102, v17 row_newbcast:12 row_mask:0xf bank_mask:0xf
v_and_b32_dpp v118, v102, v18 row_newbcast:12 row_mask:0xf bank_mask:0xf
v_and_b32_dpp v119, v102, v19 row_newbcast:12 row_mask:0xf bank_mask:0xf
s_waitcnt vmcnt(11)
v_mfma_f32_16x16x32_bf16 v[108:111], v[112:115], v[24:27], v[108:111]
buffer_load_dwordx4 v[24:27], v2, s[8:11], s45 offen offset:2048 nt
v_and_b32_dpp v112, v102, v16 row_newbcast:1 row_mask:0xf bank_mask:0xf
v_and_b32_dpp v113, v102, v17 row_newbcast:1 row_mask:0xf bank_mask:0xf
v_and_b32_dpp v114, v102, v18 row_newbcast:1 row_mask:0xf bank_mask:0xf
v_and_b32_dpp v115, v102, v19 row_newbcast:1 row_mask:0xf bank_mask:0xf
s_waitcnt vmcnt(11)
v_mfma_f32_16x16x32_bf16 v[108:111], v[116:119], v[28:31], v[108:111]
buffer_load_dwordx4 v[28:31], v2, s[8:11], s45 offen offset:3072 nt
v_and_b32_dpp v116, v102, v16 row_newbcast:5 row_mask:0xf bank_mask:0xf
v_and_b32_dpp v117, v102, v17 row_newbcast:5 row_mask:0xf bank_mask:0xf
v_and_b32_dpp v118, v102, v18 row_newbcast:5 row_mask:0xf bank_mask:0xf
v_and_b32_dpp v119, v102, v19 row_newbcast:5 row_mask:0xf bank_mask:0xf
s_waitcnt vmcnt(11)
v_mfma_f32_16x16x32_bf16 v[108:111], v[112:115], v[32:35], v[108:111]
s_mov_b32 s45, 0x3c000
buffer_load_dwordx4 v[32:35], v2, s[8:11], s45 offen offset:0
v_and_b32_dpp v112, v102, v16 row_newbcast:9 row_mask:0xf bank_mask:0xf
v_and_b32_dpp v113, v102, v17 row_newbcast:9 row_mask:0xf bank_mask:0xf
v_and_b32_dpp v114, v102, v18 row_newbcast:9 row_mask:0xf bank_mask:0xf
v_and_b32_dpp v115, v102, v19 row_newbcast:9 row_mask:0xf bank_mask:0xf
s_waitcnt vmcnt(11)
v_mfma_f32_16x16x32_bf16 v[108:111], v[116:119], v[36:39], v[108:111]
buffer_load_dwordx4 v[36:39], v2, s[8:11], s45 offen offset:1024 nt
v_and_b32_dpp v116, v102, v16 row_newbcast:13 row_mask:0xf bank_mask:0xf
v_and_b32_dpp v117, v102, v17 row_newbcast:13 row_mask:0xf bank_mask:0xf
v_and_b32_dpp v118, v102, v18 row_newbcast:13 row_mask:0xf bank_mask:0xf
v_and_b32_dpp v119, v102, v19 row_newbcast:13 row_mask:0xf bank_mask:0xf
s_waitcnt vmcnt(11)
v_mfma_f32_16x16x32_bf16 v[108:111], v[112:115], v[40:43], v[108:111]
buffer_load_dwordx4 v[40:43], v2, s[8:11], s45 offen offset:2048 nt
v_and_b32_dpp v112, v102, v16 row_newbcast:2 row_mask:0xf bank_mask:0xf
v_and_b32_dpp v113, v102, v17 row_newbcast:2 row_mask:0xf bank_mask:0xf
v_and_b32_dpp v114, v102, v18 row_newbcast:2 row_mask:0xf bank_mask:0xf
v_and_b32_dpp v115, v102, v19 row_newbcast:2 row_mask:0xf bank_mask:0xf
s_waitcnt vmcnt(11)
v_mfma_f32_16x16x32_bf16 v[108:111], v[116:119], v[44:47], v[108:111]
buffer_load_dwordx4 v[44:47], v2, s[8:11], s45 offen offset:3072
v_and_b32_dpp v116, v102, v16 row_newbcast:6 row_mask:0xf bank_mask:0xf
v_and_b32_dpp v117, v102, v17 row_newbcast:6 row_mask:0xf bank_mask:0xf
v_and_b32_dpp v118, v102, v18 row_newbcast:6 row_mask:0xf bank_mask:0xf
v_and_b32_dpp v119, v102, v19 row_newbcast:6 row_mask:0xf bank_mask:0xf
s_waitcnt vmcnt(11)
v_mfma_f32_16x16x32_bf16 v[108:111], v[112:115], v[48:51], v[108:111]
s_mov_b32 s45, 0x3d000
buffer_load_dwordx4 v[48:51], v2, s[8:11], s45 offen offset:0 nt
v_and_b32_dpp v112, v102, v16 row_newbcast:10 row_mask:0xf bank_mask:0xf
v_and_b32_dpp v113, v102, v17 row_newbcast:10 row_mask:0xf bank_mask:0xf
v_and_b32_dpp v114, v102, v18 row_newbcast:10 row_mask:0xf bank_mask:0xf
v_and_b32_dpp v115, v102, v19 row_newbcast:10 row_mask:0xf bank_mask:0xf
s_waitcnt vmcnt(11)
v_mfma_f32_16x16x32_bf16 v[108:111], v[116:119], v[52:55], v[108:111]
buffer_load_dwordx4 v[52:55], v2, s[8:11], s45 offen offset:1024 nt
v_and_b32_dpp v116, v102, v16 row_newbcast:14 row_mask:0xf bank_mask:0xf
v_and_b32_dpp v117, v102, v17 row_newbcast:14 row_mask:0xf bank_mask:0xf
v_and_b32_dpp v118, v102, v18 row_newbcast:14 row_mask:0xf bank_mask:0xf
v_and_b32_dpp v119, v102, v19 row_newbcast:14 row_mask:0xf bank_mask:0xf
s_waitcnt vmcnt(11)
v_mfma_f32_16x16x32_bf16 v[108:111], v[112:115], v[56:59], v[108:111]
buffer_load_dwordx4 v[56:59], v2, s[8:11], s45 offen offset:2048
v_and_b32_dpp v112, v102, v16 row_newbcast:3 row_mask:0xf bank_mask:0xf
v_and_b32_dpp v113, v102, v17 row_newbcast:3 row_mask:0xf bank_mask:0xf
v_and_b32_dpp v114, v102, v18 row_newbcast:3 row_mask:0xf bank_mask:0xf
v_and_b32_dpp v115, v102, v19 row_newbcast:3 row_mask:0xf bank_mask:0xf
s_waitcnt vmcnt(11)
v_mfma_f32_16x16x32_bf16 v[108:111], v[116:119], v[60:63], v[108:111]
buffer_load_dwordx4 v[60:63], v2, s[8:11], s45 offen offset:3072 nt
v_and_b32_dpp v116, v102, v16 row_newbcast:7 row_mask:0xf bank_mask:0xf
v_and_b32_dpp v117, v102, v17 row_newbcast:7 row_mask:0xf bank_mask:0xf
v_and_b32_dpp v118, v102, v18 row_newbcast:7 row_mask:0xf bank_mask:0xf
v_and_b32_dpp v119, v102, v19 row_newbcast:7 row_mask:0xf bank_mask:0xf
s_waitcnt vmcnt(11)
v_mfma_f32_16x16x32_bf16 v[108:111], v[112:115], v[64:67], v[108:111]
s_mov_b32 s45, 0x3e000
buffer_load_dwordx4 v[64:67], v2, s[8:11], s45 offen offset:0 nt
v_and_b32_dpp v112, v102, v16 row_newbcast:11 row_mask:0xf bank_mask:0xf
v_and_b32_dpp v113, v102, v17 row_newbcast:11 row_mask:0xf bank_mask:0xf
v_and_b32_dpp v114, v102, v18 row_newbcast:11 row_mask:0xf bank_mask:0xf
v_and_b32_dpp v115, v102, v19 row_newbcast:11 row_mask:0xf bank_mask:0xf
s_waitcnt vmcnt(11)
v_mfma_f32_16x16x32_bf16 v[108:111], v[116:119], v[68:71], v[108:111]
buffer_load_dwordx4 v[68:71], v2, s[8:11], s45 offen offset:1024
v_and_b32_dpp v116, v102, v16 row_newbcast:15 row_mask:0xf bank_mask:0xf
v_and_b32_dpp v117, v102, v17 row_newbcast:15 row_mask:0xf bank_mask:0xf
v_and_b32_dpp v118, v102, v18 row_newbcast:15 row_mask:0xf bank_mask:0xf
v_and_b32_dpp v119, v102, v19 row_newbcast:15 row_mask:0xf bank_mask:0xf
s_waitcnt vmcnt(11)
v_mfma_f32_16x16x32_bf16 v[108:111], v[112:115], v[24:27], v[108:111]
buffer_load_dwordx4 v[24:27], v2, s[8:11], s45 offen offset:2048 nt
v_and_b32_dpp v112, v103, v16 row_newbcast:0 row_mask:0xf bank_mask:0xf
v_and_b32_dpp v113, v103, v17 row_newbcast:0 row_mask:0xf bank_mask:0xf
v_and_b32_dpp v114, v103, v18 row_newbcast:0 row_mask:0xf bank_mask:0xf
v_and_b32_dpp v115, v103, v19 row_newbcast:0 row_mask:0xf bank_mask:0xf
s_waitcnt vmcnt(11)
v_mfma_f32_16x16x32_bf16 v[108:111], v[116:119], v[28:31], v[108:111]
buffer_load_dwordx4 v[28:31], v2, s[8:11], s45 offen offset:3072 nt
v_and_b32_dpp v116, v103, v16 row_newbcast:4 row_mask:0xf bank_mask:0xf
v_and_b32_dpp v117, v103, v17 row_newbcast:4 row_mask:0xf bank_mask:0xf
v_and_b32_dpp v118, v103, v18 row_newbcast:4 row_mask:0xf bank_mask:0xf
v_and_b32_dpp v119, v103, v19 row_newbcast:4 row_mask:0xf bank_mask:0xf
s_waitcnt vmcnt(11)
v_mfma_f32_16x16x32_bf16 v[108:111], v[112:115], v[32:35], v[108:111]
s_mov_b32 s45, 0x3f000
buffer_load_dwordx4 v[32:35], v2, s[8:11], s45 offen offset:0
v_and_b32_dpp v112, v103, v16 row_newbcast:8 row_mask:0xf bank_mask:0xf
v_and_b32_dpp v113, v103, v17 row_newbcast:8 row_mask:0xf bank_mask:0xf
v_and_b32_dpp v114, v103, v18 row_newbcast:8 row_mask:0xf bank_mask:0xf
v_and_b32_dpp v115, v103, v19 row_newbcast:8 row_mask:0xf bank_mask:0xf
s_waitcnt vmcnt(11)
v_mfma_f32_16x16x32_bf16 v[108:111], v[116:119], v[36:39], v[108:111]
buffer_load_dwordx4 v[36:39], v2, s[8:11], s45 offen offset:1024 nt
v_and_b32_dpp v116, v103, v16 row_newbcast:12 row_mask:0xf bank_mask:0xf
v_and_b32_dpp v117, v103, v17 row_newbcast:12 row_mask:0xf bank_mask:0xf
v_and_b32_dpp v118, v103, v18 row_newbcast:12 row_mask:0xf bank_mask:0xf
v_and_b32_dpp v119, v103, v19 row_newbcast:12 row_mask:0xf bank_mask:0xf
s_waitcnt vmcnt(11)
v_mfma_f32_16x16x32_bf16 v[108:111], v[112:115], v[40:43], v[108:111]
buffer_load_dwordx4 v[40:43], v2, s[8:11], s45 offen offset:2048 nt
v_and_b32_dpp v112, v103, v16 row_newbcast:1 row_mask:0xf bank_mask:0xf
v_and_b32_dpp v113, v103, v17 row_newbcast:1 row_mask:0xf bank_mask:0xf
v_and_b32_dpp v114, v103, v18 row_newbcast:1 row_mask:0xf bank_mask:0xf
v_and_b32_dpp v115, v103, v19 row_newbcast:1 row_mask:0xf bank_mask:0xf
s_waitcnt vmcnt(11)
v_mfma_f32_16x16x32_bf16 v[108:111], v[116:119], v[44:47], v[108:111]
buffer_load_dwordx4 v[44:47], v2, s[8:11], s45 offen offset:3072
v_and_b32_dpp v116, v103, v16 row_newbcast:5 row_mask:0xf bank_mask:0xf
v_and_b32_dpp v117, v103, v17 row_newbcast:5 row_mask:0xf bank_mask:0xf
v_and_b32_dpp v118, v103, v18 row_newbcast:5 row_mask:0xf bank_mask:0xf
v_and_b32_dpp v119, v103, v19 row_newbcast:5 row_mask:0xf bank_mask:0xf
s_waitcnt vmcnt(11)
v_mfma_f32_16x16x32_bf16 v[108:111], v[112:115], v[48:51], v[108:111]
buffer_load_dwordx4 v[48:51], v5, s[16:19], 0 offen offset:0
v_and_b32_dpp v112, v103, v16 row_newbcast:9 row_mask:0xf bank_mask:0xf
v_and_b32_dpp v113, v103, v17 row_newbcast:9 row_mask:0xf bank_mask:0xf
v_and_b32_dpp v114, v103, v18 row_newbcast:9 row_mask:0xf bank_mask:0xf
v_and_b32_dpp v115, v103, v19 row_newbcast:9 row_mask:0xf bank_mask:0xf
s_waitcnt vmcnt(11)
v_mfma_f32_16x16x32_bf16 v[108:111], v[116:119], v[52:55], v[108:111]
s_mov_b32 s45, 0x1000
buffer_load_dwordx4 v[52:55], v5, s[16:19], s45 offen offset:0
v_and_b32_dpp v116, v103, v16 row_newbcast:13 row_mask:0xf bank_mask:0xf
v_and_b32_dpp v117, v103, v17 row_newbcast:13 row_mask:0xf bank_mask:0xf
v_and_b32_dpp v118, v103, v18 row_newbcast:13 row_mask:0xf bank_mask:0xf
v_and_b32_dpp v119, v103, v19 row_newbcast:13 row_mask:0xf bank_mask:0xf
s_waitcnt vmcnt(11)
v_mfma_f32_16x16x32_bf16 v[108:111], v[112:115], v[56:59], v[108:111]
s_mov_b32 s45, 0x2000
buffer_load_dwordx4 v[56:59], v5, s[16:19], s45 offen offset:0
v_and_b32_dpp v112, v103, v16 row_newbcast:2 row_mask:0xf bank_mask:0xf
v_and_b32_dpp v113, v103, v17 row_newbcast:2 row_mask:0xf bank_mask:0xf
v_and_b32_dpp v114, v103, v18 row_newbcast:2 row_mask:0xf bank_mask:0xf
v_and_b32_dpp v115, v103, v19 row_newbcast:2 row_mask:0xf bank_mask:0xf
s_waitcnt vmcnt(11)
v_mfma_f32_16x16x32_bf16 v[108:111], v[116:119], v[60:63], v[108:111]
s_mov_b32 s45, 0x3000
buffer_load_dwordx4 v[60:63], v5, s[16:19], s45 offen offset:0
v_and_b32_dpp v116, v103, v16 row_newbcast:6 row_mask:0xf bank_mask:0xf
v_and_b32_dpp v117, v103, v17 row_newbcast:6 row_mask:0xf bank_mask:0xf
v_and_b32_dpp v118, v103, v18 row_newbcast:6 row_mask:0xf bank_mask:0xf
v_and_b32_dpp v119, v103, v19 row_newbcast:6 row_mask:0xf bank_mask:0xf
s_waitcnt vmcnt(11)
v_mfma_f32_16x16x32_bf16 v[108:111], v[112:115], v[64:67], v[108:111]
s_mov_b32 s45, 0x4000
buffer_load_dwordx4 v[64:67], v5, s[16:19], s45 offen offset:0
v_and_b32_dpp v112, v103, v16 row_newbcast:10 row_mask:0xf bank_mask:0xf
v_and_b32_dpp v113, v103, v17 row_newbcast:10 row_mask:0xf bank_mask:0xf
v_and_b32_dpp v114, v103, v18 row_newbcast:10 row_mask:0xf bank_mask:0xf
v_and_b32_dpp v115, v103, v19 row_newbcast:10 row_mask:0xf bank_mask:0xf
s_waitcnt vmcnt(11)
v_mfma_f32_16x16x32_bf16 v[108:111], v[116:119], v[68:71], v[108:111]
s_mov_b32 s45, 0x5000
buffer_load_dwordx4 v[68:71], v5, s[16:19], s45 offen offset:0
v_and_b32_dpp v116, v103, v16 row_newbcast:14 row_mask:0xf bank_mask:0xf
v_and_b32_dpp v117, v103, v17 row_newbcast:14 row_mask:0xf bank_mask:0xf
v_and_b32_dpp v118, v103, v18 row_newbcast:14 row_mask:0xf bank_mask:0xf
v_and_b32_dpp v119, v103, v19 row_newbcast:14 row_mask:0xf bank_mask:0xf
s_waitcnt vmcnt(11)
v_mfma_f32_16x16x32_bf16 v[108:111], v[112:115], v[24:27], v[108:111]
s_mov_b32 s45, 0x6000
buffer_load_dwordx4 v[24:27], v5, s[16:19], s45 offen offset:0
v_and_b32_dpp v112, v103, v16 row_newbcast:3 row_mask:0xf bank_mask:0xf
v_and_b32_dpp v113, v103, v17 row_newbcast:3 row_mask:0xf bank_mask:0xf
v_and_b32_dpp v114, v103, v18 row_newbcast:3 row_mask:0xf bank_mask:0xf
v_and_b32_dpp v115, v103, v19 row_newbcast:3 row_mask:0xf bank_mask:0xf
s_waitcnt vmcnt(11)
v_mfma_f32_16x16x32_bf16 v[108:111], v[116:119], v[28:31], v[108:111]
s_mov_b32 s45, 0x7000
buffer_load_dwordx4 v[28:31], v5, s[16:19], s45 offen offset:0
v_and_b32_dpp v116, v103, v16 row_newbcast:7 row_mask:0xf bank_mask:0xf
v_and_b32_dpp v117, v103, v17 row_newbcast:7 row_mask:0xf bank_mask:0xf
v_and_b32_dpp v118, v103, v18 row_newbcast:7 row_mask:0xf bank_mask:0xf
v_and_b32_dpp v119, v103, v19 row_newbcast:7 row_mask:0xf bank_mask:0xf
s_waitcnt vmcnt(11)
v_mfma_f32_16x16x32_bf16 v[108:111], v[112:115], v[32:35], v[108:111]
s_mov_b32 s45, 0x8000
buffer_load_dwordx4 v[32:35], v5, s[16:19], s45 offen offset:0
v_and_b32_dpp v112, v103, v16 row_newbcast:11 row_mask:0xf bank_mask:0xf
v_and_b32_dpp v113, v103, v17 row_newbcast:11 row_mask:0xf bank_mask:0xf
v_and_b32_dpp v114, v103, v18 row_newbcast:11 row_mask:0xf bank_mask:0xf
v_and_b32_dpp v115, v103, v19 row_newbcast:11 row_mask:0xf bank_mask:0xf
s_waitcnt vmcnt(11)
v_mfma_f32_16x16x32_bf16 v[108:111], v[116:119], v[36:39], v[108:111]
s_mov_b32 s45, 0x9000
buffer_load_dwordx4 v[36:39], v5, s[16:19], s45 offen offset:0
v_and_b32_dpp v116, v103, v16 row_newbcast:15 row_mask:0xf bank_mask:0xf
v_and_b32_dpp v117, v103, v17 row_newbcast:15 row_mask:0xf bank_mask:0xf
v_and_b32_dpp v118, v103, v18 row_newbcast:15 row_mask:0xf bank_mask:0xf
v_and_b32_dpp v119, v103, v19 row_newbcast:15 row_mask:0xf bank_mask:0xf
s_waitcnt vmcnt(11)
v_mfma_f32_16x16x32_bf16 v[108:111], v[112:115], v[40:43], v[108:111]
s_mov_b32 s45, 0xa000
buffer_load_dwordx4 v[40:43], v5, s[16:19], s45 offen offset:0
s_nop 1
s_waitcnt vmcnt(11)
v_mfma_f32_16x16x32_bf16 v[108:111], v[116:119], v[44:47], v[108:111]
s_mov_b32 s45, 0xb000
buffer_load_dwordx4 v[44:47], v5, s[16:19], s45 offen offset:0
s_nop 7
s_mov_b32 exec_hi, 0
ds_write_b128 v11, v[108:111] offset:4096
s_mov_b32 exec_hi, -1
v_mov_b32 v15, s44
v_lshlrev_b32 v15, 3, v15
v_add_u32 v15, 0x26000, v15
ds_write_b64 v15, v[132:133]
s_waitcnt lgkmcnt(0)
s_barrier
v_mov_b32 v15, 0x26000
ds_read_b128 v[120:123], v15
ds_read_b128 v[124:127], v15 offset:16
ds_read_b32 v72, v9 offset:4096
ds_read_b32 v73, v9 offset:4352
ds_read_b32 v74, v9 offset:4608
ds_read_b32 v75, v9 offset:4864
ds_read_b32 v76, v9 offset:5120
ds_read_b32 v77, v9 offset:5376
ds_read_b32 v78, v9 offset:5632
ds_read_b32 v79, v9 offset:5888
s_waitcnt lgkmcnt(8)
v_max3_f32 v128, v120, v122, v124
v_max_f32 v128, v128, v126
v_sub_f32 v120, v120, v128
v_sub_f32 v122, v122, v128
v_sub_f32 v124, v124, v128
v_sub_f32 v126, v126, v128
v_exp_f32 v120, v120
v_exp_f32 v122, v122
v_exp_f32 v124, v124
v_exp_f32 v126, v126
s_nop 0
v_mul_f32 v128, v120, v121
v_fmac_f32 v128, v122, v123
v_fmac_f32 v128, v124, v125
v_fmac_f32 v128, v126, v127
v_rcp_f32 v128, v128
s_waitcnt lgkmcnt(0)
v_mul_f32 v130, v72, v120
v_fmac_f32 v130, v74, v122
v_fmac_f32 v130, v76, v124
v_fmac_f32 v130, v78, v126
v_mul_f32 v130, v130, v128
v_cvt_pk_bf16_f32 v88, v130, v130
v_mul_f32 v131, v73, v120
v_fmac_f32 v131, v75, v122
v_fmac_f32 v131, v77, v124
v_fmac_f32 v131, v79, v126
v_mul_f32 v131, v131, v128
v_cvt_pk_bf16_f32 v89, v131, v131
s_nop 1
v_and_b32_dpp v112, v88, v16 row_newbcast:0 row_mask:0xf bank_mask:0xf
v_and_b32_dpp v113, v88, v17 row_newbcast:0 row_mask:0xf bank_mask:0xf
v_and_b32_dpp v114, v88, v18 row_newbcast:0 row_mask:0xf bank_mask:0xf
v_and_b32_dpp v115, v88, v19 row_newbcast:0 row_mask:0xf bank_mask:0xf
v_and_b32_dpp v116, v88, v16 row_newbcast:1 row_mask:0xf bank_mask:0xf
v_and_b32_dpp v117, v88, v17 row_newbcast:1 row_mask:0xf bank_mask:0xf
v_and_b32_dpp v118, v88, v18 row_newbcast:1 row_mask:0xf bank_mask:0xf
v_and_b32_dpp v119, v88, v19 row_newbcast:1 row_mask:0xf bank_mask:0xf
s_waitcnt vmcnt(11)
v_mfma_f32_16x16x32_bf16 v[104:107], v[112:115], v[48:51], 0
s_mov_b32 s45, 0xc000
buffer_load_dwordx4 v[48:51], v5, s[16:19], s45 offen offset:0
v_and_b32_dpp v112, v88, v16 row_newbcast:2 row_mask:0xf bank_mask:0xf
v_and_b32_dpp v113, v88, v17 row_newbcast:2 row_mask:0xf bank_mask:0xf
v_and_b32_dpp v114, v88, v18 row_newbcast:2 row_mask:0xf bank_mask:0xf
v_and_b32_dpp v115, v88, v19 row_newbcast:2 row_mask:0xf bank_mask:0xf
s_waitcnt vmcnt(11)
v_mfma_f32_16x16x32_bf16 v[104:107], v[116:119], v[52:55], v[104:107]
s_mov_b32 s45, 0xd000
buffer_load_dwordx4 v[52:55], v5, s[16:19], s45 offen offset:0
v_and_b32_dpp v116, v88, v16 row_newbcast:3 row_mask:0xf bank_mask:0xf
v_and_b32_dpp v117, v88, v17 row_newbcast:3 row_mask:0xf bank_mask:0xf
v_and_b32_dpp v118, v88, v18 row_newbcast:3 row_mask:0xf bank_mask:0xf
v_and_b32_dpp v119, v88, v19 row_newbcast:3 row_mask:0xf bank_mask:0xf
s_waitcnt vmcnt(11)
v_mfma_f32_16x16x32_bf16 v[104:107], v[112:115], v[56:59], v[104:107]
s_mov_b32 s45, 0xe000
buffer_load_dwordx4 v[56:59], v5, s[16:19], s45 offen offset:0
v_and_b32_dpp v112, v88, v16 row_newbcast:4 row_mask:0xf bank_mask:0xf
v_and_b32_dpp v113, v88, v17 row_newbcast:4 row_mask:0xf bank_mask:0xf
v_and_b32_dpp v114, v88, v18 row_newbcast:4 row_mask:0xf bank_mask:0xf
v_and_b32_dpp v115, v88, v19 row_newbcast:4 row_mask:0xf bank_mask:0xf
s_waitcnt vmcnt(11)
v_mfma_f32_16x16x32_bf16 v[104:107], v[116:119], v[60:63], v[104:107]
s_mov_b32 s45, 0xf000
buffer_load_dwordx4 v[60:63], v5, s[16:19], s45 offen offset:0
v_and_b32_dpp v116, v88, v16 row_newbcast:5 row_mask:0xf bank_mask:0xf
v_and_b32_dpp v117, v88, v17 row_newbcast:5 row_mask:0xf bank_mask:0xf
v_and_b32_dpp v118, v88, v18 row_newbcast:5 row_mask:0xf bank_mask:0xf
v_and_b32_dpp v119, v88, v19 row_newbcast:5 row_mask:0xf bank_mask:0xf
s_waitcnt vmcnt(11)
v_mfma_f32_16x16x32_bf16 v[104:107], v[112:115], v[64:67], v[104:107]
s_mov_b32 s45, 0x10000
buffer_load_dwordx4 v[64:67], v5, s[16:19], s45 offen offset:0
v_and_b32_dpp v112, v88, v16 row_newbcast:6 row_mask:0xf bank_mask:0xf
v_and_b32_dpp v113, v88, v17 row_newbcast:6 row_mask:0xf bank_mask:0xf
v_and_b32_dpp v114, v88, v18 row_newbcast:6 row_mask:0xf bank_mask:0xf
v_and_b32_dpp v115, v88, v19 row_newbcast:6 row_mask:0xf bank_mask:0xf
s_waitcnt vmcnt(11)
v_mfma_f32_16x16x32_bf16 v[104:107], v[116:119], v[68:71], v[104:107]
s_mov_b32 s45, 0x11000
buffer_load_dwordx4 v[68:71], v5, s[16:19], s45 offen offset:0
v_and_b32_dpp v116, v88, v16 row_newbcast:7 row_mask:0xf bank_mask:0xf
v_and_b32_dpp v117, v88, v17 row_newbcast:7 row_mask:0xf bank_mask:0xf
v_and_b32_dpp v118, v88, v18 row_newbcast:7 row_mask:0xf bank_mask:0xf
v_and_b32_dpp v119, v88, v19 row_newbcast:7 row_mask:0xf bank_mask:0xf
s_waitcnt vmcnt(11)
v_mfma_f32_16x16x32_bf16 v[104:107], v[112:115], v[24:27], v[104:107]
s_mov_b32 s45, 0x12000
buffer_load_dwordx4 v[24:27], v5, s[16:19], s45 offen offset:0
v_and_b32_dpp v112, v88, v16 row_newbcast:8 row_mask:0xf bank_mask:0xf
v_and_b32_dpp v113, v88, v17 row_newbcast:8 row_mask:0xf bank_mask:0xf
v_and_b32_dpp v114, v88, v18 row_newbcast:8 row_mask:0xf bank_mask:0xf
v_and_b32_dpp v115, v88, v19 row_newbcast:8 row_mask:0xf bank_mask:0xf
s_waitcnt vmcnt(11)
v_mfma_f32_16x16x32_bf16 v[104:107], v[116:119], v[28:31], v[104:107]
s_mov_b32 s45, 0x13000
buffer_load_dwordx4 v[28:31], v5, s[16:19], s45 offen offset:0
v_and_b32_dpp v116, v88, v16 row_newbcast:9 row_mask:0xf bank_mask:0xf
v_and_b32_dpp v117, v88, v17 row_newbcast:9 row_mask:0xf bank_mask:0xf
v_and_b32_dpp v118, v88, v18 row_newbcast:9 row_mask:0xf bank_mask:0xf
v_and_b32_dpp v119, v88, v19 row_newbcast:9 row_mask:0xf bank_mask:0xf
s_waitcnt vmcnt(11)
v_mfma_f32_16x16x32_bf16 v[104:107], v[112:115], v[32:35], v[104:107]
s_mov_b32 s45, 0x14000
buffer_load_dwordx4 v[32:35], v5, s[16:19], s45 offen offset:0
v_and_b32_dpp v112, v88, v16 row_newbcast:10 row_mask:0xf bank_mask:0xf
v_and_b32_dpp v113, v88, v17 row_newbcast:10 row_mask:0xf bank_mask:0xf
v_and_b32_dpp v114, v88, v18 row_newbcast:10 row_mask:0xf bank_mask:0xf
v_and_b32_dpp v115, v88, v19 row_newbcast:10 row_mask:0xf bank_mask:0xf
s_waitcnt vmcnt(11)
v_mfma_f32_16x16x32_bf16 v[104:107], v[116:119], v[36:39], v[104:107]
s_mov_b32 s45, 0x15000
buffer_load_dwordx4 v[36:39], v5, s[16:19], s45 offen offset:0
v_and_b32_dpp v116, v88, v16 row_newbcast:11 row_mask:0xf bank_mask:0xf
v_and_b32_dpp v117, v88, v17 row_newbcast:11 row_mask:0xf bank_mask:0xf
v_and_b32_dpp v118, v88, v18 row_newbcast:11 row_mask:0xf bank_mask:0xf
v_and_b32_dpp v119, v88, v19 row_newbcast:11 row_mask:0xf bank_mask:0xf
s_waitcnt vmcnt(11)
v_mfma_f32_16x16x32_bf16 v[104:107], v[112:115], v[40:43], v[104:107]
s_mov_b32 s45, 0x16000
buffer_load_dwordx4 v[40:43], v5, s[16:19], s45 offen offset:0
v_and_b32_dpp v112, v88, v16 row_newbcast:12 row_mask:0xf bank_mask:0xf
v_and_b32_dpp v113, v88, v17 row_newbcast:12 row_mask:0xf bank_mask:0xf
v_and_b32_dpp v114, v88, v18 row_newbcast:12 row_mask:0xf bank_mask:0xf
v_and_b32_dpp v115, v88, v19 row_newbcast:12 row_mask:0xf bank_mask:0xf
s_waitcnt vmcnt(11)
v_mfma_f32_16x16x32_bf16 v[104:107], v[116:119], v[44:47], v[104:107]
s_mov_b32 s45, 0x17000
buffer_load_dwordx4 v[44:47], v5, s[16:19], s45 offen offset:0
v_and_b32_dpp v116, v88, v16 row_newbcast:13 row_mask:0xf bank_mask:0xf
v_and_b32_dpp v117, v88, v17 row_newbcast:13 row_mask:0xf bank_mask:0xf
v_and_b32_dpp v118, v88, v18 row_newbcast:13 row_mask:0xf bank_mask:0xf
v_and_b32_dpp v119, v88, v19 row_newbcast:13 row_mask:0xf bank_mask:0xf
s_waitcnt vmcnt(11)
v_mfma_f32_16x16x32_bf16 v[104:107], v[112:115], v[48:51], v[104:107]
s_mov_b32 s45, 0x18000
buffer_load_dwordx4 v[48:51], v5, s[16:19], s45 offen offset:0
v_and_b32_dpp v112, v88, v16 row_newbcast:14 row_mask:0xf bank_mask:0xf
v_and_b32_dpp v113, v88, v17 row_newbcast:14 row_mask:0xf bank_mask:0xf
v_and_b32_dpp v114, v88, v18 row_newbcast:14 row_mask:0xf bank_mask:0xf
v_and_b32_dpp v115, v88, v19 row_newbcast:14 row_mask:0xf bank_mask:0xf
s_waitcnt vmcnt(11)
v_mfma_f32_16x16x32_bf16 v[104:107], v[116:119], v[52:55], v[104:107]
s_mov_b32 s45, 0x19000
buffer_load_dwordx4 v[52:55], v5, s[16:19], s45 offen offset:0
v_and_b32_dpp v116, v88, v16 row_newbcast:15 row_mask:0xf bank_mask:0xf
v_and_b32_dpp v117, v88, v17 row_newbcast:15 row_mask:0xf bank_mask:0xf
v_and_b32_dpp v118, v88, v18 row_newbcast:15 row_mask:0xf bank_mask:0xf
v_and_b32_dpp v119, v88, v19 row_newbcast:15 row_mask:0xf bank_mask:0xf
s_waitcnt vmcnt(11)
v_mfma_f32_16x16x32_bf16 v[104:107], v[112:115], v[56:59], v[104:107]
s_mov_b32 s45, 0x1a000
buffer_load_dwordx4 v[56:59], v5, s[16:19], s45 offen offset:0
v_and_b32_dpp v112, v89, v16 row_newbcast:0 row_mask:0xf bank_mask:0xf
v_and_b32_dpp v113, v89, v17 row_newbcast:0 row_mask:0xf bank_mask:0xf
v_and_b32_dpp v114, v89, v18 row_newbcast:0 row_mask:0xf bank_mask:0xf
v_and_b32_dpp v115, v89, v19 row_newbcast:0 row_mask:0xf bank_mask:0xf
s_waitcnt vmcnt(11)
v_mfma_f32_16x16x32_bf16 v[104:107], v[116:119], v[60:63], v[104:107]
s_mov_b32 s45, 0x1b000
buffer_load_dwordx4 v[60:63], v5, s[16:19], s45 offen offset:0
v_and_b32_dpp v116, v89, v16 row_newbcast:1 row_mask:0xf bank_mask:0xf
v_and_b32_dpp v117, v89, v17 row_newbcast:1 row_mask:0xf bank_mask:0xf
v_and_b32_dpp v118, v89, v18 row_newbcast:1 row_mask:0xf bank_mask:0xf
v_and_b32_dpp v119, v89, v19 row_newbcast:1 row_mask:0xf bank_mask:0xf
s_waitcnt vmcnt(11)
v_mfma_f32_16x16x32_bf16 v[104:107], v[112:115], v[64:67], v[104:107]
s_mov_b32 s45, 0x1c000
buffer_load_dwordx4 v[64:67], v5, s[16:19], s45 offen offset:0
v_and_b32_dpp v112, v89, v16 row_newbcast:2 row_mask:0xf bank_mask:0xf
v_and_b32_dpp v113, v89, v17 row_newbcast:2 row_mask:0xf bank_mask:0xf
v_and_b32_dpp v114, v89, v18 row_newbcast:2 row_mask:0xf bank_mask:0xf
v_and_b32_dpp v115, v89, v19 row_newbcast:2 row_mask:0xf bank_mask:0xf
s_waitcnt vmcnt(11)
v_mfma_f32_16x16x32_bf16 v[104:107], v[116:119], v[68:71], v[104:107]
s_mov_b32 s45, 0x1d000
buffer_load_dwordx4 v[68:71], v5, s[16:19], s45 offen offset:0
v_and_b32_dpp v116, v89, v16 row_newbcast:3 row_mask:0xf bank_mask:0xf
v_and_b32_dpp v117, v89, v17 row_newbcast:3 row_mask:0xf bank_mask:0xf
v_and_b32_dpp v118, v89, v18 row_newbcast:3 row_mask:0xf bank_mask:0xf
v_and_b32_dpp v119, v89, v19 row_newbcast:3 row_mask:0xf bank_mask:0xf
s_waitcnt vmcnt(11)
v_mfma_f32_16x16x32_bf16 v[104:107], v[112:115], v[24:27], v[104:107]
s_mov_b32 s45, 0x1e000
buffer_load_dwordx4 v[24:27], v5, s[16:19], s45 offen offset:0
v_and_b32_dpp v112, v89, v16 row_newbcast:4 row_mask:0xf bank_mask:0xf
v_and_b32_dpp v113, v89, v17 row_newbcast:4 row_mask:0xf bank_mask:0xf
v_and_b32_dpp v114, v89, v18 row_newbcast:4 row_mask:0xf bank_mask:0xf
v_and_b32_dpp v115, v89, v19 row_newbcast:4 row_mask:0xf bank_mask:0xf
s_waitcnt vmcnt(11)
v_mfma_f32_16x16x32_bf16 v[104:107], v[116:119], v[28:31], v[104:107]
s_mov_b32 s45, 0x1f000
buffer_load_dwordx4 v[28:31], v5, s[16:19], s45 offen offset:0
v_and_b32_dpp v116, v89, v16 row_newbcast:5 row_mask:0xf bank_mask:0xf
v_and_b32_dpp v117, v89, v17 row_newbcast:5 row_mask:0xf bank_mask:0xf
v_and_b32_dpp v118, v89, v18 row_newbcast:5 row_mask:0xf bank_mask:0xf
v_and_b32_dpp v119, v89, v19 row_newbcast:5 row_mask:0xf bank_mask:0xf
s_waitcnt vmcnt(11)
v_mfma_f32_16x16x32_bf16 v[104:107], v[112:115], v[32:35], v[104:107]
v_and_b32_dpp v112, v89, v16 row_newbcast:6 row_mask:0xf bank_mask:0xf
v_and_b32_dpp v113, v89, v17 row_newbcast:6 row_mask:0xf bank_mask:0xf
v_and_b32_dpp v114, v89, v18 row_newbcast:6 row_mask:0xf bank_mask:0xf
v_and_b32_dpp v115, v89, v19 row_newbcast:6 row_mask:0xf bank_mask:0xf
s_waitcnt vmcnt(10)
v_mfma_f32_16x16x32_bf16 v[104:107], v[116:119], v[36:39], v[104:107]
v_and_b32_dpp v116, v89, v16 row_newbcast:7 row_mask:0xf bank_mask:0xf
v_and_b32_dpp v117, v89, v17 row_newbcast:7 row_mask:0xf bank_mask:0xf
v_and_b32_dpp v118, v89, v18 row_newbcast:7 row_mask:0xf bank_mask:0xf
v_and_b32_dpp v119, v89, v19 row_newbcast:7 row_mask:0xf bank_mask:0xf
s_waitcnt vmcnt(9)
v_mfma_f32_16x16x32_bf16 v[104:107], v[112:115], v[40:43], v[104:107]
v_and_b32_dpp v112, v89, v16 row_newbcast:8 row_mask:0xf bank_mask:0xf
v_and_b32_dpp v113, v89, v17 row_newbcast:8 row_mask:0xf bank_mask:0xf
v_and_b32_dpp v114, v89, v18 row_newbcast:8 row_mask:0xf bank_mask:0xf
v_and_b32_dpp v115, v89, v19 row_newbcast:8 row_mask:0xf bank_mask:0xf
s_waitcnt vmcnt(8)
v_mfma_f32_16x16x32_bf16 v[104:107], v[116:119], v[44:47], v[104:107]
v_and_b32_dpp v116, v89, v16 row_newbcast:9 row_mask:0xf bank_mask:0xf
v_and_b32_dpp v117, v89, v17 row_newbcast:9 row_mask:0xf bank_mask:0xf
v_and_b32_dpp v118, v89, v18 row_newbcast:9 row_mask:0xf bank_mask:0xf
v_and_b32_dpp v119, v89, v19 row_newbcast:9 row_mask:0xf bank_mask:0xf
s_waitcnt vmcnt(7)
v_mfma_f32_16x16x32_bf16 v[104:107], v[112:115], v[48:51], v[104:107]
v_and_b32_dpp v112, v89, v16 row_newbcast:10 row_mask:0xf bank_mask:0xf
v_and_b32_dpp v113, v89, v17 row_newbcast:10 row_mask:0xf bank_mask:0xf
v_and_b32_dpp v114, v89, v18 row_newbcast:10 row_mask:0xf bank_mask:0xf
v_and_b32_dpp v115, v89, v19 row_newbcast:10 row_mask:0xf bank_mask:0xf
s_waitcnt vmcnt(6)
v_mfma_f32_16x16x32_bf16 v[104:107], v[116:119], v[52:55], v[104:107]
v_and_b32_dpp v116, v89, v16 row_newbcast:11 row_mask:0xf bank_mask:0xf
v_and_b32_dpp v117, v89, v17 row_newbcast:11 row_mask:0xf bank_mask:0xf
v_and_b32_dpp v118, v89, v18 row_newbcast:11 row_mask:0xf bank_mask:0xf
v_and_b32_dpp v119, v89, v19 row_newbcast:11 row_mask:0xf bank_mask:0xf
s_waitcnt vmcnt(5)
v_mfma_f32_16x16x32_bf16 v[104:107], v[112:115], v[56:59], v[104:107]
v_and_b32_dpp v112, v89, v16 row_newbcast:12 row_mask:0xf bank_mask:0xf
v_and_b32_dpp v113, v89, v17 row_newbcast:12 row_mask:0xf bank_mask:0xf
v_and_b32_dpp v114, v89, v18 row_newbcast:12 row_mask:0xf bank_mask:0xf
v_and_b32_dpp v115, v89, v19 row_newbcast:12 row_mask:0xf bank_mask:0xf
s_waitcnt vmcnt(4)
v_mfma_f32_16x16x32_bf16 v[104:107], v[116:119], v[60:63], v[104:107]
v_and_b32_dpp v116, v89, v16 row_newbcast:13 row_mask:0xf bank_mask:0xf
v_and_b32_dpp v117, v89, v17 row_newbcast:13 row_mask:0xf bank_mask:0xf
v_and_b32_dpp v118, v89, v18 row_newbcast:13 row_mask:0xf bank_mask:0xf
v_and_b32_dpp v119, v89, v19 row_newbcast:13 row_mask:0xf bank_mask:0xf
s_waitcnt vmcnt(3)
v_mfma_f32_16x16x32_bf16 v[104:107], v[112:115], v[64:67], v[104:107]
v_and_b32_dpp v112, v89, v16 row_newbcast:14 row_mask:0xf bank_mask:0xf
v_and_b32_dpp v113, v89, v17 row_newbcast:14 row_mask:0xf bank_mask:0xf
v_and_b32_dpp v114, v89, v18 row_newbcast:14 row_mask:0xf bank_mask:0xf
v_and_b32_dpp v115, v89, v19 row_newbcast:14 row_mask:0xf bank_mask:0xf
s_waitcnt vmcnt(2)
v_mfma_f32_16x16x32_bf16 v[104:107], v[116:119], v[68:71], v[104:107]
v_and_b32_dpp v116, v89, v16 row_newbcast:15 row_mask:0xf bank_mask:0xf
v_and_b32_dpp v117, v89, v17 row_newbcast:15 row_mask:0xf bank_mask:0xf
v_and_b32_dpp v118, v89, v18 row_newbcast:15 row_mask:0xf bank_mask:0xf
v_and_b32_dpp v119, v89, v19 row_newbcast:15 row_mask:0xf bank_mask:0xf
s_waitcnt vmcnt(1)
v_mfma_f32_16x16x32_bf16 v[104:107], v[112:115], v[24:27], v[104:107]
s_nop 1
s_waitcnt vmcnt(0)
v_mfma_f32_16x16x32_bf16 v[104:107], v[116:119], v[28:31], v[104:107]
s_nop 7
s_mov_b32 s54, 0xfffffffe
v_min_u32 v104, s54, v104
v_min_u32 v105, s54, v105
v_min_u32 v106, s54, v106
v_min_u32 v107, s54, v107
v_add_u32 v15, s56, v6
buffer_store_dwordx4 v[104:107], v15, s[28:31], 0 offen sc1
buffer_load_dwordx4 v[32:35], v4, s[20:23], 0 offen offset:0
s_mov_b32 s45, 0x3000
buffer_load_dwordx4 v[36:39], v4, s[20:23], s45 offen offset:2048
s_mov_b32 s45, 0x7000
buffer_load_dwordx4 v[40:43], v4, s[20:23], s45 offen offset:0
s_mov_b32 s45, 0xa000
buffer_load_dwordx4 v[44:47], v4, s[20:23], s45 offen offset:2048
s_mov_b32 s45, 0xe000
buffer_load_dwordx4 v[48:51], v4, s[20:23], s45 offen offset:0
s_mov_b32 s45, 0x11000
buffer_load_dwordx4 v[52:55], v4, s[20:23], s45 offen offset:2048
s_mov_b32 s45, 0x15000
buffer_load_dwordx4 v[56:59], v4, s[20:23], s45 offen offset:0
s_mov_b32 s45, 0x18000
buffer_load_dwordx4 v[60:63], v4, s[20:23], s45 offen offset:2048
s_mov_b32 s45, 0x1c000
buffer_load_dwordx4 v[64:67], v4, s[20:23], s45 offen offset:0
s_mov_b32 s45, 0x1f000
buffer_load_dwordx4 v[68:71], v4, s[20:23], s45 offen offset:2048
s_mov_b32 s45, 0x23000
buffer_load_dwordx4 v[24:27], v4, s[20:23], s45 offen offset:0
s_mov_b32 s45, 0x26000
buffer_load_dwordx4 v[28:31], v4, s[20:23], s45 offen offset:2048
s_cmp_lg_u32 s44, 0
s_cbranch_scc1 L_skip2
s_mov_b32 s57, 0
v_mov_b32 v120, s47
v_lshlrev_b32 v120, 2, v120
s_mov_b64 exec, 1
L_rst2:
buffer_load_dword v122, v120, s[32:35], 0 offen sc1
s_waitcnt vmcnt(0)
v_readfirstlane_b32 s54, v122
s_add_u32 s57, s57, 1
s_cmp_ge_u32 s54, 32
s_cbranch_scc1 L_rstd2
s_cmp_ge_u32 s57, 0x40000
s_cbranch_scc1 L_rstd2
s_sleep 8
s_branch L_rst2
L_rstd2:
s_mov_b64 exec, -1
v_lshlrev_b32 v120, 11, v0
v_add_u32 v120, 0x7fc, v120
s_mov_b32 exec_lo, 0xffffffff
s_mov_b32 exec_hi, 0
L_poll2:
buffer_load_dword v122, v120, s[28:31], 0 offen sc1
s_waitcnt vmcnt(0)
v_cmp_eq_u32 vcc, -1, v122
s_add_u32 s57, s57, 1
s_nop 3
s_and_b64 exec, exec, vcc
s_cbranch_scc0 L_done2
s_cmp_ge_u32 s57, 0x40000
s_cbranch_scc1 L_done2
s_sleep 4
s_branch L_poll2
L_done2:
s_mov_b64 exec, -1
L_skip2:
s_barrier
s_mov_b32 s57, 0
L_g3:
buffer_load_dwordx4 v[72:75], v7, s[28:31], 0 offen sc1
s_mov_b32 s45, 0x1000
buffer_load_dwordx4 v[76:79], v7, s[28:31], s45 offen sc1
s_mov_b32 s45, 0x2000
buffer_load_dwordx4 v[80:83], v7, s[28:31], s45 offen sc1
s_mov_b32 s45, 0x3000
buffer_load_dwordx4 v[84:87], v7, s[28:31], s45 offen sc1
s_mov_b32 s45, 0x4000
buffer_load_dwordx4 v[88:91], v7, s[28:31], s45 offen sc1
s_mov_b32 s45, 0x5000
buffer_load_dwordx4 v[92:95], v7, s[28:31], s45 offen sc1
s_mov_b32 s45, 0x6000
buffer_load_dwordx4 v[96:99], v7, s[28:31], s45 offen sc1
s_mov_b32 s45, 0x7000
buffer_load_dwordx4 v[100:103], v7, s[28:31], s45 offen sc1
s_mov_b32 s45, 0x8000
buffer_load_dwordx4 v[104:107], v7, s[28:31], s45 offen sc1
s_mov_b32 s45, 0x9000
buffer_load_dwordx4 v[108:111], v7, s[28:31], s45 offen sc1
s_mov_b32 s45, 0xa000
buffer_load_dwordx4 v[112:115], v7, s[28:31], s45 offen sc1
s_mov_b32 s45, 0xb000
buffer_load_dwordx4 v[116:119], v7, s[28:31], s45 offen sc1
s_mov_b32 s45, 0xc000
buffer_load_dwordx4 v[120:123], v7, s[28:31], s45 offen sc1
s_mov_b32 s45, 0xd000
buffer_load_dwordx4 v[124:127], v7, s[28:31], s45 offen sc1
s_mov_b32 s45, 0xe000
buffer_load_dwordx4 v[128:131], v7, s[28:31], s45 offen sc1
s_mov_b32 s45, 0xf000
buffer_load_dwordx4 v[132:135], v7, s[28:31], s45 offen sc1
s_waitcnt vmcnt(15)
v_max3_u32 v15, v72, v73, v74
v_max_u32 v15, v15, v75
s_waitcnt vmcnt(14)
v_max3_u32 v15, v15, v76, v77
v_max3_u32 v15, v15, v78, v79
v_add_f32 v72, v72, v76
v_add_f32 v73, v73, v77
v_add_f32 v74, v74, v78
v_add_f32 v75, v75, v79
s_waitcnt vmcnt(13)
v_max3_u32 v15, v15, v80, v81
v_max3_u32 v15, v15, v82, v83
v_add_f32 v72, v72, v80
v_add_f32 v73, v73, v81
v_add_f32 v74, v74, v82
v_add_f32 v75, v75, v83
s_waitcnt vmcnt(12)
v_max3_u32 v15, v15, v84, v85
v_max3_u32 v15, v15, v86, v87
v_add_f32 v72, v72, v84
v_add_f32 v73, v73, v85
v_add_f32 v74, v74, v86
v_add_f32 v75, v75, v87
s_waitcnt vmcnt(11)
v_max3_u32 v15, v15, v88, v89
v_max3_u32 v15, v15, v90, v91
v_add_f32 v72, v72, v88
v_add_f32 v73, v73, v89
v_add_f32 v74, v74, v90
v_add_f32 v75, v75, v91
s_waitcnt vmcnt(10)
v_max3_u32 v15, v15, v92, v93
v_max3_u32 v15, v15, v94, v95
v_add_f32 v72, v72, v92
v_add_f32 v73, v73, v93
v_add_f32 v74, v74, v94
v_add_f32 v75, v75, v95
s_waitcnt vmcnt(9)
v_max3_u32 v15, v15, v96, v97
v_max3_u32 v15, v15, v98, v99
v_add_f32 v72, v72, v96
v_add_f32 v73, v73, v97
v_add_f32 v74, v74, v98
v_add_f32 v75, v75, v99
s_waitcnt vmcnt(8)
v_max3_u32 v15, v15, v100, v101
v_max3_u32 v15, v15, v102, v103
v_add_f32 v72, v72, v100
v_add_f32 v73, v73, v101
v_add_f32 v74, v74, v102
v_add_f32 v75, v75, v103
s_waitcnt vmcnt(7)
v_max3_u32 v15, v15, v104, v105
v_max3_u32 v15, v15, v106, v107
v_add_f32 v72, v72, v104
v_add_f32 v73, v73, v105
v_add_f32 v74, v74, v106
v_add_f32 v75, v75, v107
s_waitcnt vmcnt(6)
v_max3_u32 v15, v15, v108, v109
v_max3_u32 v15, v15, v110, v111
v_add_f32 v72, v72, v108
v_add_f32 v73, v73, v109
v_add_f32 v74, v74, v110
v_add_f32 v75, v75, v111
s_waitcnt vmcnt(5)
v_max3_u32 v15, v15, v112, v113
v_max3_u32 v15, v15, v114, v115
v_add_f32 v72, v72, v112
v_add_f32 v73, v73, v113
v_add_f32 v74, v74, v114
v_add_f32 v75, v75, v115
s_waitcnt vmcnt(4)
v_max3_u32 v15, v15, v116, v117
v_max3_u32 v15, v15, v118, v119
v_add_f32 v72, v72, v116
v_add_f32 v73, v73, v117
v_add_f32 v74, v74, v118
v_add_f32 v75, v75, v119
s_waitcnt vmcnt(3)
v_max3_u32 v15, v15, v120, v121
v_max3_u32 v15, v15, v122, v123
v_add_f32 v72, v72, v120
v_add_f32 v73, v73, v121
v_add_f32 v74, v74, v122
v_add_f32 v75, v75, v123
s_waitcnt vmcnt(2)
v_max3_u32 v15, v15, v124, v125
v_max3_u32 v15, v15, v126, v127
v_add_f32 v72, v72, v124
v_add_f32 v73, v73, v125
v_add_f32 v74, v74, v126
v_add_f32 v75, v75, v127
s_waitcnt vmcnt(1)
v_max3_u32 v15, v15, v128, v129
v_max3_u32 v15, v15, v130, v131
v_add_f32 v72, v72, v128
v_add_f32 v73, v73, v129
v_add_f32 v74, v74, v130
v_add_f32 v75, v75, v131
s_waitcnt vmcnt(0)
v_max3_u32 v15, v15, v132, v133
v_max3_u32 v15, v15, v134, v135
v_add_f32 v72, v72, v132
v_add_f32 v73, v73, v133
v_add_f32 v74, v74, v134
v_add_f32 v75, v75, v135
v_cmp_eq_u32 vcc, -1, v15
s_add_u32 s57, s57, 1
s_nop 3
s_cbranch_vccz L_gd3
s_cmp_ge_u32 s57, 0x40000
s_cbranch_scc1 L_gd3
s_sleep 2
s_branch L_g3
L_gd3:
v_mov_b32 v76, v72
v_mov_b32 v77, v73
v_mov_b32 v78, v74
v_mov_b32 v79, v75
s_nop 1
v_permlane32_swap_b32 v72, v76
v_permlane32_swap_b32 v73, v77
v_permlane32_swap_b32 v74, v78
v_permlane32_swap_b32 v75, v79
s_nop 0
v_add_f32 v72, v72, v76
v_add_f32 v73, v73, v77
v_add_f32 v74, v74, v78
v_add_f32 v75, v75, v79
v_cvt_pk_bf16_f32 v76, v72, v73
v_lshlrev_b32 v72, 16, v76
v_and_b32 v73, 0xffff0000, v76
v_cvt_pk_bf16_f32 v76, v74, v75
v_lshlrev_b32 v74, 16, v76
v_and_b32 v75, 0xffff0000, v76
v_add_f32 v20, v20, v72
v_add_f32 v21, v21, v73
v_add_f32 v22, v22, v74
v_add_f32 v23, v23, v75
v_cvt_pk_bf16_f32 v76, v20, v21
v_lshlrev_b32 v20, 16, v76
v_and_b32 v21, 0xffff0000, v76
v_cvt_pk_bf16_f32 v76, v22, v23
v_lshlrev_b32 v22, 16, v76
v_and_b32 v23, 0xffff0000, v76
ds_write_b128 v12, v[20:23] offset:0
s_waitcnt lgkmcnt(0)
s_barrier
ds_read_b128 v[120:123], v14 offset:0
ds_read_b128 v[124:127], v14 offset:16
ds_read_b32 v132, v10 offset:0
ds_read_b32 v133, v10 offset:256
s_waitcnt lgkmcnt(2)
v_add_f32 v128, v120, v121
v_add_f32 v128, v128, v122
v_add_f32 v128, v128, v123
v_add_f32 v128, v128, v124
v_add_f32 v128, v128, v125
v_add_f32 v128, v128, v126
v_add_f32 v128, v128, v127
s_nop 1
v_add_f32_dpp v128, v128, v128 row_ror:8 row_mask:0xf bank_mask:0xf
s_nop 1
v_add_f32_dpp v128, v128, v128 row_ror:4 row_mask:0xf bank_mask:0xf
s_nop 1
v_add_f32_dpp v128, v128, v128 row_ror:2 row_mask:0xf bank_mask:0xf
s_nop 1
v_add_f32_dpp v128, v128, v128 row_ror:1 row_mask:0xf bank_mask:0xf
v_mov_b32 v129, v128
s_nop 1
v_permlane16_swap_b32 v128, v129
s_nop 0
v_add_f32 v128, v128, v129
v_mov_b32 v129, v128
s_nop 1
v_permlane32_swap_b32 v128, v129
s_nop 0
v_add_f32 v128, v128, v129
v_mul_f32 v128, 0x3b000000, v128
v_sub_f32 v120, v120, v128
v_sub_f32 v121, v121, v128
v_sub_f32 v122, v122, v128
v_sub_f32 v123, v123, v128
v_sub_f32 v124, v124, v128
v_sub_f32 v125, v125, v128
v_sub_f32 v126, v126, v128
v_sub_f32 v127, v127, v128
v_mul_f32 v130, v120, v120
v_fmac_f32 v130, v121, v121
v_fmac_f32 v130, v122, v122
v_fmac_f32 v130, v123, v123
v_fmac_f32 v130, v124, v124
v_fmac_f32 v130, v125, v125
v_fmac_f32 v130, v126, v126
v_fmac_f32 v130, v127, v127
s_nop 1
v_add_f32_dpp v130, v130, v130 row_ror:8 row_mask:0xf bank_mask:0xf
s_nop 1
v_add_f32_dpp v130, v130, v130 row_ror:4 row_mask:0xf bank_mask:0xf
s_nop 1
v_add_f32_dpp v130, v130, v130 row_ror:2 row_mask:0xf bank_mask:0xf
s_nop 1
v_add_f32_dpp v130, v130, v130 row_ror:1 row_mask:0xf bank_mask:0xf
v_mov_b32 v129, v130
s_nop 1
v_permlane16_swap_b32 v130, v129
s_nop 0
v_add_f32 v130, v130, v129
v_mov_b32 v129, v130
s_nop 1
v_permlane32_swap_b32 v130, v129
s_nop 0
v_add_f32 v130, v130, v129
v_mov_b32 v129, 0x3727c5ac
v_fmac_f32 v129, 0x3b000000, v130
v_rsq_f32 v130, v129
s_waitcnt lgkmcnt(0)
v_sub_f32 v132, v132, v128
v_mul_f32 v132, v132, v130
v_cvt_pk_bf16_f32 v88, v132, v132
v_sub_f32 v133, v133, v128
v_mul_f32 v133, v133, v130
v_cvt_pk_bf16_f32 v89, v133, v133
s_nop 1
v_and_b32_dpp v112, v88, v16 row_newbcast:0 row_mask:0xf bank_mask:0xf
v_and_b32_dpp v113, v88, v17 row_newbcast:0 row_mask:0xf bank_mask:0xf
v_and_b32_dpp v114, v88, v18 row_newbcast:0 row_mask:0xf bank_mask:0xf
v_and_b32_dpp v115, v88, v19 row_newbcast:0 row_mask:0xf bank_mask:0xf
v_and_b32_dpp v116, v88, v16 row_newbcast:1 row_mask:0xf bank_mask:0xf
v_and_b32_dpp v117, v88, v17 row_newbcast:1 row_mask:0xf bank_mask:0xf
v_and_b32_dpp v118, v88, v18 row_newbcast:1 row_mask:0xf bank_mask:0xf
v_and_b32_dpp v119, v88, v19 row_newbcast:1 row_mask:0xf bank_mask:0xf
v_mfma_f32_16x16x32_bf16 v[104:107], v[112:115], v[32:35], 0
s_mov_b32 s45, 0x2a000
buffer_load_dwordx4 v[32:35], v4, s[20:23], s45 offen offset:0
v_and_b32_dpp v112, v88, v16 row_newbcast:2 row_mask:0xf bank_mask:0xf
v_and_b32_dpp v113, v88, v17 row_newbcast:2 row_mask:0xf bank_mask:0xf
v_and_b32_dpp v114, v88, v18 row_newbcast:2 row_mask:0xf bank_mask:0xf
v_and_b32_dpp v115, v88, v19 row_newbcast:2 row_mask:0xf bank_mask:0xf
v_mfma_f32_16x16x32_bf16 v[104:107], v[116:119], v[36:39], v[104:107]
s_mov_b32 s45, 0x2d000
buffer_load_dwordx4 v[36:39], v4, s[20:23], s45 offen offset:2048
v_and_b32_dpp v116, v88, v16 row_newbcast:3 row_mask:0xf bank_mask:0xf
v_and_b32_dpp v117, v88, v17 row_newbcast:3 row_mask:0xf bank_mask:0xf
v_and_b32_dpp v118, v88, v18 row_newbcast:3 row_mask:0xf bank_mask:0xf
v_and_b32_dpp v119, v88, v19 row_newbcast:3 row_mask:0xf bank_mask:0xf
v_mfma_f32_16x16x32_bf16 v[104:107], v[112:115], v[40:43], v[104:107]
s_mov_b32 s45, 0x31000
buffer_load_dwordx4 v[40:43], v4, s[20:23], s45 offen offset:0
v_and_b32_dpp v112, v88, v16 row_newbcast:4 row_mask:0xf bank_mask:0xf
v_and_b32_dpp v113, v88, v17 row_newbcast:4 row_mask:0xf bank_mask:0xf
v_and_b32_dpp v114, v88, v18 row_newbcast:4 row_mask:0xf bank_mask:0xf
v_and_b32_dpp v115, v88, v19 row_newbcast:4 row_mask:0xf bank_mask:0xf
v_mfma_f32_16x16x32_bf16 v[104:107], v[116:119], v[44:47], v[104:107]
s_mov_b32 s45, 0x34000
buffer_load_dwordx4 v[44:47], v4, s[20:23], s45 offen offset:2048
v_and_b32_dpp v116, v88, v16 row_newbcast:5 row_mask:0xf bank_mask:0xf
v_and_b32_dpp v117, v88, v17 row_newbcast:5 row_mask:0xf bank_mask:0xf
v_and_b32_dpp v118, v88, v18 row_newbcast:5 row_mask:0xf bank_mask:0xf
v_and_b32_dpp v119, v88, v19 row_newbcast:5 row_mask:0xf bank_mask:0xf
v_mfma_f32_16x16x32_bf16 v[104:107], v[112:115], v[48:51], v[104:107]
s_mov_b32 s45, 0x38000
buffer_load_dwordx4 v[48:51], v4, s[20:23], s45 offen offset:0
v_and_b32_dpp v112, v88, v16 row_newbcast:6 row_mask:0xf bank_mask:0xf
v_and_b32_dpp v113, v88, v17 row_newbcast:6 row_mask:0xf bank_mask:0xf
v_and_b32_dpp v114, v88, v18 row_newbcast:6 row_mask:0xf bank_mask:0xf
v_and_b32_dpp v115, v88, v19 row_newbcast:6 row_mask:0xf bank_mask:0xf
v_mfma_f32_16x16x32_bf16 v[104:107], v[116:119], v[52:55], v[104:107]
s_mov_b32 s45, 0x3b000
buffer_load_dwordx4 v[52:55], v4, s[20:23], s45 offen offset:2048
v_and_b32_dpp v116, v88, v16 row_newbcast:7 row_mask:0xf bank_mask:0xf
v_and_b32_dpp v117, v88, v17 row_newbcast:7 row_mask:0xf bank_mask:0xf
v_and_b32_dpp v118, v88, v18 row_newbcast:7 row_mask:0xf bank_mask:0xf
v_and_b32_dpp v119, v88, v19 row_newbcast:7 row_mask:0xf bank_mask:0xf
v_mfma_f32_16x16x32_bf16 v[104:107], v[112:115], v[56:59], v[104:107]
s_mov_b32 s45, 0x3f000
buffer_load_dwordx4 v[56:59], v4, s[20:23], s45 offen offset:0
v_and_b32_dpp v112, v88, v16 row_newbcast:8 row_mask:0xf bank_mask:0xf
v_and_b32_dpp v113, v88, v17 row_newbcast:8 row_mask:0xf bank_mask:0xf
v_and_b32_dpp v114, v88, v18 row_newbcast:8 row_mask:0xf bank_mask:0xf
v_and_b32_dpp v115, v88, v19 row_newbcast:8 row_mask:0xf bank_mask:0xf
v_mfma_f32_16x16x32_bf16 v[104:107], v[116:119], v[60:63], v[104:107]
s_mov_b32 s45, 0x42000
buffer_load_dwordx4 v[60:63], v4, s[20:23], s45 offen offset:2048
v_and_b32_dpp v116, v88, v16 row_newbcast:9 row_mask:0xf bank_mask:0xf
v_and_b32_dpp v117, v88, v17 row_newbcast:9 row_mask:0xf bank_mask:0xf
v_and_b32_dpp v118, v88, v18 row_newbcast:9 row_mask:0xf bank_mask:0xf
v_and_b32_dpp v119, v88, v19 row_newbcast:9 row_mask:0xf bank_mask:0xf
v_mfma_f32_16x16x32_bf16 v[104:107], v[112:115], v[64:67], v[104:107]
s_mov_b32 s45, 0x46000
buffer_load_dwordx4 v[64:67], v4, s[20:23], s45 offen offset:0
v_and_b32_dpp v112, v88, v16 row_newbcast:10 row_mask:0xf bank_mask:0xf
v_and_b32_dpp v113, v88, v17 row_newbcast:10 row_mask:0xf bank_mask:0xf
v_and_b32_dpp v114, v88, v18 row_newbcast:10 row_mask:0xf bank_mask:0xf
v_and_b32_dpp v115, v88, v19 row_newbcast:10 row_mask:0xf bank_mask:0xf
v_mfma_f32_16x16x32_bf16 v[104:107], v[116:119], v[68:71], v[104:107]
s_mov_b32 s45, 0x49000
buffer_load_dwordx4 v[68:71], v4, s[20:23], s45 offen offset:2048
v_and_b32_dpp v116, v88, v16 row_newbcast:11 row_mask:0xf bank_mask:0xf
v_and_b32_dpp v117, v88, v17 row_newbcast:11 row_mask:0xf bank_mask:0xf
v_and_b32_dpp v118, v88, v18 row_newbcast:11 row_mask:0xf bank_mask:0xf
v_and_b32_dpp v119, v88, v19 row_newbcast:11 row_mask:0xf bank_mask:0xf
v_mfma_f32_16x16x32_bf16 v[104:107], v[112:115], v[24:27], v[104:107]
s_mov_b32 s45, 0x4d000
buffer_load_dwordx4 v[24:27], v4, s[20:23], s45 offen offset:0
v_and_b32_dpp v112, v88, v16 row_newbcast:12 row_mask:0xf bank_mask:0xf
v_and_b32_dpp v113, v88, v17 row_newbcast:12 row_mask:0xf bank_mask:0xf
v_and_b32_dpp v114, v88, v18 row_newbcast:12 row_mask:0xf bank_mask:0xf
v_and_b32_dpp v115, v88, v19 row_newbcast:12 row_mask:0xf bank_mask:0xf
v_mfma_f32_16x16x32_bf16 v[104:107], v[116:119], v[28:31], v[104:107]
s_mov_b32 s45, 0x50000
buffer_load_dwordx4 v[28:31], v4, s[20:23], s45 offen offset:2048
v_and_b32_dpp v116, v88, v16 row_newbcast:13 row_mask:0xf bank_mask:0xf
v_and_b32_dpp v117, v88, v17 row_newbcast:13 row_mask:0xf bank_mask:0xf
v_and_b32_dpp v118, v88, v18 row_newbcast:13 row_mask:0xf bank_mask:0xf
v_and_b32_dpp v119, v88, v19 row_newbcast:13 row_mask:0xf bank_mask:0xf
s_waitcnt vmcnt(11)
v_mfma_f32_16x16x32_bf16 v[104:107], v[112:115], v[32:35], v[104:107]
s_mov_b32 s45, 0x54000
buffer_load_dwordx4 v[32:35], v4, s[20:23], s45 offen offset:0
v_and_b32_dpp v112, v88, v16 row_newbcast:14 row_mask:0xf bank_mask:0xf
v_and_b32_dpp v113, v88, v17 row_newbcast:14 row_mask:0xf bank_mask:0xf
v_and_b32_dpp v114, v88, v18 row_newbcast:14 row_mask:0xf bank_mask:0xf
v_and_b32_dpp v115, v88, v19 row_newbcast:14 row_mask:0xf bank_mask:0xf
s_waitcnt vmcnt(11)
v_mfma_f32_16x16x32_bf16 v[104:107], v[116:119], v[36:39], v[104:107]
s_mov_b32 s45, 0x57000
buffer_load_dwordx4 v[36:39], v4, s[20:23], s45 offen offset:2048
v_and_b32_dpp v116, v88, v16 row_newbcast:15 row_mask:0xf bank_mask:0xf
v_and_b32_dpp v117, v88, v17 row_newbcast:15 row_mask:0xf bank_mask:0xf
v_and_b32_dpp v118, v88, v18 row_newbcast:15 row_mask:0xf bank_mask:0xf
v_and_b32_dpp v119, v88, v19 row_newbcast:15 row_mask:0xf bank_mask:0xf
s_waitcnt vmcnt(11)
v_mfma_f32_16x16x32_bf16 v[104:107], v[112:115], v[40:43], v[104:107]
s_mov_b32 s45, 0x5b000
buffer_load_dwordx4 v[40:43], v4, s[20:23], s45 offen offset:0
v_and_b32_dpp v112, v89, v16 row_newbcast:0 row_mask:0xf bank_mask:0xf
v_and_b32_dpp v113, v89, v17 row_newbcast:0 row_mask:0xf bank_mask:0xf
v_and_b32_dpp v114, v89, v18 row_newbcast:0 row_mask:0xf bank_mask:0xf
v_and_b32_dpp v115, v89, v19 row_newbcast:0 row_mask:0xf bank_mask:0xf
s_waitcnt vmcnt(11)
v_mfma_f32_16x16x32_bf16 v[104:107], v[116:119], v[44:47], v[104:107]
s_mov_b32 s45, 0x5e000
buffer_load_dwordx4 v[44:47], v4, s[20:23], s45 offen offset:2048
v_and_b32_dpp v116, v89, v16 row_newbcast:1 row_mask:0xf bank_mask:0xf
v_and_b32_dpp v117, v89, v17 row_newbcast:1 row_mask:0xf bank_mask:0xf
v_and_b32_dpp v118, v89, v18 row_newbcast:1 row_mask:0xf bank_mask:0xf
v_and_b32_dpp v119, v89, v19 row_newbcast:1 row_mask:0xf bank_mask:0xf
s_waitcnt vmcnt(11)
v_mfma_f32_16x16x32_bf16 v[104:107], v[112:115], v[48:51], v[104:107]
s_mov_b32 s45, 0x62000
buffer_load_dwordx4 v[48:51], v4, s[20:23], s45 offen offset:0
v_and_b32_dpp v112, v89, v16 row_newbcast:2 row_mask:0xf bank_mask:0xf
v_and_b32_dpp v113, v89, v17 row_newbcast:2 row_mask:0xf bank_mask:0xf
v_and_b32_dpp v114, v89, v18 row_newbcast:2 row_mask:0xf bank_mask:0xf
v_and_b32_dpp v115, v89, v19 row_newbcast:2 row_mask:0xf bank_mask:0xf
s_waitcnt vmcnt(11)
v_mfma_f32_16x16x32_bf16 v[104:107], v[116:119], v[52:55], v[104:107]
s_mov_b32 s45, 0x65000
buffer_load_dwordx4 v[52:55], v4, s[20:23], s45 offen offset:2048
v_and_b32_dpp v116, v89, v16 row_newbcast:3 row_mask:0xf bank_mask:0xf
v_and_b32_dpp v117, v89, v17 row_newbcast:3 row_mask:0xf bank_mask:0xf
v_and_b32_dpp v118, v89, v18 row_newbcast:3 row_mask:0xf bank_mask:0xf
v_and_b32_dpp v119, v89, v19 row_newbcast:3 row_mask:0xf bank_mask:0xf
s_waitcnt vmcnt(11)
v_mfma_f32_16x16x32_bf16 v[104:107], v[112:115], v[56:59], v[104:107]
s_mov_b32 s45, 0x69000
buffer_load_dwordx4 v[56:59], v4, s[20:23], s45 offen offset:0
v_and_b32_dpp v112, v89, v16 row_newbcast:4 row_mask:0xf bank_mask:0xf
v_and_b32_dpp v113, v89, v17 row_newbcast:4 row_mask:0xf bank_mask:0xf
v_and_b32_dpp v114, v89, v18 row_newbcast:4 row_mask:0xf bank_mask:0xf
v_and_b32_dpp v115, v89, v19 row_newbcast:4 row_mask:0xf bank_mask:0xf
s_waitcnt vmcnt(11)
v_mfma_f32_16x16x32_bf16 v[104:107], v[116:119], v[60:63], v[104:107]
s_mov_b32 s45, 0x6c000
buffer_load_dwordx4 v[60:63], v4, s[20:23], s45 offen offset:2048
v_and_b32_dpp v116, v89, v16 row_newbcast:5 row_mask:0xf bank_mask:0xf
v_and_b32_dpp v117, v89, v17 row_newbcast:5 row_mask:0xf bank_mask:0xf
v_and_b32_dpp v118, v89, v18 row_newbcast:5 row_mask:0xf bank_mask:0xf
v_and_b32_dpp v119, v89, v19 row_newbcast:5 row_mask:0xf bank_mask:0xf
s_waitcnt vmcnt(11)
v_mfma_f32_16x16x32_bf16 v[104:107], v[112:115], v[64:67], v[104:107]
buffer_load_dwordx4 v[64:67], v5, s[24:27], 0 offen offset:0
v_and_b32_dpp v112, v89, v16 row_newbcast:6 row_mask:0xf bank_mask:0xf
v_and_b32_dpp v113, v89, v17 row_newbcast:6 row_mask:0xf bank_mask:0xf
v_and_b32_dpp v114, v89, v18 row_newbcast:6 row_mask:0xf bank_mask:0xf
v_and_b32_dpp v115, v89, v19 row_newbcast:6 row_mask:0xf bank_mask:0xf
s_waitcnt vmcnt(11)
v_mfma_f32_16x16x32_bf16 v[104:107], v[116:119], v[68:71], v[104:107]
s_mov_b32 s45, 0x1000
buffer_load_dwordx4 v[68:71], v5, s[24:27], s45 offen offset:0
v_and_b32_dpp v116, v89, v16 row_newbcast:7 row_mask:0xf bank_mask:0xf
v_and_b32_dpp v117, v89, v17 row_newbcast:7 row_mask:0xf bank_mask:0xf
v_and_b32_dpp v118, v89, v18 row_newbcast:7 row_mask:0xf bank_mask:0xf
v_and_b32_dpp v119, v89, v19 row_newbcast:7 row_mask:0xf bank_mask:0xf
s_waitcnt vmcnt(11)
v_mfma_f32_16x16x32_bf16 v[104:107], v[112:115], v[24:27], v[104:107]
s_mov_b32 s45, 0x2000
buffer_load_dwordx4 v[24:27], v5, s[24:27], s45 offen offset:0
v_and_b32_dpp v112, v89, v16 row_newbcast:8 row_mask:0xf bank_mask:0xf
v_and_b32_dpp v113, v89, v17 row_newbcast:8 row_mask:0xf bank_mask:0xf
v_and_b32_dpp v114, v89, v18 row_newbcast:8 row_mask:0xf bank_mask:0xf
v_and_b32_dpp v115, v89, v19 row_newbcast:8 row_mask:0xf bank_mask:0xf
s_waitcnt vmcnt(11)
v_mfma_f32_16x16x32_bf16 v[104:107], v[116:119], v[28:31], v[104:107]
s_mov_b32 s45, 0x3000
buffer_load_dwordx4 v[28:31], v5, s[24:27], s45 offen offset:0
v_and_b32_dpp v116, v89, v16 row_newbcast:9 row_mask:0xf bank_mask:0xf
v_and_b32_dpp v117, v89, v17 row_newbcast:9 row_mask:0xf bank_mask:0xf
v_and_b32_dpp v118, v89, v18 row_newbcast:9 row_mask:0xf bank_mask:0xf
v_and_b32_dpp v119, v89, v19 row_newbcast:9 row_mask:0xf bank_mask:0xf
s_waitcnt vmcnt(11)
v_mfma_f32_16x16x32_bf16 v[104:107], v[112:115], v[32:35], v[104:107]
s_mov_b32 s45, 0x4000
buffer_load_dwordx4 v[32:35], v5, s[24:27], s45 offen offset:0
v_and_b32_dpp v112, v89, v16 row_newbcast:10 row_mask:0xf bank_mask:0xf
v_and_b32_dpp v113, v89, v17 row_newbcast:10 row_mask:0xf bank_mask:0xf
v_and_b32_dpp v114, v89, v18 row_newbcast:10 row_mask:0xf bank_mask:0xf
v_and_b32_dpp v115, v89, v19 row_newbcast:10 row_mask:0xf bank_mask:0xf
s_waitcnt vmcnt(11)
v_mfma_f32_16x16x32_bf16 v[104:107], v[116:119], v[36:39], v[104:107]
s_mov_b32 s45, 0x5000
buffer_load_dwordx4 v[36:39], v5, s[24:27], s45 offen offset:0
v_and_b32_dpp v116, v89, v16 row_newbcast:11 row_mask:0xf bank_mask:0xf
v_and_b32_dpp v117, v89, v17 row_newbcast:11 row_mask:0xf bank_mask:0xf
v_and_b32_dpp v118, v89, v18 row_newbcast:11 row_mask:0xf bank_mask:0xf
v_and_b32_dpp v119, v89, v19 row_newbcast:11 row_mask:0xf bank_mask:0xf
s_waitcnt vmcnt(11)
v_mfma_f32_16x16x32_bf16 v[104:107], v[112:115], v[40:43], v[104:107]
s_mov_b32 s45, 0x6000
buffer_load_dwordx4 v[40:43], v5, s[24:27], s45 offen offset:0
v_and_b32_dpp v112, v89, v16 row_newbcast:12 row_mask:0xf bank_mask:0xf
v_and_b32_dpp v113, v89, v17 row_newbcast:12 row_mask:0xf bank_mask:0xf
v_and_b32_dpp v114, v89, v18 row_newbcast:12 row_mask:0xf bank_mask:0xf
v_and_b32_dpp v115, v89, v19 row_newbcast:12 row_mask:0xf bank_mask:0xf
s_waitcnt vmcnt(11)
v_mfma_f32_16x16x32_bf16 v[104:107], v[116:119], v[44:47], v[104:107]
s_mov_b32 s45, 0x7000
buffer_load_dwordx4 v[44:47], v5, s[24:27], s45 offen offset:0
v_and_b32_dpp v116, v89, v16 row_newbcast:13 row_mask:0xf bank_mask:0xf
v_and_b32_dpp v117, v89, v17 row_newbcast:13 row_mask:0xf bank_mask:0xf
v_and_b32_dpp v118, v89, v18 row_newbcast:13 row_mask:0xf bank_mask:0xf
v_and_b32_dpp v119, v89, v19 row_newbcast:13 row_mask:0xf bank_mask:0xf
s_waitcnt vmcnt(11)
v_mfma_f32_16x16x32_bf16 v[104:107], v[112:115], v[48:51], v[104:107]
s_mov_b32 s45, 0x8000
buffer_load_dwordx4 v[48:51], v5, s[24:27], s45 offen offset:0
v_and_b32_dpp v112, v89, v16 row_newbcast:14 row_mask:0xf bank_mask:0xf
v_and_b32_dpp v113, v89, v17 row_newbcast:14 row_mask:0xf bank_mask:0xf
v_and_b32_dpp v114, v89, v18 row_newbcast:14 row_mask:0xf bank_mask:0xf
v_and_b32_dpp v115, v89, v19 row_newbcast:14 row_mask:0xf bank_mask:0xf
s_waitcnt vmcnt(11)
v_mfma_f32_16x16x32_bf16 v[104:107], v[116:119], v[52:55], v[104:107]
s_mov_b32 s45, 0x9000
buffer_load_dwordx4 v[52:55], v5, s[24:27], s45 offen offset:0
v_and_b32_dpp v116, v89, v16 row_newbcast:15 row_mask:0xf bank_mask:0xf
v_and_b32_dpp v117, v89, v17 row_newbcast:15 row_mask:0xf bank_mask:0xf
v_and_b32_dpp v118, v89, v18 row_newbcast:15 row_mask:0xf bank_mask:0xf
v_and_b32_dpp v119, v89, v19 row_newbcast:15 row_mask:0xf bank_mask:0xf
s_waitcnt vmcnt(11)
v_mfma_f32_16x16x32_bf16 v[104:107], v[112:115], v[56:59], v[104:107]
s_mov_b32 s45, 0xa000
buffer_load_dwordx4 v[56:59], v5, s[24:27], s45 offen offset:0
s_nop 1
s_waitcnt vmcnt(11)
v_mfma_f32_16x16x32_bf16 v[104:107], v[116:119], v[60:63], v[104:107]
s_mov_b32 s45, 0xb000
buffer_load_dwordx4 v[60:63], v5, s[24:27], s45 offen offset:0
s_nop 7
s_mov_b32 exec_hi, 0
ds_write_b128 v11, v[104:107] offset:6144
s_mov_b32 exec_hi, -1
s_waitcnt lgkmcnt(0)
s_barrier
ds_read_b32 v120, v9 offset:6144
ds_read_b32 v121, v9 offset:6400
ds_read_b32 v122, v9 offset:6656
ds_read_b32 v123, v9 offset:6912
ds_read_b32 v124, v9 offset:7168
ds_read_b32 v125, v9 offset:7424
ds_read_b32 v126, v9 offset:7680
ds_read_b32 v127, v9 offset:7936
s_waitcnt lgkmcnt(0)
v_add_f32 v120, v120, v122
v_add_f32 v120, v120, v124
v_add_f32 v120, v120, v126
v_add_f32 v121, v121, v123
v_add_f32 v121, v121, v125
v_add_f32 v121, v121, v127
v_cvt_pk_bf16_f32 v122, v120, v121
v_lshlrev_b32 v120, 16, v122
v_and_b32 v121, 0xffff0000, v122
v_mul_f32 v124, 0xbfb8aa3b, v120
v_mul_f32 v125, 0xbfb8aa3b, v121
v_exp_f32 v124, v124
v_exp_f32 v125, v125
s_nop 0
v_add_f32 v124, 1.0, v124
v_add_f32 v125, 1.0, v125
v_rcp_f32 v124, v124
v_rcp_f32 v125, v125
s_nop 0
v_mul_f32 v120, v120, v124
v_cvt_pk_bf16_f32 v88, v120, v120
v_mul_f32 v121, v121, v125
v_cvt_pk_bf16_f32 v89, v121, v121
s_nop 1
v_and_b32_dpp v112, v88, v16 row_newbcast:0 row_mask:0xf bank_mask:0xf
v_and_b32_dpp v113, v88, v17 row_newbcast:0 row_mask:0xf bank_mask:0xf
v_and_b32_dpp v114, v88, v18 row_newbcast:0 row_mask:0xf bank_mask:0xf
v_and_b32_dpp v115, v88, v19 row_newbcast:0 row_mask:0xf bank_mask:0xf
v_and_b32_dpp v116, v88, v16 row_newbcast:1 row_mask:0xf bank_mask:0xf
v_and_b32_dpp v117, v88, v17 row_newbcast:1 row_mask:0xf bank_mask:0xf
v_and_b32_dpp v118, v88, v18 row_newbcast:1 row_mask:0xf bank_mask:0xf
v_and_b32_dpp v119, v88, v19 row_newbcast:1 row_mask:0xf bank_mask:0xf
s_waitcnt vmcnt(11)
v_mfma_f32_16x16x32_bf16 v[104:107], v[112:115], v[64:67], 0
s_mov_b32 s45, 0xc000
buffer_load_dwordx4 v[64:67], v5, s[24:27], s45 offen offset:0
v_and_b32_dpp v112, v88, v16 row_newbcast:2 row_mask:0xf bank_mask:0xf
v_and_b32_dpp v113, v88, v17 row_newbcast:2 row_mask:0xf bank_mask:0xf
v_and_b32_dpp v114, v88, v18 row_newbcast:2 row_mask:0xf bank_mask:0xf
v_and_b32_dpp v115, v88, v19 row_newbcast:2 row_mask:0xf bank_mask:0xf
s_waitcnt vmcnt(11)
v_mfma_f32_16x16x32_bf16 v[104:107], v[116:119], v[68:71], v[104:107]
s_mov_b32 s45, 0xd000
buffer_load_dwordx4 v[68:71], v5, s[24:27], s45 offen offset:0
v_and_b32_dpp v116, v88, v16 row_newbcast:3 row_mask:0xf bank_mask:0xf
v_and_b32_dpp v117, v88, v17 row_newbcast:3 row_mask:0xf bank_mask:0xf
v_and_b32_dpp v118, v88, v18 row_newbcast:3 row_mask:0xf bank_mask:0xf
v_and_b32_dpp v119, v88, v19 row_newbcast:3 row_mask:0xf bank_mask:0xf
s_waitcnt vmcnt(11)
v_mfma_f32_16x16x32_bf16 v[104:107], v[112:115], v[24:27], v[104:107]
s_mov_b32 s45, 0xe000
buffer_load_dwordx4 v[24:27], v5, s[24:27], s45 offen offset:0
v_and_b32_dpp v112, v88, v16 row_newbcast:4 row_mask:0xf bank_mask:0xf
v_and_b32_dpp v113, v88, v17 row_newbcast:4 row_mask:0xf bank_mask:0xf
v_and_b32_dpp v114, v88, v18 row_newbcast:4 row_mask:0xf bank_mask:0xf
v_and_b32_dpp v115, v88, v19 row_newbcast:4 row_mask:0xf bank_mask:0xf
s_waitcnt vmcnt(11)
v_mfma_f32_16x16x32_bf16 v[104:107], v[116:119], v[28:31], v[104:107]
s_mov_b32 s45, 0xf000
buffer_load_dwordx4 v[28:31], v5, s[24:27], s45 offen offset:0
v_and_b32_dpp v116, v88, v16 row_newbcast:5 row_mask:0xf bank_mask:0xf
v_and_b32_dpp v117, v88, v17 row_newbcast:5 row_mask:0xf bank_mask:0xf
v_and_b32_dpp v118, v88, v18 row_newbcast:5 row_mask:0xf bank_mask:0xf
v_and_b32_dpp v119, v88, v19 row_newbcast:5 row_mask:0xf bank_mask:0xf
s_waitcnt vmcnt(11)
v_mfma_f32_16x16x32_bf16 v[104:107], v[112:115], v[32:35], v[104:107]
s_mov_b32 s45, 0x10000
buffer_load_dwordx4 v[32:35], v5, s[24:27], s45 offen offset:0
v_and_b32_dpp v112, v88, v16 row_newbcast:6 row_mask:0xf bank_mask:0xf
v_and_b32_dpp v113, v88, v17 row_newbcast:6 row_mask:0xf bank_mask:0xf
v_and_b32_dpp v114, v88, v18 row_newbcast:6 row_mask:0xf bank_mask:0xf
v_and_b32_dpp v115, v88, v19 row_newbcast:6 row_mask:0xf bank_mask:0xf
s_waitcnt vmcnt(11)
v_mfma_f32_16x16x32_bf16 v[104:107], v[116:119], v[36:39], v[104:107]
s_mov_b32 s45, 0x11000
buffer_load_dwordx4 v[36:39], v5, s[24:27], s45 offen offset:0
v_and_b32_dpp v116, v88, v16 row_newbcast:7 row_mask:0xf bank_mask:0xf
v_and_b32_dpp v117, v88, v17 row_newbcast:7 row_mask:0xf bank_mask:0xf
v_and_b32_dpp v118, v88, v18 row_newbcast:7 row_mask:0xf bank_mask:0xf
v_and_b32_dpp v119, v88, v19 row_newbcast:7 row_mask:0xf bank_mask:0xf
s_waitcnt vmcnt(11)
v_mfma_f32_16x16x32_bf16 v[104:107], v[112:115], v[40:43], v[104:107]
s_mov_b32 s45, 0x12000
buffer_load_dwordx4 v[40:43], v5, s[24:27], s45 offen offset:0
v_and_b32_dpp v112, v88, v16 row_newbcast:8 row_mask:0xf bank_mask:0xf
v_and_b32_dpp v113, v88, v17 row_newbcast:8 row_mask:0xf bank_mask:0xf
v_and_b32_dpp v114, v88, v18 row_newbcast:8 row_mask:0xf bank_mask:0xf
v_and_b32_dpp v115, v88, v19 row_newbcast:8 row_mask:0xf bank_mask:0xf
s_waitcnt vmcnt(11)
v_mfma_f32_16x16x32_bf16 v[104:107], v[116:119], v[44:47], v[104:107]
s_mov_b32 s45, 0x13000
buffer_load_dwordx4 v[44:47], v5, s[24:27], s45 offen offset:0
v_and_b32_dpp v116, v88, v16 row_newbcast:9 row_mask:0xf bank_mask:0xf
v_and_b32_dpp v117, v88, v17 row_newbcast:9 row_mask:0xf bank_mask:0xf
v_and_b32_dpp v118, v88, v18 row_newbcast:9 row_mask:0xf bank_mask:0xf
v_and_b32_dpp v119, v88, v19 row_newbcast:9 row_mask:0xf bank_mask:0xf
s_waitcnt vmcnt(11)
v_mfma_f32_16x16x32_bf16 v[104:107], v[112:115], v[48:51], v[104:107]
s_mov_b32 s45, 0x14000
buffer_load_dwordx4 v[48:51], v5, s[24:27], s45 offen offset:0
v_and_b32_dpp v112, v88, v16 row_newbcast:10 row_mask:0xf bank_mask:0xf
v_and_b32_dpp v113, v88, v17 row_newbcast:10 row_mask:0xf bank_mask:0xf
v_and_b32_dpp v114, v88, v18 row_newbcast:10 row_mask:0xf bank_mask:0xf
v_and_b32_dpp v115, v88, v19 row_newbcast:10 row_mask:0xf bank_mask:0xf
s_waitcnt vmcnt(11)
v_mfma_f32_16x16x32_bf16 v[104:107], v[116:119], v[52:55], v[104:107]
s_mov_b32 s45, 0x15000
buffer_load_dwordx4 v[52:55], v5, s[24:27], s45 offen offset:0
v_and_b32_dpp v116, v88, v16 row_newbcast:11 row_mask:0xf bank_mask:0xf
v_and_b32_dpp v117, v88, v17 row_newbcast:11 row_mask:0xf bank_mask:0xf
v_and_b32_dpp v118, v88, v18 row_newbcast:11 row_mask:0xf bank_mask:0xf
v_and_b32_dpp v119, v88, v19 row_newbcast:11 row_mask:0xf bank_mask:0xf
s_waitcnt vmcnt(11)
v_mfma_f32_16x16x32_bf16 v[104:107], v[112:115], v[56:59], v[104:107]
s_mov_b32 s45, 0x16000
buffer_load_dwordx4 v[56:59], v5, s[24:27], s45 offen offset:0
v_and_b32_dpp v112, v88, v16 row_newbcast:12 row_mask:0xf bank_mask:0xf
v_and_b32_dpp v113, v88, v17 row_newbcast:12 row_mask:0xf bank_mask:0xf
v_and_b32_dpp v114, v88, v18 row_newbcast:12 row_mask:0xf bank_mask:0xf
v_and_b32_dpp v115, v88, v19 row_newbcast:12 row_mask:0xf bank_mask:0xf
s_waitcnt vmcnt(11)
v_mfma_f32_16x16x32_bf16 v[104:107], v[116:119], v[60:63], v[104:107]
s_mov_b32 s45, 0x17000
buffer_load_dwordx4 v[60:63], v5, s[24:27], s45 offen offset:0
v_and_b32_dpp v116, v88, v16 row_newbcast:13 row_mask:0xf bank_mask:0xf
v_and_b32_dpp v117, v88, v17 row_newbcast:13 row_mask:0xf bank_mask:0xf
v_and_b32_dpp v118, v88, v18 row_newbcast:13 row_mask:0xf bank_mask:0xf
v_and_b32_dpp v119, v88, v19 row_newbcast:13 row_mask:0xf bank_mask:0xf
s_waitcnt vmcnt(11)
v_mfma_f32_16x16x32_bf16 v[104:107], v[112:115], v[64:67], v[104:107]
s_mov_b32 s45, 0x18000
buffer_load_dwordx4 v[64:67], v5, s[24:27], s45 offen offset:0
v_and_b32_dpp v112, v88, v16 row_newbcast:14 row_mask:0xf bank_mask:0xf
v_and_b32_dpp v113, v88, v17 row_newbcast:14 row_mask:0xf bank_mask:0xf
v_and_b32_dpp v114, v88, v18 row_newbcast:14 row_mask:0xf bank_mask:0xf
v_and_b32_dpp v115, v88, v19 row_newbcast:14 row_mask:0xf bank_mask:0xf
s_waitcnt vmcnt(11)
v_mfma_f32_16x16x32_bf16 v[104:107], v[116:119], v[68:71], v[104:107]
s_mov_b32 s45, 0x19000
buffer_load_dwordx4 v[68:71], v5, s[24:27], s45 offen offset:0
v_and_b32_dpp v116, v88, v16 row_newbcast:15 row_mask:0xf bank_mask:0xf
v_and_b32_dpp v117, v88, v17 row_newbcast:15 row_mask:0xf bank_mask:0xf
v_and_b32_dpp v118, v88, v18 row_newbcast:15 row_mask:0xf bank_mask:0xf
v_and_b32_dpp v119, v88, v19 row_newbcast:15 row_mask:0xf bank_mask:0xf
s_waitcnt vmcnt(11)
v_mfma_f32_16x16x32_bf16 v[104:107], v[112:115], v[24:27], v[104:107]
s_mov_b32 s45, 0x1a000
buffer_load_dwordx4 v[24:27], v5, s[24:27], s45 offen offset:0
v_and_b32_dpp v112, v89, v16 row_newbcast:0 row_mask:0xf bank_mask:0xf
v_and_b32_dpp v113, v89, v17 row_newbcast:0 row_mask:0xf bank_mask:0xf
v_and_b32_dpp v114, v89, v18 row_newbcast:0 row_mask:0xf bank_mask:0xf
v_and_b32_dpp v115, v89, v19 row_newbcast:0 row_mask:0xf bank_mask:0xf
s_waitcnt vmcnt(11)
v_mfma_f32_16x16x32_bf16 v[104:107], v[116:119], v[28:31], v[104:107]
s_mov_b32 s45, 0x1b000
buffer_load_dwordx4 v[28:31], v5, s[24:27], s45 offen offset:0
v_and_b32_dpp v116, v89, v16 row_newbcast:1 row_mask:0xf bank_mask:0xf
v_and_b32_dpp v117, v89, v17 row_newbcast:1 row_mask:0xf bank_mask:0xf
v_and_b32_dpp v118, v89, v18 row_newbcast:1 row_mask:0xf bank_mask:0xf
v_and_b32_dpp v119, v89, v19 row_newbcast:1 row_mask:0xf bank_mask:0xf
s_waitcnt vmcnt(11)
v_mfma_f32_16x16x32_bf16 v[104:107], v[112:115], v[32:35], v[104:107]
s_mov_b32 s45, 0x1c000
buffer_load_dwordx4 v[32:35], v5, s[24:27], s45 offen offset:0
v_and_b32_dpp v112, v89, v16 row_newbcast:2 row_mask:0xf bank_mask:0xf
v_and_b32_dpp v113, v89, v17 row_newbcast:2 row_mask:0xf bank_mask:0xf
v_and_b32_dpp v114, v89, v18 row_newbcast:2 row_mask:0xf bank_mask:0xf
v_and_b32_dpp v115, v89, v19 row_newbcast:2 row_mask:0xf bank_mask:0xf
s_waitcnt vmcnt(11)
v_mfma_f32_16x16x32_bf16 v[104:107], v[116:119], v[36:39], v[104:107]
s_mov_b32 s45, 0x1d000
buffer_load_dwordx4 v[36:39], v5, s[24:27], s45 offen offset:0
v_and_b32_dpp v116, v89, v16 row_newbcast:3 row_mask:0xf bank_mask:0xf
v_and_b32_dpp v117, v89, v17 row_newbcast:3 row_mask:0xf bank_mask:0xf
v_and_b32_dpp v118, v89, v18 row_newbcast:3 row_mask:0xf bank_mask:0xf
v_and_b32_dpp v119, v89, v19 row_newbcast:3 row_mask:0xf bank_mask:0xf
s_waitcnt vmcnt(11)
v_mfma_f32_16x16x32_bf16 v[104:107], v[112:115], v[40:43], v[104:107]
s_mov_b32 s45, 0x1e000
buffer_load_dwordx4 v[40:43], v5, s[24:27], s45 offen offset:0
v_and_b32_dpp v112, v89, v16 row_newbcast:4 row_mask:0xf bank_mask:0xf
v_and_b32_dpp v113, v89, v17 row_newbcast:4 row_mask:0xf bank_mask:0xf
v_and_b32_dpp v114, v89, v18 row_newbcast:4 row_mask:0xf bank_mask:0xf
v_and_b32_dpp v115, v89, v19 row_newbcast:4 row_mask:0xf bank_mask:0xf
s_waitcnt vmcnt(11)
v_mfma_f32_16x16x32_bf16 v[104:107], v[116:119], v[44:47], v[104:107]
s_mov_b32 s45, 0x1f000
buffer_load_dwordx4 v[44:47], v5, s[24:27], s45 offen offset:0
v_and_b32_dpp v116, v89, v16 row_newbcast:5 row_mask:0xf bank_mask:0xf
v_and_b32_dpp v117, v89, v17 row_newbcast:5 row_mask:0xf bank_mask:0xf
v_and_b32_dpp v118, v89, v18 row_newbcast:5 row_mask:0xf bank_mask:0xf
v_and_b32_dpp v119, v89, v19 row_newbcast:5 row_mask:0xf bank_mask:0xf
s_waitcnt vmcnt(11)
v_mfma_f32_16x16x32_bf16 v[104:107], v[112:115], v[48:51], v[104:107]
v_and_b32_dpp v112, v89, v16 row_newbcast:6 row_mask:0xf bank_mask:0xf
v_and_b32_dpp v113, v89, v17 row_newbcast:6 row_mask:0xf bank_mask:0xf
v_and_b32_dpp v114, v89, v18 row_newbcast:6 row_mask:0xf bank_mask:0xf
v_and_b32_dpp v115, v89, v19 row_newbcast:6 row_mask:0xf bank_mask:0xf
s_waitcnt vmcnt(10)
v_mfma_f32_16x16x32_bf16 v[104:107], v[116:119], v[52:55], v[104:107]
v_and_b32_dpp v116, v89, v16 row_newbcast:7 row_mask:0xf bank_mask:0xf
v_and_b32_dpp v117, v89, v17 row_newbcast:7 row_mask:0xf bank_mask:0xf
v_and_b32_dpp v118, v89, v18 row_newbcast:7 row_mask:0xf bank_mask:0xf
v_and_b32_dpp v119, v89, v19 row_newbcast:7 row_mask:0xf bank_mask:0xf
s_waitcnt vmcnt(9)
v_mfma_f32_16x16x32_bf16 v[104:107], v[112:115], v[56:59], v[104:107]
v_and_b32_dpp v112, v89, v16 row_newbcast:8 row_mask:0xf bank_mask:0xf
v_and_b32_dpp v113, v89, v17 row_newbcast:8 row_mask:0xf bank_mask:0xf
v_and_b32_dpp v114, v89, v18 row_newbcast:8 row_mask:0xf bank_mask:0xf
v_and_b32_dpp v115, v89, v19 row_newbcast:8 row_mask:0xf bank_mask:0xf
s_waitcnt vmcnt(8)
v_mfma_f32_16x16x32_bf16 v[104:107], v[116:119], v[60:63], v[104:107]
v_and_b32_dpp v116, v89, v16 row_newbcast:9 row_mask:0xf bank_mask:0xf
v_and_b32_dpp v117, v89, v17 row_newbcast:9 row_mask:0xf bank_mask:0xf
v_and_b32_dpp v118, v89, v18 row_newbcast:9 row_mask:0xf bank_mask:0xf
v_and_b32_dpp v119, v89, v19 row_newbcast:9 row_mask:0xf bank_mask:0xf
s_waitcnt vmcnt(7)
v_mfma_f32_16x16x32_bf16 v[104:107], v[112:115], v[64:67], v[104:107]
v_and_b32_dpp v112, v89, v16 row_newbcast:10 row_mask:0xf bank_mask:0xf
v_and_b32_dpp v113, v89, v17 row_newbcast:10 row_mask:0xf bank_mask:0xf
v_and_b32_dpp v114, v89, v18 row_newbcast:10 row_mask:0xf bank_mask:0xf
v_and_b32_dpp v115, v89, v19 row_newbcast:10 row_mask:0xf bank_mask:0xf
s_waitcnt vmcnt(6)
v_mfma_f32_16x16x32_bf16 v[104:107], v[116:119], v[68:71], v[104:107]
v_and_b32_dpp v116, v89, v16 row_newbcast:11 row_mask:0xf bank_mask:0xf
v_and_b32_dpp v117, v89, v17 row_newbcast:11 row_mask:0xf bank_mask:0xf
v_and_b32_dpp v118, v89, v18 row_newbcast:11 row_mask:0xf bank_mask:0xf
v_and_b32_dpp v119, v89, v19 row_newbcast:11 row_mask:0xf bank_mask:0xf
s_waitcnt vmcnt(5)
v_mfma_f32_16x16x32_bf16 v[104:107], v[112:115], v[24:27], v[104:107]
v_and_b32_dpp v112, v89, v16 row_newbcast:12 row_mask:0xf bank_mask:0xf
v_and_b32_dpp v113, v89, v17 row_newbcast:12 row_mask:0xf bank_mask:0xf
v_and_b32_dpp v114, v89, v18 row_newbcast:12 row_mask:0xf bank_mask:0xf
v_and_b32_dpp v115, v89, v19 row_newbcast:12 row_mask:0xf bank_mask:0xf
s_waitcnt vmcnt(4)
v_mfma_f32_16x16x32_bf16 v[104:107], v[116:119], v[28:31], v[104:107]
v_and_b32_dpp v116, v89, v16 row_newbcast:13 row_mask:0xf bank_mask:0xf
v_and_b32_dpp v117, v89, v17 row_newbcast:13 row_mask:0xf bank_mask:0xf
v_and_b32_dpp v118, v89, v18 row_newbcast:13 row_mask:0xf bank_mask:0xf
v_and_b32_dpp v119, v89, v19 row_newbcast:13 row_mask:0xf bank_mask:0xf
s_waitcnt vmcnt(3)
v_mfma_f32_16x16x32_bf16 v[104:107], v[112:115], v[32:35], v[104:107]
v_and_b32_dpp v112, v89, v16 row_newbcast:14 row_mask:0xf bank_mask:0xf
v_and_b32_dpp v113, v89, v17 row_newbcast:14 row_mask:0xf bank_mask:0xf
v_and_b32_dpp v114, v89, v18 row_newbcast:14 row_mask:0xf bank_mask:0xf
v_and_b32_dpp v115, v89, v19 row_newbcast:14 row_mask:0xf bank_mask:0xf
s_waitcnt vmcnt(2)
v_mfma_f32_16x16x32_bf16 v[104:107], v[116:119], v[36:39], v[104:107]
v_and_b32_dpp v116, v89, v16 row_newbcast:15 row_mask:0xf bank_mask:0xf
v_and_b32_dpp v117, v89, v17 row_newbcast:15 row_mask:0xf bank_mask:0xf
v_and_b32_dpp v118, v89, v18 row_newbcast:15 row_mask:0xf bank_mask:0xf
v_and_b32_dpp v119, v89, v19 row_newbcast:15 row_mask:0xf bank_mask:0xf
s_waitcnt vmcnt(1)
v_mfma_f32_16x16x32_bf16 v[104:107], v[112:115], v[40:43], v[104:107]
s_nop 1
s_waitcnt vmcnt(0)
v_mfma_f32_16x16x32_bf16 v[104:107], v[116:119], v[44:47], v[104:107]
s_nop 7
s_mov_b32 s54, 0xfffffffe
v_min_u32 v104, s54, v104
v_min_u32 v105, s54, v105
v_min_u32 v106, s54, v106
v_min_u32 v107, s54, v107
s_mov_b32 s45, 0x10000
v_add_u32 v15, s56, v6
buffer_store_dwordx4 v[104:107], v15, s[28:31], s45 offen sc1
buffer_load_dwordx4 v[48:51], v3, s[12:15], 0 offen offset:0
s_mov_b32 s45, 0x8000
buffer_load_dwordx4 v[52:55], v3, s[12:15], s45 offen offset:0
s_mov_b32 s45, 0x10000
buffer_load_dwordx4 v[56:59], v3, s[12:15], s45 offen offset:0
s_mov_b32 s45, 0x18000
buffer_load_dwordx4 v[60:63], v3, s[12:15], s45 offen offset:0
s_mov_b32 s45, 0x20000
buffer_load_dwordx4 v[64:67], v3, s[12:15], s45 offen offset:0
s_mov_b32 s45, 0x28000
buffer_load_dwordx4 v[68:71], v3, s[12:15], s45 offen offset:0
s_mov_b32 s45, 0x30000
buffer_load_dwordx4 v[24:27], v3, s[12:15], s45 offen offset:0
s_mov_b32 s45, 0x38000
buffer_load_dwordx4 v[28:31], v3, s[12:15], s45 offen offset:0
s_mov_b32 s45, 0x40000
buffer_load_dwordx4 v[32:35], v3, s[12:15], s45 offen offset:0
s_mov_b32 s45, 0x48000
buffer_load_dwordx4 v[36:39], v3, s[12:15], s45 offen offset:0
s_mov_b32 s45, 0x50000
buffer_load_dwordx4 v[40:43], v3, s[12:15], s45 offen offset:0
s_mov_b32 s45, 0x58000
buffer_load_dwordx4 v[44:47], v3, s[12:15], s45 offen offset:0
s_cmp_lg_u32 s44, 0
s_cbranch_scc1 L_skip4
s_mov_b32 s57, 0
v_lshlrev_b32 v120, 11, v0
v_add_u32 v120, 0x107fc, v120
s_mov_b32 exec_lo, 0x3fff
s_mov_b32 exec_hi, 0
L_poll4:
buffer_load_dword v122, v120, s[28:31], 0 offen sc1
s_waitcnt vmcnt(0)
v_cmp_eq_u32 vcc, -1, v122
s_add_u32 s57, s57, 1
s_nop 3
s_and_b64 exec, exec, vcc
s_cbranch_scc0 L_done4
s_cmp_ge_u32 s57, 0x40000
s_cbranch_scc1 L_done4
s_sleep 4
s_branch L_poll4
L_done4:
s_mov_b64 exec, -1
L_skip4:
s_barrier
s_mov_b32 s57, 0
L_g5:
s_mov_b32 s45, 0x10000
buffer_load_dwordx4 v[72:75], v7, s[28:31], s45 offen sc1
s_mov_b32 s45, 0x11000
buffer_load_dwordx4 v[76:79], v7, s[28:31], s45 offen sc1
s_mov_b32 s45, 0x12000
buffer_load_dwordx4 v[80:83], v7, s[28:31], s45 offen sc1
s_mov_b32 s45, 0x13000
buffer_load_dwordx4 v[84:87], v7, s[28:31], s45 offen sc1
s_mov_b32 s45, 0x14000
buffer_load_dwordx4 v[88:91], v7, s[28:31], s45 offen sc1
s_mov_b32 s45, 0x15000
buffer_load_dwordx4 v[92:95], v7, s[28:31], s45 offen sc1
s_mov_b32 s45, 0x16000
buffer_load_dwordx4 v[96:99], v7, s[28:31], s45 offen sc1
s_waitcnt vmcnt(6)
v_max3_u32 v15, v72, v73, v74
v_max_u32 v15, v15, v75
s_waitcnt vmcnt(5)
v_max3_u32 v15, v15, v76, v77
v_max3_u32 v15, v15, v78, v79
v_add_f32 v72, v72, v76
v_add_f32 v73, v73, v77
v_add_f32 v74, v74, v78
v_add_f32 v75, v75, v79
s_waitcnt vmcnt(4)
v_max3_u32 v15, v15, v80, v81
v_max3_u32 v15, v15, v82, v83
v_add_f32 v72, v72, v80
v_add_f32 v73, v73, v81
v_add_f32 v74, v74, v82
v_add_f32 v75, v75, v83
s_waitcnt vmcnt(3)
v_max3_u32 v15, v15, v84, v85
v_max3_u32 v15, v15, v86, v87
v_add_f32 v72, v72, v84
v_add_f32 v73, v73, v85
v_add_f32 v74, v74, v86
v_add_f32 v75, v75, v87
s_waitcnt vmcnt(2)
v_max3_u32 v15, v15, v88, v89
v_max3_u32 v15, v15, v90, v91
v_add_f32 v72, v72, v88
v_add_f32 v73, v73, v89
v_add_f32 v74, v74, v90
v_add_f32 v75, v75, v91
s_waitcnt vmcnt(1)
v_max3_u32 v15, v15, v92, v93
v_max3_u32 v15, v15, v94, v95
v_add_f32 v72, v72, v92
v_add_f32 v73, v73, v93
v_add_f32 v74, v74, v94
v_add_f32 v75, v75, v95
s_waitcnt vmcnt(0)
v_max3_u32 v15, v15, v96, v97
v_max3_u32 v15, v15, v98, v99
v_add_f32 v72, v72, v96
v_add_f32 v73, v73, v97
v_add_f32 v74, v74, v98
v_add_f32 v75, v75, v99
v_cmp_eq_u32 vcc, -1, v15
s_add_u32 s57, s57, 1
s_nop 3
s_cbranch_vccz L_gd5
s_cmp_ge_u32 s57, 0x40000
s_cbranch_scc1 L_gd5
s_sleep 2
s_branch L_g5
L_gd5:
v_mov_b32 v76, v72
v_mov_b32 v77, v73
v_mov_b32 v78, v74
v_mov_b32 v79, v75
s_nop 1
v_permlane32_swap_b32 v72, v76
v_permlane32_swap_b32 v73, v77
v_permlane32_swap_b32 v74, v78
v_permlane32_swap_b32 v75, v79
s_nop 0
v_add_f32 v72, v72, v76
v_add_f32 v73, v73, v77
v_add_f32 v74, v74, v78
v_add_f32 v75, v75, v79
v_cvt_pk_bf16_f32 v76, v72, v73
v_lshlrev_b32 v72, 16, v76
v_and_b32 v73, 0xffff0000, v76
v_cvt_pk_bf16_f32 v76, v74, v75
v_lshlrev_b32 v74, 16, v76
v_and_b32 v75, 0xffff0000, v76
v_add_f32 v20, v20, v72
v_add_f32 v21, v21, v73
v_add_f32 v22, v22, v74
v_add_f32 v23, v23, v75
v_cvt_pk_bf16_f32 v76, v20, v21
v_lshlrev_b32 v20, 16, v76
v_and_b32 v21, 0xffff0000, v76
v_cvt_pk_bf16_f32 v76, v22, v23
v_lshlrev_b32 v22, 16, v76
v_and_b32 v23, 0xffff0000, v76
ds_write_b128 v12, v[20:23] offset:0
s_waitcnt lgkmcnt(0)
s_barrier
ds_read_b128 v[120:123], v14 offset:0
ds_read_b128 v[124:127], v14 offset:16
ds_read_b32 v132, v10 offset:0
ds_read_b32 v133, v10 offset:256
s_waitcnt lgkmcnt(2)
v_add_f32 v128, v120, v121
v_add_f32 v128, v128, v122
v_add_f32 v128, v128, v123
v_add_f32 v128, v128, v124
v_add_f32 v128, v128, v125
v_add_f32 v128, v128, v126
v_add_f32 v128, v128, v127
s_nop 1
v_add_f32_dpp v128, v128, v128 row_ror:8 row_mask:0xf bank_mask:0xf
s_nop 1
v_add_f32_dpp v128, v128, v128 row_ror:4 row_mask:0xf bank_mask:0xf
s_nop 1
v_add_f32_dpp v128, v128, v128 row_ror:2 row_mask:0xf bank_mask:0xf
s_nop 1
v_add_f32_dpp v128, v128, v128 row_ror:1 row_mask:0xf bank_mask:0xf
v_mov_b32 v129, v128
s_nop 1
v_permlane16_swap_b32 v128, v129
s_nop 0
v_add_f32 v128, v128, v129
v_mov_b32 v129, v128
s_nop 1
v_permlane32_swap_b32 v128, v129
s_nop 0
v_add_f32 v128, v128, v129
v_mul_f32 v128, 0x3b000000, v128
v_sub_f32 v120, v120, v128
v_sub_f32 v121, v121, v128
v_sub_f32 v122, v122, v128
v_sub_f32 v123, v123, v128
v_sub_f32 v124, v124, v128
v_sub_f32 v125, v125, v128
v_sub_f32 v126, v126, v128
v_sub_f32 v127, v127, v128
v_mul_f32 v130, v120, v120
v_fmac_f32 v130, v121, v121
v_fmac_f32 v130, v122, v122
v_fmac_f32 v130, v123, v123
v_fmac_f32 v130, v124, v124
v_fmac_f32 v130, v125, v125
v_fmac_f32 v130, v126, v126
v_fmac_f32 v130, v127, v127
s_nop 1
v_add_f32_dpp v130, v130, v130 row_ror:8 row_mask:0xf bank_mask:0xf
s_nop 1
v_add_f32_dpp v130, v130, v130 row_ror:4 row_mask:0xf bank_mask:0xf
s_nop 1
v_add_f32_dpp v130, v130, v130 row_ror:2 row_mask:0xf bank_mask:0xf
s_nop 1
v_add_f32_dpp v130, v130, v130 row_ror:1 row_mask:0xf bank_mask:0xf
v_mov_b32 v129, v130
s_nop 1
v_permlane16_swap_b32 v130, v129
s_nop 0
v_add_f32 v130, v130, v129
v_mov_b32 v129, v130
s_nop 1
v_permlane32_swap_b32 v130, v129
s_nop 0
v_add_f32 v130, v130, v129
v_mov_b32 v129, 0x3727c5ac
v_fmac_f32 v129, 0x3b000000, v130
v_rsq_f32 v130, v129
s_waitcnt lgkmcnt(0)
v_sub_f32 v132, v132, v128
v_mul_f32 v132, v132, v130
v_cvt_pk_bf16_f32 v88, v132, v132
v_sub_f32 v133, v133, v128
v_mul_f32 v133, v133, v130
v_cvt_pk_bf16_f32 v89, v133, v133
s_nop 1
v_and_b32_dpp v112, v88, v16 row_newbcast:0 row_mask:0xf bank_mask:0xf
v_and_b32_dpp v113, v88, v17 row_newbcast:0 row_mask:0xf bank_mask:0xf
v_and_b32_dpp v114, v88, v18 row_newbcast:0 row_mask:0xf bank_mask:0xf
v_and_b32_dpp v115, v88, v19 row_newbcast:0 row_mask:0xf bank_mask:0xf
v_and_b32_dpp v116, v88, v16 row_newbcast:1 row_mask:0xf bank_mask:0xf
v_and_b32_dpp v117, v88, v17 row_newbcast:1 row_mask:0xf bank_mask:0xf
v_and_b32_dpp v118, v88, v18 row_newbcast:1 row_mask:0xf bank_mask:0xf
v_and_b32_dpp v119, v88, v19 row_newbcast:1 row_mask:0xf bank_mask:0xf
v_mfma_f32_16x16x32_bf16 v[104:107], v[112:115], v[48:51], 0
s_mov_b32 s45, 0x60000
buffer_load_dwordx4 v[48:51], v3, s[12:15], s45 offen offset:0
v_and_b32_dpp v112, v88, v16 row_newbcast:2 row_mask:0xf bank_mask:0xf
v_and_b32_dpp v113, v88, v17 row_newbcast:2 row_mask:0xf bank_mask:0xf
v_and_b32_dpp v114, v88, v18 row_newbcast:2 row_mask:0xf bank_mask:0xf
v_and_b32_dpp v115, v88, v19 row_newbcast:2 row_mask:0xf bank_mask:0xf
v_mfma_f32_16x16x32_bf16 v[104:107], v[116:119], v[52:55], v[104:107]
s_mov_b32 s45, 0x68000
buffer_load_dwordx4 v[52:55], v3, s[12:15], s45 offen offset:0
v_and_b32_dpp v116, v88, v16 row_newbcast:3 row_mask:0xf bank_mask:0xf
v_and_b32_dpp v117, v88, v17 row_newbcast:3 row_mask:0xf bank_mask:0xf
v_and_b32_dpp v118, v88, v18 row_newbcast:3 row_mask:0xf bank_mask:0xf
v_and_b32_dpp v119, v88, v19 row_newbcast:3 row_mask:0xf bank_mask:0xf
v_mfma_f32_16x16x32_bf16 v[104:107], v[112:115], v[56:59], v[104:107]
s_mov_b32 s45, 0x70000
buffer_load_dwordx4 v[56:59], v3, s[12:15], s45 offen offset:0
v_and_b32_dpp v112, v88, v16 row_newbcast:4 row_mask:0xf bank_mask:0xf
v_and_b32_dpp v113, v88, v17 row_newbcast:4 row_mask:0xf bank_mask:0xf
v_and_b32_dpp v114, v88, v18 row_newbcast:4 row_mask:0xf bank_mask:0xf
v_and_b32_dpp v115, v88, v19 row_newbcast:4 row_mask:0xf bank_mask:0xf
v_mfma_f32_16x16x32_bf16 v[104:107], v[116:119], v[60:63], v[104:107]
s_mov_b32 s45, 0x78000
buffer_load_dwordx4 v[60:63], v3, s[12:15], s45 offen offset:0
v_and_b32_dpp v116, v88, v16 row_newbcast:5 row_mask:0xf bank_mask:0xf
v_and_b32_dpp v117, v88, v17 row_newbcast:5 row_mask:0xf bank_mask:0xf
v_and_b32_dpp v118, v88, v18 row_newbcast:5 row_mask:0xf bank_mask:0xf
v_and_b32_dpp v119, v88, v19 row_newbcast:5 row_mask:0xf bank_mask:0xf
v_mfma_f32_16x16x32_bf16 v[104:107], v[112:115], v[64:67], v[104:107]
s_mov_b32 s45, 0x80000
buffer_load_dwordx4 v[64:67], v3, s[12:15], s45 offen offset:0
v_and_b32_dpp v112, v88, v16 row_newbcast:6 row_mask:0xf bank_mask:0xf
v_and_b32_dpp v113, v88, v17 row_newbcast:6 row_mask:0xf bank_mask:0xf
v_and_b32_dpp v114, v88, v18 row_newbcast:6 row_mask:0xf bank_mask:0xf
v_and_b32_dpp v115, v88, v19 row_newbcast:6 row_mask:0xf bank_mask:0xf
v_mfma_f32_16x16x32_bf16 v[104:107], v[116:119], v[68:71], v[104:107]
s_mov_b32 s45, 0x88000
buffer_load_dwordx4 v[68:71], v3, s[12:15], s45 offen offset:0
v_and_b32_dpp v116, v88, v16 row_newbcast:7 row_mask:0xf bank_mask:0xf
v_and_b32_dpp v117, v88, v17 row_newbcast:7 row_mask:0xf bank_mask:0xf
v_and_b32_dpp v118, v88, v18 row_newbcast:7 row_mask:0xf bank_mask:0xf
v_and_b32_dpp v119, v88, v19 row_newbcast:7 row_mask:0xf bank_mask:0xf
v_mfma_f32_16x16x32_bf16 v[104:107], v[112:115], v[24:27], v[104:107]
s_mov_b32 s45, 0x90000
buffer_load_dwordx4 v[24:27], v3, s[12:15], s45 offen offset:0
v_and_b32_dpp v112, v88, v16 row_newbcast:8 row_mask:0xf bank_mask:0xf
v_and_b32_dpp v113, v88, v17 row_newbcast:8 row_mask:0xf bank_mask:0xf
v_and_b32_dpp v114, v88, v18 row_newbcast:8 row_mask:0xf bank_mask:0xf
v_and_b32_dpp v115, v88, v19 row_newbcast:8 row_mask:0xf bank_mask:0xf
v_mfma_f32_16x16x32_bf16 v[104:107], v[116:119], v[28:31], v[104:107]
s_mov_b32 s45, 0x98000
buffer_load_dwordx4 v[28:31], v3, s[12:15], s45 offen offset:0
v_and_b32_dpp v116, v88, v16 row_newbcast:9 row_mask:0xf bank_mask:0xf
v_and_b32_dpp v117, v88, v17 row_newbcast:9 row_mask:0xf bank_mask:0xf
v_and_b32_dpp v118, v88, v18 row_newbcast:9 row_mask:0xf bank_mask:0xf
v_and_b32_dpp v119, v88, v19 row_newbcast:9 row_mask:0xf bank_mask:0xf
v_mfma_f32_16x16x32_bf16 v[104:107], v[112:115], v[32:35], v[104:107]
s_mov_b32 s45, 0xa0000
buffer_load_dwordx4 v[32:35], v3, s[12:15], s45 offen offset:0
v_and_b32_dpp v112, v88, v16 row_newbcast:10 row_mask:0xf bank_mask:0xf
v_and_b32_dpp v113, v88, v17 row_newbcast:10 row_mask:0xf bank_mask:0xf
v_and_b32_dpp v114, v88, v18 row_newbcast:10 row_mask:0xf bank_mask:0xf
v_and_b32_dpp v115, v88, v19 row_newbcast:10 row_mask:0xf bank_mask:0xf
v_mfma_f32_16x16x32_bf16 v[104:107], v[116:119], v[36:39], v[104:107]
s_mov_b32 s45, 0xa8000
buffer_load_dwordx4 v[36:39], v3, s[12:15], s45 offen offset:0
v_and_b32_dpp v116, v88, v16 row_newbcast:11 row_mask:0xf bank_mask:0xf
v_and_b32_dpp v117, v88, v17 row_newbcast:11 row_mask:0xf bank_mask:0xf
v_and_b32_dpp v118, v88, v18 row_newbcast:11 row_mask:0xf bank_mask:0xf
v_and_b32_dpp v119, v88, v19 row_newbcast:11 row_mask:0xf bank_mask:0xf
v_mfma_f32_16x16x32_bf16 v[104:107], v[112:115], v[40:43], v[104:107]
s_mov_b32 s45, 0xb0000
buffer_load_dwordx4 v[40:43], v3, s[12:15], s45 offen offset:0
v_and_b32_dpp v112, v88, v16 row_newbcast:12 row_mask:0xf bank_mask:0xf
v_and_b32_dpp v113, v88, v17 row_newbcast:12 row_mask:0xf bank_mask:0xf
v_and_b32_dpp v114, v88, v18 row_newbcast:12 row_mask:0xf bank_mask:0xf
v_and_b32_dpp v115, v88, v19 row_newbcast:12 row_mask:0xf bank_mask:0xf
v_mfma_f32_16x16x32_bf16 v[104:107], v[116:119], v[44:47], v[104:107]
s_mov_b32 s45, 0xb8000
buffer_load_dwordx4 v[44:47], v3, s[12:15], s45 offen offset:0
v_and_b32_dpp v116, v88, v16 row_newbcast:13 row_mask:0xf bank_mask:0xf
v_and_b32_dpp v117, v88, v17 row_newbcast:13 row_mask:0xf bank_mask:0xf
v_and_b32_dpp v118, v88, v18 row_newbcast:13 row_mask:0xf bank_mask:0xf
v_and_b32_dpp v119, v88, v19 row_newbcast:13 row_mask:0xf bank_mask:0xf
s_waitcnt vmcnt(11)
v_mfma_f32_16x16x32_bf16 v[104:107], v[112:115], v[48:51], v[104:107]
s_mov_b32 s45, 0xc0000
buffer_load_dwordx4 v[48:51], v3, s[12:15], s45 offen offset:0
v_and_b32_dpp v112, v88, v16 row_newbcast:14 row_mask:0xf bank_mask:0xf
v_and_b32_dpp v113, v88, v17 row_newbcast:14 row_mask:0xf bank_mask:0xf
v_and_b32_dpp v114, v88, v18 row_newbcast:14 row_mask:0xf bank_mask:0xf
v_and_b32_dpp v115, v88, v19 row_newbcast:14 row_mask:0xf bank_mask:0xf
s_waitcnt vmcnt(11)
v_mfma_f32_16x16x32_bf16 v[104:107], v[116:119], v[52:55], v[104:107]
s_mov_b32 s45, 0xc8000
buffer_load_dwordx4 v[52:55], v3, s[12:15], s45 offen offset:0
v_and_b32_dpp v116, v88, v16 row_newbcast:15 row_mask:0xf bank_mask:0xf
v_and_b32_dpp v117, v88, v17 row_newbcast:15 row_mask:0xf bank_mask:0xf
v_and_b32_dpp v118, v88, v18 row_newbcast:15 row_mask:0xf bank_mask:0xf
v_and_b32_dpp v119, v88, v19 row_newbcast:15 row_mask:0xf bank_mask:0xf
s_waitcnt vmcnt(11)
v_mfma_f32_16x16x32_bf16 v[104:107], v[112:115], v[56:59], v[104:107]
s_mov_b32 s45, 0xd0000
buffer_load_dwordx4 v[56:59], v3, s[12:15], s45 offen offset:0
v_and_b32_dpp v112, v89, v16 row_newbcast:0 row_mask:0xf bank_mask:0xf
v_and_b32_dpp v113, v89, v17 row_newbcast:0 row_mask:0xf bank_mask:0xf
v_and_b32_dpp v114, v89, v18 row_newbcast:0 row_mask:0xf bank_mask:0xf
v_and_b32_dpp v115, v89, v19 row_newbcast:0 row_mask:0xf bank_mask:0xf
s_waitcnt vmcnt(11)
v_mfma_f32_16x16x32_bf16 v[104:107], v[116:119], v[60:63], v[104:107]
s_mov_b32 s45, 0xd8000
buffer_load_dwordx4 v[60:63], v3, s[12:15], s45 offen offset:0
v_and_b32_dpp v116, v89, v16 row_newbcast:1 row_mask:0xf bank_mask:0xf
v_and_b32_dpp v117, v89, v17 row_newbcast:1 row_mask:0xf bank_mask:0xf
v_and_b32_dpp v118, v89, v18 row_newbcast:1 row_mask:0xf bank_mask:0xf
v_and_b32_dpp v119, v89, v19 row_newbcast:1 row_mask:0xf bank_mask:0xf
s_waitcnt vmcnt(11)
v_mfma_f32_16x16x32_bf16 v[104:107], v[112:115], v[64:67], v[104:107]
s_mov_b32 s45, 0xe0000
buffer_load_dwordx4 v[64:67], v3, s[12:15], s45 offen offset:0
v_and_b32_dpp v112, v89, v16 row_newbcast:2 row_mask:0xf bank_mask:0xf
v_and_b32_dpp v113, v89, v17 row_newbcast:2 row_mask:0xf bank_mask:0xf
v_and_b32_dpp v114, v89, v18 row_newbcast:2 row_mask:0xf bank_mask:0xf
v_and_b32_dpp v115, v89, v19 row_newbcast:2 row_mask:0xf bank_mask:0xf
s_waitcnt vmcnt(11)
v_mfma_f32_16x16x32_bf16 v[104:107], v[116:119], v[68:71], v[104:107]
s_mov_b32 s45, 0xe8000
buffer_load_dwordx4 v[68:71], v3, s[12:15], s45 offen offset:0
v_and_b32_dpp v116, v89, v16 row_newbcast:3 row_mask:0xf bank_mask:0xf
v_and_b32_dpp v117, v89, v17 row_newbcast:3 row_mask:0xf bank_mask:0xf
v_and_b32_dpp v118, v89, v18 row_newbcast:3 row_mask:0xf bank_mask:0xf
v_and_b32_dpp v119, v89, v19 row_newbcast:3 row_mask:0xf bank_mask:0xf
s_waitcnt vmcnt(11)
v_mfma_f32_16x16x32_bf16 v[104:107], v[112:115], v[24:27], v[104:107]
s_mov_b32 s45, 0xf0000
buffer_load_dwordx4 v[24:27], v3, s[12:15], s45 offen offset:0
v_and_b32_dpp v112, v89, v16 row_newbcast:4 row_mask:0xf bank_mask:0xf
v_and_b32_dpp v113, v89, v17 row_newbcast:4 row_mask:0xf bank_mask:0xf
v_and_b32_dpp v114, v89, v18 row_newbcast:4 row_mask:0xf bank_mask:0xf
v_and_b32_dpp v115, v89, v19 row_newbcast:4 row_mask:0xf bank_mask:0xf
s_waitcnt vmcnt(11)
v_mfma_f32_16x16x32_bf16 v[104:107], v[116:119], v[28:31], v[104:107]
s_mov_b32 s45, 0xf8000
buffer_load_dwordx4 v[28:31], v3, s[12:15], s45 offen offset:0
v_and_b32_dpp v116, v89, v16 row_newbcast:5 row_mask:0xf bank_mask:0xf
v_and_b32_dpp v117, v89, v17 row_newbcast:5 row_mask:0xf bank_mask:0xf
v_and_b32_dpp v118, v89, v18 row_newbcast:5 row_mask:0xf bank_mask:0xf
v_and_b32_dpp v119, v89, v19 row_newbcast:5 row_mask:0xf bank_mask:0xf
s_waitcnt vmcnt(11)
v_mfma_f32_16x16x32_bf16 v[104:107], v[112:115], v[32:35], v[104:107]
s_mov_b32 s45, 0x20000
buffer_load_dwordx4 v[32:35], v1, s[4:7], s45 offen offset:2048 nt
v_and_b32_dpp v112, v89, v16 row_newbcast:6 row_mask:0xf bank_mask:0xf
v_and_b32_dpp v113, v89, v17 row_newbcast:6 row_mask:0xf bank_mask:0xf
v_and_b32_dpp v114, v89, v18 row_newbcast:6 row_mask:0xf bank_mask:0xf
v_and_b32_dpp v115, v89, v19 row_newbcast:6 row_mask:0xf bank_mask:0xf
s_waitcnt vmcnt(11)
v_mfma_f32_16x16x32_bf16 v[104:107], v[116:119], v[36:39], v[104:107]
buffer_load_dwordx4 v[36:39], v1, s[4:7], s45 offen offset:3072 nt
v_and_b32_dpp v116, v89, v16 row_newbcast:7 row_mask:0xf bank_mask:0xf
v_and_b32_dpp v117, v89, v17 row_newbcast:7 row_mask:0xf bank_mask:0xf
v_and_b32_dpp v118, v89, v18 row_newbcast:7 row_mask:0xf bank_mask:0xf
v_and_b32_dpp v119, v89, v19 row_newbcast:7 row_mask:0xf bank_mask:0xf
s_waitcnt vmcnt(11)
v_mfma_f32_16x16x32_bf16 v[104:107], v[112:115], v[40:43], v[104:107]
s_mov_b32 s45, 0x21000
buffer_load_dwordx4 v[40:43], v1, s[4:7], s45 offen offset:0 nt
v_and_b32_dpp v112, v89, v16 row_newbcast:8 row_mask:0xf bank_mask:0xf
v_and_b32_dpp v113, v89, v17 row_newbcast:8 row_mask:0xf bank_mask:0xf
v_and_b32_dpp v114, v89, v18 row_newbcast:8 row_mask:0xf bank_mask:0xf
v_and_b32_dpp v115, v89, v19 row_newbcast:8 row_mask:0xf bank_mask:0xf
s_waitcnt vmcnt(11)
v_mfma_f32_16x16x32_bf16 v[104:107], v[116:119], v[44:47], v[104:107]
buffer_load_dwordx4 v[44:47], v1, s[4:7], s45 offen offset:1024 nt
v_and_b32_dpp v116, v89, v16 row_newbcast:9 row_mask:0xf bank_mask:0xf
v_and_b32_dpp v117, v89, v17 row_newbcast:9 row_mask:0xf bank_mask:0xf
v_and_b32_dpp v118, v89, v18 row_newbcast:9 row_mask:0xf bank_mask:0xf
v_and_b32_dpp v119, v89, v19 row_newbcast:9 row_mask:0xf bank_mask:0xf
s_waitcnt vmcnt(11)
v_mfma_f32_16x16x32_bf16 v[104:107], v[112:115], v[48:51], v[104:107]
buffer_load_dwordx4 v[48:51], v1, s[4:7], s45 offen offset:2048 nt
v_and_b32_dpp v112, v89, v16 row_newbcast:10 row_mask:0xf bank_mask:0xf
v_and_b32_dpp v113, v89, v17 row_newbcast:10 row_mask:0xf bank_mask:0xf
v_and_b32_dpp v114, v89, v18 row_newbcast:10 row_mask:0xf bank_mask:0xf
v_and_b32_dpp v115, v89, v19 row_newbcast:10 row_mask:0xf bank_mask:0xf
s_waitcnt vmcnt(11)
v_mfma_f32_16x16x32_bf16 v[104:107], v[116:119], v[52:55], v[104:107]
buffer_load_dwordx4 v[52:55], v1, s[4:7], s45 offen offset:3072 nt
v_and_b32_dpp v116, v89, v16 row_newbcast:11 row_mask:0xf bank_mask:0xf
v_and_b32_dpp v117, v89, v17 row_newbcast:11 row_mask:0xf bank_mask:0xf
v_and_b32_dpp v118, v89, v18 row_newbcast:11 row_mask:0xf bank_mask:0xf
v_and_b32_dpp v119, v89, v19 row_newbcast:11 row_mask:0xf bank_mask:0xf
s_waitcnt vmcnt(11)
v_mfma_f32_16x16x32_bf16 v[104:107], v[112:115], v[56:59], v[104:107]
s_mov_b32 s45, 0x22000
buffer_load_dwordx4 v[56:59], v1, s[4:7], s45 offen offset:0 nt
v_and_b32_dpp v112, v89, v16 row_newbcast:12 row_mask:0xf bank_mask:0xf
v_and_b32_dpp v113, v89, v17 row_newbcast:12 row_mask:0xf bank_mask:0xf
v_and_b32_dpp v114, v89, v18 row_newbcast:12 row_mask:0xf bank_mask:0xf
v_and_b32_dpp v115, v89, v19 row_newbcast:12 row_mask:0xf bank_mask:0xf
s_waitcnt vmcnt(11)
v_mfma_f32_16x16x32_bf16 v[104:107], v[116:119], v[60:63], v[104:107]
buffer_load_dwordx4 v[60:63], v1, s[4:7], s45 offen offset:1024 nt
v_and_b32_dpp v116, v89, v16 row_newbcast:13 row_mask:0xf bank_mask:0xf
v_and_b32_dpp v117, v89, v17 row_newbcast:13 row_mask:0xf bank_mask:0xf
v_and_b32_dpp v118, v89, v18 row_newbcast:13 row_mask:0xf bank_mask:0xf
v_and_b32_dpp v119, v89, v19 row_newbcast:13 row_mask:0xf bank_mask:0xf
s_waitcnt vmcnt(11)
v_mfma_f32_16x16x32_bf16 v[104:107], v[112:115], v[64:67], v[104:107]
buffer_load_dwordx4 v[64:67], v1, s[4:7], s45 offen offset:2048 nt
v_and_b32_dpp v112, v89, v16 row_newbcast:14 row_mask:0xf bank_mask:0xf
v_and_b32_dpp v113, v89, v17 row_newbcast:14 row_mask:0xf bank_mask:0xf
v_and_b32_dpp v114, v89, v18 row_newbcast:14 row_mask:0xf bank_mask:0xf
v_and_b32_dpp v115, v89, v19 row_newbcast:14 row_mask:0xf bank_mask:0xf
s_waitcnt vmcnt(11)
v_mfma_f32_16x16x32_bf16 v[104:107], v[116:119], v[68:71], v[104:107]
buffer_load_dwordx4 v[68:71], v1, s[4:7], s45 offen offset:3072 nt
v_and_b32_dpp v116, v89, v16 row_newbcast:15 row_mask:0xf bank_mask:0xf
v_and_b32_dpp v117, v89, v17 row_newbcast:15 row_mask:0xf bank_mask:0xf
v_and_b32_dpp v118, v89, v18 row_newbcast:15 row_mask:0xf bank_mask:0xf
v_and_b32_dpp v119, v89, v19 row_newbcast:15 row_mask:0xf bank_mask:0xf
s_waitcnt vmcnt(11)
v_mfma_f32_16x16x32_bf16 v[104:107], v[112:115], v[24:27], v[104:107]
s_mov_b32 s45, 0x23000
buffer_load_dwordx4 v[24:27], v1, s[4:7], s45 offen offset:0 nt
s_nop 1
s_waitcnt vmcnt(11)
v_mfma_f32_16x16x32_bf16 v[104:107], v[116:119], v[28:31], v[104:107]
buffer_load_dwordx4 v[28:31], v1, s[4:7], s45 offen offset:1024 nt
s_nop 7
s_mov_b32 exec_hi, 0
ds_write_b128 v11, v[104:107] offset:2048
s_mov_b32 exec_hi, -1
s_waitcnt lgkmcnt(0)
s_barrier
ds_read_b128 v[120:123], v13 offset:2048
ds_read_b128 v[124:127], v13 offset:2064
ds_read_b128 v[128:131], v13 offset:2560
ds_read_b128 v[132:135], v13 offset:2576
s_waitcnt lgkmcnt(0)
v_add_f32 v120, v120, v128
v_add_f32 v121, v121, v129
v_add_f32 v122, v122, v130
v_add_f32 v123, v123, v131
v_add_f32 v124, v124, v132
v_add_f32 v125, v125, v133
v_add_f32 v126, v126, v134
v_add_f32 v127, v127, v135
ds_read_b128 v[128:131], v13 offset:3072
ds_read_b128 v[132:135], v13 offset:3088
s_waitcnt lgkmcnt(0)
v_add_f32 v120, v120, v128
v_add_f32 v121, v121, v129
v_add_f32 v122, v122, v130
v_add_f32 v123, v123, v131
v_add_f32 v124, v124, v132
v_add_f32 v125, v125, v133
v_add_f32 v126, v126, v134
v_add_f32 v127, v127, v135
ds_read_b128 v[128:131], v13 offset:3584
ds_read_b128 v[132:135], v13 offset:3600
s_waitcnt lgkmcnt(0)
v_add_f32 v120, v120, v128
v_add_f32 v121, v121, v129
v_add_f32 v122, v122, v130
v_add_f32 v123, v123, v131
v_add_f32 v124, v124, v132
v_add_f32 v125, v125, v133
v_add_f32 v126, v126, v134
v_add_f32 v127, v127, v135
v_cvt_pk_bf16_f32 v128, v120, v121
v_cvt_pk_bf16_f32 v129, v122, v123
v_cvt_pk_bf16_f32 v130, v124, v125
v_cvt_pk_bf16_f32 v131, v126, v127
v_lshrrev_b32 v120, 2, v0
v_and_b32 v120, 3, v120
v_cmp_eq_u32 vcc, 0, v120
s_nop 1
v_cndmask_b32 v72, 0, v128, vcc
v_cndmask_b32 v73, 0, v129, vcc
v_cndmask_b32 v74, 0, v130, vcc
v_cndmask_b32 v75, 0, v131, vcc
v_cmp_eq_u32 vcc, 1, v120
s_nop 1
v_cndmask_b32 v76, 0, v128, vcc
v_cndmask_b32 v77, 0, v129, vcc
v_cndmask_b32 v78, 0, v130, vcc
v_cndmask_b32 v79, 0, v131, vcc
v_cmp_eq_u32 vcc, 2, v120
s_nop 1
v_cndmask_b32 v80, 0, v128, vcc
v_cndmask_b32 v81, 0, v129, vcc
v_cndmask_b32 v82, 0, v130, vcc
v_cndmask_b32 v83, 0, v131, vcc
v_cmp_eq_u32 vcc, 3, v120
s_nop 1
v_cndmask_b32 v84, 0, v128, vcc
v_cndmask_b32 v85, 0, v129, vcc
v_cndmask_b32 v86, 0, v130, vcc
v_cndmask_b32 v87, 0, v131, vcc
s_nop 1
v_mfma_f32_16x16x32_bf16 v[104:107], v[248:251], v[72:75], 0
v_mfma_f32_16x16x32_bf16 v[104:107], v[252:255], v[76:79], v[104:107]
s_waitcnt vmcnt(11)
v_mfma_f32_16x16x32_bf16 v[104:107], v[32:35], v[80:83], v[104:107]
buffer_load_dwordx4 v[32:35], v1, s[4:7], s45 offen offset:2048 nt
s_waitcnt vmcnt(11)
v_mfma_f32_16x16x32_bf16 v[104:107], v[36:39], v[84:87], v[104:107]
buffer_load_dwordx4 v[36:39], v1, s[4:7], s45 offen offset:3072 nt
ds_read_b128 v[120:123], v8 offset:0
ds_read_b128 v[124:127], v8 offset:1024
ds_read_b128 v[128:131], v8 offset:2048
ds_read_b128 v[132:135], v8 offset:3072
s_waitcnt lgkmcnt(0)
v_mfma_f32_16x16x32_bf16 v[108:111], v[120:123], v[72:75], 0
v_mfma_f32_16x16x32_bf16 v[108:111], v[124:127], v[76:79], v[108:111]
v_mfma_f32_16x16x32_bf16 v[108:111], v[128:131], v[80:83], v[108:111]
v_mfma_f32_16x16x32_bf16 v[108:111], v[132:135], v[84:87], v[108:111]
s_nop 3
v_mov_b32_dpp v112, v104 quad_perm:[0,0,0,0] row_mask:0xf bank_mask:0xf
v_add_f32_dpp v112, v105, v112 quad_perm:[1,1,1,1] row_mask:0xf bank_mask:0xf
v_add_f32_dpp v112, v106, v112 quad_perm:[2,2,2,2] row_mask:0xf bank_mask:0xf
v_add_f32_dpp v112, v107, v112 quad_perm:[3,3,3,3] row_mask:0xf bank_mask:0xf
v_mov_b32 v96, v112
s_waitcnt vmcnt(11)
v_mfma_f32_16x16x32_bf16 v[104:107], v[40:43], v[72:75], 0
s_mov_b32 s45, 0x24000
buffer_load_dwordx4 v[40:43], v1, s[4:7], s45 offen offset:0 nt
s_waitcnt vmcnt(11)
v_mfma_f32_16x16x32_bf16 v[104:107], v[44:47], v[76:79], v[104:107]
buffer_load_dwordx4 v[44:47], v1, s[4:7], s45 offen offset:1024 nt
s_waitcnt vmcnt(11)
v_mfma_f32_16x16x32_bf16 v[104:107], v[48:51], v[80:83], v[104:107]
buffer_load_dwordx4 v[48:51], v1, s[4:7], s45 offen offset:2048 nt
s_waitcnt vmcnt(11)
v_mfma_f32_16x16x32_bf16 v[104:107], v[52:55], v[84:87], v[104:107]
buffer_load_dwordx4 v[52:55], v1, s[4:7], s45 offen offset:3072 nt
ds_read_b128 v[120:123], v8 offset:4096
ds_read_b128 v[124:127], v8 offset:5120
ds_read_b128 v[128:131], v8 offset:6144
ds_read_b128 v[132:135], v8 offset:7168
s_nop 3
v_mov_b32_dpp v112, v108 quad_perm:[0,0,0,0] row_mask:0xf bank_mask:0xf
v_add_f32_dpp v112, v109, v112 quad_perm:[1,1,1,1] row_mask:0xf bank_mask:0xf
v_add_f32_dpp v112, v110, v112 quad_perm:[2,2,2,2] row_mask:0xf bank_mask:0xf
v_add_f32_dpp v112, v111, v112 quad_perm:[3,3,3,3] row_mask:0xf bank_mask:0xf
v_mov_b32 v88, v112
s_waitcnt lgkmcnt(0)
v_mfma_f32_16x16x32_bf16 v[108:111], v[120:123], v[72:75], 0
v_mfma_f32_16x16x32_bf16 v[108:111], v[124:127], v[76:79], v[108:111]
v_mfma_f32_16x16x32_bf16 v[108:111], v[128:131], v[80:83], v[108:111]
v_mfma_f32_16x16x32_bf16 v[108:111], v[132:135], v[84:87], v[108:111]
s_nop 3
v_mov_b32_dpp v112, v104 quad_perm:[0,0,0,0] row_mask:0xf bank_mask:0xf
v_add_f32_dpp v112, v105, v112 quad_perm:[1,1,1,1] row_mask:0xf bank_mask:0xf
v_add_f32_dpp v112, v106, v112 quad_perm:[2,2,2,2] row_mask:0xf bank_mask:0xf
v_add_f32_dpp v112, v107, v112 quad_perm:[3,3,3,3] row_mask:0xf bank_mask:0xf
v_cndmask_b32 v96, v96, v112, s[48:49]
s_waitcnt vmcnt(11)
v_mfma_f32_16x16x32_bf16 v[104:107], v[56:59], v[72:75], 0
s_mov_b32 s45, 0x25000
buffer_load_dwordx4 v[56:59], v1, s[4:7], s45 offen offset:0 nt
s_waitcnt vmcnt(11)
v_mfma_f32_16x16x32_bf16 v[104:107], v[60:63], v[76:79], v[104:107]
buffer_load_dwordx4 v[60:63], v1, s[4:7], s45 offen offset:1024 nt
s_waitcnt vmcnt(11)
v_mfma_f32_16x16x32_bf16 v[104:107], v[64:67], v[80:83], v[104:107]
buffer_load_dwordx4 v[64:67], v1, s[4:7], s45 offen offset:2048 nt
s_waitcnt vmcnt(11)
v_mfma_f32_16x16x32_bf16 v[104:107], v[68:71], v[84:87], v[104:107]
buffer_load_dwordx4 v[68:71], v1, s[4:7], s45 offen offset:3072 nt
ds_read_b128 v[120:123], v8 offset:8192
ds_read_b128 v[124:127], v8 offset:9216
ds_read_b128 v[128:131], v8 offset:10240
ds_read_b128 v[132:135], v8 offset:11264
s_nop 3
v_mov_b32_dpp v112, v108 quad_perm:[0,0,0,0] row_mask:0xf bank_mask:0xf
v_add_f32_dpp v112, v109, v112 quad_perm:[1,1,1,1] row_mask:0xf bank_mask:0xf
v_add_f32_dpp v112, v110, v112 quad_perm:[2,2,2,2] row_mask:0xf bank_mask:0xf
v_add_f32_dpp v112, v111, v112 quad_perm:[3,3,3,3] row_mask:0xf bank_mask:0xf
v_cndmask_b32 v88, v88, v112, s[48:49]
s_waitcnt lgkmcnt(0)
v_mfma_f32_16x16x32_bf16 v[108:111], v[120:123], v[72:75], 0
v_mfma_f32_16x16x32_bf16 v[108:111], v[124:127], v[76:79], v[108:111]
v_mfma_f32_16x16x32_bf16 v[108:111], v[128:131], v[80:83], v[108:111]
v_mfma_f32_16x16x32_bf16 v[108:111], v[132:135], v[84:87], v[108:111]
s_nop 3
v_mov_b32_dpp v112, v104 quad_perm:[0,0,0,0] row_mask:0xf bank_mask:0xf
v_add_f32_dpp v112, v105, v112 quad_perm:[1,1,1,1] row_mask:0xf bank_mask:0xf
v_add_f32_dpp v112, v106, v112 quad_perm:[2,2,2,2] row_mask:0xf bank_mask:0xf
v_add_f32_dpp v112, v107, v112 quad_perm:[3,3,3,3] row_mask:0xf bank_mask:0xf
v_cndmask_b32 v96, v96, v112, s[50:51]
s_waitcnt vmcnt(11)
v_mfma_f32_16x16x32_bf16 v[104:107], v[24:27], v[72:75], 0
s_mov_b32 s45, 0x26000
buffer_load_dwordx4 v[24:27], v1, s[4:7], s45 offen offset:0 nt
s_waitcnt vmcnt(11)
v_mfma_f32_16x16x32_bf16 v[104:107], v[28:31], v[76:79], v[104:107]
buffer_load_dwordx4 v[28:31], v1, s[4:7], s45 offen offset:1024 nt
s_waitcnt vmcnt(11)
v_mfma_f32_16x16x32_bf16 v[104:107], v[32:35], v[80:83], v[104:107]
buffer_load_dwordx4 v[32:35], v1, s[4:7], s45 offen offset:2048 nt
s_waitcnt vmcnt(11)
v_mfma_f32_16x16x32_bf16 v[104:107], v[36:39], v[84:87], v[104:107]
buffer_load_dwordx4 v[36:39], v1, s[4:7], s45 offen offset:3072 nt
ds_read_b128 v[120:123], v8 offset:12288
ds_read_b128 v[124:127], v8 offset:13312
ds_read_b128 v[128:131], v8 offset:14336
ds_read_b128 v[132:135], v8 offset:15360
s_nop 3
v_mov_b32_dpp v112, v108 quad_perm:[0,0,0,0] row_mask:0xf bank_mask:0xf
v_add_f32_dpp v112, v109, v112 quad_perm:[1,1,1,1] row_mask:0xf bank_mask:0xf
v_add_f32_dpp v112, v110, v112 quad_perm:[2,2,2,2] row_mask:0xf bank_mask:0xf
v_add_f32_dpp v112, v111, v112 quad_perm:[3,3,3,3] row_mask:0xf bank_mask:0xf
v_cndmask_b32 v88, v88, v112, s[50:51]
s_waitcnt lgkmcnt(0)
v_mfma_f32_16x16x32_bf16 v[108:111], v[120:123], v[72:75], 0
v_mfma_f32_16x16x32_bf16 v[108:111], v[124:127], v[76:79], v[108:111]
v_mfma_f32_16x16x32_bf16 v[108:111], v[128:131], v[80:83], v[108:111]
v_mfma_f32_16x16x32_bf16 v[108:111], v[132:135], v[84:87], v[108:111]
s_nop 3
v_mov_b32_dpp v112, v104 quad_perm:[0,0,0,0] row_mask:0xf bank_mask:0xf
v_add_f32_dpp v112, v105, v112 quad_perm:[1,1,1,1] row_mask:0xf bank_mask:0xf
v_add_f32_dpp v112, v106, v112 quad_perm:[2,2,2,2] row_mask:0xf bank_mask:0xf
v_add_f32_dpp v112, v107, v112 quad_perm:[3,3,3,3] row_mask:0xf bank_mask:0xf
v_cndmask_b32 v96, v96, v112, s[52:53]
s_waitcnt vmcnt(11)
v_mfma_f32_16x16x32_bf16 v[104:107], v[40:43], v[72:75], 0
s_mov_b32 s45, 0x27000
buffer_load_dwordx4 v[40:43], v1, s[4:7], s45 offen offset:0 nt
s_waitcnt vmcnt(11)
v_mfma_f32_16x16x32_bf16 v[104:107], v[44:47], v[76:79], v[104:107]
buffer_load_dwordx4 v[44:47], v1, s[4:7], s45 offen offset:1024 nt
s_waitcnt vmcnt(11)
v_mfma_f32_16x16x32_bf16 v[104:107], v[48:51], v[80:83], v[104:107]
buffer_load_dwordx4 v[48:51], v1, s[4:7], s45 offen offset:2048 nt
s_waitcnt vmcnt(11)
v_mfma_f32_16x16x32_bf16 v[104:107], v[52:55], v[84:87], v[104:107]
buffer_load_dwordx4 v[52:55], v1, s[4:7], s45 offen offset:3072 nt
ds_read_b128 v[120:123], v8 offset:16384
ds_read_b128 v[124:127], v8 offset:17408
ds_read_b128 v[128:131], v8 offset:18432
ds_read_b128 v[132:135], v8 offset:19456
s_nop 3
v_mov_b32_dpp v112, v108 quad_perm:[0,0,0,0] row_mask:0xf bank_mask:0xf
v_add_f32_dpp v112, v109, v112 quad_perm:[1,1,1,1] row_mask:0xf bank_mask:0xf
v_add_f32_dpp v112, v110, v112 quad_perm:[2,2,2,2] row_mask:0xf bank_mask:0xf
v_add_f32_dpp v112, v111, v112 quad_perm:[3,3,3,3] row_mask:0xf bank_mask:0xf
v_cndmask_b32 v88, v88, v112, s[52:53]
s_waitcnt lgkmcnt(0)
v_mfma_f32_16x16x32_bf16 v[108:111], v[120:123], v[72:75], 0
v_mfma_f32_16x16x32_bf16 v[108:111], v[124:127], v[76:79], v[108:111]
v_mfma_f32_16x16x32_bf16 v[108:111], v[128:131], v[80:83], v[108:111]
v_mfma_f32_16x16x32_bf16 v[108:111], v[132:135], v[84:87], v[108:111]
s_nop 3
v_mov_b32_dpp v112, v104 quad_perm:[0,0,0,0] row_mask:0xf bank_mask:0xf
v_add_f32_dpp v112, v105, v112 quad_perm:[1,1,1,1] row_mask:0xf bank_mask:0xf
v_add_f32_dpp v112, v106, v112 quad_perm:[2,2,2,2] row_mask:0xf bank_mask:0xf
v_add_f32_dpp v112, v107, v112 quad_perm:[3,3,3,3] row_mask:0xf bank_mask:0xf
v_mov_b32 v97, v112
s_waitcnt vmcnt(11)
v_mfma_f32_16x16x32_bf16 v[104:107], v[56:59], v[72:75], 0
s_mov_b32 s45, 0x28000
buffer_load_dwordx4 v[56:59], v1, s[4:7], s45 offen offset:0 nt
s_waitcnt vmcnt(11)
v_mfma_f32_16x16x32_bf16 v[104:107], v[60:63], v[76:79], v[104:107]
buffer_load_dwordx4 v[60:63], v1, s[4:7], s45 offen offset:1024 nt
s_waitcnt vmcnt(11)
v_mfma_f32_16x16x32_bf16 v[104:107], v[64:67], v[80:83], v[104:107]
buffer_load_dwordx4 v[64:67], v1, s[4:7], s45 offen offset:2048 nt
s_waitcnt vmcnt(11)
v_mfma_f32_16x16x32_bf16 v[104:107], v[68:71], v[84:87], v[104:107]
buffer_load_dwordx4 v[68:71], v1, s[4:7], s45 offen offset:3072 nt
ds_read_b128 v[120:123], v8 offset:20480
ds_read_b128 v[124:127], v8 offset:21504
ds_read_b128 v[128:131], v8 offset:22528
ds_read_b128 v[132:135], v8 offset:23552
s_nop 3
v_mov_b32_dpp v112, v108 quad_perm:[0,0,0,0] row_mask:0xf bank_mask:0xf
v_add_f32_dpp v112, v109, v112 quad_perm:[1,1,1,1] row_mask:0xf bank_mask:0xf
v_add_f32_dpp v112, v110, v112 quad_perm:[2,2,2,2] row_mask:0xf bank_mask:0xf
v_add_f32_dpp v112, v111, v112 quad_perm:[3,3,3,3] row_mask:0xf bank_mask:0xf
v_mov_b32 v89, v112
s_waitcnt lgkmcnt(0)
v_mfma_f32_16x16x32_bf16 v[108:111], v[120:123], v[72:75], 0
v_mfma_f32_16x16x32_bf16 v[108:111], v[124:127], v[76:79], v[108:111]
v_mfma_f32_16x16x32_bf16 v[108:111], v[128:131], v[80:83], v[108:111]
v_mfma_f32_16x16x32_bf16 v[108:111], v[132:135], v[84:87], v[108:111]
s_nop 3
v_mov_b32_dpp v112, v104 quad_perm:[0,0,0,0] row_mask:0xf bank_mask:0xf
v_add_f32_dpp v112, v105, v112 quad_perm:[1,1,1,1] row_mask:0xf bank_mask:0xf
v_add_f32_dpp v112, v106, v112 quad_perm:[2,2,2,2] row_mask:0xf bank_mask:0xf
v_add_f32_dpp v112, v107, v112 quad_perm:[3,3,3,3] row_mask:0xf bank_mask:0xf
v_cndmask_b32 v97, v97, v112, s[48:49]
s_waitcnt vmcnt(11)
v_mfma_f32_16x16x32_bf16 v[104:107], v[24:27], v[72:75], 0
s_mov_b32 s45, 0x29000
buffer_load_dwordx4 v[24:27], v1, s[4:7], s45 offen offset:0 nt
s_waitcnt vmcnt(11)
v_mfma_f32_16x16x32_bf16 v[104:107], v[28:31], v[76:79], v[104:107]
buffer_load_dwordx4 v[28:31], v1, s[4:7], s45 offen offset:1024 nt
s_waitcnt vmcnt(11)
v_mfma_f32_16x16x32_bf16 v[104:107], v[32:35], v[80:83], v[104:107]
buffer_load_dwordx4 v[32:35], v1, s[4:7], s45 offen offset:2048 nt
s_waitcnt vmcnt(11)
v_mfma_f32_16x16x32_bf16 v[104:107], v[36:39], v[84:87], v[104:107]
buffer_load_dwordx4 v[36:39], v1, s[4:7], s45 offen offset:3072 nt
ds_read_b128 v[120:123], v8 offset:24576
ds_read_b128 v[124:127], v8 offset:25600
ds_read_b128 v[128:131], v8 offset:26624
ds_read_b128 v[132:135], v8 offset:27648
s_nop 3
v_mov_b32_dpp v112, v108 quad_perm:[0,0,0,0] row_mask:0xf bank_mask:0xf
v_add_f32_dpp v112, v109, v112 quad_perm:[1,1,1,1] row_mask:0xf bank_mask:0xf
v_add_f32_dpp v112, v110, v112 quad_perm:[2,2,2,2] row_mask:0xf bank_mask:0xf
v_add_f32_dpp v112, v111, v112 quad_perm:[3,3,3,3] row_mask:0xf bank_mask:0xf
v_cndmask_b32 v89, v89, v112, s[48:49]
s_waitcnt lgkmcnt(0)
v_mfma_f32_16x16x32_bf16 v[108:111], v[120:123], v[72:75], 0
v_mfma_f32_16x16x32_bf16 v[108:111], v[124:127], v[76:79], v[108:111]
v_mfma_f32_16x16x32_bf16 v[108:111], v[128:131], v[80:83], v[108:111]
v_mfma_f32_16x16x32_bf16 v[108:111], v[132:135], v[84:87], v[108:111]
s_nop 3
v_mov_b32_dpp v112, v104 quad_perm:[0,0,0,0] row_mask:0xf bank_mask:0xf
v_add_f32_dpp v112, v105, v112 quad_perm:[1,1,1,1] row_mask:0xf bank_mask:0xf
v_add_f32_dpp v112, v106, v112 quad_perm:[2,2,2,2] row_mask:0xf bank_mask:0xf
v_add_f32_dpp v112, v107, v112 quad_perm:[3,3,3,3] row_mask:0xf bank_mask:0xf
v_cndmask_b32 v97, v97, v112, s[50:51]
s_waitcnt vmcnt(11)
v_mfma_f32_16x16x32_bf16 v[104:107], v[40:43], v[72:75], 0
s_mov_b32 s45, 0x2a000
buffer_load_dwordx4 v[40:43], v1, s[4:7], s45 offen offset:0 nt
s_waitcnt vmcnt(11)
v_mfma_f32_16x16x32_bf16 v[104:107], v[44:47], v[76:79], v[104:107]
buffer_load_dwordx4 v[44:47], v1, s[4:7], s45 offen offset:1024 nt
s_waitcnt vmcnt(11)
v_mfma_f32_16x16x32_bf16 v[104:107], v[48:51], v[80:83], v[104:107]
buffer_load_dwordx4 v[48:51], v1, s[4:7], s45 offen offset:2048 nt
s_waitcnt vmcnt(11)
v_mfma_f32_16x16x32_bf16 v[104:107], v[52:55], v[84:87], v[104:107]
buffer_load_dwordx4 v[52:55], v1, s[4:7], s45 offen offset:3072 nt
ds_read_b128 v[120:123], v8 offset:28672
ds_read_b128 v[124:127], v8 offset:29696
ds_read_b128 v[128:131], v8 offset:30720
ds_read_b128 v[132:135], v8 offset:31744
s_nop 3
v_mov_b32_dpp v112, v108 quad_perm:[0,0,0,0] row_mask:0xf bank_mask:0xf
v_add_f32_dpp v112, v109, v112 quad_perm:[1,1,1,1] row_mask:0xf bank_mask:0xf
v_add_f32_dpp v112, v110, v112 quad_perm:[2,2,2,2] row_mask:0xf bank_mask:0xf
v_add_f32_dpp v112, v111, v112 quad_perm:[3,3,3,3] row_mask:0xf bank_mask:0xf
v_cndmask_b32 v89, v89, v112, s[50:51]
s_waitcnt lgkmcnt(0)
v_mfma_f32_16x16x32_bf16 v[108:111], v[120:123], v[72:75], 0
v_mfma_f32_16x16x32_bf16 v[108:111], v[124:127], v[76:79], v[108:111]
v_mfma_f32_16x16x32_bf16 v[108:111], v[128:131], v[80:83], v[108:111]
v_mfma_f32_16x16x32_bf16 v[108:111], v[132:135], v[84:87], v[108:111]
s_nop 3
v_mov_b32_dpp v112, v104 quad_perm:[0,0,0,0] row_mask:0xf bank_mask:0xf
v_add_f32_dpp v112, v105, v112 quad_perm:[1,1,1,1] row_mask:0xf bank_mask:0xf
v_add_f32_dpp v112, v106, v112 quad_perm:[2,2,2,2] row_mask:0xf bank_mask:0xf
v_add_f32_dpp v112, v107, v112 quad_perm:[3,3,3,3] row_mask:0xf bank_mask:0xf
v_cndmask_b32 v97, v97, v112, s[52:53]
s_waitcnt vmcnt(11)
v_mfma_f32_16x16x32_bf16 v[104:107], v[56:59], v[72:75], 0
s_mov_b32 s45, 0x2b000
buffer_load_dwordx4 v[56:59], v1, s[4:7], s45 offen offset:0 nt
s_waitcnt vmcnt(11)
v_mfma_f32_16x16x32_bf16 v[104:107], v[60:63], v[76:79], v[104:107]
buffer_load_dwordx4 v[60:63], v1, s[4:7], s45 offen offset:1024 nt
s_waitcnt vmcnt(11)
v_mfma_f32_16x16x32_bf16 v[104:107], v[64:67], v[80:83], v[104:107]
buffer_load_dwordx4 v[64:67], v1, s[4:7], s45 offen offset:2048 nt
s_waitcnt vmcnt(11)
v_mfma_f32_16x16x32_bf16 v[104:107], v[68:71], v[84:87], v[104:107]
buffer_load_dwordx4 v[68:71], v1, s[4:7], s45 offen offset:3072 nt
ds_read_b128 v[120:123], v8 offset:32768
ds_read_b128 v[124:127], v8 offset:33792
ds_read_b128 v[128:131], v8 offset:34816
ds_read_b128 v[132:135], v8 offset:35840
s_nop 3
v_mov_b32_dpp v112, v108 quad_perm:[0,0,0,0] row_mask:0xf bank_mask:0xf
v_add_f32_dpp v112, v109, v112 quad_perm:[1,1,1,1] row_mask:0xf bank_mask:0xf
v_add_f32_dpp v112, v110, v112 quad_perm:[2,2,2,2] row_mask:0xf bank_mask:0xf
v_add_f32_dpp v112, v111, v112 quad_perm:[3,3,3,3] row_mask:0xf bank_mask:0xf
v_cndmask_b32 v89, v89, v112, s[52:53]
s_waitcnt lgkmcnt(0)
v_mfma_f32_16x16x32_bf16 v[108:111], v[120:123], v[72:75], 0
v_mfma_f32_16x16x32_bf16 v[108:111], v[124:127], v[76:79], v[108:111]
v_mfma_f32_16x16x32_bf16 v[108:111], v[128:131], v[80:83], v[108:111]
v_mfma_f32_16x16x32_bf16 v[108:111], v[132:135], v[84:87], v[108:111]
s_nop 3
v_mov_b32_dpp v112, v104 quad_perm:[0,0,0,0] row_mask:0xf bank_mask:0xf
v_add_f32_dpp v112, v105, v112 quad_perm:[1,1,1,1] row_mask:0xf bank_mask:0xf
v_add_f32_dpp v112, v106, v112 quad_perm:[2,2,2,2] row_mask:0xf bank_mask:0xf
v_add_f32_dpp v112, v107, v112 quad_perm:[3,3,3,3] row_mask:0xf bank_mask:0xf
v_mov_b32 v98, v112
s_waitcnt vmcnt(11)
v_mfma_f32_16x16x32_bf16 v[104:107], v[24:27], v[72:75], 0
s_mov_b32 s45, 0x2c000
buffer_load_dwordx4 v[24:27], v1, s[4:7], s45 offen offset:0 nt
s_waitcnt vmcnt(11)
v_mfma_f32_16x16x32_bf16 v[104:107], v[28:31], v[76:79], v[104:107]
buffer_load_dwordx4 v[28:31], v1, s[4:7], s45 offen offset:1024 nt
s_waitcnt vmcnt(11)
v_mfma_f32_16x16x32_bf16 v[104:107], v[32:35], v[80:83], v[104:107]
buffer_load_dwordx4 v[32:35], v1, s[4:7], s45 offen offset:2048 nt
s_waitcnt vmcnt(11)
v_mfma_f32_16x16x32_bf16 v[104:107], v[36:39], v[84:87], v[104:107]
buffer_load_dwordx4 v[36:39], v1, s[4:7], s45 offen offset:3072 nt
s_nop 3
v_mov_b32_dpp v112, v108 quad_perm:[0,0,0,0] row_mask:0xf bank_mask:0xf
v_add_f32_dpp v112, v109, v112 quad_perm:[1,1,1,1] row_mask:0xf bank_mask:0xf
v_add_f32_dpp v112, v110, v112 quad_perm:[2,2,2,2] row_mask:0xf bank_mask:0xf
v_add_f32_dpp v112, v111, v112 quad_perm:[3,3,3,3] row_mask:0xf bank_mask:0xf
v_mov_b32 v90, v112
v_mfma_f32_16x16x32_bf16 v[108:111], a[0:3], v[72:75], 0
v_mfma_f32_16x16x32_bf16 v[108:111], a[4:7], v[76:79], v[108:111]
v_mfma_f32_16x16x32_bf16 v[108:111], a[8:11], v[80:83], v[108:111]
v_mfma_f32_16x16x32_bf16 v[108:111], a[12:15], v[84:87], v[108:111]
s_nop 3
v_mov_b32_dpp v112, v104 quad_perm:[0,0,0,0] row_mask:0xf bank_mask:0xf
v_add_f32_dpp v112, v105, v112 quad_perm:[1,1,1,1] row_mask:0xf bank_mask:0xf
v_add_f32_dpp v112, v106, v112 quad_perm:[2,2,2,2] row_mask:0xf bank_mask:0xf
v_add_f32_dpp v112, v107, v112 quad_perm:[3,3,3,3] row_mask:0xf bank_mask:0xf
v_cndmask_b32 v98, v98, v112, s[48:49]
s_waitcnt vmcnt(11)
v_mfma_f32_16x16x32_bf16 v[104:107], v[40:43], v[72:75], 0
s_mov_b32 s45, 0x2d000
buffer_load_dwordx4 v[40:43], v1, s[4:7], s45 offen offset:0 nt
s_waitcnt vmcnt(11)
v_mfma_f32_16x16x32_bf16 v[104:107], v[44:47], v[76:79], v[104:107]
buffer_load_dwordx4 v[44:47], v1, s[4:7], s45 offen offset:1024 nt
s_waitcnt vmcnt(11)
v_mfma_f32_16x16x32_bf16 v[104:107], v[48:51], v[80:83], v[104:107]
buffer_load_dwordx4 v[48:51], v1, s[4:7], s45 offen offset:2048 nt
s_waitcnt vmcnt(11)
v_mfma_f32_16x16x32_bf16 v[104:107], v[52:55], v[84:87], v[104:107]
buffer_load_dwordx4 v[52:55], v1, s[4:7], s45 offen offset:3072 nt
s_nop 3
v_mov_b32_dpp v112, v108 quad_perm:[0,0,0,0] row_mask:0xf bank_mask:0xf
v_add_f32_dpp v112, v109, v112 quad_perm:[1,1,1,1] row_mask:0xf bank_mask:0xf
v_add_f32_dpp v112, v110, v112 quad_perm:[2,2,2,2] row_mask:0xf bank_mask:0xf
v_add_f32_dpp v112, v111, v112 quad_perm:[3,3,3,3] row_mask:0xf bank_mask:0xf
v_cndmask_b32 v90, v90, v112, s[48:49]
v_mfma_f32_16x16x32_bf16 v[108:111], a[16:19], v[72:75], 0
v_mfma_f32_16x16x32_bf16 v[108:111], a[20:23], v[76:79], v[108:111]
v_mfma_f32_16x16x32_bf16 v[108:111], a[24:27], v[80:83], v[108:111]
v_mfma_f32_16x16x32_bf16 v[108:111], a[28:31], v[84:87], v[108:111]
s_nop 3
v_mov_b32_dpp v112, v104 quad_perm:[0,0,0,0] row_mask:0xf bank_mask:0xf
v_add_f32_dpp v112, v105, v112 quad_perm:[1,1,1,1] row_mask:0xf bank_mask:0xf
v_add_f32_dpp v112, v106, v112 quad_perm:[2,2,2,2] row_mask:0xf bank_mask:0xf
v_add_f32_dpp v112, v107, v112 quad_perm:[3,3,3,3] row_mask:0xf bank_mask:0xf
v_cndmask_b32 v98, v98, v112, s[50:51]
s_waitcnt vmcnt(11)
v_mfma_f32_16x16x32_bf16 v[104:107], v[56:59], v[72:75], 0
s_mov_b32 s45, 0x2e000
buffer_load_dwordx4 v[56:59], v1, s[4:7], s45 offen offset:0 nt
s_waitcnt vmcnt(11)
v_mfma_f32_16x16x32_bf16 v[104:107], v[60:63], v[76:79], v[104:107]
buffer_load_dwordx4 v[60:63], v1, s[4:7], s45 offen offset:1024 nt
s_waitcnt vmcnt(11)
v_mfma_f32_16x16x32_bf16 v[104:107], v[64:67], v[80:83], v[104:107]
buffer_load_dwordx4 v[64:67], v1, s[4:7], s45 offen offset:2048 nt
s_waitcnt vmcnt(11)
v_mfma_f32_16x16x32_bf16 v[104:107], v[68:71], v[84:87], v[104:107]
buffer_load_dwordx4 v[68:71], v1, s[4:7], s45 offen offset:3072 nt
s_nop 3
v_mov_b32_dpp v112, v108 quad_perm:[0,0,0,0] row_mask:0xf bank_mask:0xf
v_add_f32_dpp v112, v109, v112 quad_perm:[1,1,1,1] row_mask:0xf bank_mask:0xf
v_add_f32_dpp v112, v110, v112 quad_perm:[2,2,2,2] row_mask:0xf bank_mask:0xf
v_add_f32_dpp v112, v111, v112 quad_perm:[3,3,3,3] row_mask:0xf bank_mask:0xf
v_cndmask_b32 v90, v90, v112, s[50:51]
v_mfma_f32_16x16x32_bf16 v[108:111], a[32:35], v[72:75], 0
v_mfma_f32_16x16x32_bf16 v[108:111], a[36:39], v[76:79], v[108:111]
v_mfma_f32_16x16x32_bf16 v[108:111], a[40:43], v[80:83], v[108:111]
v_mfma_f32_16x16x32_bf16 v[108:111], a[44:47], v[84:87], v[108:111]
s_nop 3
v_mov_b32_dpp v112, v104 quad_perm:[0,0,0,0] row_mask:0xf bank_mask:0xf
v_add_f32_dpp v112, v105, v112 quad_perm:[1,1,1,1] row_mask:0xf bank_mask:0xf
v_add_f32_dpp v112, v106, v112 quad_perm:[2,2,2,2] row_mask:0xf bank_mask:0xf
v_add_f32_dpp v112, v107, v112 quad_perm:[3,3,3,3] row_mask:0xf bank_mask:0xf
v_cndmask_b32 v98, v98, v112, s[52:53]
s_waitcnt vmcnt(11)
v_mfma_f32_16x16x32_bf16 v[104:107], v[24:27], v[72:75], 0
s_mov_b32 s45, 0x2f000
buffer_load_dwordx4 v[24:27], v1, s[4:7], s45 offen offset:0 nt
s_waitcnt vmcnt(11)
v_mfma_f32_16x16x32_bf16 v[104:107], v[28:31], v[76:79], v[104:107]
buffer_load_dwordx4 v[28:31], v1, s[4:7], s45 offen offset:1024 nt
s_waitcnt vmcnt(11)
v_mfma_f32_16x16x32_bf16 v[104:107], v[32:35], v[80:83], v[104:107]
buffer_load_dwordx4 v[32:35], v1, s[4:7], s45 offen offset:2048 nt
s_waitcnt vmcnt(11)
v_mfma_f32_16x16x32_bf16 v[104:107], v[36:39], v[84:87], v[104:107]
buffer_load_dwordx4 v[36:39], v1, s[4:7], s45 offen offset:3072 nt
s_nop 3
v_mov_b32_dpp v112, v108 quad_perm:[0,0,0,0] row_mask:0xf bank_mask:0xf
v_add_f32_dpp v112, v109, v112 quad_perm:[1,1,1,1] row_mask:0xf bank_mask:0xf
v_add_f32_dpp v112, v110, v112 quad_perm:[2,2,2,2] row_mask:0xf bank_mask:0xf
v_add_f32_dpp v112, v111, v112 quad_perm:[3,3,3,3] row_mask:0xf bank_mask:0xf
v_cndmask_b32 v90, v90, v112, s[52:53]
v_mfma_f32_16x16x32_bf16 v[108:111], a[48:51], v[72:75], 0
v_mfma_f32_16x16x32_bf16 v[108:111], a[52:55], v[76:79], v[108:111]
v_mfma_f32_16x16x32_bf16 v[108:111], a[56:59], v[80:83], v[108:111]
v_mfma_f32_16x16x32_bf16 v[108:111], a[60:63], v[84:87], v[108:111]
s_nop 3
v_mov_b32_dpp v112, v104 quad_perm:[0,0,0,0] row_mask:0xf bank_mask:0xf
v_add_f32_dpp v112, v105, v112 quad_perm:[1,1,1,1] row_mask:0xf bank_mask:0xf
v_add_f32_dpp v112, v106, v112 quad_perm:[2,2,2,2] row_mask:0xf bank_mask:0xf
v_add_f32_dpp v112, v107, v112 quad_perm:[3,3,3,3] row_mask:0xf bank_mask:0xf
v_mov_b32 v99, v112
s_waitcnt vmcnt(11)
v_mfma_f32_16x16x32_bf16 v[104:107], v[40:43], v[72:75], 0
s_mov_b32 s45, 0x30000
buffer_load_dwordx4 v[40:43], v1, s[4:7], s45 offen offset:0 nt
s_waitcnt vmcnt(11)
v_mfma_f32_16x16x32_bf16 v[104:107], v[44:47], v[76:79], v[104:107]
buffer_load_dwordx4 v[44:47], v1, s[4:7], s45 offen offset:1024 nt
s_waitcnt vmcnt(11)
v_mfma_f32_16x16x32_bf16 v[104:107], v[48:51], v[80:83], v[104:107]
buffer_load_dwordx4 v[48:51], v1, s[4:7], s45 offen offset:2048 nt
s_waitcnt vmcnt(11)
v_mfma_f32_16x16x32_bf16 v[104:107], v[52:55], v[84:87], v[104:107]
buffer_load_dwordx4 v[52:55], v1, s[4:7], s45 offen offset:3072 nt
s_nop 3
v_mov_b32_dpp v112, v108 quad_perm:[0,0,0,0] row_mask:0xf bank_mask:0xf
v_add_f32_dpp v112, v109, v112 quad_perm:[1,1,1,1] row_mask:0xf bank_mask:0xf
v_add_f32_dpp v112, v110, v112 quad_perm:[2,2,2,2] row_mask:0xf bank_mask:0xf
v_add_f32_dpp v112, v111, v112 quad_perm:[3,3,3,3] row_mask:0xf bank_mask:0xf
v_mov_b32 v91, v112
v_mfma_f32_16x16x32_bf16 v[108:111], a[64:67], v[72:75], 0
v_mfma_f32_16x16x32_bf16 v[108:111], a[68:71], v[76:79], v[108:111]
v_mfma_f32_16x16x32_bf16 v[108:111], a[72:75], v[80:83], v[108:111]
v_mfma_f32_16x16x32_bf16 v[108:111], a[76:79], v[84:87], v[108:111]
s_nop 3
v_mov_b32_dpp v112, v104 quad_perm:[0,0,0,0] row_mask:0xf bank_mask:0xf
v_add_f32_dpp v112, v105, v112 quad_perm:[1,1,1,1] row_mask:0xf bank_mask:0xf
v_add_f32_dpp v112, v106, v112 quad_perm:[2,2,2,2] row_mask:0xf bank_mask:0xf
v_add_f32_dpp v112, v107, v112 quad_perm:[3,3,3,3] row_mask:0xf bank_mask:0xf
v_cndmask_b32 v99, v99, v112, s[48:49]
s_waitcnt vmcnt(11)
v_mfma_f32_16x16x32_bf16 v[104:107], v[56:59], v[72:75], 0
s_mov_b32 s45, 0x31000
buffer_load_dwordx4 v[56:59], v1, s[4:7], s45 offen offset:0 nt
s_waitcnt vmcnt(11)
v_mfma_f32_16x16x32_bf16 v[104:107], v[60:63], v[76:79], v[104:107]
buffer_load_dwordx4 v[60:63], v1, s[4:7], s45 offen offset:1024 nt
s_waitcnt vmcnt(11)
v_mfma_f32_16x16x32_bf16 v[104:107], v[64:67], v[80:83], v[104:107]
buffer_load_dwordx4 v[64:67], v1, s[4:7], s45 offen offset:2048 nt
s_waitcnt vmcnt(11)
v_mfma_f32_16x16x32_bf16 v[104:107], v[68:71], v[84:87], v[104:107]
buffer_load_dwordx4 v[68:71], v1, s[4:7], s45 offen offset:3072 nt
s_nop 3
v_mov_b32_dpp v112, v108 quad_perm:[0,0,0,0] row_mask:0xf bank_mask:0xf
v_add_f32_dpp v112, v109, v112 quad_perm:[1,1,1,1] row_mask:0xf bank_mask:0xf
v_add_f32_dpp v112, v110, v112 quad_perm:[2,2,2,2] row_mask:0xf bank_mask:0xf
v_add_f32_dpp v112, v111, v112 quad_perm:[3,3,3,3] row_mask:0xf bank_mask:0xf
v_cndmask_b32 v91, v91, v112, s[48:49]
v_mfma_f32_16x16x32_bf16 v[108:111], a[80:83], v[72:75], 0
v_mfma_f32_16x16x32_bf16 v[108:111], a[84:87], v[76:79], v[108:111]
v_mfma_f32_16x16x32_bf16 v[108:111], a[88:91], v[80:83], v[108:111]
v_mfma_f32_16x16x32_bf16 v[108:111], a[92:95], v[84:87], v[108:111]
s_nop 3
v_mov_b32_dpp v112, v104 quad_perm:[0,0,0,0] row_mask:0xf bank_mask:0xf
v_add_f32_dpp v112, v105, v112 quad_perm:[1,1,1,1] row_mask:0xf bank_mask:0xf
v_add_f32_dpp v112, v106, v112 quad_perm:[2,2,2,2] row_mask:0xf bank_mask:0xf
v_add_f32_dpp v112, v107, v112 quad_perm:[3,3,3,3] row_mask:0xf bank_mask:0xf
v_cndmask_b32 v99, v99, v112, s[50:51]
s_waitcnt vmcnt(11)
v_mfma_f32_16x16x32_bf16 v[104:107], v[24:27], v[72:75], 0
s_mov_b32 s45, 0x32000
buffer_load_dwordx4 v[24:27], v1, s[4:7], s45 offen offset:0 nt
s_waitcnt vmcnt(11)
v_mfma_f32_16x16x32_bf16 v[104:107], v[28:31], v[76:79], v[104:107]
buffer_load_dwordx4 v[28:31], v1, s[4:7], s45 offen offset:1024 nt
s_waitcnt vmcnt(11)
v_mfma_f32_16x16x32_bf16 v[104:107], v[32:35], v[80:83], v[104:107]
buffer_load_dwordx4 v[32:35], v1, s[4:7], s45 offen offset:2048 nt
s_waitcnt vmcnt(11)
v_mfma_f32_16x16x32_bf16 v[104:107], v[36:39], v[84:87], v[104:107]
buffer_load_dwordx4 v[36:39], v1, s[4:7], s45 offen offset:3072 nt
s_nop 3
v_mov_b32_dpp v112, v108 quad_perm:[0,0,0,0] row_mask:0xf bank_mask:0xf
v_add_f32_dpp v112, v109, v112 quad_perm:[1,1,1,1] row_mask:0xf bank_mask:0xf
v_add_f32_dpp v112, v110, v112 quad_perm:[2,2,2,2] row_mask:0xf bank_mask:0xf
v_add_f32_dpp v112, v111, v112 quad_perm:[3,3,3,3] row_mask:0xf bank_mask:0xf
v_cndmask_b32 v91, v91, v112, s[50:51]
v_mfma_f32_16x16x32_bf16 v[108:111], a[96:99], v[72:75], 0
v_mfma_f32_16x16x32_bf16 v[108:111], a[100:103], v[76:79], v[108:111]
v_mfma_f32_16x16x32_bf16 v[108:111], a[104:107], v[80:83], v[108:111]
v_mfma_f32_16x16x32_bf16 v[108:111], a[108:111], v[84:87], v[108:111]
s_nop 3
v_mov_b32_dpp v112, v104 quad_perm:[0,0,0,0] row_mask:0xf bank_mask:0xf
v_add_f32_dpp v112, v105, v112 quad_perm:[1,1,1,1] row_mask:0xf bank_mask:0xf
v_add_f32_dpp v112, v106, v112 quad_perm:[2,2,2,2] row_mask:0xf bank_mask:0xf
v_add_f32_dpp v112, v107, v112 quad_perm:[3,3,3,3] row_mask:0xf bank_mask:0xf
v_cndmask_b32 v99, v99, v112, s[52:53]
s_waitcnt vmcnt(11)
v_mfma_f32_16x16x32_bf16 v[104:107], v[40:43], v[72:75], 0
s_mov_b32 s45, 0x33000
buffer_load_dwordx4 v[40:43], v1, s[4:7], s45 offen offset:0 nt
s_waitcnt vmcnt(11)
v_mfma_f32_16x16x32_bf16 v[104:107], v[44:47], v[76:79], v[104:107]
buffer_load_dwordx4 v[44:47], v1, s[4:7], s45 offen offset:1024 nt
s_waitcnt vmcnt(11)
v_mfma_f32_16x16x32_bf16 v[104:107], v[48:51], v[80:83], v[104:107]
buffer_load_dwordx4 v[48:51], v1, s[4:7], s45 offen offset:2048 nt
s_waitcnt vmcnt(11)
v_mfma_f32_16x16x32_bf16 v[104:107], v[52:55], v[84:87], v[104:107]
buffer_load_dwordx4 v[52:55], v1, s[4:7], s45 offen offset:3072 nt
s_nop 3
v_mov_b32_dpp v112, v108 quad_perm:[0,0,0,0] row_mask:0xf bank_mask:0xf
v_add_f32_dpp v112, v109, v112 quad_perm:[1,1,1,1] row_mask:0xf bank_mask:0xf
v_add_f32_dpp v112, v110, v112 quad_perm:[2,2,2,2] row_mask:0xf bank_mask:0xf
v_add_f32_dpp v112, v111, v112 quad_perm:[3,3,3,3] row_mask:0xf bank_mask:0xf
v_cndmask_b32 v91, v91, v112, s[52:53]
v_mfma_f32_16x16x32_bf16 v[108:111], a[112:115], v[72:75], 0
v_mfma_f32_16x16x32_bf16 v[108:111], a[116:119], v[76:79], v[108:111]
v_mfma_f32_16x16x32_bf16 v[108:111], a[120:123], v[80:83], v[108:111]
v_mfma_f32_16x16x32_bf16 v[108:111], a[124:127], v[84:87], v[108:111]
s_nop 3
v_mov_b32_dpp v112, v104 quad_perm:[0,0,0,0] row_mask:0xf bank_mask:0xf
v_add_f32_dpp v112, v105, v112 quad_perm:[1,1,1,1] row_mask:0xf bank_mask:0xf
v_add_f32_dpp v112, v106, v112 quad_perm:[2,2,2,2] row_mask:0xf bank_mask:0xf
v_add_f32_dpp v112, v107, v112 quad_perm:[3,3,3,3] row_mask:0xf bank_mask:0xf
v_mov_b32 v100, v112
s_waitcnt vmcnt(11)
v_mfma_f32_16x16x32_bf16 v[104:107], v[56:59], v[72:75], 0
s_mov_b32 s45, 0x34000
buffer_load_dwordx4 v[56:59], v1, s[4:7], s45 offen offset:0 nt
s_waitcnt vmcnt(11)
v_mfma_f32_16x16x32_bf16 v[104:107], v[60:63], v[76:79], v[104:107]
buffer_load_dwordx4 v[60:63], v1, s[4:7], s45 offen offset:1024 nt
s_waitcnt vmcnt(11)
v_mfma_f32_16x16x32_bf16 v[104:107], v[64:67], v[80:83], v[104:107]
buffer_load_dwordx4 v[64:67], v1, s[4:7], s45 offen offset:2048 nt
s_waitcnt vmcnt(11)
v_mfma_f32_16x16x32_bf16 v[104:107], v[68:71], v[84:87], v[104:107]
buffer_load_dwordx4 v[68:71], v1, s[4:7], s45 offen offset:3072 nt
s_nop 3
v_mov_b32_dpp v112, v108 quad_perm:[0,0,0,0] row_mask:0xf bank_mask:0xf
v_add_f32_dpp v112, v109, v112 quad_perm:[1,1,1,1] row_mask:0xf bank_mask:0xf
v_add_f32_dpp v112, v110, v112 quad_perm:[2,2,2,2] row_mask:0xf bank_mask:0xf
v_add_f32_dpp v112, v111, v112 quad_perm:[3,3,3,3] row_mask:0xf bank_mask:0xf
v_mov_b32 v92, v112
v_mfma_f32_16x16x32_bf16 v[108:111], a[128:131], v[72:75], 0
v_mfma_f32_16x16x32_bf16 v[108:111], a[132:135], v[76:79], v[108:111]
v_mfma_f32_16x16x32_bf16 v[108:111], a[136:139], v[80:83], v[108:111]
v_mfma_f32_16x16x32_bf16 v[108:111], a[140:143], v[84:87], v[108:111]
s_nop 3
v_mov_b32_dpp v112, v104 quad_perm:[0,0,0,0] row_mask:0xf bank_mask:0xf
v_add_f32_dpp v112, v105, v112 quad_perm:[1,1,1,1] row_mask:0xf bank_mask:0xf
v_add_f32_dpp v112, v106, v112 quad_perm:[2,2,2,2] row_mask:0xf bank_mask:0xf
v_add_f32_dpp v112, v107, v112 quad_perm:[3,3,3,3] row_mask:0xf bank_mask:0xf
v_cndmask_b32 v100, v100, v112, s[48:49]
s_waitcnt vmcnt(11)
v_mfma_f32_16x16x32_bf16 v[104:107], v[24:27], v[72:75], 0
s_mov_b32 s45, 0x35000
buffer_load_dwordx4 v[24:27], v1, s[4:7], s45 offen offset:0 nt
s_waitcnt vmcnt(11)
v_mfma_f32_16x16x32_bf16 v[104:107], v[28:31], v[76:79], v[104:107]
buffer_load_dwordx4 v[28:31], v1, s[4:7], s45 offen offset:1024 nt
s_waitcnt vmcnt(11)
v_mfma_f32_16x16x32_bf16 v[104:107], v[32:35], v[80:83], v[104:107]
buffer_load_dwordx4 v[32:35], v1, s[4:7], s45 offen offset:2048 nt
s_waitcnt vmcnt(11)
v_mfma_f32_16x16x32_bf16 v[104:107], v[36:39], v[84:87], v[104:107]
buffer_load_dwordx4 v[36:39], v1, s[4:7], s45 offen offset:3072 nt
s_nop 3
v_mov_b32_dpp v112, v108 quad_perm:[0,0,0,0] row_mask:0xf bank_mask:0xf
v_add_f32_dpp v112, v109, v112 quad_perm:[1,1,1,1] row_mask:0xf bank_mask:0xf
v_add_f32_dpp v112, v110, v112 quad_perm:[2,2,2,2] row_mask:0xf bank_mask:0xf
v_add_f32_dpp v112, v111, v112 quad_perm:[3,3,3,3] row_mask:0xf bank_mask:0xf
v_cndmask_b32 v92, v92, v112, s[48:49]
v_mfma_f32_16x16x32_bf16 v[108:111], a[144:147], v[72:75], 0
v_mfma_f32_16x16x32_bf16 v[108:111], a[148:151], v[76:79], v[108:111]
v_mfma_f32_16x16x32_bf16 v[108:111], a[152:155], v[80:83], v[108:111]
v_mfma_f32_16x16x32_bf16 v[108:111], a[156:159], v[84:87], v[108:111]
s_nop 3
v_mov_b32_dpp v112, v104 quad_perm:[0,0,0,0] row_mask:0xf bank_mask:0xf
v_add_f32_dpp v112, v105, v112 quad_perm:[1,1,1,1] row_mask:0xf bank_mask:0xf
v_add_f32_dpp v112, v106, v112 quad_perm:[2,2,2,2] row_mask:0xf bank_mask:0xf
v_add_f32_dpp v112, v107, v112 quad_perm:[3,3,3,3] row_mask:0xf bank_mask:0xf
v_cndmask_b32 v100, v100, v112, s[50:51]
s_waitcnt vmcnt(11)
v_mfma_f32_16x16x32_bf16 v[104:107], v[40:43], v[72:75], 0
s_mov_b32 s45, 0x36000
buffer_load_dwordx4 v[40:43], v1, s[4:7], s45 offen offset:0 nt
s_waitcnt vmcnt(11)
v_mfma_f32_16x16x32_bf16 v[104:107], v[44:47], v[76:79], v[104:107]
buffer_load_dwordx4 v[44:47], v1, s[4:7], s45 offen offset:1024 nt
s_waitcnt vmcnt(11)
v_mfma_f32_16x16x32_bf16 v[104:107], v[48:51], v[80:83], v[104:107]
buffer_load_dwordx4 v[48:51], v1, s[4:7], s45 offen offset:2048 nt
s_waitcnt vmcnt(11)
v_mfma_f32_16x16x32_bf16 v[104:107], v[52:55], v[84:87], v[104:107]
buffer_load_dwordx4 v[52:55], v1, s[4:7], s45 offen offset:3072 nt
s_nop 3
v_mov_b32_dpp v112, v108 quad_perm:[0,0,0,0] row_mask:0xf bank_mask:0xf
v_add_f32_dpp v112, v109, v112 quad_perm:[1,1,1,1] row_mask:0xf bank_mask:0xf
v_add_f32_dpp v112, v110, v112 quad_perm:[2,2,2,2] row_mask:0xf bank_mask:0xf
v_add_f32_dpp v112, v111, v112 quad_perm:[3,3,3,3] row_mask:0xf bank_mask:0xf
v_cndmask_b32 v92, v92, v112, s[50:51]
v_mfma_f32_16x16x32_bf16 v[108:111], a[160:163], v[72:75], 0
v_mfma_f32_16x16x32_bf16 v[108:111], a[164:167], v[76:79], v[108:111]
v_mfma_f32_16x16x32_bf16 v[108:111], a[168:171], v[80:83], v[108:111]
v_mfma_f32_16x16x32_bf16 v[108:111], a[172:175], v[84:87], v[108:111]
s_nop 3
v_mov_b32_dpp v112, v104 quad_perm:[0,0,0,0] row_mask:0xf bank_mask:0xf
v_add_f32_dpp v112, v105, v112 quad_perm:[1,1,1,1] row_mask:0xf bank_mask:0xf
v_add_f32_dpp v112, v106, v112 quad_perm:[2,2,2,2] row_mask:0xf bank_mask:0xf
v_add_f32_dpp v112, v107, v112 quad_perm:[3,3,3,3] row_mask:0xf bank_mask:0xf
v_cndmask_b32 v100, v100, v112, s[52:53]
s_waitcnt vmcnt(11)
v_mfma_f32_16x16x32_bf16 v[104:107], v[56:59], v[72:75], 0
s_mov_b32 s45, 0x37000
buffer_load_dwordx4 v[56:59], v1, s[4:7], s45 offen offset:0 nt
s_waitcnt vmcnt(11)
v_mfma_f32_16x16x32_bf16 v[104:107], v[60:63], v[76:79], v[104:107]
buffer_load_dwordx4 v[60:63], v1, s[4:7], s45 offen offset:1024 nt
s_waitcnt vmcnt(11)
v_mfma_f32_16x16x32_bf16 v[104:107], v[64:67], v[80:83], v[104:107]
buffer_load_dwordx4 v[64:67], v1, s[4:7], s45 offen offset:2048 nt
s_waitcnt vmcnt(11)
v_mfma_f32_16x16x32_bf16 v[104:107], v[68:71], v[84:87], v[104:107]
buffer_load_dwordx4 v[68:71], v1, s[4:7], s45 offen offset:3072 nt
s_nop 3
v_mov_b32_dpp v112, v108 quad_perm:[0,0,0,0] row_mask:0xf bank_mask:0xf
v_add_f32_dpp v112, v109, v112 quad_perm:[1,1,1,1] row_mask:0xf bank_mask:0xf
v_add_f32_dpp v112, v110, v112 quad_perm:[2,2,2,2] row_mask:0xf bank_mask:0xf
v_add_f32_dpp v112, v111, v112 quad_perm:[3,3,3,3] row_mask:0xf bank_mask:0xf
v_cndmask_b32 v92, v92, v112, s[52:53]
v_mfma_f32_16x16x32_bf16 v[108:111], a[176:179], v[72:75], 0
v_mfma_f32_16x16x32_bf16 v[108:111], a[180:183], v[76:79], v[108:111]
v_mfma_f32_16x16x32_bf16 v[108:111], a[184:187], v[80:83], v[108:111]
v_mfma_f32_16x16x32_bf16 v[108:111], a[188:191], v[84:87], v[108:111]
s_nop 3
v_mov_b32_dpp v112, v104 quad_perm:[0,0,0,0] row_mask:0xf bank_mask:0xf
v_add_f32_dpp v112, v105, v112 quad_perm:[1,1,1,1] row_mask:0xf bank_mask:0xf
v_add_f32_dpp v112, v106, v112 quad_perm:[2,2,2,2] row_mask:0xf bank_mask:0xf
v_add_f32_dpp v112, v107, v112 quad_perm:[3,3,3,3] row_mask:0xf bank_mask:0xf
v_mov_b32 v101, v112
s_waitcnt vmcnt(11)
v_mfma_f32_16x16x32_bf16 v[104:107], v[24:27], v[72:75], 0
s_mov_b32 s45, 0x38000
buffer_load_dwordx4 v[24:27], v1, s[4:7], s45 offen offset:0 nt
s_waitcnt vmcnt(11)
v_mfma_f32_16x16x32_bf16 v[104:107], v[28:31], v[76:79], v[104:107]
buffer_load_dwordx4 v[28:31], v1, s[4:7], s45 offen offset:1024 nt
s_waitcnt vmcnt(11)
v_mfma_f32_16x16x32_bf16 v[104:107], v[32:35], v[80:83], v[104:107]
buffer_load_dwordx4 v[32:35], v1, s[4:7], s45 offen offset:2048 nt
s_waitcnt vmcnt(11)
v_mfma_f32_16x16x32_bf16 v[104:107], v[36:39], v[84:87], v[104:107]
buffer_load_dwordx4 v[36:39], v1, s[4:7], s45 offen offset:3072 nt
s_nop 3
v_mov_b32_dpp v112, v108 quad_perm:[0,0,0,0] row_mask:0xf bank_mask:0xf
v_add_f32_dpp v112, v109, v112 quad_perm:[1,1,1,1] row_mask:0xf bank_mask:0xf
v_add_f32_dpp v112, v110, v112 quad_perm:[2,2,2,2] row_mask:0xf bank_mask:0xf
v_add_f32_dpp v112, v111, v112 quad_perm:[3,3,3,3] row_mask:0xf bank_mask:0xf
v_mov_b32 v93, v112
v_mfma_f32_16x16x32_bf16 v[108:111], a[192:195], v[72:75], 0
v_mfma_f32_16x16x32_bf16 v[108:111], a[196:199], v[76:79], v[108:111]
v_mfma_f32_16x16x32_bf16 v[108:111], a[200:203], v[80:83], v[108:111]
v_mfma_f32_16x16x32_bf16 v[108:111], a[204:207], v[84:87], v[108:111]
s_nop 3
v_mov_b32_dpp v112, v104 quad_perm:[0,0,0,0] row_mask:0xf bank_mask:0xf
v_add_f32_dpp v112, v105, v112 quad_perm:[1,1,1,1] row_mask:0xf bank_mask:0xf
v_add_f32_dpp v112, v106, v112 quad_perm:[2,2,2,2] row_mask:0xf bank_mask:0xf
v_add_f32_dpp v112, v107, v112 quad_perm:[3,3,3,3] row_mask:0xf bank_mask:0xf
v_cndmask_b32 v101, v101, v112, s[48:49]
s_waitcnt vmcnt(11)
v_mfma_f32_16x16x32_bf16 v[104:107], v[40:43], v[72:75], 0
s_mov_b32 s45, 0x39000
buffer_load_dwordx4 v[40:43], v1, s[4:7], s45 offen offset:0 nt
s_waitcnt vmcnt(11)
v_mfma_f32_16x16x32_bf16 v[104:107], v[44:47], v[76:79], v[104:107]
buffer_load_dwordx4 v[44:47], v1, s[4:7], s45 offen offset:1024 nt
s_waitcnt vmcnt(11)
v_mfma_f32_16x16x32_bf16 v[104:107], v[48:51], v[80:83], v[104:107]
buffer_load_dwordx4 v[48:51], v1, s[4:7], s45 offen offset:2048 nt
s_waitcnt vmcnt(11)
v_mfma_f32_16x16x32_bf16 v[104:107], v[52:55], v[84:87], v[104:107]
buffer_load_dwordx4 v[52:55], v1, s[4:7], s45 offen offset:3072 nt
s_nop 3
v_mov_b32_dpp v112, v108 quad_perm:[0,0,0,0] row_mask:0xf bank_mask:0xf
v_add_f32_dpp v112, v109, v112 quad_perm:[1,1,1,1] row_mask:0xf bank_mask:0xf
v_add_f32_dpp v112, v110, v112 quad_perm:[2,2,2,2] row_mask:0xf bank_mask:0xf
v_add_f32_dpp v112, v111, v112 quad_perm:[3,3,3,3] row_mask:0xf bank_mask:0xf
v_cndmask_b32 v93, v93, v112, s[48:49]
v_mfma_f32_16x16x32_bf16 v[108:111], a[208:211], v[72:75], 0
v_mfma_f32_16x16x32_bf16 v[108:111], a[212:215], v[76:79], v[108:111]
v_mfma_f32_16x16x32_bf16 v[108:111], a[216:219], v[80:83], v[108:111]
v_mfma_f32_16x16x32_bf16 v[108:111], a[220:223], v[84:87], v[108:111]
s_nop 3
v_mov_b32_dpp v112, v104 quad_perm:[0,0,0,0] row_mask:0xf bank_mask:0xf
v_add_f32_dpp v112, v105, v112 quad_perm:[1,1,1,1] row_mask:0xf bank_mask:0xf
v_add_f32_dpp v112, v106, v112 quad_perm:[2,2,2,2] row_mask:0xf bank_mask:0xf
v_add_f32_dpp v112, v107, v112 quad_perm:[3,3,3,3] row_mask:0xf bank_mask:0xf
v_cndmask_b32 v101, v101, v112, s[50:51]
s_waitcnt vmcnt(11)
v_mfma_f32_16x16x32_bf16 v[104:107], v[56:59], v[72:75], 0
s_mov_b32 s45, 0x3a000
buffer_load_dwordx4 v[56:59], v1, s[4:7], s45 offen offset:0 nt
s_waitcnt vmcnt(11)
v_mfma_f32_16x16x32_bf16 v[104:107], v[60:63], v[76:79], v[104:107]
buffer_load_dwordx4 v[60:63], v1, s[4:7], s45 offen offset:1024 nt
s_waitcnt vmcnt(11)
v_mfma_f32_16x16x32_bf16 v[104:107], v[64:67], v[80:83], v[104:107]
buffer_load_dwordx4 v[64:67], v1, s[4:7], s45 offen offset:2048 nt
s_waitcnt vmcnt(11)
v_mfma_f32_16x16x32_bf16 v[104:107], v[68:71], v[84:87], v[104:107]
buffer_load_dwordx4 v[68:71], v1, s[4:7], s45 offen offset:3072 nt
s_nop 3
v_mov_b32_dpp v112, v108 quad_perm:[0,0,0,0] row_mask:0xf bank_mask:0xf
v_add_f32_dpp v112, v109, v112 quad_perm:[1,1,1,1] row_mask:0xf bank_mask:0xf
v_add_f32_dpp v112, v110, v112 quad_perm:[2,2,2,2] row_mask:0xf bank_mask:0xf
v_add_f32_dpp v112, v111, v112 quad_perm:[3,3,3,3] row_mask:0xf bank_mask:0xf
v_cndmask_b32 v93, v93, v112, s[50:51]
v_mfma_f32_16x16x32_bf16 v[108:111], a[224:227], v[72:75], 0
v_mfma_f32_16x16x32_bf16 v[108:111], a[228:231], v[76:79], v[108:111]
v_mfma_f32_16x16x32_bf16 v[108:111], a[232:235], v[80:83], v[108:111]
v_mfma_f32_16x16x32_bf16 v[108:111], a[236:239], v[84:87], v[108:111]
s_nop 3
v_mov_b32_dpp v112, v104 quad_perm:[0,0,0,0] row_mask:0xf bank_mask:0xf
v_add_f32_dpp v112, v105, v112 quad_perm:[1,1,1,1] row_mask:0xf bank_mask:0xf
v_add_f32_dpp v112, v106, v112 quad_perm:[2,2,2,2] row_mask:0xf bank_mask:0xf
v_add_f32_dpp v112, v107, v112 quad_perm:[3,3,3,3] row_mask:0xf bank_mask:0xf
v_cndmask_b32 v101, v101, v112, s[52:53]
s_waitcnt vmcnt(11)
v_mfma_f32_16x16x32_bf16 v[104:107], v[24:27], v[72:75], 0
s_mov_b32 s45, 0x3b000
buffer_load_dwordx4 v[24:27], v1, s[4:7], s45 offen offset:0 nt
s_waitcnt vmcnt(11)
v_mfma_f32_16x16x32_bf16 v[104:107], v[28:31], v[76:79], v[104:107]
buffer_load_dwordx4 v[28:31], v1, s[4:7], s45 offen offset:1024 nt
s_waitcnt vmcnt(11)
v_mfma_f32_16x16x32_bf16 v[104:107], v[32:35], v[80:83], v[104:107]
buffer_load_dwordx4 v[32:35], v1, s[4:7], s45 offen offset:2048 nt
s_waitcnt vmcnt(11)
v_mfma_f32_16x16x32_bf16 v[104:107], v[36:39], v[84:87], v[104:107]
buffer_load_dwordx4 v[36:39], v1, s[4:7], s45 offen offset:3072 nt
s_nop 3
v_mov_b32_dpp v112, v108 quad_perm:[0,0,0,0] row_mask:0xf bank_mask:0xf
v_add_f32_dpp v112, v109, v112 quad_perm:[1,1,1,1] row_mask:0xf bank_mask:0xf
v_add_f32_dpp v112, v110, v112 quad_perm:[2,2,2,2] row_mask:0xf bank_mask:0xf
v_add_f32_dpp v112, v111, v112 quad_perm:[3,3,3,3] row_mask:0xf bank_mask:0xf
v_cndmask_b32 v93, v93, v112, s[52:53]
v_mfma_f32_16x16x32_bf16 v[108:111], a[240:243], v[72:75], 0
v_mfma_f32_16x16x32_bf16 v[108:111], a[244:247], v[76:79], v[108:111]
v_mfma_f32_16x16x32_bf16 v[108:111], a[248:251], v[80:83], v[108:111]
v_mfma_f32_16x16x32_bf16 v[108:111], a[252:255], v[84:87], v[108:111]
s_nop 3
v_mov_b32_dpp v112, v104 quad_perm:[0,0,0,0] row_mask:0xf bank_mask:0xf
v_add_f32_dpp v112, v105, v112 quad_perm:[1,1,1,1] row_mask:0xf bank_mask:0xf
v_add_f32_dpp v112, v106, v112 quad_perm:[2,2,2,2] row_mask:0xf bank_mask:0xf
v_add_f32_dpp v112, v107, v112 quad_perm:[3,3,3,3] row_mask:0xf bank_mask:0xf
v_mov_b32 v102, v112
s_waitcnt vmcnt(11)
v_mfma_f32_16x16x32_bf16 v[104:107], v[40:43], v[72:75], 0
s_mov_b32 s45, 0x3c000
buffer_load_dwordx4 v[40:43], v1, s[4:7], s45 offen offset:0 nt
s_waitcnt vmcnt(11)
v_mfma_f32_16x16x32_bf16 v[104:107], v[44:47], v[76:79], v[104:107]
buffer_load_dwordx4 v[44:47], v1, s[4:7], s45 offen offset:1024 nt
s_waitcnt vmcnt(11)
v_mfma_f32_16x16x32_bf16 v[104:107], v[48:51], v[80:83], v[104:107]
buffer_load_dwordx4 v[48:51], v1, s[4:7], s45 offen offset:2048 nt
s_waitcnt vmcnt(11)
v_mfma_f32_16x16x32_bf16 v[104:107], v[52:55], v[84:87], v[104:107]
buffer_load_dwordx4 v[52:55], v1, s[4:7], s45 offen offset:3072 nt
s_nop 3
v_mov_b32_dpp v112, v108 quad_perm:[0,0,0,0] row_mask:0xf bank_mask:0xf
v_add_f32_dpp v112, v109, v112 quad_perm:[1,1,1,1] row_mask:0xf bank_mask:0xf
v_add_f32_dpp v112, v110, v112 quad_perm:[2,2,2,2] row_mask:0xf bank_mask:0xf
v_add_f32_dpp v112, v111, v112 quad_perm:[3,3,3,3] row_mask:0xf bank_mask:0xf
v_mov_b32 v94, v112
v_mfma_f32_16x16x32_bf16 v[108:111], v[136:139], v[72:75], 0
v_mfma_f32_16x16x32_bf16 v[108:111], v[140:143], v[76:79], v[108:111]
v_mfma_f32_16x16x32_bf16 v[108:111], v[144:147], v[80:83], v[108:111]
v_mfma_f32_16x16x32_bf16 v[108:111], v[148:151], v[84:87], v[108:111]
s_nop 3
v_mov_b32_dpp v112, v104 quad_perm:[0,0,0,0] row_mask:0xf bank_mask:0xf
v_add_f32_dpp v112, v105, v112 quad_perm:[1,1,1,1] row_mask:0xf bank_mask:0xf
v_add_f32_dpp v112, v106, v112 quad_perm:[2,2,2,2] row_mask:0xf bank_mask:0xf
v_add_f32_dpp v112, v107, v112 quad_perm:[3,3,3,3] row_mask:0xf bank_mask:0xf
v_cndmask_b32 v102, v102, v112, s[48:49]
s_waitcnt vmcnt(11)
v_mfma_f32_16x16x32_bf16 v[104:107], v[56:59], v[72:75], 0
s_mov_b32 s45, 0x3d000
buffer_load_dwordx4 v[56:59], v1, s[4:7], s45 offen offset:0 nt
s_waitcnt vmcnt(11)
v_mfma_f32_16x16x32_bf16 v[104:107], v[60:63], v[76:79], v[104:107]
buffer_load_dwordx4 v[60:63], v1, s[4:7], s45 offen offset:1024 nt
s_waitcnt vmcnt(11)
v_mfma_f32_16x16x32_bf16 v[104:107], v[64:67], v[80:83], v[104:107]
buffer_load_dwordx4 v[64:67], v1, s[4:7], s45 offen offset:2048 nt
s_waitcnt vmcnt(11)
v_mfma_f32_16x16x32_bf16 v[104:107], v[68:71], v[84:87], v[104:107]
buffer_load_dwordx4 v[68:71], v1, s[4:7], s45 offen offset:3072 nt
s_nop 3
v_mov_b32_dpp v112, v108 quad_perm:[0,0,0,0] row_mask:0xf bank_mask:0xf
v_add_f32_dpp v112, v109, v112 quad_perm:[1,1,1,1] row_mask:0xf bank_mask:0xf
v_add_f32_dpp v112, v110, v112 quad_perm:[2,2,2,2] row_mask:0xf bank_mask:0xf
v_add_f32_dpp v112, v111, v112 quad_perm:[3,3,3,3] row_mask:0xf bank_mask:0xf
v_cndmask_b32 v94, v94, v112, s[48:49]
v_mfma_f32_16x16x32_bf16 v[108:111], v[152:155], v[72:75], 0
v_mfma_f32_16x16x32_bf16 v[108:111], v[156:159], v[76:79], v[108:111]
v_mfma_f32_16x16x32_bf16 v[108:111], v[160:163], v[80:83], v[108:111]
v_mfma_f32_16x16x32_bf16 v[108:111], v[164:167], v[84:87], v[108:111]
s_nop 3
v_mov_b32_dpp v112, v104 quad_perm:[0,0,0,0] row_mask:0xf bank_mask:0xf
v_add_f32_dpp v112, v105, v112 quad_perm:[1,1,1,1] row_mask:0xf bank_mask:0xf
v_add_f32_dpp v112, v106, v112 quad_perm:[2,2,2,2] row_mask:0xf bank_mask:0xf
v_add_f32_dpp v112, v107, v112 quad_perm:[3,3,3,3] row_mask:0xf bank_mask:0xf
v_cndmask_b32 v102, v102, v112, s[50:51]
s_waitcnt vmcnt(11)
v_mfma_f32_16x16x32_bf16 v[104:107], v[24:27], v[72:75], 0
s_mov_b32 s45, 0x3e000
buffer_load_dwordx4 v[24:27], v1, s[4:7], s45 offen offset:0 nt
s_waitcnt vmcnt(11)
v_mfma_f32_16x16x32_bf16 v[104:107], v[28:31], v[76:79], v[104:107]
buffer_load_dwordx4 v[28:31], v1, s[4:7], s45 offen offset:1024 nt
s_waitcnt vmcnt(11)
v_mfma_f32_16x16x32_bf16 v[104:107], v[32:35], v[80:83], v[104:107]
buffer_load_dwordx4 v[32:35], v1, s[4:7], s45 offen offset:2048 nt
s_waitcnt vmcnt(11)
v_mfma_f32_16x16x32_bf16 v[104:107], v[36:39], v[84:87], v[104:107]
buffer_load_dwordx4 v[36:39], v1, s[4:7], s45 offen offset:3072 nt
s_nop 3
v_mov_b32_dpp v112, v108 quad_perm:[0,0,0,0] row_mask:0xf bank_mask:0xf
v_add_f32_dpp v112, v109, v112 quad_perm:[1,1,1,1] row_mask:0xf bank_mask:0xf
v_add_f32_dpp v112, v110, v112 quad_perm:[2,2,2,2] row_mask:0xf bank_mask:0xf
v_add_f32_dpp v112, v111, v112 quad_perm:[3,3,3,3] row_mask:0xf bank_mask:0xf
v_cndmask_b32 v94, v94, v112, s[50:51]
v_mfma_f32_16x16x32_bf16 v[108:111], v[168:171], v[72:75], 0
v_mfma_f32_16x16x32_bf16 v[108:111], v[172:175], v[76:79], v[108:111]
v_mfma_f32_16x16x32_bf16 v[108:111], v[176:179], v[80:83], v[108:111]
v_mfma_f32_16x16x32_bf16 v[108:111], v[180:183], v[84:87], v[108:111]
s_nop 3
v_mov_b32_dpp v112, v104 quad_perm:[0,0,0,0] row_mask:0xf bank_mask:0xf
v_add_f32_dpp v112, v105, v112 quad_perm:[1,1,1,1] row_mask:0xf bank_mask:0xf
v_add_f32_dpp v112, v106, v112 quad_perm:[2,2,2,2] row_mask:0xf bank_mask:0xf
v_add_f32_dpp v112, v107, v112 quad_perm:[3,3,3,3] row_mask:0xf bank_mask:0xf
v_cndmask_b32 v102, v102, v112, s[52:53]
s_waitcnt vmcnt(11)
v_mfma_f32_16x16x32_bf16 v[104:107], v[40:43], v[72:75], 0
s_mov_b32 s45, 0x3f000
buffer_load_dwordx4 v[40:43], v1, s[4:7], s45 offen offset:0 nt
s_waitcnt vmcnt(11)
v_mfma_f32_16x16x32_bf16 v[104:107], v[44:47], v[76:79], v[104:107]
buffer_load_dwordx4 v[44:47], v1, s[4:7], s45 offen offset:1024 nt
s_waitcnt vmcnt(11)
v_mfma_f32_16x16x32_bf16 v[104:107], v[48:51], v[80:83], v[104:107]
buffer_load_dwordx4 v[48:51], v1, s[4:7], s45 offen offset:2048 nt
s_waitcnt vmcnt(11)
v_mfma_f32_16x16x32_bf16 v[104:107], v[52:55], v[84:87], v[104:107]
buffer_load_dwordx4 v[52:55], v1, s[4:7], s45 offen offset:3072 nt
s_nop 3
v_mov_b32_dpp v112, v108 quad_perm:[0,0,0,0] row_mask:0xf bank_mask:0xf
v_add_f32_dpp v112, v109, v112 quad_perm:[1,1,1,1] row_mask:0xf bank_mask:0xf
v_add_f32_dpp v112, v110, v112 quad_perm:[2,2,2,2] row_mask:0xf bank_mask:0xf
v_add_f32_dpp v112, v111, v112 quad_perm:[3,3,3,3] row_mask:0xf bank_mask:0xf
v_cndmask_b32 v94, v94, v112, s[52:53]
v_mfma_f32_16x16x32_bf16 v[108:111], v[184:187], v[72:75], 0
v_mfma_f32_16x16x32_bf16 v[108:111], v[188:191], v[76:79], v[108:111]
v_mfma_f32_16x16x32_bf16 v[108:111], v[192:195], v[80:83], v[108:111]
v_mfma_f32_16x16x32_bf16 v[108:111], v[196:199], v[84:87], v[108:111]
s_nop 3
v_mov_b32_dpp v112, v104 quad_perm:[0,0,0,0] row_mask:0xf bank_mask:0xf
v_add_f32_dpp v112, v105, v112 quad_perm:[1,1,1,1] row_mask:0xf bank_mask:0xf
v_add_f32_dpp v112, v106, v112 quad_perm:[2,2,2,2] row_mask:0xf bank_mask:0xf
v_add_f32_dpp v112, v107, v112 quad_perm:[3,3,3,3] row_mask:0xf bank_mask:0xf
v_mov_b32 v103, v112
s_waitcnt vmcnt(11)
v_mfma_f32_16x16x32_bf16 v[104:107], v[56:59], v[72:75], 0
s_bitcmp1_b32 s47, 2
s_cbranch_scc1 L_th239
s_waitcnt vmcnt(3)
L_th239:
s_waitcnt vmcnt(8)
buffer_load_dwordx4 v[56:59], v2, s[8:11], 0 offen offset:0 nt
s_waitcnt vmcnt(11)
v_mfma_f32_16x16x32_bf16 v[104:107], v[60:63], v[76:79], v[104:107]
s_bitcmp1_b32 s47, 2
s_cbranch_scc1 L_th240
s_waitcnt vmcnt(3)
L_th240:
s_waitcnt vmcnt(8)
buffer_load_dwordx4 v[60:63], v2, s[8:11], 0 offen offset:1024 nt
s_waitcnt vmcnt(11)
v_mfma_f32_16x16x32_bf16 v[104:107], v[64:67], v[80:83], v[104:107]
s_bitcmp1_b32 s47, 2
s_cbranch_scc1 L_th241
s_waitcnt vmcnt(3)
L_th241:
s_waitcnt vmcnt(8)
buffer_load_dwordx4 v[64:67], v2, s[8:11], 0 offen offset:2048 nt
s_waitcnt vmcnt(11)
v_mfma_f32_16x16x32_bf16 v[104:107], v[68:71], v[84:87], v[104:107]
s_bitcmp1_b32 s47, 2
s_cbranch_scc1 L_th242
s_waitcnt vmcnt(3)
L_th242:
s_waitcnt vmcnt(8)
buffer_load_dwordx4 v[68:71], v2, s[8:11], 0 offen offset:3072 nt
s_nop 3
v_mov_b32_dpp v112, v108 quad_perm:[0,0,0,0] row_mask:0xf bank_mask:0xf
v_add_f32_dpp v112, v109, v112 quad_perm:[1,1,1,1] row_mask:0xf bank_mask:0xf
v_add_f32_dpp v112, v110, v112 quad_perm:[2,2,2,2] row_mask:0xf bank_mask:0xf
v_add_f32_dpp v112, v111, v112 quad_perm:[3,3,3,3] row_mask:0xf bank_mask:0xf
v_mov_b32 v95, v112
v_mfma_f32_16x16x32_bf16 v[108:111], v[200:203], v[72:75], 0
v_mfma_f32_16x16x32_bf16 v[108:111], v[204:207], v[76:79], v[108:111]
v_mfma_f32_16x16x32_bf16 v[108:111], v[208:211], v[80:83], v[108:111]
v_mfma_f32_16x16x32_bf16 v[108:111], v[212:215], v[84:87], v[108:111]
s_nop 3
v_mov_b32_dpp v112, v104 quad_perm:[0,0,0,0] row_mask:0xf bank_mask:0xf
v_add_f32_dpp v112, v105, v112 quad_perm:[1,1,1,1] row_mask:0xf bank_mask:0xf
v_add_f32_dpp v112, v106, v112 quad_perm:[2,2,2,2] row_mask:0xf bank_mask:0xf
v_add_f32_dpp v112, v107, v112 quad_perm:[3,3,3,3] row_mask:0xf bank_mask:0xf
v_cndmask_b32 v103, v103, v112, s[48:49]
s_waitcnt vmcnt(11)
v_mfma_f32_16x16x32_bf16 v[104:107], v[24:27], v[72:75], 0
s_bitcmp1_b32 s47, 2
s_cbranch_scc1 L_th243
s_waitcnt vmcnt(3)
L_th243:
s_waitcnt vmcnt(8)
s_mov_b32 s45, 0x1000
buffer_load_dwordx4 v[24:27], v2, s[8:11], s45 offen offset:0 nt
s_waitcnt vmcnt(11)
v_mfma_f32_16x16x32_bf16 v[104:107], v[28:31], v[76:79], v[104:107]
s_bitcmp1_b32 s47, 2
s_cbranch_scc1 L_th244
s_waitcnt vmcnt(3)
L_th244:
s_waitcnt vmcnt(8)
buffer_load_dwordx4 v[28:31], v2, s[8:11], s45 offen offset:1024 nt
s_waitcnt vmcnt(11)
v_mfma_f32_16x16x32_bf16 v[104:107], v[32:35], v[80:83], v[104:107]
s_bitcmp1_b32 s47, 2
s_cbranch_scc1 L_th245
s_waitcnt vmcnt(3)
L_th245:
s_waitcnt vmcnt(8)
buffer_load_dwordx4 v[32:35], v2, s[8:11], s45 offen offset:2048 nt
s_waitcnt vmcnt(11)
v_mfma_f32_16x16x32_bf16 v[104:107], v[36:39], v[84:87], v[104:107]
s_bitcmp1_b32 s47, 2
s_cbranch_scc1 L_th246
s_waitcnt vmcnt(3)
L_th246:
s_waitcnt vmcnt(8)
buffer_load_dwordx4 v[36:39], v2, s[8:11], s45 offen offset:3072 nt
s_nop 3
v_mov_b32_dpp v112, v108 quad_perm:[0,0,0,0] row_mask:0xf bank_mask:0xf
v_add_f32_dpp v112, v109, v112 quad_perm:[1,1,1,1] row_mask:0xf bank_mask:0xf
v_add_f32_dpp v112, v110, v112 quad_perm:[2,2,2,2] row_mask:0xf bank_mask:0xf
v_add_f32_dpp v112, v111, v112 quad_perm:[3,3,3,3] row_mask:0xf bank_mask:0xf
v_cndmask_b32 v95, v95, v112, s[48:49]
v_mfma_f32_16x16x32_bf16 v[108:111], v[216:219], v[72:75], 0
v_mfma_f32_16x16x32_bf16 v[108:111], v[220:223], v[76:79], v[108:111]
v_mfma_f32_16x16x32_bf16 v[108:111], v[224:227], v[80:83], v[108:111]
v_mfma_f32_16x16x32_bf16 v[108:111], v[228:231], v[84:87], v[108:111]
s_nop 3
v_mov_b32_dpp v112, v104 quad_perm:[0,0,0,0] row_mask:0xf bank_mask:0xf
v_add_f32_dpp v112, v105, v112 quad_perm:[1,1,1,1] row_mask:0xf bank_mask:0xf
v_add_f32_dpp v112, v106, v112 quad_perm:[2,2,2,2] row_mask:0xf bank_mask:0xf
v_add_f32_dpp v112, v107, v112 quad_perm:[3,3,3,3] row_mask:0xf bank_mask:0xf
v_cndmask_b32 v103, v103, v112, s[50:51]
s_waitcnt vmcnt(11)
v_mfma_f32_16x16x32_bf16 v[104:107], v[40:43], v[72:75], 0
s_bitcmp1_b32 s47, 2
s_cbranch_scc1 L_th247
s_waitcnt vmcnt(3)
L_th247:
s_waitcnt vmcnt(8)
s_mov_b32 s45, 0x2000
buffer_load_dwordx4 v[40:43], v2, s[8:11], s45 offen offset:0 nt
s_waitcnt vmcnt(11)
v_mfma_f32_16x16x32_bf16 v[104:107], v[44:47], v[76:79], v[104:107]
s_bitcmp1_b32 s47, 2
s_cbranch_scc1 L_th248
s_waitcnt vmcnt(3)
L_th248:
s_waitcnt vmcnt(8)
buffer_load_dwordx4 v[44:47], v2, s[8:11], s45 offen offset:1024 nt
s_waitcnt vmcnt(11)
v_mfma_f32_16x16x32_bf16 v[104:107], v[48:51], v[80:83], v[104:107]
s_bitcmp1_b32 s47, 2
s_cbranch_scc1 L_th249
s_waitcnt vmcnt(3)
L_th249:
s_waitcnt vmcnt(8)
buffer_load_dwordx4 v[48:51], v2, s[8:11], s45 offen offset:2048 nt
s_waitcnt vmcnt(11)
v_mfma_f32_16x16x32_bf16 v[104:107], v[52:55], v[84:87], v[104:107]
s_bitcmp1_b32 s47, 2
s_cbranch_scc1 L_th250
s_waitcnt vmcnt(3)
L_th250:
s_waitcnt vmcnt(8)
buffer_load_dwordx4 v[52:55], v2, s[8:11], s45 offen offset:3072 nt
s_nop 3
v_mov_b32_dpp v112, v108 quad_perm:[0,0,0,0] row_mask:0xf bank_mask:0xf
v_add_f32_dpp v112, v109, v112 quad_perm:[1,1,1,1] row_mask:0xf bank_mask:0xf
v_add_f32_dpp v112, v110, v112 quad_perm:[2,2,2,2] row_mask:0xf bank_mask:0xf
v_add_f32_dpp v112, v111, v112 quad_perm:[3,3,3,3] row_mask:0xf bank_mask:0xf
v_cndmask_b32 v95, v95, v112, s[50:51]
v_mfma_f32_16x16x32_bf16 v[108:111], v[232:235], v[72:75], 0
v_mfma_f32_16x16x32_bf16 v[108:111], v[236:239], v[76:79], v[108:111]
v_mfma_f32_16x16x32_bf16 v[108:111], v[240:243], v[80:83], v[108:111]
v_mfma_f32_16x16x32_bf16 v[108:111], v[244:247], v[84:87], v[108:111]
s_nop 3
v_mov_b32_dpp v112, v104 quad_perm:[0,0,0,0] row_mask:0xf bank_mask:0xf
v_add_f32_dpp v112, v105, v112 quad_perm:[1,1,1,1] row_mask:0xf bank_mask:0xf
v_add_f32_dpp v112, v106, v112 quad_perm:[2,2,2,2] row_mask:0xf bank_mask:0xf
v_add_f32_dpp v112, v107, v112 quad_perm:[3,3,3,3] row_mask:0xf bank_mask:0xf
v_cndmask_b32 v103, v103, v112, s[52:53]
s_nop 7
v_mov_b32_dpp v112, v108 quad_perm:[0,0,0,0] row_mask:0xf bank_mask:0xf
v_add_f32_dpp v112, v109, v112 quad_perm:[1,1,1,1] row_mask:0xf bank_mask:0xf
v_add_f32_dpp v112, v110, v112 quad_perm:[2,2,2,2] row_mask:0xf bank_mask:0xf
v_add_f32_dpp v112, v111, v112 quad_perm:[3,3,3,3] row_mask:0xf bank_mask:0xf
v_cndmask_b32 v95, v95, v112, s[52:53]
v_max3_f32 v104, v88, v89, v90
v_max3_f32 v104, v104, v91, v92
v_max3_f32 v104, v104, v93, v94
v_max3_f32 v104, v104, v95, v96
v_max3_f32 v104, v104, v97, v98
v_max3_f32 v104, v104, v99, v100
v_max3_f32 v104, v104, v101, v102
v_max_f32 v104, v104, v103
s_nop 1
v_max_f32_dpp v104, v104, v104 row_ror:8 row_mask:0xf bank_mask:0xf
s_nop 1
v_max_f32_dpp v104, v104, v104 row_ror:4 row_mask:0xf bank_mask:0xf
s_nop 1
v_max_f32_dpp v104, v104, v104 row_ror:2 row_mask:0xf bank_mask:0xf
s_nop 1
v_max_f32_dpp v104, v104, v104 row_ror:1 row_mask:0xf bank_mask:0xf
v_mov_b32 v105, v104
s_nop 1
v_permlane16_swap_b32 v104, v105
s_nop 0
v_max_f32 v104, v104, v105
v_mov_b32 v105, v104
s_nop 1
v_permlane32_swap_b32 v104, v105
s_nop 0
v_max_f32 v104, v104, v105
s_mov_b32 s54, 0x3e0293ee
v_mul_f32 v105, s54, v104
v_fma_f32 v88, v88, s54, -v105
v_fma_f32 v89, v89, s54, -v105
v_fma_f32 v90, v90, s54, -v105
v_fma_f32 v91, v91, s54, -v105
v_fma_f32 v92, v92, s54, -v105
v_fma_f32 v93, v93, s54, -v105
v_fma_f32 v94, v94, s54, -v105
v_fma_f32 v95, v95, s54, -v105
v_fma_f32 v96, v96, s54, -v105
v_fma_f32 v97, v97, s54, -v105
v_fma_f32 v98, v98, s54, -v105
v_fma_f32 v99, v99, s54, -v105
v_fma_f32 v100, v100, s54, -v105
v_fma_f32 v101, v101, s54, -v105
v_fma_f32 v102, v102, s54, -v105
v_fma_f32 v103, v103, s54, -v105
v_exp_f32 v88, v88
v_exp_f32 v89, v89
v_exp_f32 v90, v90
v_exp_f32 v91, v91
v_exp_f32 v92, v92
v_exp_f32 v93, v93
v_exp_f32 v94, v94
v_exp_f32 v95, v95
v_exp_f32 v96, v96
v_exp_f32 v97, v97
v_exp_f32 v98, v98
v_exp_f32 v99, v99
v_exp_f32 v100, v100
v_exp_f32 v101, v101
v_exp_f32 v102, v102
v_exp_f32 v103, v103
s_nop 0
v_add_f32 v106, v88, v89
v_add_f32 v106, v106, v90
v_add_f32 v106, v106, v91
v_add_f32 v106, v106, v92
v_add_f32 v106, v106, v93
v_add_f32 v106, v106, v94
v_add_f32 v106, v106, v95
v_add_f32 v106, v106, v96
v_add_f32 v106, v106, v97
v_add_f32 v106, v106, v98
v_add_f32 v106, v106, v99
v_add_f32 v106, v106, v100
v_add_f32 v106, v106, v101
v_add_f32 v106, v106, v102
v_add_f32 v106, v106, v103
v_cvt_pk_bf16_f32 v88, v88, v88
v_cvt_pk_bf16_f32 v89, v89, v89
v_cvt_pk_bf16_f32 v90, v90, v90
v_cvt_pk_bf16_f32 v91, v91, v91
v_cvt_pk_bf16_f32 v92, v92, v92
v_cvt_pk_bf16_f32 v93, v93, v93
v_cvt_pk_bf16_f32 v94, v94, v94
v_cvt_pk_bf16_f32 v95, v95, v95
v_cvt_pk_bf16_f32 v96, v96, v96
v_cvt_pk_bf16_f32 v97, v97, v97
v_cvt_pk_bf16_f32 v98, v98, v98
v_cvt_pk_bf16_f32 v99, v99, v99
v_cvt_pk_bf16_f32 v100, v100, v100
v_cvt_pk_bf16_f32 v101, v101, v101
v_cvt_pk_bf16_f32 v102, v102, v102
v_cvt_pk_bf16_f32 v103, v103, v103
s_nop 1
v_add_f32_dpp v106, v106, v106 row_ror:8 row_mask:0xf bank_mask:0xf
s_nop 1
v_add_f32_dpp v106, v106, v106 row_ror:4 row_mask:0xf bank_mask:0xf
s_nop 1
v_add_f32_dpp v106, v106, v106 row_ror:2 row_mask:0xf bank_mask:0xf
s_nop 1
v_add_f32_dpp v106, v106, v106 row_ror:1 row_mask:0xf bank_mask:0xf
v_mov_b32 v105, v106
s_nop 1
v_permlane16_swap_b32 v106, v105
s_nop 0
v_add_f32 v106, v106, v105
v_mov_b32 v105, v106
s_nop 1
v_permlane32_swap_b32 v106, v105
s_nop 0
v_add_f32 v106, v106, v105
v_mul_f32 v15, s54, v104
v_mov_b32 v133, v106
v_mov_b32 v132, v15
s_nop 1
v_and_b32_dpp v112, v88, v16 row_newbcast:0 row_mask:0xf bank_mask:0xf
v_and_b32_dpp v113, v88, v17 row_newbcast:0 row_mask:0xf bank_mask:0xf
v_and_b32_dpp v114, v88, v18 row_newbcast:0 row_mask:0xf bank_mask:0xf
v_and_b32_dpp v115, v88, v19 row_newbcast:0 row_mask:0xf bank_mask:0xf
v_and_b32_dpp v116, v88, v16 row_newbcast:4 row_mask:0xf bank_mask:0xf
v_and_b32_dpp v117, v88, v17 row_newbcast:4 row_mask:0xf bank_mask:0xf
v_and_b32_dpp v118, v88, v18 row_newbcast:4 row_mask:0xf bank_mask:0xf
v_and_b32_dpp v119, v88, v19 row_newbcast:4 row_mask:0xf bank_mask:0xf
s_waitcnt vmcnt(11)
v_mfma_f32_16x16x32_bf16 v[108:111], v[112:115], v[56:59], 0
s_bitcmp1_b32 s47, 2
s_cbranch_scc1 L_th251
s_waitcnt vmcnt(3)
L_th251:
s_waitcnt vmcnt(8)
s_mov_b32 s45, 0x3000
buffer_load_dwordx4 v[56:59], v2, s[8:11], s45 offen offset:0 nt
v_and_b32_dpp v112, v88, v16 row_newbcast:8 row_mask:0xf bank_mask:0xf
v_and_b32_dpp v113, v88, v17 row_newbcast:8 row_mask:0xf bank_mask:0xf
v_and_b32_dpp v114, v88, v18 row_newbcast:8 row_mask:0xf bank_mask:0xf
v_and_b32_dpp v115, v88, v19 row_newbcast:8 row_mask:0xf bank_mask:0xf
s_waitcnt vmcnt(11)
v_mfma_f32_16x16x32_bf16 v[108:111], v[116:119], v[60:63], v[108:111]
s_bitcmp1_b32 s47, 2
s_cbranch_scc1 L_th252
s_waitcnt vmcnt(3)
L_th252:
s_waitcnt vmcnt(8)
buffer_load_dwordx4 v[60:63], v2, s[8:11], s45 offen offset:1024 nt
v_and_b32_dpp v116, v88, v16 row_newbcast:12 row_mask:0xf bank_mask:0xf
v_and_b32_dpp v117, v88, v17 row_newbcast:12 row_mask:0xf bank_mask:0xf
v_and_b32_dpp v118, v88, v18 row_newbcast:12 row_mask:0xf bank_mask:0xf
v_and_b32_dpp v119, v88, v19 row_newbcast:12 row_mask:0xf bank_mask:0xf
s_waitcnt vmcnt(11)
v_mfma_f32_16x16x32_bf16 v[108:111], v[112:115], v[64:67], v[108:111]
s_bitcmp1_b32 s47, 2
s_cbranch_scc1 L_th253
s_waitcnt vmcnt(3)
L_th253:
s_waitcnt vmcnt(8)
buffer_load_dwordx4 v[64:67], v2, s[8:11], s45 offen offset:2048 nt
v_and_b32_dpp v112, v88, v16 row_newbcast:1 row_mask:0xf bank_mask:0xf
v_and_b32_dpp v113, v88, v17 row_newbcast:1 row_mask:0xf bank_mask:0xf
v_and_b32_dpp v114, v88, v18 row_newbcast:1 row_mask:0xf bank_mask:0xf
v_and_b32_dpp v115, v88, v19 row_newbcast:1 row_mask:0xf bank_mask:0xf
s_waitcnt vmcnt(11)
v_mfma_f32_16x16x32_bf16 v[108:111], v[116:119], v[68:71], v[108:111]
s_bitcmp1_b32 s47, 2
s_cbranch_scc1 L_th254
s_waitcnt vmcnt(3)
L_th254:
s_waitcnt vmcnt(8)
buffer_load_dwordx4 v[68:71], v2, s[8:11], s45 offen offset:3072 nt
v_and_b32_dpp v116, v88, v16 row_newbcast:5 row_mask:0xf bank_mask:0xf
v_and_b32_dpp v117, v88, v17 row_newbcast:5 row_mask:0xf bank_mask:0xf
v_and_b32_dpp v118, v88, v18 row_newbcast:5 row_mask:0xf bank_mask:0xf
v_and_b32_dpp v119, v88, v19 row_newbcast:5 row_mask:0xf bank_mask:0xf
s_waitcnt vmcnt(11)
v_mfma_f32_16x16x32_bf16 v[108:111], v[112:115], v[24:27], v[108:111]
s_bitcmp1_b32 s47, 2
s_cbranch_scc1 L_th255
s_waitcnt vmcnt(3)
L_th255:
s_waitcnt vmcnt(8)
s_mov_b32 s45, 0x4000
buffer_load_dwordx4 v[24:27], v2, s[8:11], s45 offen offset:0 nt
v_and_b32_dpp v112, v88, v16 row_newbcast:9 row_mask:0xf bank_mask:0xf
v_and_b32_dpp v113, v88, v17 row_newbcast:9 row_mask:0xf bank_mask:0xf
v_and_b32_dpp v114, v88, v18 row_newbcast:9 row_mask:0xf bank_mask:0xf
v_and_b32_dpp v115, v88, v19 row_newbcast:9 row_mask:0xf bank_mask:0xf
s_waitcnt vmcnt(11)
v_mfma_f32_16x16x32_bf16 v[108:111], v[116:119], v[28:31], v[108:111]
s_bitcmp1_b32 s47, 2
s_cbranch_scc1 L_th256
s_waitcnt vmcnt(3)
L_th256:
s_waitcnt vmcnt(8)
buffer_load_dwordx4 v[28:31], v2, s[8:11], s45 offen offset:1024 nt
v_and_b32_dpp v116, v88, v16 row_newbcast:13 row_mask:0xf bank_mask:0xf
v_and_b32_dpp v117, v88, v17 row_newbcast:13 row_mask:0xf bank_mask:0xf
v_and_b32_dpp v118, v88, v18 row_newbcast:13 row_mask:0xf bank_mask:0xf
v_and_b32_dpp v119, v88, v19 row_newbcast:13 row_mask:0xf bank_mask:0xf
s_waitcnt vmcnt(11)
v_mfma_f32_16x16x32_bf16 v[108:111], v[112:115], v[32:35], v[108:111]
s_bitcmp1_b32 s47, 2
s_cbranch_scc1 L_th257
s_waitcnt vmcnt(3)
L_th257:
s_waitcnt vmcnt(8)
buffer_load_dwordx4 v[32:35], v2, s[8:11], s45 offen offset:2048 nt
v_and_b32_dpp v112, v88, v16 row_newbcast:2 row_mask:0xf bank_mask:0xf
v_and_b32_dpp v113, v88, v17 row_newbcast:2 row_mask:0xf bank_mask:0xf
v_and_b32_dpp v114, v88, v18 row_newbcast:2 row_mask:0xf bank_mask:0xf
v_and_b32_dpp v115, v88, v19 row_newbcast:2 row_mask:0xf bank_mask:0xf
s_waitcnt vmcnt(11)
v_mfma_f32_16x16x32_bf16 v[108:111], v[116:119], v[36:39], v[108:111]
s_bitcmp1_b32 s47, 2
s_cbranch_scc1 L_th258
s_waitcnt vmcnt(3)
L_th258:
s_waitcnt vmcnt(8)
buffer_load_dwordx4 v[36:39], v2, s[8:11], s45 offen offset:3072 nt
v_and_b32_dpp v116, v88, v16 row_newbcast:6 row_mask:0xf bank_mask:0xf
v_and_b32_dpp v117, v88, v17 row_newbcast:6 row_mask:0xf bank_mask:0xf
v_and_b32_dpp v118, v88, v18 row_newbcast:6 row_mask:0xf bank_mask:0xf
v_and_b32_dpp v119, v88, v19 row_newbcast:6 row_mask:0xf bank_mask:0xf
s_waitcnt vmcnt(11)
v_mfma_f32_16x16x32_bf16 v[108:111], v[112:115], v[40:43], v[108:111]
s_bitcmp1_b32 s47, 2
s_cbranch_scc1 L_th259
s_waitcnt vmcnt(3)
L_th259:
s_waitcnt vmcnt(8)
s_mov_b32 s45, 0x5000
buffer_load_dwordx4 v[40:43], v2, s[8:11], s45 offen offset:0 nt
v_and_b32_dpp v112, v88, v16 row_newbcast:10 row_mask:0xf bank_mask:0xf
v_and_b32_dpp v113, v88, v17 row_newbcast:10 row_mask:0xf bank_mask:0xf
v_and_b32_dpp v114, v88, v18 row_newbcast:10 row_mask:0xf bank_mask:0xf
v_and_b32_dpp v115, v88, v19 row_newbcast:10 row_mask:0xf bank_mask:0xf
s_waitcnt vmcnt(11)
v_mfma_f32_16x16x32_bf16 v[108:111], v[116:119], v[44:47], v[108:111]
s_bitcmp1_b32 s47, 2
s_cbranch_scc1 L_th260
s_waitcnt vmcnt(3)
L_th260:
s_waitcnt vmcnt(8)
buffer_load_dwordx4 v[44:47], v2, s[8:11], s45 offen offset:1024 nt
v_and_b32_dpp v116, v88, v16 row_newbcast:14 row_mask:0xf bank_mask:0xf
v_and_b32_dpp v117, v88, v17 row_newbcast:14 row_mask:0xf bank_mask:0xf
v_and_b32_dpp v118, v88, v18 row_newbcast:14 row_mask:0xf bank_mask:0xf
v_and_b32_dpp v119, v88, v19 row_newbcast:14 row_mask:0xf bank_mask:0xf
s_waitcnt vmcnt(11)
v_mfma_f32_16x16x32_bf16 v[108:111], v[112:115], v[48:51], v[108:111]
s_bitcmp1_b32 s47, 2
s_cbranch_scc1 L_th261
s_waitcnt vmcnt(3)
L_th261:
s_waitcnt vmcnt(8)
buffer_load_dwordx4 v[48:51], v2, s[8:11], s45 offen offset:2048 nt
v_and_b32_dpp v112, v88, v16 row_newbcast:3 row_mask:0xf bank_mask:0xf
v_and_b32_dpp v113, v88, v17 row_newbcast:3 row_mask:0xf bank_mask:0xf
v_and_b32_dpp v114, v88, v18 row_newbcast:3 row_mask:0xf bank_mask:0xf
v_and_b32_dpp v115, v88, v19 row_newbcast:3 row_mask:0xf bank_mask:0xf
s_waitcnt vmcnt(11)
v_mfma_f32_16x16x32_bf16 v[108:111], v[116:119], v[52:55], v[108:111]
s_bitcmp1_b32 s47, 2
s_cbranch_scc1 L_th262
s_waitcnt vmcnt(3)
L_th262:
s_waitcnt vmcnt(8)
buffer_load_dwordx4 v[52:55], v2, s[8:11], s45 offen offset:3072 nt
v_and_b32_dpp v116, v88, v16 row_newbcast:7 row_mask:0xf bank_mask:0xf
v_and_b32_dpp v117, v88, v17 row_newbcast:7 row_mask:0xf bank_mask:0xf
v_and_b32_dpp v118, v88, v18 row_newbcast:7 row_mask:0xf bank_mask:0xf
v_and_b32_dpp v119, v88, v19 row_newbcast:7 row_mask:0xf bank_mask:0xf
s_waitcnt vmcnt(11)
v_mfma_f32_16x16x32_bf16 v[108:111], v[112:115], v[56:59], v[108:111]
s_bitcmp1_b32 s47, 2
s_cbranch_scc1 L_th263
s_waitcnt vmcnt(3)
L_th263:
s_waitcnt vmcnt(8)
s_mov_b32 s45, 0x6000
buffer_load_dwordx4 v[56:59], v2, s[8:11], s45 offen offset:0 nt
v_and_b32_dpp v112, v88, v16 row_newbcast:11 row_mask:0xf bank_mask:0xf
v_and_b32_dpp v113, v88, v17 row_newbcast:11 row_mask:0xf bank_mask:0xf
v_and_b32_dpp v114, v88, v18 row_newbcast:11 row_mask:0xf bank_mask:0xf
v_and_b32_dpp v115, v88, v19 row_newbcast:11 row_mask:0xf bank_mask:0xf
s_waitcnt vmcnt(11)
v_mfma_f32_16x16x32_bf16 v[108:111], v[116:119], v[60:63], v[108:111]
s_bitcmp1_b32 s47, 2
s_cbranch_scc1 L_th264
s_waitcnt vmcnt(3)
L_th264:
s_waitcnt vmcnt(8)
buffer_load_dwordx4 v[60:63], v2, s[8:11], s45 offen offset:1024 nt
v_and_b32_dpp v116, v88, v16 row_newbcast:15 row_mask:0xf bank_mask:0xf
v_and_b32_dpp v117, v88, v17 row_newbcast:15 row_mask:0xf bank_mask:0xf
v_and_b32_dpp v118, v88, v18 row_newbcast:15 row_mask:0xf bank_mask:0xf
v_and_b32_dpp v119, v88, v19 row_newbcast:15 row_mask:0xf bank_mask:0xf
s_waitcnt vmcnt(11)
v_mfma_f32_16x16x32_bf16 v[108:111], v[112:115], v[64:67], v[108:111]
s_bitcmp1_b32 s47, 2
s_cbranch_scc1 L_th265
s_waitcnt vmcnt(3)
L_th265:
s_waitcnt vmcnt(8)
buffer_load_dwordx4 v[64:67], v2, s[8:11], s45 offen offset:2048 nt
v_and_b32_dpp v112, v89, v16 row_newbcast:0 row_mask:0xf bank_mask:0xf
v_and_b32_dpp v113, v89, v17 row_newbcast:0 row_mask:0xf bank_mask:0xf
v_and_b32_dpp v114, v89, v18 row_newbcast:0 row_mask:0xf bank_mask:0xf
v_and_b32_dpp v115, v89, v19 row_newbcast:0 row_mask:0xf bank_mask:0xf
s_waitcnt vmcnt(11)
v_mfma_f32_16x16x32_bf16 v[108:111], v[116:119], v[68:71], v[108:111]
s_bitcmp1_b32 s47, 2
s_cbranch_scc1 L_th266
s_waitcnt vmcnt(3)
L_th266:
s_waitcnt vmcnt(8)
buffer_load_dwordx4 v[68:71], v2, s[8:11], s45 offen offset:3072 nt
v_and_b32_dpp v116, v89, v16 row_newbcast:4 row_mask:0xf bank_mask:0xf
v_and_b32_dpp v117, v89, v17 row_newbcast:4 row_mask:0xf bank_mask:0xf
v_and_b32_dpp v118, v89, v18 row_newbcast:4 row_mask:0xf bank_mask:0xf
v_and_b32_dpp v119, v89, v19 row_newbcast:4 row_mask:0xf bank_mask:0xf
s_waitcnt vmcnt(11)
v_mfma_f32_16x16x32_bf16 v[108:111], v[112:115], v[24:27], v[108:111]
s_bitcmp1_b32 s47, 2
s_cbranch_scc1 L_th267
s_waitcnt vmcnt(3)
L_th267:
s_waitcnt vmcnt(8)
s_mov_b32 s45, 0x7000
buffer_load_dwordx4 v[24:27], v2, s[8:11], s45 offen offset:0 nt
v_and_b32_dpp v112, v89, v16 row_newbcast:8 row_mask:0xf bank_mask:0xf
v_and_b32_dpp v113, v89, v17 row_newbcast:8 row_mask:0xf bank_mask:0xf
v_and_b32_dpp v114, v89, v18 row_newbcast:8 row_mask:0xf bank_mask:0xf
v_and_b32_dpp v115, v89, v19 row_newbcast:8 row_mask:0xf bank_mask:0xf
s_waitcnt vmcnt(11)
v_mfma_f32_16x16x32_bf16 v[108:111], v[116:119], v[28:31], v[108:111]
s_bitcmp1_b32 s47, 2
s_cbranch_scc1 L_th268
s_waitcnt vmcnt(3)
L_th268:
s_waitcnt vmcnt(8)
buffer_load_dwordx4 v[28:31], v2, s[8:11], s45 offen offset:1024 nt
v_and_b32_dpp v116, v89, v16 row_newbcast:12 row_mask:0xf bank_mask:0xf
v_and_b32_dpp v117, v89, v17 row_newbcast:12 row_mask:0xf bank_mask:0xf
v_and_b32_dpp v118, v89, v18 row_newbcast:12 row_mask:0xf bank_mask:0xf
v_and_b32_dpp v119, v89, v19 row_newbcast:12 row_mask:0xf bank_mask:0xf
s_waitcnt vmcnt(11)
v_mfma_f32_16x16x32_bf16 v[108:111], v[112:115], v[32:35], v[108:111]
s_bitcmp1_b32 s47, 2
s_cbranch_scc1 L_th269
s_waitcnt vmcnt(3)
L_th269:
s_waitcnt vmcnt(8)
buffer_load_dwordx4 v[32:35], v2, s[8:11], s45 offen offset:2048 nt
v_and_b32_dpp v112, v89, v16 row_newbcast:1 row_mask:0xf bank_mask:0xf
v_and_b32_dpp v113, v89, v17 row_newbcast:1 row_mask:0xf bank_mask:0xf
v_and_b32_dpp v114, v89, v18 row_newbcast:1 row_mask:0xf bank_mask:0xf
v_and_b32_dpp v115, v89, v19 row_newbcast:1 row_mask:0xf bank_mask:0xf
s_waitcnt vmcnt(11)
v_mfma_f32_16x16x32_bf16 v[108:111], v[116:119], v[36:39], v[108:111]
s_bitcmp1_b32 s47, 2
s_cbranch_scc1 L_th270
s_waitcnt vmcnt(3)
L_th270:
s_waitcnt vmcnt(8)
buffer_load_dwordx4 v[36:39], v2, s[8:11], s45 offen offset:3072 nt
v_and_b32_dpp v116, v89, v16 row_newbcast:5 row_mask:0xf bank_mask:0xf
v_and_b32_dpp v117, v89, v17 row_newbcast:5 row_mask:0xf bank_mask:0xf
v_and_b32_dpp v118, v89, v18 row_newbcast:5 row_mask:0xf bank_mask:0xf
v_and_b32_dpp v119, v89, v19 row_newbcast:5 row_mask:0xf bank_mask:0xf
s_waitcnt vmcnt(11)
v_mfma_f32_16x16x32_bf16 v[108:111], v[112:115], v[40:43], v[108:111]
s_bitcmp1_b32 s47, 2
s_cbranch_scc1 L_th271
s_waitcnt vmcnt(3)
L_th271:
s_waitcnt vmcnt(8)
s_mov_b32 s45, 0x8000
buffer_load_dwordx4 v[40:43], v2, s[8:11], s45 offen offset:0 nt
v_and_b32_dpp v112, v89, v16 row_newbcast:9 row_mask:0xf bank_mask:0xf
v_and_b32_dpp v113, v89, v17 row_newbcast:9 row_mask:0xf bank_mask:0xf
v_and_b32_dpp v114, v89, v18 row_newbcast:9 row_mask:0xf bank_mask:0xf
v_and_b32_dpp v115, v89, v19 row_newbcast:9 row_mask:0xf bank_mask:0xf
s_waitcnt vmcnt(11)
v_mfma_f32_16x16x32_bf16 v[108:111], v[116:119], v[44:47], v[108:111]
s_bitcmp1_b32 s47, 2
s_cbranch_scc1 L_th272
s_waitcnt vmcnt(3)
L_th272:
s_waitcnt vmcnt(8)
buffer_load_dwordx4 v[44:47], v2, s[8:11], s45 offen offset:1024 nt
v_and_b32_dpp v116, v89, v16 row_newbcast:13 row_mask:0xf bank_mask:0xf
v_and_b32_dpp v117, v89, v17 row_newbcast:13 row_mask:0xf bank_mask:0xf
v_and_b32_dpp v118, v89, v18 row_newbcast:13 row_mask:0xf bank_mask:0xf
v_and_b32_dpp v119, v89, v19 row_newbcast:13 row_mask:0xf bank_mask:0xf
s_waitcnt vmcnt(11)
v_mfma_f32_16x16x32_bf16 v[108:111], v[112:115], v[48:51], v[108:111]
s_bitcmp1_b32 s47, 2
s_cbranch_scc1 L_th273
s_waitcnt vmcnt(3)
L_th273:
s_waitcnt vmcnt(8)
buffer_load_dwordx4 v[48:51], v2, s[8:11], s45 offen offset:2048 nt
v_and_b32_dpp v112, v89, v16 row_newbcast:2 row_mask:0xf bank_mask:0xf
v_and_b32_dpp v113, v89, v17 row_newbcast:2 row_mask:0xf bank_mask:0xf
v_and_b32_dpp v114, v89, v18 row_newbcast:2 row_mask:0xf bank_mask:0xf
v_and_b32_dpp v115, v89, v19 row_newbcast:2 row_mask:0xf bank_mask:0xf
s_waitcnt vmcnt(11)
v_mfma_f32_16x16x32_bf16 v[108:111], v[116:119], v[52:55], v[108:111]
s_bitcmp1_b32 s47, 2
s_cbranch_scc1 L_th274
s_waitcnt vmcnt(3)
L_th274:
s_waitcnt vmcnt(8)
buffer_load_dwordx4 v[52:55], v2, s[8:11], s45 offen offset:3072 nt
v_and_b32_dpp v116, v89, v16 row_newbcast:6 row_mask:0xf bank_mask:0xf
v_and_b32_dpp v117, v89, v17 row_newbcast:6 row_mask:0xf bank_mask:0xf
v_and_b32_dpp v118, v89, v18 row_newbcast:6 row_mask:0xf bank_mask:0xf
v_and_b32_dpp v119, v89, v19 row_newbcast:6 row_mask:0xf bank_mask:0xf
s_waitcnt vmcnt(11)
v_mfma_f32_16x16x32_bf16 v[108:111], v[112:115], v[56:59], v[108:111]
s_bitcmp1_b32 s47, 2
s_cbranch_scc1 L_th275
s_waitcnt vmcnt(3)
L_th275:
s_waitcnt vmcnt(8)
s_mov_b32 s45, 0x9000
buffer_load_dwordx4 v[56:59], v2, s[8:11], s45 offen offset:0 nt
v_and_b32_dpp v112, v89, v16 row_newbcast:10 row_mask:0xf bank_mask:0xf
v_and_b32_dpp v113, v89, v17 row_newbcast:10 row_mask:0xf bank_mask:0xf
v_and_b32_dpp v114, v89, v18 row_newbcast:10 row_mask:0xf bank_mask:0xf
v_and_b32_dpp v115, v89, v19 row_newbcast:10 row_mask:0xf bank_mask:0xf
s_waitcnt vmcnt(11)
v_mfma_f32_16x16x32_bf16 v[108:111], v[116:119], v[60:63], v[108:111]
s_bitcmp1_b32 s47, 2
s_cbranch_scc1 L_th276
s_waitcnt vmcnt(3)
L_th276:
s_waitcnt vmcnt(8)
buffer_load_dwordx4 v[60:63], v2, s[8:11], s45 offen offset:1024 nt
v_and_b32_dpp v116, v89, v16 row_newbcast:14 row_mask:0xf bank_mask:0xf
v_and_b32_dpp v117, v89, v17 row_newbcast:14 row_mask:0xf bank_mask:0xf
v_and_b32_dpp v118, v89, v18 row_newbcast:14 row_mask:0xf bank_mask:0xf
v_and_b32_dpp v119, v89, v19 row_newbcast:14 row_mask:0xf bank_mask:0xf
s_waitcnt vmcnt(11)
v_mfma_f32_16x16x32_bf16 v[108:111], v[112:115], v[64:67], v[108:111]
s_bitcmp1_b32 s47, 2
s_cbranch_scc1 L_th277
s_waitcnt vmcnt(3)
L_th277:
s_waitcnt vmcnt(8)
buffer_load_dwordx4 v[64:67], v2, s[8:11], s45 offen offset:2048 nt
v_and_b32_dpp v112, v89, v16 row_newbcast:3 row_mask:0xf bank_mask:0xf
v_and_b32_dpp v113, v89, v17 row_newbcast:3 row_mask:0xf bank_mask:0xf
v_and_b32_dpp v114, v89, v18 row_newbcast:3 row_mask:0xf bank_mask:0xf
v_and_b32_dpp v115, v89, v19 row_newbcast:3 row_mask:0xf bank_mask:0xf
s_waitcnt vmcnt(11)
v_mfma_f32_16x16x32_bf16 v[108:111], v[116:119], v[68:71], v[108:111]
s_bitcmp1_b32 s47, 2
s_cbranch_scc1 L_th278
s_waitcnt vmcnt(3)
L_th278:
s_waitcnt vmcnt(8)
buffer_load_dwordx4 v[68:71], v2, s[8:11], s45 offen offset:3072 nt
v_and_b32_dpp v116, v89, v16 row_newbcast:7 row_mask:0xf bank_mask:0xf
v_and_b32_dpp v117, v89, v17 row_newbcast:7 row_mask:0xf bank_mask:0xf
v_and_b32_dpp v118, v89, v18 row_newbcast:7 row_mask:0xf bank_mask:0xf
v_and_b32_dpp v119, v89, v19 row_newbcast:7 row_mask:0xf bank_mask:0xf
s_waitcnt vmcnt(11)
v_mfma_f32_16x16x32_bf16 v[108:111], v[112:115], v[24:27], v[108:111]
s_bitcmp1_b32 s47, 2
s_cbranch_scc1 L_th279
s_waitcnt vmcnt(3)
L_th279:
s_waitcnt vmcnt(8)
s_mov_b32 s45, 0xa000
buffer_load_dwordx4 v[24:27], v2, s[8:11], s45 offen offset:0 nt
v_and_b32_dpp v112, v89, v16 row_newbcast:11 row_mask:0xf bank_mask:0xf
v_and_b32_dpp v113, v89, v17 row_newbcast:11 row_mask:0xf bank_mask:0xf
v_and_b32_dpp v114, v89, v18 row_newbcast:11 row_mask:0xf bank_mask:0xf
v_and_b32_dpp v115, v89, v19 row_newbcast:11 row_mask:0xf bank_mask:0xf
s_waitcnt vmcnt(11)
v_mfma_f32_16x16x32_bf16 v[108:111], v[116:119], v[28:31], v[108:111]
s_bitcmp1_b32 s47, 2
s_cbranch_scc1 L_th280
s_waitcnt vmcnt(3)
L_th280:
s_waitcnt vmcnt(8)
buffer_load_dwordx4 v[28:31], v2, s[8:11], s45 offen offset:1024 nt
v_and_b32_dpp v116, v89, v16 row_newbcast:15 row_mask:0xf bank_mask:0xf
v_and_b32_dpp v117, v89, v17 row_newbcast:15 row_mask:0xf bank_mask:0xf
v_and_b32_dpp v118, v89, v18 row_newbcast:15 row_mask:0xf bank_mask:0xf
v_and_b32_dpp v119, v89, v19 row_newbcast:15 row_mask:0xf bank_mask:0xf
s_waitcnt vmcnt(11)
v_mfma_f32_16x16x32_bf16 v[108:111], v[112:115], v[32:35], v[108:111]
s_bitcmp1_b32 s47, 2
s_cbranch_scc1 L_th281
s_waitcnt vmcnt(3)
L_th281:
s_waitcnt vmcnt(8)
buffer_load_dwordx4 v[32:35], v2, s[8:11], s45 offen offset:2048 nt
v_and_b32_dpp v112, v90, v16 row_newbcast:0 row_mask:0xf bank_mask:0xf
v_and_b32_dpp v113, v90, v17 row_newbcast:0 row_mask:0xf bank_mask:0xf
v_and_b32_dpp v114, v90, v18 row_newbcast:0 row_mask:0xf bank_mask:0xf
v_and_b32_dpp v115, v90, v19 row_newbcast:0 row_mask:0xf bank_mask:0xf
s_waitcnt vmcnt(11)
v_mfma_f32_16x16x32_bf16 v[108:111], v[116:119], v[36:39], v[108:111]
s_bitcmp1_b32 s47, 2
s_cbranch_scc1 L_th282
s_waitcnt vmcnt(3)
L_th282:
s_waitcnt vmcnt(8)
buffer_load_dwordx4 v[36:39], v2, s[8:11], s45 offen offset:3072 nt
v_and_b32_dpp v116, v90, v16 row_newbcast:4 row_mask:0xf bank_mask:0xf
v_and_b32_dpp v117, v90, v17 row_newbcast:4 row_mask:0xf bank_mask:0xf
v_and_b32_dpp v118, v90, v18 row_newbcast:4 row_mask:0xf bank_mask:0xf
v_and_b32_dpp v119, v90, v19 row_newbcast:4 row_mask:0xf bank_mask:0xf
s_waitcnt vmcnt(11)
v_mfma_f32_16x16x32_bf16 v[108:111], v[112:115], v[40:43], v[108:111]
s_bitcmp1_b32 s47, 2
s_cbranch_scc1 L_th283
s_waitcnt vmcnt(3)
L_th283:
s_waitcnt vmcnt(8)
s_mov_b32 s45, 0xb000
buffer_load_dwordx4 v[40:43], v2, s[8:11], s45 offen offset:0 nt
v_and_b32_dpp v112, v90, v16 row_newbcast:8 row_mask:0xf bank_mask:0xf
v_and_b32_dpp v113, v90, v17 row_newbcast:8 row_mask:0xf bank_mask:0xf
v_and_b32_dpp v114, v90, v18 row_newbcast:8 row_mask:0xf bank_mask:0xf
v_and_b32_dpp v115, v90, v19 row_newbcast:8 row_mask:0xf bank_mask:0xf
s_waitcnt vmcnt(11)
v_mfma_f32_16x16x32_bf16 v[108:111], v[116:119], v[44:47], v[108:111]
s_bitcmp1_b32 s47, 2
s_cbranch_scc1 L_th284
s_waitcnt vmcnt(3)
L_th284:
s_waitcnt vmcnt(8)
buffer_load_dwordx4 v[44:47], v2, s[8:11], s45 offen offset:1024 nt
v_and_b32_dpp v116, v90, v16 row_newbcast:12 row_mask:0xf bank_mask:0xf
v_and_b32_dpp v117, v90, v17 row_newbcast:12 row_mask:0xf bank_mask:0xf
v_and_b32_dpp v118, v90, v18 row_newbcast:12 row_mask:0xf bank_mask:0xf
v_and_b32_dpp v119, v90, v19 row_newbcast:12 row_mask:0xf bank_mask:0xf
s_waitcnt vmcnt(11)
v_mfma_f32_16x16x32_bf16 v[108:111], v[112:115], v[48:51], v[108:111]
s_bitcmp1_b32 s47, 2
s_cbranch_scc1 L_th285
s_waitcnt vmcnt(3)
L_th285:
s_waitcnt vmcnt(8)
buffer_load_dwordx4 v[48:51], v2, s[8:11], s45 offen offset:2048 nt
v_and_b32_dpp v112, v90, v16 row_newbcast:1 row_mask:0xf bank_mask:0xf
v_and_b32_dpp v113, v90, v17 row_newbcast:1 row_mask:0xf bank_mask:0xf
v_and_b32_dpp v114, v90, v18 row_newbcast:1 row_mask:0xf bank_mask:0xf
v_and_b32_dpp v115, v90, v19 row_newbcast:1 row_mask:0xf bank_mask:0xf
s_waitcnt vmcnt(11)
v_mfma_f32_16x16x32_bf16 v[108:111], v[116:119], v[52:55], v[108:111]
s_bitcmp1_b32 s47, 2
s_cbranch_scc1 L_th286
s_waitcnt vmcnt(3)
L_th286:
s_waitcnt vmcnt(8)
buffer_load_dwordx4 v[52:55], v2, s[8:11], s45 offen offset:3072 nt
v_and_b32_dpp v116, v90, v16 row_newbcast:5 row_mask:0xf bank_mask:0xf
v_and_b32_dpp v117, v90, v17 row_newbcast:5 row_mask:0xf bank_mask:0xf
v_and_b32_dpp v118, v90, v18 row_newbcast:5 row_mask:0xf bank_mask:0xf
v_and_b32_dpp v119, v90, v19 row_newbcast:5 row_mask:0xf bank_mask:0xf
s_waitcnt vmcnt(11)
v_mfma_f32_16x16x32_bf16 v[108:111], v[112:115], v[56:59], v[108:111]
s_bitcmp1_b32 s47, 2
s_cbranch_scc1 L_th287
s_waitcnt vmcnt(3)
L_th287:
s_waitcnt vmcnt(8)
s_mov_b32 s45, 0xc000
buffer_load_dwordx4 v[56:59], v2, s[8:11], s45 offen offset:0 nt
v_and_b32_dpp v112, v90, v16 row_newbcast:9 row_mask:0xf bank_mask:0xf
v_and_b32_dpp v113, v90, v17 row_newbcast:9 row_mask:0xf bank_mask:0xf
v_and_b32_dpp v114, v90, v18 row_newbcast:9 row_mask:0xf bank_mask:0xf
v_and_b32_dpp v115, v90, v19 row_newbcast:9 row_mask:0xf bank_mask:0xf
s_waitcnt vmcnt(11)
v_mfma_f32_16x16x32_bf16 v[108:111], v[116:119], v[60:63], v[108:111]
s_bitcmp1_b32 s47, 2
s_cbranch_scc1 L_th288
s_waitcnt vmcnt(3)
L_th288:
s_waitcnt vmcnt(8)
buffer_load_dwordx4 v[60:63], v2, s[8:11], s45 offen offset:1024 nt
v_and_b32_dpp v116, v90, v16 row_newbcast:13 row_mask:0xf bank_mask:0xf
v_and_b32_dpp v117, v90, v17 row_newbcast:13 row_mask:0xf bank_mask:0xf
v_and_b32_dpp v118, v90, v18 row_newbcast:13 row_mask:0xf bank_mask:0xf
v_and_b32_dpp v119, v90, v19 row_newbcast:13 row_mask:0xf bank_mask:0xf
s_waitcnt vmcnt(11)
v_mfma_f32_16x16x32_bf16 v[108:111], v[112:115], v[64:67], v[108:111]
s_bitcmp1_b32 s47, 2
s_cbranch_scc1 L_th289
s_waitcnt vmcnt(3)
L_th289:
s_waitcnt vmcnt(8)
buffer_load_dwordx4 v[64:67], v2, s[8:11], s45 offen offset:2048 nt
v_and_b32_dpp v112, v90, v16 row_newbcast:2 row_mask:0xf bank_mask:0xf
v_and_b32_dpp v113, v90, v17 row_newbcast:2 row_mask:0xf bank_mask:0xf
v_and_b32_dpp v114, v90, v18 row_newbcast:2 row_mask:0xf bank_mask:0xf
v_and_b32_dpp v115, v90, v19 row_newbcast:2 row_mask:0xf bank_mask:0xf
s_waitcnt vmcnt(11)
v_mfma_f32_16x16x32_bf16 v[108:111], v[116:119], v[68:71], v[108:111]
s_bitcmp1_b32 s47, 2
s_cbranch_scc1 L_th290
s_waitcnt vmcnt(3)
L_th290:
s_waitcnt vmcnt(8)
buffer_load_dwordx4 v[68:71], v2, s[8:11], s45 offen offset:3072 nt
v_and_b32_dpp v116, v90, v16 row_newbcast:6 row_mask:0xf bank_mask:0xf
v_and_b32_dpp v117, v90, v17 row_newbcast:6 row_mask:0xf bank_mask:0xf
v_and_b32_dpp v118, v90, v18 row_newbcast:6 row_mask:0xf bank_mask:0xf
v_and_b32_dpp v119, v90, v19 row_newbcast:6 row_mask:0xf bank_mask:0xf
s_waitcnt vmcnt(11)
v_mfma_f32_16x16x32_bf16 v[108:111], v[112:115], v[24:27], v[108:111]
s_bitcmp1_b32 s47, 2
s_cbranch_scc1 L_th291
s_waitcnt vmcnt(3)
L_th291:
s_waitcnt vmcnt(8)
s_mov_b32 s45, 0xd000
buffer_load_dwordx4 v[24:27], v2, s[8:11], s45 offen offset:0 nt
v_and_b32_dpp v112, v90, v16 row_newbcast:10 row_mask:0xf bank_mask:0xf
v_and_b32_dpp v113, v90, v17 row_newbcast:10 row_mask:0xf bank_mask:0xf
v_and_b32_dpp v114, v90, v18 row_newbcast:10 row_mask:0xf bank_mask:0xf
v_and_b32_dpp v115, v90, v19 row_newbcast:10 row_mask:0xf bank_mask:0xf
s_waitcnt vmcnt(11)
v_mfma_f32_16x16x32_bf16 v[108:111], v[116:119], v[28:31], v[108:111]
s_bitcmp1_b32 s47, 2
s_cbranch_scc1 L_th292
s_waitcnt vmcnt(3)
L_th292:
s_waitcnt vmcnt(8)
buffer_load_dwordx4 v[28:31], v2, s[8:11], s45 offen offset:1024 nt
v_and_b32_dpp v116, v90, v16 row_newbcast:14 row_mask:0xf bank_mask:0xf
v_and_b32_dpp v117, v90, v17 row_newbcast:14 row_mask:0xf bank_mask:0xf
v_and_b32_dpp v118, v90, v18 row_newbcast:14 row_mask:0xf bank_mask:0xf
v_and_b32_dpp v119, v90, v19 row_newbcast:14 row_mask:0xf bank_mask:0xf
s_waitcnt vmcnt(11)
v_mfma_f32_16x16x32_bf16 v[108:111], v[112:115], v[32:35], v[108:111]
s_bitcmp1_b32 s47, 2
s_cbranch_scc1 L_th293
s_waitcnt vmcnt(3)
L_th293:
s_waitcnt vmcnt(8)
buffer_load_dwordx4 v[32:35], v2, s[8:11], s45 offen offset:2048 nt
v_and_b32_dpp v112, v90, v16 row_newbcast:3 row_mask:0xf bank_mask:0xf
v_and_b32_dpp v113, v90, v17 row_newbcast:3 row_mask:0xf bank_mask:0xf
v_and_b32_dpp v114, v90, v18 row_newbcast:3 row_mask:0xf bank_mask:0xf
v_and_b32_dpp v115, v90, v19 row_newbcast:3 row_mask:0xf bank_mask:0xf
s_waitcnt vmcnt(11)
v_mfma_f32_16x16x32_bf16 v[108:111], v[116:119], v[36:39], v[108:111]
s_bitcmp1_b32 s47, 2
s_cbranch_scc1 L_th294
s_waitcnt vmcnt(3)
L_th294:
s_waitcnt vmcnt(8)
buffer_load_dwordx4 v[36:39], v2, s[8:11], s45 offen offset:3072 nt
v_and_b32_dpp v116, v90, v16 row_newbcast:7 row_mask:0xf bank_mask:0xf
v_and_b32_dpp v117, v90, v17 row_newbcast:7 row_mask:0xf bank_mask:0xf
v_and_b32_dpp v118, v90, v18 row_newbcast:7 row_mask:0xf bank_mask:0xf
v_and_b32_dpp v119, v90, v19 row_newbcast:7 row_mask:0xf bank_mask:0xf
s_waitcnt vmcnt(11)
v_mfma_f32_16x16x32_bf16 v[108:111], v[112:115], v[40:43], v[108:111]
s_bitcmp1_b32 s47, 2
s_cbranch_scc1 L_th295
s_waitcnt vmcnt(3)
L_th295:
s_waitcnt vmcnt(8)
s_mov_b32 s45, 0xe000
buffer_load_dwordx4 v[40:43], v2, s[8:11], s45 offen offset:0 nt
v_and_b32_dpp v112, v90, v16 row_newbcast:11 row_mask:0xf bank_mask:0xf
v_and_b32_dpp v113, v90, v17 row_newbcast:11 row_mask:0xf bank_mask:0xf
v_and_b32_dpp v114, v90, v18 row_newbcast:11 row_mask:0xf bank_mask:0xf
v_and_b32_dpp v115, v90, v19 row_newbcast:11 row_mask:0xf bank_mask:0xf
s_waitcnt vmcnt(11)
v_mfma_f32_16x16x32_bf16 v[108:111], v[116:119], v[44:47], v[108:111]
s_bitcmp1_b32 s47, 2
s_cbranch_scc1 L_th296
s_waitcnt vmcnt(3)
L_th296:
s_waitcnt vmcnt(8)
buffer_load_dwordx4 v[44:47], v2, s[8:11], s45 offen offset:1024 nt
v_and_b32_dpp v116, v90, v16 row_newbcast:15 row_mask:0xf bank_mask:0xf
v_and_b32_dpp v117, v90, v17 row_newbcast:15 row_mask:0xf bank_mask:0xf
v_and_b32_dpp v118, v90, v18 row_newbcast:15 row_mask:0xf bank_mask:0xf
v_and_b32_dpp v119, v90, v19 row_newbcast:15 row_mask:0xf bank_mask:0xf
s_waitcnt vmcnt(11)
v_mfma_f32_16x16x32_bf16 v[108:111], v[112:115], v[48:51], v[108:111]
s_bitcmp1_b32 s47, 2
s_cbranch_scc1 L_th297
s_waitcnt vmcnt(3)
L_th297:
s_waitcnt vmcnt(8)
buffer_load_dwordx4 v[48:51], v2, s[8:11], s45 offen offset:2048 nt
v_and_b32_dpp v112, v91, v16 row_newbcast:0 row_mask:0xf bank_mask:0xf
v_and_b32_dpp v113, v91, v17 row_newbcast:0 row_mask:0xf bank_mask:0xf
v_and_b32_dpp v114, v91, v18 row_newbcast:0 row_mask:0xf bank_mask:0xf
v_and_b32_dpp v115, v91, v19 row_newbcast:0 row_mask:0xf bank_mask:0xf
s_waitcnt vmcnt(11)
v_mfma_f32_16x16x32_bf16 v[108:111], v[116:119], v[52:55], v[108:111]
s_bitcmp1_b32 s47, 2
s_cbranch_scc1 L_th298
s_waitcnt vmcnt(3)
L_th298:
s_waitcnt vmcnt(8)
buffer_load_dwordx4 v[52:55], v2, s[8:11], s45 offen offset:3072 nt
v_and_b32_dpp v116, v91, v16 row_newbcast:4 row_mask:0xf bank_mask:0xf
v_and_b32_dpp v117, v91, v17 row_newbcast:4 row_mask:0xf bank_mask:0xf
v_and_b32_dpp v118, v91, v18 row_newbcast:4 row_mask:0xf bank_mask:0xf
v_and_b32_dpp v119, v91, v19 row_newbcast:4 row_mask:0xf bank_mask:0xf
s_waitcnt vmcnt(11)
v_mfma_f32_16x16x32_bf16 v[108:111], v[112:115], v[56:59], v[108:111]
s_bitcmp1_b32 s47, 2
s_cbranch_scc1 L_th299
s_waitcnt vmcnt(3)
L_th299:
s_waitcnt vmcnt(8)
s_mov_b32 s45, 0xf000
buffer_load_dwordx4 v[56:59], v2, s[8:11], s45 offen offset:0 nt
v_and_b32_dpp v112, v91, v16 row_newbcast:8 row_mask:0xf bank_mask:0xf
v_and_b32_dpp v113, v91, v17 row_newbcast:8 row_mask:0xf bank_mask:0xf
v_and_b32_dpp v114, v91, v18 row_newbcast:8 row_mask:0xf bank_mask:0xf
v_and_b32_dpp v115, v91, v19 row_newbcast:8 row_mask:0xf bank_mask:0xf
s_waitcnt vmcnt(11)
v_mfma_f32_16x16x32_bf16 v[108:111], v[116:119], v[60:63], v[108:111]
s_bitcmp1_b32 s47, 2
s_cbranch_scc1 L_th300
s_waitcnt vmcnt(3)
L_th300:
s_waitcnt vmcnt(8)
buffer_load_dwordx4 v[60:63], v2, s[8:11], s45 offen offset:1024 nt
v_and_b32_dpp v116, v91, v16 row_newbcast:12 row_mask:0xf bank_mask:0xf
v_and_b32_dpp v117, v91, v17 row_newbcast:12 row_mask:0xf bank_mask:0xf
v_and_b32_dpp v118, v91, v18 row_newbcast:12 row_mask:0xf bank_mask:0xf
v_and_b32_dpp v119, v91, v19 row_newbcast:12 row_mask:0xf bank_mask:0xf
s_waitcnt vmcnt(11)
v_mfma_f32_16x16x32_bf16 v[108:111], v[112:115], v[64:67], v[108:111]
s_bitcmp1_b32 s47, 2
s_cbranch_scc1 L_th301
s_waitcnt vmcnt(3)
L_th301:
s_waitcnt vmcnt(8)
buffer_load_dwordx4 v[64:67], v2, s[8:11], s45 offen offset:2048 nt
v_and_b32_dpp v112, v91, v16 row_newbcast:1 row_mask:0xf bank_mask:0xf
v_and_b32_dpp v113, v91, v17 row_newbcast:1 row_mask:0xf bank_mask:0xf
v_and_b32_dpp v114, v91, v18 row_newbcast:1 row_mask:0xf bank_mask:0xf
v_and_b32_dpp v115, v91, v19 row_newbcast:1 row_mask:0xf bank_mask:0xf
s_waitcnt vmcnt(11)
v_mfma_f32_16x16x32_bf16 v[108:111], v[116:119], v[68:71], v[108:111]
s_bitcmp1_b32 s47, 2
s_cbranch_scc1 L_th302
s_waitcnt vmcnt(3)
L_th302:
s_waitcnt vmcnt(8)
buffer_load_dwordx4 v[68:71], v2, s[8:11], s45 offen offset:3072 nt
v_and_b32_dpp v116, v91, v16 row_newbcast:5 row_mask:0xf bank_mask:0xf
v_and_b32_dpp v117, v91, v17 row_newbcast:5 row_mask:0xf bank_mask:0xf
v_and_b32_dpp v118, v91, v18 row_newbcast:5 row_mask:0xf bank_mask:0xf
v_and_b32_dpp v119, v91, v19 row_newbcast:5 row_mask:0xf bank_mask:0xf
s_waitcnt vmcnt(11)
v_mfma_f32_16x16x32_bf16 v[108:111], v[112:115], v[24:27], v[108:111]
s_bitcmp1_b32 s47, 2
s_cbranch_scc1 L_th303
s_waitcnt vmcnt(3)
L_th303:
s_waitcnt vmcnt(8)
s_mov_b32 s45, 0x10000
buffer_load_dwordx4 v[24:27], v2, s[8:11], s45 offen offset:0 nt
v_and_b32_dpp v112, v91, v16 row_newbcast:9 row_mask:0xf bank_mask:0xf
v_and_b32_dpp v113, v91, v17 row_newbcast:9 row_mask:0xf bank_mask:0xf
v_and_b32_dpp v114, v91, v18 row_newbcast:9 row_mask:0xf bank_mask:0xf
v_and_b32_dpp v115, v91, v19 row_newbcast:9 row_mask:0xf bank_mask:0xf
s_waitcnt vmcnt(11)
v_mfma_f32_16x16x32_bf16 v[108:111], v[116:119], v[28:31], v[108:111]
s_bitcmp1_b32 s47, 2
s_cbranch_scc1 L_th304
s_waitcnt vmcnt(3)
L_th304:
s_waitcnt vmcnt(8)
buffer_load_dwordx4 v[28:31], v2, s[8:11], s45 offen offset:1024 nt
v_and_b32_dpp v116, v91, v16 row_newbcast:13 row_mask:0xf bank_mask:0xf
v_and_b32_dpp v117, v91, v17 row_newbcast:13 row_mask:0xf bank_mask:0xf
v_and_b32_dpp v118, v91, v18 row_newbcast:13 row_mask:0xf bank_mask:0xf
v_and_b32_dpp v119, v91, v19 row_newbcast:13 row_mask:0xf bank_mask:0xf
s_waitcnt vmcnt(11)
v_mfma_f32_16x16x32_bf16 v[108:111], v[112:115], v[32:35], v[108:111]
s_bitcmp1_b32 s47, 2
s_cbranch_scc1 L_th305
s_waitcnt vmcnt(3)
L_th305:
s_waitcnt vmcnt(8)
buffer_load_dwordx4 v[32:35], v2, s[8:11], s45 offen offset:2048 nt
v_and_b32_dpp v112, v91, v16 row_newbcast:2 row_mask:0xf bank_mask:0xf
v_and_b32_dpp v113, v91, v17 row_newbcast:2 row_mask:0xf bank_mask:0xf
v_and_b32_dpp v114, v91, v18 row_newbcast:2 row_mask:0xf bank_mask:0xf
v_and_b32_dpp v115, v91, v19 row_newbcast:2 row_mask:0xf bank_mask:0xf
s_waitcnt vmcnt(11)
v_mfma_f32_16x16x32_bf16 v[108:111], v[116:119], v[36:39], v[108:111]
s_bitcmp1_b32 s47, 2
s_cbranch_scc1 L_th306
s_waitcnt vmcnt(3)
L_th306:
s_waitcnt vmcnt(8)
buffer_load_dwordx4 v[36:39], v2, s[8:11], s45 offen offset:3072 nt
v_and_b32_dpp v116, v91, v16 row_newbcast:6 row_mask:0xf bank_mask:0xf
v_and_b32_dpp v117, v91, v17 row_newbcast:6 row_mask:0xf bank_mask:0xf
v_and_b32_dpp v118, v91, v18 row_newbcast:6 row_mask:0xf bank_mask:0xf
v_and_b32_dpp v119, v91, v19 row_newbcast:6 row_mask:0xf bank_mask:0xf
s_waitcnt vmcnt(11)
v_mfma_f32_16x16x32_bf16 v[108:111], v[112:115], v[40:43], v[108:111]
s_bitcmp1_b32 s47, 2
s_cbranch_scc1 L_th307
s_waitcnt vmcnt(3)
L_th307:
s_waitcnt vmcnt(8)
s_mov_b32 s45, 0x11000
buffer_load_dwordx4 v[40:43], v2, s[8:11], s45 offen offset:0 nt
v_and_b32_dpp v112, v91, v16 row_newbcast:10 row_mask:0xf bank_mask:0xf
v_and_b32_dpp v113, v91, v17 row_newbcast:10 row_mask:0xf bank_mask:0xf
v_and_b32_dpp v114, v91, v18 row_newbcast:10 row_mask:0xf bank_mask:0xf
v_and_b32_dpp v115, v91, v19 row_newbcast:10 row_mask:0xf bank_mask:0xf
s_waitcnt vmcnt(11)
v_mfma_f32_16x16x32_bf16 v[108:111], v[116:119], v[44:47], v[108:111]
s_bitcmp1_b32 s47, 2
s_cbranch_scc1 L_th308
s_waitcnt vmcnt(3)
L_th308:
s_waitcnt vmcnt(8)
buffer_load_dwordx4 v[44:47], v2, s[8:11], s45 offen offset:1024 nt
v_and_b32_dpp v116, v91, v16 row_newbcast:14 row_mask:0xf bank_mask:0xf
v_and_b32_dpp v117, v91, v17 row_newbcast:14 row_mask:0xf bank_mask:0xf
v_and_b32_dpp v118, v91, v18 row_newbcast:14 row_mask:0xf bank_mask:0xf
v_and_b32_dpp v119, v91, v19 row_newbcast:14 row_mask:0xf bank_mask:0xf
s_waitcnt vmcnt(11)
v_mfma_f32_16x16x32_bf16 v[108:111], v[112:115], v[48:51], v[108:111]
s_bitcmp1_b32 s47, 2
s_cbranch_scc1 L_th309
s_waitcnt vmcnt(3)
L_th309:
s_waitcnt vmcnt(8)
buffer_load_dwordx4 v[48:51], v2, s[8:11], s45 offen offset:2048 nt
v_and_b32_dpp v112, v91, v16 row_newbcast:3 row_mask:0xf bank_mask:0xf
v_and_b32_dpp v113, v91, v17 row_newbcast:3 row_mask:0xf bank_mask:0xf
v_and_b32_dpp v114, v91, v18 row_newbcast:3 row_mask:0xf bank_mask:0xf
v_and_b32_dpp v115, v91, v19 row_newbcast:3 row_mask:0xf bank_mask:0xf
s_waitcnt vmcnt(11)
v_mfma_f32_16x16x32_bf16 v[108:111], v[116:119], v[52:55], v[108:111]
s_bitcmp1_b32 s47, 2
s_cbranch_scc1 L_th310
s_waitcnt vmcnt(3)
L_th310:
s_waitcnt vmcnt(8)
buffer_load_dwordx4 v[52:55], v2, s[8:11], s45 offen offset:3072 nt
v_and_b32_dpp v116, v91, v16 row_newbcast:7 row_mask:0xf bank_mask:0xf
v_and_b32_dpp v117, v91, v17 row_newbcast:7 row_mask:0xf bank_mask:0xf
v_and_b32_dpp v118, v91, v18 row_newbcast:7 row_mask:0xf bank_mask:0xf
v_and_b32_dpp v119, v91, v19 row_newbcast:7 row_mask:0xf bank_mask:0xf
s_waitcnt vmcnt(11)
v_mfma_f32_16x16x32_bf16 v[108:111], v[112:115], v[56:59], v[108:111]
s_bitcmp1_b32 s47, 2
s_cbranch_scc1 L_th311
s_waitcnt vmcnt(3)
L_th311:
s_waitcnt vmcnt(8)
s_mov_b32 s45, 0x12000
buffer_load_dwordx4 v[56:59], v2, s[8:11], s45 offen offset:0 nt
v_and_b32_dpp v112, v91, v16 row_newbcast:11 row_mask:0xf bank_mask:0xf
v_and_b32_dpp v113, v91, v17 row_newbcast:11 row_mask:0xf bank_mask:0xf
v_and_b32_dpp v114, v91, v18 row_newbcast:11 row_mask:0xf bank_mask:0xf
v_and_b32_dpp v115, v91, v19 row_newbcast:11 row_mask:0xf bank_mask:0xf
s_waitcnt vmcnt(11)
v_mfma_f32_16x16x32_bf16 v[108:111], v[116:119], v[60:63], v[108:111]
s_bitcmp1_b32 s47, 2
s_cbranch_scc1 L_th312
s_waitcnt vmcnt(3)
L_th312:
s_waitcnt vmcnt(8)
buffer_load_dwordx4 v[60:63], v2, s[8:11], s45 offen offset:1024 nt
v_and_b32_dpp v116, v91, v16 row_newbcast:15 row_mask:0xf bank_mask:0xf
v_and_b32_dpp v117, v91, v17 row_newbcast:15 row_mask:0xf bank_mask:0xf
v_and_b32_dpp v118, v91, v18 row_newbcast:15 row_mask:0xf bank_mask:0xf
v_and_b32_dpp v119, v91, v19 row_newbcast:15 row_mask:0xf bank_mask:0xf
s_waitcnt vmcnt(11)
v_mfma_f32_16x16x32_bf16 v[108:111], v[112:115], v[64:67], v[108:111]
s_bitcmp1_b32 s47, 2
s_cbranch_scc1 L_th313
s_waitcnt vmcnt(3)
L_th313:
s_waitcnt vmcnt(8)
buffer_load_dwordx4 v[64:67], v2, s[8:11], s45 offen offset:2048 nt
v_and_b32_dpp v112, v92, v16 row_newbcast:0 row_mask:0xf bank_mask:0xf
v_and_b32_dpp v113, v92, v17 row_newbcast:0 row_mask:0xf bank_mask:0xf
v_and_b32_dpp v114, v92, v18 row_newbcast:0 row_mask:0xf bank_mask:0xf
v_and_b32_dpp v115, v92, v19 row_newbcast:0 row_mask:0xf bank_mask:0xf
s_waitcnt vmcnt(11)
v_mfma_f32_16x16x32_bf16 v[108:111], v[116:119], v[68:71], v[108:111]
s_bitcmp1_b32 s47, 2
s_cbranch_scc1 L_th314
s_waitcnt vmcnt(3)
L_th314:
s_waitcnt vmcnt(8)
buffer_load_dwordx4 v[68:71], v2, s[8:11], s45 offen offset:3072 nt
v_and_b32_dpp v116, v92, v16 row_newbcast:4 row_mask:0xf bank_mask:0xf
v_and_b32_dpp v117, v92, v17 row_newbcast:4 row_mask:0xf bank_mask:0xf
v_and_b32_dpp v118, v92, v18 row_newbcast:4 row_mask:0xf bank_mask:0xf
v_and_b32_dpp v119, v92, v19 row_newbcast:4 row_mask:0xf bank_mask:0xf
s_waitcnt vmcnt(11)
v_mfma_f32_16x16x32_bf16 v[108:111], v[112:115], v[24:27], v[108:111]
s_bitcmp1_b32 s47, 2
s_cbranch_scc1 L_th315
s_waitcnt vmcnt(3)
L_th315:
s_waitcnt vmcnt(8)
s_mov_b32 s45, 0x13000
buffer_load_dwordx4 v[24:27], v2, s[8:11], s45 offen offset:0 nt
v_and_b32_dpp v112, v92, v16 row_newbcast:8 row_mask:0xf bank_mask:0xf
v_and_b32_dpp v113, v92, v17 row_newbcast:8 row_mask:0xf bank_mask:0xf
v_and_b32_dpp v114, v92, v18 row_newbcast:8 row_mask:0xf bank_mask:0xf
v_and_b32_dpp v115, v92, v19 row_newbcast:8 row_mask:0xf bank_mask:0xf
s_waitcnt vmcnt(11)
v_mfma_f32_16x16x32_bf16 v[108:111], v[116:119], v[28:31], v[108:111]
s_bitcmp1_b32 s47, 2
s_cbranch_scc1 L_th316
s_waitcnt vmcnt(3)
L_th316:
s_waitcnt vmcnt(8)
buffer_load_dwordx4 v[28:31], v2, s[8:11], s45 offen offset:1024 nt
v_and_b32_dpp v116, v92, v16 row_newbcast:12 row_mask:0xf bank_mask:0xf
v_and_b32_dpp v117, v92, v17 row_newbcast:12 row_mask:0xf bank_mask:0xf
v_and_b32_dpp v118, v92, v18 row_newbcast:12 row_mask:0xf bank_mask:0xf
v_and_b32_dpp v119, v92, v19 row_newbcast:12 row_mask:0xf bank_mask:0xf
s_waitcnt vmcnt(11)
v_mfma_f32_16x16x32_bf16 v[108:111], v[112:115], v[32:35], v[108:111]
s_bitcmp1_b32 s47, 2
s_cbranch_scc1 L_th317
s_waitcnt vmcnt(3)
L_th317:
s_waitcnt vmcnt(8)
buffer_load_dwordx4 v[32:35], v2, s[8:11], s45 offen offset:2048 nt
v_and_b32_dpp v112, v92, v16 row_newbcast:1 row_mask:0xf bank_mask:0xf
v_and_b32_dpp v113, v92, v17 row_newbcast:1 row_mask:0xf bank_mask:0xf
v_and_b32_dpp v114, v92, v18 row_newbcast:1 row_mask:0xf bank_mask:0xf
v_and_b32_dpp v115, v92, v19 row_newbcast:1 row_mask:0xf bank_mask:0xf
s_waitcnt vmcnt(11)
v_mfma_f32_16x16x32_bf16 v[108:111], v[116:119], v[36:39], v[108:111]
s_bitcmp1_b32 s47, 2
s_cbranch_scc1 L_th318
s_waitcnt vmcnt(3)
L_th318:
s_waitcnt vmcnt(8)
buffer_load_dwordx4 v[36:39], v2, s[8:11], s45 offen offset:3072 nt
v_and_b32_dpp v116, v92, v16 row_newbcast:5 row_mask:0xf bank_mask:0xf
v_and_b32_dpp v117, v92, v17 row_newbcast:5 row_mask:0xf bank_mask:0xf
v_and_b32_dpp v118, v92, v18 row_newbcast:5 row_mask:0xf bank_mask:0xf
v_and_b32_dpp v119, v92, v19 row_newbcast:5 row_mask:0xf bank_mask:0xf
s_waitcnt vmcnt(11)
v_mfma_f32_16x16x32_bf16 v[108:111], v[112:115], v[40:43], v[108:111]
s_bitcmp1_b32 s47, 2
s_cbranch_scc1 L_th319
s_waitcnt vmcnt(3)
L_th319:
s_waitcnt vmcnt(8)
s_mov_b32 s45, 0x14000
buffer_load_dwordx4 v[40:43], v2, s[8:11], s45 offen offset:0 nt
v_and_b32_dpp v112, v92, v16 row_newbcast:9 row_mask:0xf bank_mask:0xf
v_and_b32_dpp v113, v92, v17 row_newbcast:9 row_mask:0xf bank_mask:0xf
v_and_b32_dpp v114, v92, v18 row_newbcast:9 row_mask:0xf bank_mask:0xf
v_and_b32_dpp v115, v92, v19 row_newbcast:9 row_mask:0xf bank_mask:0xf
s_waitcnt vmcnt(11)
v_mfma_f32_16x16x32_bf16 v[108:111], v[116:119], v[44:47], v[108:111]
s_bitcmp1_b32 s47, 2
s_cbranch_scc1 L_th320
s_waitcnt vmcnt(3)
L_th320:
s_waitcnt vmcnt(8)
buffer_load_dwordx4 v[44:47], v2, s[8:11], s45 offen offset:1024 nt
v_and_b32_dpp v116, v92, v16 row_newbcast:13 row_mask:0xf bank_mask:0xf
v_and_b32_dpp v117, v92, v17 row_newbcast:13 row_mask:0xf bank_mask:0xf
v_and_b32_dpp v118, v92, v18 row_newbcast:13 row_mask:0xf bank_mask:0xf
v_and_b32_dpp v119, v92, v19 row_newbcast:13 row_mask:0xf bank_mask:0xf
s_waitcnt vmcnt(11)
v_mfma_f32_16x16x32_bf16 v[108:111], v[112:115], v[48:51], v[108:111]
s_bitcmp1_b32 s47, 2
s_cbranch_scc1 L_th321
s_waitcnt vmcnt(3)
L_th321:
s_waitcnt vmcnt(8)
buffer_load_dwordx4 v[48:51], v2, s[8:11], s45 offen offset:2048 nt
v_and_b32_dpp v112, v92, v16 row_newbcast:2 row_mask:0xf bank_mask:0xf
v_and_b32_dpp v113, v92, v17 row_newbcast:2 row_mask:0xf bank_mask:0xf
v_and_b32_dpp v114, v92, v18 row_newbcast:2 row_mask:0xf bank_mask:0xf
v_and_b32_dpp v115, v92, v19 row_newbcast:2 row_mask:0xf bank_mask:0xf
s_waitcnt vmcnt(11)
v_mfma_f32_16x16x32_bf16 v[108:111], v[116:119], v[52:55], v[108:111]
s_bitcmp1_b32 s47, 2
s_cbranch_scc1 L_th322
s_waitcnt vmcnt(3)
L_th322:
s_waitcnt vmcnt(8)
buffer_load_dwordx4 v[52:55], v2, s[8:11], s45 offen offset:3072 nt
v_and_b32_dpp v116, v92, v16 row_newbcast:6 row_mask:0xf bank_mask:0xf
v_and_b32_dpp v117, v92, v17 row_newbcast:6 row_mask:0xf bank_mask:0xf
v_and_b32_dpp v118, v92, v18 row_newbcast:6 row_mask:0xf bank_mask:0xf
v_and_b32_dpp v119, v92, v19 row_newbcast:6 row_mask:0xf bank_mask:0xf
s_waitcnt vmcnt(11)
v_mfma_f32_16x16x32_bf16 v[108:111], v[112:115], v[56:59], v[108:111]
s_bitcmp1_b32 s47, 2
s_cbranch_scc1 L_th323
s_waitcnt vmcnt(3)
L_th323:
s_waitcnt vmcnt(8)
s_mov_b32 s45, 0x15000
buffer_load_dwordx4 v[56:59], v2, s[8:11], s45 offen offset:0 nt
v_and_b32_dpp v112, v92, v16 row_newbcast:10 row_mask:0xf bank_mask:0xf
v_and_b32_dpp v113, v92, v17 row_newbcast:10 row_mask:0xf bank_mask:0xf
v_and_b32_dpp v114, v92, v18 row_newbcast:10 row_mask:0xf bank_mask:0xf
v_and_b32_dpp v115, v92, v19 row_newbcast:10 row_mask:0xf bank_mask:0xf
s_waitcnt vmcnt(11)
v_mfma_f32_16x16x32_bf16 v[108:111], v[116:119], v[60:63], v[108:111]
s_bitcmp1_b32 s47, 2
s_cbranch_scc1 L_th324
s_waitcnt vmcnt(3)
L_th324:
s_waitcnt vmcnt(8)
buffer_load_dwordx4 v[60:63], v2, s[8:11], s45 offen offset:1024 nt
v_and_b32_dpp v116, v92, v16 row_newbcast:14 row_mask:0xf bank_mask:0xf
v_and_b32_dpp v117, v92, v17 row_newbcast:14 row_mask:0xf bank_mask:0xf
v_and_b32_dpp v118, v92, v18 row_newbcast:14 row_mask:0xf bank_mask:0xf
v_and_b32_dpp v119, v92, v19 row_newbcast:14 row_mask:0xf bank_mask:0xf
s_waitcnt vmcnt(11)
v_mfma_f32_16x16x32_bf16 v[108:111], v[112:115], v[64:67], v[108:111]
s_bitcmp1_b32 s47, 2
s_cbranch_scc1 L_th325
s_waitcnt vmcnt(3)
L_th325:
s_waitcnt vmcnt(8)
buffer_load_dwordx4 v[64:67], v2, s[8:11], s45 offen offset:2048 nt
v_and_b32_dpp v112, v92, v16 row_newbcast:3 row_mask:0xf bank_mask:0xf
v_and_b32_dpp v113, v92, v17 row_newbcast:3 row_mask:0xf bank_mask:0xf
v_and_b32_dpp v114, v92, v18 row_newbcast:3 row_mask:0xf bank_mask:0xf
v_and_b32_dpp v115, v92, v19 row_newbcast:3 row_mask:0xf bank_mask:0xf
s_waitcnt vmcnt(11)
v_mfma_f32_16x16x32_bf16 v[108:111], v[116:119], v[68:71], v[108:111]
s_bitcmp1_b32 s47, 2
s_cbranch_scc1 L_th326
s_waitcnt vmcnt(3)
L_th326:
s_waitcnt vmcnt(8)
buffer_load_dwordx4 v[68:71], v2, s[8:11], s45 offen offset:3072 nt
v_and_b32_dpp v116, v92, v16 row_newbcast:7 row_mask:0xf bank_mask:0xf
v_and_b32_dpp v117, v92, v17 row_newbcast:7 row_mask:0xf bank_mask:0xf
v_and_b32_dpp v118, v92, v18 row_newbcast:7 row_mask:0xf bank_mask:0xf
v_and_b32_dpp v119, v92, v19 row_newbcast:7 row_mask:0xf bank_mask:0xf
s_waitcnt vmcnt(11)
v_mfma_f32_16x16x32_bf16 v[108:111], v[112:115], v[24:27], v[108:111]
s_bitcmp1_b32 s47, 2
s_cbranch_scc1 L_th327
s_waitcnt vmcnt(3)
L_th327:
s_waitcnt vmcnt(8)
s_mov_b32 s45, 0x16000
buffer_load_dwordx4 v[24:27], v2, s[8:11], s45 offen offset:0 nt
v_and_b32_dpp v112, v92, v16 row_newbcast:11 row_mask:0xf bank_mask:0xf
v_and_b32_dpp v113, v92, v17 row_newbcast:11 row_mask:0xf bank_mask:0xf
v_and_b32_dpp v114, v92, v18 row_newbcast:11 row_mask:0xf bank_mask:0xf
v_and_b32_dpp v115, v92, v19 row_newbcast:11 row_mask:0xf bank_mask:0xf
s_waitcnt vmcnt(11)
v_mfma_f32_16x16x32_bf16 v[108:111], v[116:119], v[28:31], v[108:111]
s_bitcmp1_b32 s47, 2
s_cbranch_scc1 L_th328
s_waitcnt vmcnt(3)
L_th328:
s_waitcnt vmcnt(8)
buffer_load_dwordx4 v[28:31], v2, s[8:11], s45 offen offset:1024 nt
v_and_b32_dpp v116, v92, v16 row_newbcast:15 row_mask:0xf bank_mask:0xf
v_and_b32_dpp v117, v92, v17 row_newbcast:15 row_mask:0xf bank_mask:0xf
v_and_b32_dpp v118, v92, v18 row_newbcast:15 row_mask:0xf bank_mask:0xf
v_and_b32_dpp v119, v92, v19 row_newbcast:15 row_mask:0xf bank_mask:0xf
s_waitcnt vmcnt(11)
v_mfma_f32_16x16x32_bf16 v[108:111], v[112:115], v[32:35], v[108:111]
s_bitcmp1_b32 s47, 2
s_cbranch_scc1 L_th329
s_waitcnt vmcnt(3)
L_th329:
s_waitcnt vmcnt(8)
buffer_load_dwordx4 v[32:35], v2, s[8:11], s45 offen offset:2048 nt
v_and_b32_dpp v112, v93, v16 row_newbcast:0 row_mask:0xf bank_mask:0xf
v_and_b32_dpp v113, v93, v17 row_newbcast:0 row_mask:0xf bank_mask:0xf
v_and_b32_dpp v114, v93, v18 row_newbcast:0 row_mask:0xf bank_mask:0xf
v_and_b32_dpp v115, v93, v19 row_newbcast:0 row_mask:0xf bank_mask:0xf
s_waitcnt vmcnt(11)
v_mfma_f32_16x16x32_bf16 v[108:111], v[116:119], v[36:39], v[108:111]
s_bitcmp1_b32 s47, 2
s_cbranch_scc1 L_th330
s_waitcnt vmcnt(3)
L_th330:
s_waitcnt vmcnt(8)
buffer_load_dwordx4 v[36:39], v2, s[8:11], s45 offen offset:3072 nt
v_and_b32_dpp v116, v93, v16 row_newbcast:4 row_mask:0xf bank_mask:0xf
v_and_b32_dpp v117, v93, v17 row_newbcast:4 row_mask:0xf bank_mask:0xf
v_and_b32_dpp v118, v93, v18 row_newbcast:4 row_mask:0xf bank_mask:0xf
v_and_b32_dpp v119, v93, v19 row_newbcast:4 row_mask:0xf bank_mask:0xf
s_waitcnt vmcnt(11)
v_mfma_f32_16x16x32_bf16 v[108:111], v[112:115], v[40:43], v[108:111]
s_bitcmp1_b32 s47, 2
s_cbranch_scc1 L_th331
s_waitcnt vmcnt(3)
L_th331:
s_waitcnt vmcnt(8)
s_mov_b32 s45, 0x17000
buffer_load_dwordx4 v[40:43], v2, s[8:11], s45 offen offset:0 nt
v_and_b32_dpp v112, v93, v16 row_newbcast:8 row_mask:0xf bank_mask:0xf
v_and_b32_dpp v113, v93, v17 row_newbcast:8 row_mask:0xf bank_mask:0xf
v_and_b32_dpp v114, v93, v18 row_newbcast:8 row_mask:0xf bank_mask:0xf
v_and_b32_dpp v115, v93, v19 row_newbcast:8 row_mask:0xf bank_mask:0xf
s_waitcnt vmcnt(11)
v_mfma_f32_16x16x32_bf16 v[108:111], v[116:119], v[44:47], v[108:111]
s_bitcmp1_b32 s47, 2
s_cbranch_scc1 L_th332
s_waitcnt vmcnt(3)
L_th332:
s_waitcnt vmcnt(8)
buffer_load_dwordx4 v[44:47], v2, s[8:11], s45 offen offset:1024 nt
v_and_b32_dpp v116, v93, v16 row_newbcast:12 row_mask:0xf bank_mask:0xf
v_and_b32_dpp v117, v93, v17 row_newbcast:12 row_mask:0xf bank_mask:0xf
v_and_b32_dpp v118, v93, v18 row_newbcast:12 row_mask:0xf bank_mask:0xf
v_and_b32_dpp v119, v93, v19 row_newbcast:12 row_mask:0xf bank_mask:0xf
s_waitcnt vmcnt(11)
v_mfma_f32_16x16x32_bf16 v[108:111], v[112:115], v[48:51], v[108:111]
s_bitcmp1_b32 s47, 2
s_cbranch_scc1 L_th333
s_waitcnt vmcnt(3)
L_th333:
s_waitcnt vmcnt(8)
buffer_load_dwordx4 v[48:51], v2, s[8:11], s45 offen offset:2048 nt
v_and_b32_dpp v112, v93, v16 row_newbcast:1 row_mask:0xf bank_mask:0xf
v_and_b32_dpp v113, v93, v17 row_newbcast:1 row_mask:0xf bank_mask:0xf
v_and_b32_dpp v114, v93, v18 row_newbcast:1 row_mask:0xf bank_mask:0xf
v_and_b32_dpp v115, v93, v19 row_newbcast:1 row_mask:0xf bank_mask:0xf
s_waitcnt vmcnt(11)
v_mfma_f32_16x16x32_bf16 v[108:111], v[116:119], v[52:55], v[108:111]
s_bitcmp1_b32 s47, 2
s_cbranch_scc1 L_th334
s_waitcnt vmcnt(3)
L_th334:
s_waitcnt vmcnt(8)
buffer_load_dwordx4 v[52:55], v2, s[8:11], s45 offen offset:3072 nt
v_and_b32_dpp v116, v93, v16 row_newbcast:5 row_mask:0xf bank_mask:0xf
v_and_b32_dpp v117, v93, v17 row_newbcast:5 row_mask:0xf bank_mask:0xf
v_and_b32_dpp v118, v93, v18 row_newbcast:5 row_mask:0xf bank_mask:0xf
v_and_b32_dpp v119, v93, v19 row_newbcast:5 row_mask:0xf bank_mask:0xf
s_waitcnt vmcnt(11)
v_mfma_f32_16x16x32_bf16 v[108:111], v[112:115], v[56:59], v[108:111]
s_bitcmp1_b32 s47, 2
s_cbranch_scc1 L_th335
s_waitcnt vmcnt(3)
L_th335:
s_waitcnt vmcnt(8)
s_mov_b32 s45, 0x18000
buffer_load_dwordx4 v[56:59], v2, s[8:11], s45 offen offset:0 nt
v_and_b32_dpp v112, v93, v16 row_newbcast:9 row_mask:0xf bank_mask:0xf
v_and_b32_dpp v113, v93, v17 row_newbcast:9 row_mask:0xf bank_mask:0xf
v_and_b32_dpp v114, v93, v18 row_newbcast:9 row_mask:0xf bank_mask:0xf
v_and_b32_dpp v115, v93, v19 row_newbcast:9 row_mask:0xf bank_mask:0xf
s_waitcnt vmcnt(11)
v_mfma_f32_16x16x32_bf16 v[108:111], v[116:119], v[60:63], v[108:111]
s_bitcmp1_b32 s47, 2
s_cbranch_scc1 L_th336
s_waitcnt vmcnt(3)
L_th336:
s_waitcnt vmcnt(8)
buffer_load_dwordx4 v[60:63], v2, s[8:11], s45 offen offset:1024 nt
v_and_b32_dpp v116, v93, v16 row_newbcast:13 row_mask:0xf bank_mask:0xf
v_and_b32_dpp v117, v93, v17 row_newbcast:13 row_mask:0xf bank_mask:0xf
v_and_b32_dpp v118, v93, v18 row_newbcast:13 row_mask:0xf bank_mask:0xf
v_and_b32_dpp v119, v93, v19 row_newbcast:13 row_mask:0xf bank_mask:0xf
s_waitcnt vmcnt(11)
v_mfma_f32_16x16x32_bf16 v[108:111], v[112:115], v[64:67], v[108:111]
s_bitcmp1_b32 s47, 2
s_cbranch_scc1 L_th337
s_waitcnt vmcnt(3)
L_th337:
s_waitcnt vmcnt(8)
buffer_load_dwordx4 v[64:67], v2, s[8:11], s45 offen offset:2048 nt
v_and_b32_dpp v112, v93, v16 row_newbcast:2 row_mask:0xf bank_mask:0xf
v_and_b32_dpp v113, v93, v17 row_newbcast:2 row_mask:0xf bank_mask:0xf
v_and_b32_dpp v114, v93, v18 row_newbcast:2 row_mask:0xf bank_mask:0xf
v_and_b32_dpp v115, v93, v19 row_newbcast:2 row_mask:0xf bank_mask:0xf
s_waitcnt vmcnt(11)
v_mfma_f32_16x16x32_bf16 v[108:111], v[116:119], v[68:71], v[108:111]
s_bitcmp1_b32 s47, 2
s_cbranch_scc1 L_th338
s_waitcnt vmcnt(3)
L_th338:
s_waitcnt vmcnt(8)
buffer_load_dwordx4 v[68:71], v2, s[8:11], s45 offen offset:3072 nt
v_and_b32_dpp v116, v93, v16 row_newbcast:6 row_mask:0xf bank_mask:0xf
v_and_b32_dpp v117, v93, v17 row_newbcast:6 row_mask:0xf bank_mask:0xf
v_and_b32_dpp v118, v93, v18 row_newbcast:6 row_mask:0xf bank_mask:0xf
v_and_b32_dpp v119, v93, v19 row_newbcast:6 row_mask:0xf bank_mask:0xf
s_waitcnt vmcnt(11)
v_mfma_f32_16x16x32_bf16 v[108:111], v[112:115], v[24:27], v[108:111]
s_bitcmp1_b32 s47, 2
s_cbranch_scc1 L_th339
s_waitcnt vmcnt(3)
L_th339:
s_waitcnt vmcnt(8)
s_mov_b32 s45, 0x19000
buffer_load_dwordx4 v[24:27], v2, s[8:11], s45 offen offset:0 nt
v_and_b32_dpp v112, v93, v16 row_newbcast:10 row_mask:0xf bank_mask:0xf
v_and_b32_dpp v113, v93, v17 row_newbcast:10 row_mask:0xf bank_mask:0xf
v_and_b32_dpp v114, v93, v18 row_newbcast:10 row_mask:0xf bank_mask:0xf
v_and_b32_dpp v115, v93, v19 row_newbcast:10 row_mask:0xf bank_mask:0xf
s_waitcnt vmcnt(11)
v_mfma_f32_16x16x32_bf16 v[108:111], v[116:119], v[28:31], v[108:111]
s_bitcmp1_b32 s47, 2
s_cbranch_scc1 L_th340
s_waitcnt vmcnt(3)
L_th340:
s_waitcnt vmcnt(8)
buffer_load_dwordx4 v[28:31], v2, s[8:11], s45 offen offset:1024 nt
v_and_b32_dpp v116, v93, v16 row_newbcast:14 row_mask:0xf bank_mask:0xf
v_and_b32_dpp v117, v93, v17 row_newbcast:14 row_mask:0xf bank_mask:0xf
v_and_b32_dpp v118, v93, v18 row_newbcast:14 row_mask:0xf bank_mask:0xf
v_and_b32_dpp v119, v93, v19 row_newbcast:14 row_mask:0xf bank_mask:0xf
s_waitcnt vmcnt(11)
v_mfma_f32_16x16x32_bf16 v[108:111], v[112:115], v[32:35], v[108:111]
s_bitcmp1_b32 s47, 2
s_cbranch_scc1 L_th341
s_waitcnt vmcnt(3)
L_th341:
s_waitcnt vmcnt(8)
buffer_load_dwordx4 v[32:35], v2, s[8:11], s45 offen offset:2048 nt
v_and_b32_dpp v112, v93, v16 row_newbcast:3 row_mask:0xf bank_mask:0xf
v_and_b32_dpp v113, v93, v17 row_newbcast:3 row_mask:0xf bank_mask:0xf
v_and_b32_dpp v114, v93, v18 row_newbcast:3 row_mask:0xf bank_mask:0xf
v_and_b32_dpp v115, v93, v19 row_newbcast:3 row_mask:0xf bank_mask:0xf
s_waitcnt vmcnt(11)
v_mfma_f32_16x16x32_bf16 v[108:111], v[116:119], v[36:39], v[108:111]
s_bitcmp1_b32 s47, 2
s_cbranch_scc1 L_th342
s_waitcnt vmcnt(3)
L_th342:
s_waitcnt vmcnt(8)
buffer_load_dwordx4 v[36:39], v2, s[8:11], s45 offen offset:3072 nt
v_and_b32_dpp v116, v93, v16 row_newbcast:7 row_mask:0xf bank_mask:0xf
v_and_b32_dpp v117, v93, v17 row_newbcast:7 row_mask:0xf bank_mask:0xf
v_and_b32_dpp v118, v93, v18 row_newbcast:7 row_mask:0xf bank_mask:0xf
v_and_b32_dpp v119, v93, v19 row_newbcast:7 row_mask:0xf bank_mask:0xf
s_waitcnt vmcnt(11)
v_mfma_f32_16x16x32_bf16 v[108:111], v[112:115], v[40:43], v[108:111]
s_bitcmp1_b32 s47, 2
s_cbranch_scc1 L_th343
s_waitcnt vmcnt(3)
L_th343:
s_waitcnt vmcnt(8)
s_mov_b32 s45, 0x1a000
buffer_load_dwordx4 v[40:43], v2, s[8:11], s45 offen offset:0 nt
v_and_b32_dpp v112, v93, v16 row_newbcast:11 row_mask:0xf bank_mask:0xf
v_and_b32_dpp v113, v93, v17 row_newbcast:11 row_mask:0xf bank_mask:0xf
v_and_b32_dpp v114, v93, v18 row_newbcast:11 row_mask:0xf bank_mask:0xf
v_and_b32_dpp v115, v93, v19 row_newbcast:11 row_mask:0xf bank_mask:0xf
s_waitcnt vmcnt(11)
v_mfma_f32_16x16x32_bf16 v[108:111], v[116:119], v[44:47], v[108:111]
s_bitcmp1_b32 s47, 2
s_cbranch_scc1 L_th344
s_waitcnt vmcnt(3)
L_th344:
s_waitcnt vmcnt(8)
buffer_load_dwordx4 v[44:47], v2, s[8:11], s45 offen offset:1024 nt
v_and_b32_dpp v116, v93, v16 row_newbcast:15 row_mask:0xf bank_mask:0xf
v_and_b32_dpp v117, v93, v17 row_newbcast:15 row_mask:0xf bank_mask:0xf
v_and_b32_dpp v118, v93, v18 row_newbcast:15 row_mask:0xf bank_mask:0xf
v_and_b32_dpp v119, v93, v19 row_newbcast:15 row_mask:0xf bank_mask:0xf
s_waitcnt vmcnt(11)
v_mfma_f32_16x16x32_bf16 v[108:111], v[112:115], v[48:51], v[108:111]
s_bitcmp1_b32 s47, 2
s_cbranch_scc1 L_th345
s_waitcnt vmcnt(3)
L_th345:
s_waitcnt vmcnt(8)
buffer_load_dwordx4 v[48:51], v2, s[8:11], s45 offen offset:2048 nt
v_and_b32_dpp v112, v94, v16 row_newbcast:0 row_mask:0xf bank_mask:0xf
v_and_b32_dpp v113, v94, v17 row_newbcast:0 row_mask:0xf bank_mask:0xf
v_and_b32_dpp v114, v94, v18 row_newbcast:0 row_mask:0xf bank_mask:0xf
v_and_b32_dpp v115, v94, v19 row_newbcast:0 row_mask:0xf bank_mask:0xf
s_waitcnt vmcnt(11)
v_mfma_f32_16x16x32_bf16 v[108:111], v[116:119], v[52:55], v[108:111]
s_bitcmp1_b32 s47, 2
s_cbranch_scc1 L_th346
s_waitcnt vmcnt(3)
L_th346:
s_waitcnt vmcnt(8)
buffer_load_dwordx4 v[52:55], v2, s[8:11], s45 offen offset:3072 nt
v_and_b32_dpp v116, v94, v16 row_newbcast:4 row_mask:0xf bank_mask:0xf
v_and_b32_dpp v117, v94, v17 row_newbcast:4 row_mask:0xf bank_mask:0xf
v_and_b32_dpp v118, v94, v18 row_newbcast:4 row_mask:0xf bank_mask:0xf
v_and_b32_dpp v119, v94, v19 row_newbcast:4 row_mask:0xf bank_mask:0xf
s_waitcnt vmcnt(11)
v_mfma_f32_16x16x32_bf16 v[108:111], v[112:115], v[56:59], v[108:111]
s_bitcmp1_b32 s47, 2
s_cbranch_scc1 L_th347
s_waitcnt vmcnt(3)
L_th347:
s_waitcnt vmcnt(8)
s_mov_b32 s45, 0x1b000
buffer_load_dwordx4 v[56:59], v2, s[8:11], s45 offen offset:0 nt
v_and_b32_dpp v112, v94, v16 row_newbcast:8 row_mask:0xf bank_mask:0xf
v_and_b32_dpp v113, v94, v17 row_newbcast:8 row_mask:0xf bank_mask:0xf
v_and_b32_dpp v114, v94, v18 row_newbcast:8 row_mask:0xf bank_mask:0xf
v_and_b32_dpp v115, v94, v19 row_newbcast:8 row_mask:0xf bank_mask:0xf
s_waitcnt vmcnt(11)
v_mfma_f32_16x16x32_bf16 v[108:111], v[116:119], v[60:63], v[108:111]
s_bitcmp1_b32 s47, 2
s_cbranch_scc1 L_th348
s_waitcnt vmcnt(3)
L_th348:
s_waitcnt vmcnt(8)
buffer_load_dwordx4 v[60:63], v2, s[8:11], s45 offen offset:1024 nt
v_and_b32_dpp v116, v94, v16 row_newbcast:12 row_mask:0xf bank_mask:0xf
v_and_b32_dpp v117, v94, v17 row_newbcast:12 row_mask:0xf bank_mask:0xf
v_and_b32_dpp v118, v94, v18 row_newbcast:12 row_mask:0xf bank_mask:0xf
v_and_b32_dpp v119, v94, v19 row_newbcast:12 row_mask:0xf bank_mask:0xf
s_waitcnt vmcnt(11)
v_mfma_f32_16x16x32_bf16 v[108:111], v[112:115], v[64:67], v[108:111]
s_bitcmp1_b32 s47, 2
s_cbranch_scc1 L_th349
s_waitcnt vmcnt(3)
L_th349:
s_waitcnt vmcnt(8)
buffer_load_dwordx4 v[64:67], v2, s[8:11], s45 offen offset:2048 nt
v_and_b32_dpp v112, v94, v16 row_newbcast:1 row_mask:0xf bank_mask:0xf
v_and_b32_dpp v113, v94, v17 row_newbcast:1 row_mask:0xf bank_mask:0xf
v_and_b32_dpp v114, v94, v18 row_newbcast:1 row_mask:0xf bank_mask:0xf
v_and_b32_dpp v115, v94, v19 row_newbcast:1 row_mask:0xf bank_mask:0xf
s_waitcnt vmcnt(11)
v_mfma_f32_16x16x32_bf16 v[108:111], v[116:119], v[68:71], v[108:111]
s_bitcmp1_b32 s47, 2
s_cbranch_scc1 L_th350
s_waitcnt vmcnt(3)
L_th350:
s_waitcnt vmcnt(8)
buffer_load_dwordx4 v[68:71], v2, s[8:11], s45 offen offset:3072 nt
v_and_b32_dpp v116, v94, v16 row_newbcast:5 row_mask:0xf bank_mask:0xf
v_and_b32_dpp v117, v94, v17 row_newbcast:5 row_mask:0xf bank_mask:0xf
v_and_b32_dpp v118, v94, v18 row_newbcast:5 row_mask:0xf bank_mask:0xf
v_and_b32_dpp v119, v94, v19 row_newbcast:5 row_mask:0xf bank_mask:0xf
s_waitcnt vmcnt(11)
v_mfma_f32_16x16x32_bf16 v[108:111], v[112:115], v[24:27], v[108:111]
s_bitcmp1_b32 s47, 2
s_cbranch_scc1 L_th351
s_waitcnt vmcnt(3)
L_th351:
s_waitcnt vmcnt(8)
s_mov_b32 s45, 0x1c000
buffer_load_dwordx4 v[24:27], v2, s[8:11], s45 offen offset:0 nt
v_and_b32_dpp v112, v94, v16 row_newbcast:9 row_mask:0xf bank_mask:0xf
v_and_b32_dpp v113, v94, v17 row_newbcast:9 row_mask:0xf bank_mask:0xf
v_and_b32_dpp v114, v94, v18 row_newbcast:9 row_mask:0xf bank_mask:0xf
v_and_b32_dpp v115, v94, v19 row_newbcast:9 row_mask:0xf bank_mask:0xf
s_waitcnt vmcnt(11)
v_mfma_f32_16x16x32_bf16 v[108:111], v[116:119], v[28:31], v[108:111]
s_bitcmp1_b32 s47, 2
s_cbranch_scc1 L_th352
s_waitcnt vmcnt(3)
L_th352:
s_waitcnt vmcnt(8)
buffer_load_dwordx4 v[28:31], v2, s[8:11], s45 offen offset:1024 nt
v_and_b32_dpp v116, v94, v16 row_newbcast:13 row_mask:0xf bank_mask:0xf
v_and_b32_dpp v117, v94, v17 row_newbcast:13 row_mask:0xf bank_mask:0xf
v_and_b32_dpp v118, v94, v18 row_newbcast:13 row_mask:0xf bank_mask:0xf
v_and_b32_dpp v119, v94, v19 row_newbcast:13 row_mask:0xf bank_mask:0xf
s_waitcnt vmcnt(11)
v_mfma_f32_16x16x32_bf16 v[108:111], v[112:115], v[32:35], v[108:111]
s_bitcmp1_b32 s47, 2
s_cbranch_scc1 L_th353
s_waitcnt vmcnt(3)
L_th353:
s_waitcnt vmcnt(8)
buffer_load_dwordx4 v[32:35], v2, s[8:11], s45 offen offset:2048 nt
v_and_b32_dpp v112, v94, v16 row_newbcast:2 row_mask:0xf bank_mask:0xf
v_and_b32_dpp v113, v94, v17 row_newbcast:2 row_mask:0xf bank_mask:0xf
v_and_b32_dpp v114, v94, v18 row_newbcast:2 row_mask:0xf bank_mask:0xf
v_and_b32_dpp v115, v94, v19 row_newbcast:2 row_mask:0xf bank_mask:0xf
s_waitcnt vmcnt(11)
v_mfma_f32_16x16x32_bf16 v[108:111], v[116:119], v[36:39], v[108:111]
s_bitcmp1_b32 s47, 2
s_cbranch_scc1 L_th354
s_waitcnt vmcnt(3)
L_th354:
s_waitcnt vmcnt(8)
buffer_load_dwordx4 v[36:39], v2, s[8:11], s45 offen offset:3072 nt
v_and_b32_dpp v116, v94, v16 row_newbcast:6 row_mask:0xf bank_mask:0xf
v_and_b32_dpp v117, v94, v17 row_newbcast:6 row_mask:0xf bank_mask:0xf
v_and_b32_dpp v118, v94, v18 row_newbcast:6 row_mask:0xf bank_mask:0xf
v_and_b32_dpp v119, v94, v19 row_newbcast:6 row_mask:0xf bank_mask:0xf
s_waitcnt vmcnt(11)
v_mfma_f32_16x16x32_bf16 v[108:111], v[112:115], v[40:43], v[108:111]
s_bitcmp1_b32 s47, 2
s_cbranch_scc1 L_th355
s_waitcnt vmcnt(3)
L_th355:
s_waitcnt vmcnt(8)
s_mov_b32 s45, 0x1d000
buffer_load_dwordx4 v[40:43], v2, s[8:11], s45 offen offset:0 nt
v_and_b32_dpp v112, v94, v16 row_newbcast:10 row_mask:0xf bank_mask:0xf
v_and_b32_dpp v113, v94, v17 row_newbcast:10 row_mask:0xf bank_mask:0xf
v_and_b32_dpp v114, v94, v18 row_newbcast:10 row_mask:0xf bank_mask:0xf
v_and_b32_dpp v115, v94, v19 row_newbcast:10 row_mask:0xf bank_mask:0xf
s_waitcnt vmcnt(11)
v_mfma_f32_16x16x32_bf16 v[108:111], v[116:119], v[44:47], v[108:111]
s_bitcmp1_b32 s47, 2
s_cbranch_scc1 L_th356
s_waitcnt vmcnt(3)
L_th356:
s_waitcnt vmcnt(8)
buffer_load_dwordx4 v[44:47], v2, s[8:11], s45 offen offset:1024 nt
v_and_b32_dpp v116, v94, v16 row_newbcast:14 row_mask:0xf bank_mask:0xf
v_and_b32_dpp v117, v94, v17 row_newbcast:14 row_mask:0xf bank_mask:0xf
v_and_b32_dpp v118, v94, v18 row_newbcast:14 row_mask:0xf bank_mask:0xf
v_and_b32_dpp v119, v94, v19 row_newbcast:14 row_mask:0xf bank_mask:0xf
s_waitcnt vmcnt(11)
v_mfma_f32_16x16x32_bf16 v[108:111], v[112:115], v[48:51], v[108:111]
s_bitcmp1_b32 s47, 2
s_cbranch_scc1 L_th357
s_waitcnt vmcnt(3)
L_th357:
s_waitcnt vmcnt(8)
buffer_load_dwordx4 v[48:51], v2, s[8:11], s45 offen offset:2048 nt
v_and_b32_dpp v112, v94, v16 row_newbcast:3 row_mask:0xf bank_mask:0xf
v_and_b32_dpp v113, v94, v17 row_newbcast:3 row_mask:0xf bank_mask:0xf
v_and_b32_dpp v114, v94, v18 row_newbcast:3 row_mask:0xf bank_mask:0xf
v_and_b32_dpp v115, v94, v19 row_newbcast:3 row_mask:0xf bank_mask:0xf
s_waitcnt vmcnt(11)
v_mfma_f32_16x16x32_bf16 v[108:111], v[116:119], v[52:55], v[108:111]
s_bitcmp1_b32 s47, 2
s_cbranch_scc1 L_th358
s_waitcnt vmcnt(3)
L_th358:
s_waitcnt vmcnt(8)
buffer_load_dwordx4 v[52:55], v2, s[8:11], s45 offen offset:3072 nt
v_and_b32_dpp v116, v94, v16 row_newbcast:7 row_mask:0xf bank_mask:0xf
v_and_b32_dpp v117, v94, v17 row_newbcast:7 row_mask:0xf bank_mask:0xf
v_and_b32_dpp v118, v94, v18 row_newbcast:7 row_mask:0xf bank_mask:0xf
v_and_b32_dpp v119, v94, v19 row_newbcast:7 row_mask:0xf bank_mask:0xf
s_waitcnt vmcnt(11)
v_mfma_f32_16x16x32_bf16 v[108:111], v[112:115], v[56:59], v[108:111]
s_bitcmp1_b32 s47, 2
s_cbranch_scc1 L_th359
s_waitcnt vmcnt(3)
L_th359:
s_waitcnt vmcnt(8)
s_mov_b32 s45, 0x1e000
buffer_load_dwordx4 v[56:59], v2, s[8:11], s45 offen offset:0 nt
v_and_b32_dpp v112, v94, v16 row_newbcast:11 row_mask:0xf bank_mask:0xf
v_and_b32_dpp v113, v94, v17 row_newbcast:11 row_mask:0xf bank_mask:0xf
v_and_b32_dpp v114, v94, v18 row_newbcast:11 row_mask:0xf bank_mask:0xf
v_and_b32_dpp v115, v94, v19 row_newbcast:11 row_mask:0xf bank_mask:0xf
s_waitcnt vmcnt(11)
v_mfma_f32_16x16x32_bf16 v[108:111], v[116:119], v[60:63], v[108:111]
s_bitcmp1_b32 s47, 2
s_cbranch_scc1 L_th360
s_waitcnt vmcnt(3)
L_th360:
s_waitcnt vmcnt(8)
buffer_load_dwordx4 v[60:63], v2, s[8:11], s45 offen offset:1024 nt
v_and_b32_dpp v116, v94, v16 row_newbcast:15 row_mask:0xf bank_mask:0xf
v_and_b32_dpp v117, v94, v17 row_newbcast:15 row_mask:0xf bank_mask:0xf
v_and_b32_dpp v118, v94, v18 row_newbcast:15 row_mask:0xf bank_mask:0xf
v_and_b32_dpp v119, v94, v19 row_newbcast:15 row_mask:0xf bank_mask:0xf
s_waitcnt vmcnt(11)
v_mfma_f32_16x16x32_bf16 v[108:111], v[112:115], v[64:67], v[108:111]
s_bitcmp1_b32 s47, 2
s_cbranch_scc1 L_th361
s_waitcnt vmcnt(3)
L_th361:
s_waitcnt vmcnt(8)
buffer_load_dwordx4 v[64:67], v2, s[8:11], s45 offen offset:2048 nt
v_and_b32_dpp v112, v95, v16 row_newbcast:0 row_mask:0xf bank_mask:0xf
v_and_b32_dpp v113, v95, v17 row_newbcast:0 row_mask:0xf bank_mask:0xf
v_and_b32_dpp v114, v95, v18 row_newbcast:0 row_mask:0xf bank_mask:0xf
v_and_b32_dpp v115, v95, v19 row_newbcast:0 row_mask:0xf bank_mask:0xf
s_waitcnt vmcnt(11)
v_mfma_f32_16x16x32_bf16 v[108:111], v[116:119], v[68:71], v[108:111]
s_bitcmp1_b32 s47, 2
s_cbranch_scc1 L_th362
s_waitcnt vmcnt(3)
L_th362:
s_waitcnt vmcnt(8)
buffer_load_dwordx4 v[68:71], v2, s[8:11], s45 offen offset:3072 nt
v_and_b32_dpp v116, v95, v16 row_newbcast:4 row_mask:0xf bank_mask:0xf
v_and_b32_dpp v117, v95, v17 row_newbcast:4 row_mask:0xf bank_mask:0xf
v_and_b32_dpp v118, v95, v18 row_newbcast:4 row_mask:0xf bank_mask:0xf
v_and_b32_dpp v119, v95, v19 row_newbcast:4 row_mask:0xf bank_mask:0xf
s_waitcnt vmcnt(11)
v_mfma_f32_16x16x32_bf16 v[108:111], v[112:115], v[24:27], v[108:111]
s_bitcmp1_b32 s47, 2
s_cbranch_scc1 L_th363
s_waitcnt vmcnt(3)
L_th363:
s_waitcnt vmcnt(8)
s_mov_b32 s45, 0x1f000
buffer_load_dwordx4 v[24:27], v2, s[8:11], s45 offen offset:0 nt
v_and_b32_dpp v112, v95, v16 row_newbcast:8 row_mask:0xf bank_mask:0xf
v_and_b32_dpp v113, v95, v17 row_newbcast:8 row_mask:0xf bank_mask:0xf
v_and_b32_dpp v114, v95, v18 row_newbcast:8 row_mask:0xf bank_mask:0xf
v_and_b32_dpp v115, v95, v19 row_newbcast:8 row_mask:0xf bank_mask:0xf
s_waitcnt vmcnt(11)
v_mfma_f32_16x16x32_bf16 v[108:111], v[116:119], v[28:31], v[108:111]
s_bitcmp1_b32 s47, 2
s_cbranch_scc1 L_th364
s_waitcnt vmcnt(3)
L_th364:
s_waitcnt vmcnt(8)
buffer_load_dwordx4 v[28:31], v2, s[8:11], s45 offen offset:1024 nt
v_and_b32_dpp v116, v95, v16 row_newbcast:12 row_mask:0xf bank_mask:0xf
v_and_b32_dpp v117, v95, v17 row_newbcast:12 row_mask:0xf bank_mask:0xf
v_and_b32_dpp v118, v95, v18 row_newbcast:12 row_mask:0xf bank_mask:0xf
v_and_b32_dpp v119, v95, v19 row_newbcast:12 row_mask:0xf bank_mask:0xf
s_waitcnt vmcnt(11)
v_mfma_f32_16x16x32_bf16 v[108:111], v[112:115], v[32:35], v[108:111]
s_bitcmp1_b32 s47, 2
s_cbranch_scc1 L_th365
s_waitcnt vmcnt(3)
L_th365:
s_waitcnt vmcnt(8)
buffer_load_dwordx4 v[32:35], v2, s[8:11], s45 offen offset:2048 nt
v_and_b32_dpp v112, v95, v16 row_newbcast:1 row_mask:0xf bank_mask:0xf
v_and_b32_dpp v113, v95, v17 row_newbcast:1 row_mask:0xf bank_mask:0xf
v_and_b32_dpp v114, v95, v18 row_newbcast:1 row_mask:0xf bank_mask:0xf
v_and_b32_dpp v115, v95, v19 row_newbcast:1 row_mask:0xf bank_mask:0xf
s_waitcnt vmcnt(11)
v_mfma_f32_16x16x32_bf16 v[108:111], v[116:119], v[36:39], v[108:111]
s_bitcmp1_b32 s47, 2
s_cbranch_scc1 L_th366
s_waitcnt vmcnt(3)
L_th366:
s_waitcnt vmcnt(8)
buffer_load_dwordx4 v[36:39], v2, s[8:11], s45 offen offset:3072 nt
v_and_b32_dpp v116, v95, v16 row_newbcast:5 row_mask:0xf bank_mask:0xf
v_and_b32_dpp v117, v95, v17 row_newbcast:5 row_mask:0xf bank_mask:0xf
v_and_b32_dpp v118, v95, v18 row_newbcast:5 row_mask:0xf bank_mask:0xf
v_and_b32_dpp v119, v95, v19 row_newbcast:5 row_mask:0xf bank_mask:0xf
s_waitcnt vmcnt(11)
v_mfma_f32_16x16x32_bf16 v[108:111], v[112:115], v[40:43], v[108:111]
s_bitcmp1_b32 s47, 2
s_cbranch_scc1 L_th367
s_waitcnt vmcnt(3)
L_th367:
s_waitcnt vmcnt(8)
s_mov_b32 s45, 0x20000
buffer_load_dwordx4 v[40:43], v2, s[8:11], s45 offen offset:0 nt
v_and_b32_dpp v112, v95, v16 row_newbcast:9 row_mask:0xf bank_mask:0xf
v_and_b32_dpp v113, v95, v17 row_newbcast:9 row_mask:0xf bank_mask:0xf
v_and_b32_dpp v114, v95, v18 row_newbcast:9 row_mask:0xf bank_mask:0xf
v_and_b32_dpp v115, v95, v19 row_newbcast:9 row_mask:0xf bank_mask:0xf
s_waitcnt vmcnt(11)
v_mfma_f32_16x16x32_bf16 v[108:111], v[116:119], v[44:47], v[108:111]
s_bitcmp1_b32 s47, 2
s_cbranch_scc1 L_th368
s_waitcnt vmcnt(3)
L_th368:
s_waitcnt vmcnt(8)
buffer_load_dwordx4 v[44:47], v2, s[8:11], s45 offen offset:1024 nt
v_and_b32_dpp v116, v95, v16 row_newbcast:13 row_mask:0xf bank_mask:0xf
v_and_b32_dpp v117, v95, v17 row_newbcast:13 row_mask:0xf bank_mask:0xf
v_and_b32_dpp v118, v95, v18 row_newbcast:13 row_mask:0xf bank_mask:0xf
v_and_b32_dpp v119, v95, v19 row_newbcast:13 row_mask:0xf bank_mask:0xf
s_waitcnt vmcnt(11)
v_mfma_f32_16x16x32_bf16 v[108:111], v[112:115], v[48:51], v[108:111]
s_bitcmp1_b32 s47, 2
s_cbranch_scc1 L_th369
s_waitcnt vmcnt(3)
L_th369:
s_waitcnt vmcnt(8)
buffer_load_dwordx4 v[48:51], v2, s[8:11], s45 offen offset:2048 nt
v_and_b32_dpp v112, v95, v16 row_newbcast:2 row_mask:0xf bank_mask:0xf
v_and_b32_dpp v113, v95, v17 row_newbcast:2 row_mask:0xf bank_mask:0xf
v_and_b32_dpp v114, v95, v18 row_newbcast:2 row_mask:0xf bank_mask:0xf
v_and_b32_dpp v115, v95, v19 row_newbcast:2 row_mask:0xf bank_mask:0xf
s_waitcnt vmcnt(11)
v_mfma_f32_16x16x32_bf16 v[108:111], v[116:119], v[52:55], v[108:111]
s_bitcmp1_b32 s47, 2
s_cbranch_scc1 L_th370
s_waitcnt vmcnt(3)
L_th370:
s_waitcnt vmcnt(8)
buffer_load_dwordx4 v[52:55], v2, s[8:11], s45 offen offset:3072 nt
v_and_b32_dpp v116, v95, v16 row_newbcast:6 row_mask:0xf bank_mask:0xf
v_and_b32_dpp v117, v95, v17 row_newbcast:6 row_mask:0xf bank_mask:0xf
v_and_b32_dpp v118, v95, v18 row_newbcast:6 row_mask:0xf bank_mask:0xf
v_and_b32_dpp v119, v95, v19 row_newbcast:6 row_mask:0xf bank_mask:0xf
s_waitcnt vmcnt(11)
v_mfma_f32_16x16x32_bf16 v[108:111], v[112:115], v[56:59], v[108:111]
s_bitcmp1_b32 s47, 2
s_cbranch_scc1 L_th371
s_waitcnt vmcnt(3)
L_th371:
s_waitcnt vmcnt(8)
s_mov_b32 s45, 0x21000
buffer_load_dwordx4 v[56:59], v2, s[8:11], s45 offen offset:0 nt
v_and_b32_dpp v112, v95, v16 row_newbcast:10 row_mask:0xf bank_mask:0xf
v_and_b32_dpp v113, v95, v17 row_newbcast:10 row_mask:0xf bank_mask:0xf
v_and_b32_dpp v114, v95, v18 row_newbcast:10 row_mask:0xf bank_mask:0xf
v_and_b32_dpp v115, v95, v19 row_newbcast:10 row_mask:0xf bank_mask:0xf
s_waitcnt vmcnt(11)
v_mfma_f32_16x16x32_bf16 v[108:111], v[116:119], v[60:63], v[108:111]
s_bitcmp1_b32 s47, 2
s_cbranch_scc1 L_th372
s_waitcnt vmcnt(3)
L_th372:
s_waitcnt vmcnt(8)
buffer_load_dwordx4 v[60:63], v2, s[8:11], s45 offen offset:1024 nt
v_and_b32_dpp v116, v95, v16 row_newbcast:14 row_mask:0xf bank_mask:0xf
v_and_b32_dpp v117, v95, v17 row_newbcast:14 row_mask:0xf bank_mask:0xf
v_and_b32_dpp v118, v95, v18 row_newbcast:14 row_mask:0xf bank_mask:0xf
v_and_b32_dpp v119, v95, v19 row_newbcast:14 row_mask:0xf bank_mask:0xf
s_waitcnt vmcnt(11)
v_mfma_f32_16x16x32_bf16 v[108:111], v[112:115], v[64:67], v[108:111]
s_bitcmp1_b32 s47, 2
s_cbranch_scc1 L_th373
s_waitcnt vmcnt(3)
L_th373:
s_waitcnt vmcnt(8)
buffer_load_dwordx4 v[64:67], v2, s[8:11], s45 offen offset:2048 nt
v_and_b32_dpp v112, v95, v16 row_newbcast:3 row_mask:0xf bank_mask:0xf
v_and_b32_dpp v113, v95, v17 row_newbcast:3 row_mask:0xf bank_mask:0xf
v_and_b32_dpp v114, v95, v18 row_newbcast:3 row_mask:0xf bank_mask:0xf
v_and_b32_dpp v115, v95, v19 row_newbcast:3 row_mask:0xf bank_mask:0xf
s_waitcnt vmcnt(11)
v_mfma_f32_16x16x32_bf16 v[108:111], v[116:119], v[68:71], v[108:111]
s_bitcmp1_b32 s47, 2
s_cbranch_scc1 L_th374
s_waitcnt vmcnt(3)
L_th374:
s_waitcnt vmcnt(8)
buffer_load_dwordx4 v[68:71], v2, s[8:11], s45 offen offset:3072 nt
v_and_b32_dpp v116, v95, v16 row_newbcast:7 row_mask:0xf bank_mask:0xf
v_and_b32_dpp v117, v95, v17 row_newbcast:7 row_mask:0xf bank_mask:0xf
v_and_b32_dpp v118, v95, v18 row_newbcast:7 row_mask:0xf bank_mask:0xf
v_and_b32_dpp v119, v95, v19 row_newbcast:7 row_mask:0xf bank_mask:0xf
s_waitcnt vmcnt(11)
v_mfma_f32_16x16x32_bf16 v[108:111], v[112:115], v[24:27], v[108:111]
s_bitcmp1_b32 s47, 2
s_cbranch_scc1 L_th375
s_waitcnt vmcnt(3)
L_th375:
s_waitcnt vmcnt(8)
s_mov_b32 s45, 0x22000
buffer_load_dwordx4 v[24:27], v2, s[8:11], s45 offen offset:0 nt
v_and_b32_dpp v112, v95, v16 row_newbcast:11 row_mask:0xf bank_mask:0xf
v_and_b32_dpp v113, v95, v17 row_newbcast:11 row_mask:0xf bank_mask:0xf
v_and_b32_dpp v114, v95, v18 row_newbcast:11 row_mask:0xf bank_mask:0xf
v_and_b32_dpp v115, v95, v19 row_newbcast:11 row_mask:0xf bank_mask:0xf
s_waitcnt vmcnt(11)
v_mfma_f32_16x16x32_bf16 v[108:111], v[116:119], v[28:31], v[108:111]
s_bitcmp1_b32 s47, 2
s_cbranch_scc1 L_th376
s_waitcnt vmcnt(3)
L_th376:
s_waitcnt vmcnt(8)
buffer_load_dwordx4 v[28:31], v2, s[8:11], s45 offen offset:1024 nt
v_and_b32_dpp v116, v95, v16 row_newbcast:15 row_mask:0xf bank_mask:0xf
v_and_b32_dpp v117, v95, v17 row_newbcast:15 row_mask:0xf bank_mask:0xf
v_and_b32_dpp v118, v95, v18 row_newbcast:15 row_mask:0xf bank_mask:0xf
v_and_b32_dpp v119, v95, v19 row_newbcast:15 row_mask:0xf bank_mask:0xf
s_waitcnt vmcnt(11)
v_mfma_f32_16x16x32_bf16 v[108:111], v[112:115], v[32:35], v[108:111]
s_bitcmp1_b32 s47, 2
s_cbranch_scc1 L_th377
s_waitcnt vmcnt(3)
L_th377:
s_waitcnt vmcnt(8)
buffer_load_dwordx4 v[32:35], v2, s[8:11], s45 offen offset:2048 nt
v_and_b32_dpp v112, v96, v16 row_newbcast:0 row_mask:0xf bank_mask:0xf
v_and_b32_dpp v113, v96, v17 row_newbcast:0 row_mask:0xf bank_mask:0xf
v_and_b32_dpp v114, v96, v18 row_newbcast:0 row_mask:0xf bank_mask:0xf
v_and_b32_dpp v115, v96, v19 row_newbcast:0 row_mask:0xf bank_mask:0xf
s_waitcnt vmcnt(11)
v_mfma_f32_16x16x32_bf16 v[108:111], v[116:119], v[36:39], v[108:111]
s_bitcmp1_b32 s47, 2
s_cbranch_scc1 L_th378
s_waitcnt vmcnt(3)
L_th378:
s_waitcnt vmcnt(8)
buffer_load_dwordx4 v[36:39], v2, s[8:11], s45 offen offset:3072 nt
v_and_b32_dpp v116, v96, v16 row_newbcast:4 row_mask:0xf bank_mask:0xf
v_and_b32_dpp v117, v96, v17 row_newbcast:4 row_mask:0xf bank_mask:0xf
v_and_b32_dpp v118, v96, v18 row_newbcast:4 row_mask:0xf bank_mask:0xf
v_and_b32_dpp v119, v96, v19 row_newbcast:4 row_mask:0xf bank_mask:0xf
s_waitcnt vmcnt(11)
v_mfma_f32_16x16x32_bf16 v[108:111], v[112:115], v[40:43], v[108:111]
s_bitcmp1_b32 s47, 2
s_cbranch_scc1 L_th379
s_waitcnt vmcnt(3)
L_th379:
s_waitcnt vmcnt(8)
s_mov_b32 s45, 0x23000
buffer_load_dwordx4 v[40:43], v2, s[8:11], s45 offen offset:0 nt
v_and_b32_dpp v112, v96, v16 row_newbcast:8 row_mask:0xf bank_mask:0xf
v_and_b32_dpp v113, v96, v17 row_newbcast:8 row_mask:0xf bank_mask:0xf
v_and_b32_dpp v114, v96, v18 row_newbcast:8 row_mask:0xf bank_mask:0xf
v_and_b32_dpp v115, v96, v19 row_newbcast:8 row_mask:0xf bank_mask:0xf
s_waitcnt vmcnt(11)
v_mfma_f32_16x16x32_bf16 v[108:111], v[116:119], v[44:47], v[108:111]
s_bitcmp1_b32 s47, 2
s_cbranch_scc1 L_th380
s_waitcnt vmcnt(3)
L_th380:
s_waitcnt vmcnt(8)
buffer_load_dwordx4 v[44:47], v2, s[8:11], s45 offen offset:1024 nt
v_and_b32_dpp v116, v96, v16 row_newbcast:12 row_mask:0xf bank_mask:0xf
v_and_b32_dpp v117, v96, v17 row_newbcast:12 row_mask:0xf bank_mask:0xf
v_and_b32_dpp v118, v96, v18 row_newbcast:12 row_mask:0xf bank_mask:0xf
v_and_b32_dpp v119, v96, v19 row_newbcast:12 row_mask:0xf bank_mask:0xf
s_waitcnt vmcnt(11)
v_mfma_f32_16x16x32_bf16 v[108:111], v[112:115], v[48:51], v[108:111]
s_bitcmp1_b32 s47, 2
s_cbranch_scc1 L_th381
s_waitcnt vmcnt(3)
L_th381:
s_waitcnt vmcnt(8)
buffer_load_dwordx4 v[48:51], v2, s[8:11], s45 offen offset:2048 nt
v_and_b32_dpp v112, v96, v16 row_newbcast:1 row_mask:0xf bank_mask:0xf
v_and_b32_dpp v113, v96, v17 row_newbcast:1 row_mask:0xf bank_mask:0xf
v_and_b32_dpp v114, v96, v18 row_newbcast:1 row_mask:0xf bank_mask:0xf
v_and_b32_dpp v115, v96, v19 row_newbcast:1 row_mask:0xf bank_mask:0xf
s_waitcnt vmcnt(11)
v_mfma_f32_16x16x32_bf16 v[108:111], v[116:119], v[52:55], v[108:111]
s_bitcmp1_b32 s47, 2
s_cbranch_scc1 L_th382
s_waitcnt vmcnt(3)
L_th382:
s_waitcnt vmcnt(8)
buffer_load_dwordx4 v[52:55], v2, s[8:11], s45 offen offset:3072 nt
v_and_b32_dpp v116, v96, v16 row_newbcast:5 row_mask:0xf bank_mask:0xf
v_and_b32_dpp v117, v96, v17 row_newbcast:5 row_mask:0xf bank_mask:0xf
v_and_b32_dpp v118, v96, v18 row_newbcast:5 row_mask:0xf bank_mask:0xf
v_and_b32_dpp v119, v96, v19 row_newbcast:5 row_mask:0xf bank_mask:0xf
s_waitcnt vmcnt(11)
v_mfma_f32_16x16x32_bf16 v[108:111], v[112:115], v[56:59], v[108:111]
s_bitcmp1_b32 s47, 2
s_cbranch_scc1 L_th383
s_waitcnt vmcnt(3)
L_th383:
s_waitcnt vmcnt(8)
s_mov_b32 s45, 0x24000
buffer_load_dwordx4 v[56:59], v2, s[8:11], s45 offen offset:0 nt
v_and_b32_dpp v112, v96, v16 row_newbcast:9 row_mask:0xf bank_mask:0xf
v_and_b32_dpp v113, v96, v17 row_newbcast:9 row_mask:0xf bank_mask:0xf
v_and_b32_dpp v114, v96, v18 row_newbcast:9 row_mask:0xf bank_mask:0xf
v_and_b32_dpp v115, v96, v19 row_newbcast:9 row_mask:0xf bank_mask:0xf
s_waitcnt vmcnt(11)
v_mfma_f32_16x16x32_bf16 v[108:111], v[116:119], v[60:63], v[108:111]
s_bitcmp1_b32 s47, 2
s_cbranch_scc1 L_th384
s_waitcnt vmcnt(3)
L_th384:
s_waitcnt vmcnt(8)
buffer_load_dwordx4 v[60:63], v2, s[8:11], s45 offen offset:1024 nt
v_and_b32_dpp v116, v96, v16 row_newbcast:13 row_mask:0xf bank_mask:0xf
v_and_b32_dpp v117, v96, v17 row_newbcast:13 row_mask:0xf bank_mask:0xf
v_and_b32_dpp v118, v96, v18 row_newbcast:13 row_mask:0xf bank_mask:0xf
v_and_b32_dpp v119, v96, v19 row_newbcast:13 row_mask:0xf bank_mask:0xf
s_waitcnt vmcnt(11)
v_mfma_f32_16x16x32_bf16 v[108:111], v[112:115], v[64:67], v[108:111]
s_bitcmp1_b32 s47, 2
s_cbranch_scc1 L_th385
s_waitcnt vmcnt(3)
L_th385:
s_waitcnt vmcnt(8)
buffer_load_dwordx4 v[64:67], v2, s[8:11], s45 offen offset:2048 nt
v_and_b32_dpp v112, v96, v16 row_newbcast:2 row_mask:0xf bank_mask:0xf
v_and_b32_dpp v113, v96, v17 row_newbcast:2 row_mask:0xf bank_mask:0xf
v_and_b32_dpp v114, v96, v18 row_newbcast:2 row_mask:0xf bank_mask:0xf
v_and_b32_dpp v115, v96, v19 row_newbcast:2 row_mask:0xf bank_mask:0xf
s_waitcnt vmcnt(11)
v_mfma_f32_16x16x32_bf16 v[108:111], v[116:119], v[68:71], v[108:111]
s_bitcmp1_b32 s47, 2
s_cbranch_scc1 L_th386
s_waitcnt vmcnt(3)
L_th386:
s_waitcnt vmcnt(8)
buffer_load_dwordx4 v[68:71], v2, s[8:11], s45 offen offset:3072 nt
v_and_b32_dpp v116, v96, v16 row_newbcast:6 row_mask:0xf bank_mask:0xf
v_and_b32_dpp v117, v96, v17 row_newbcast:6 row_mask:0xf bank_mask:0xf
v_and_b32_dpp v118, v96, v18 row_newbcast:6 row_mask:0xf bank_mask:0xf
v_and_b32_dpp v119, v96, v19 row_newbcast:6 row_mask:0xf bank_mask:0xf
s_waitcnt vmcnt(11)
v_mfma_f32_16x16x32_bf16 v[108:111], v[112:115], v[24:27], v[108:111]
s_bitcmp1_b32 s47, 2
s_cbranch_scc1 L_th387
s_waitcnt vmcnt(3)
L_th387:
s_waitcnt vmcnt(8)
s_mov_b32 s45, 0x25000
buffer_load_dwordx4 v[24:27], v2, s[8:11], s45 offen offset:0 nt
v_and_b32_dpp v112, v96, v16 row_newbcast:10 row_mask:0xf bank_mask:0xf
v_and_b32_dpp v113, v96, v17 row_newbcast:10 row_mask:0xf bank_mask:0xf
v_and_b32_dpp v114, v96, v18 row_newbcast:10 row_mask:0xf bank_mask:0xf
v_and_b32_dpp v115, v96, v19 row_newbcast:10 row_mask:0xf bank_mask:0xf
s_waitcnt vmcnt(11)
v_mfma_f32_16x16x32_bf16 v[108:111], v[116:119], v[28:31], v[108:111]
s_bitcmp1_b32 s47, 2
s_cbranch_scc1 L_th388
s_waitcnt vmcnt(3)
L_th388:
s_waitcnt vmcnt(8)
buffer_load_dwordx4 v[28:31], v2, s[8:11], s45 offen offset:1024 nt
v_and_b32_dpp v116, v96, v16 row_newbcast:14 row_mask:0xf bank_mask:0xf
v_and_b32_dpp v117, v96, v17 row_newbcast:14 row_mask:0xf bank_mask:0xf
v_and_b32_dpp v118, v96, v18 row_newbcast:14 row_mask:0xf bank_mask:0xf
v_and_b32_dpp v119, v96, v19 row_newbcast:14 row_mask:0xf bank_mask:0xf
s_waitcnt vmcnt(11)
v_mfma_f32_16x16x32_bf16 v[108:111], v[112:115], v[32:35], v[108:111]
s_bitcmp1_b32 s47, 2
s_cbranch_scc1 L_th389
s_waitcnt vmcnt(3)
L_th389:
s_waitcnt vmcnt(8)
buffer_load_dwordx4 v[32:35], v2, s[8:11], s45 offen offset:2048 nt
v_and_b32_dpp v112, v96, v16 row_newbcast:3 row_mask:0xf bank_mask:0xf
v_and_b32_dpp v113, v96, v17 row_newbcast:3 row_mask:0xf bank_mask:0xf
v_and_b32_dpp v114, v96, v18 row_newbcast:3 row_mask:0xf bank_mask:0xf
v_and_b32_dpp v115, v96, v19 row_newbcast:3 row_mask:0xf bank_mask:0xf
s_waitcnt vmcnt(11)
v_mfma_f32_16x16x32_bf16 v[108:111], v[116:119], v[36:39], v[108:111]
s_bitcmp1_b32 s47, 2
s_cbranch_scc1 L_th390
s_waitcnt vmcnt(3)
L_th390:
s_waitcnt vmcnt(8)
buffer_load_dwordx4 v[36:39], v2, s[8:11], s45 offen offset:3072 nt
v_and_b32_dpp v116, v96, v16 row_newbcast:7 row_mask:0xf bank_mask:0xf
v_and_b32_dpp v117, v96, v17 row_newbcast:7 row_mask:0xf bank_mask:0xf
v_and_b32_dpp v118, v96, v18 row_newbcast:7 row_mask:0xf bank_mask:0xf
v_and_b32_dpp v119, v96, v19 row_newbcast:7 row_mask:0xf bank_mask:0xf
s_waitcnt vmcnt(11)
v_mfma_f32_16x16x32_bf16 v[108:111], v[112:115], v[40:43], v[108:111]
s_bitcmp1_b32 s47, 2
s_cbranch_scc1 L_th391
s_waitcnt vmcnt(3)
L_th391:
s_waitcnt vmcnt(8)
s_mov_b32 s45, 0x26000
buffer_load_dwordx4 v[40:43], v2, s[8:11], s45 offen offset:0 nt
v_and_b32_dpp v112, v96, v16 row_newbcast:11 row_mask:0xf bank_mask:0xf
v_and_b32_dpp v113, v96, v17 row_newbcast:11 row_mask:0xf bank_mask:0xf
v_and_b32_dpp v114, v96, v18 row_newbcast:11 row_mask:0xf bank_mask:0xf
v_and_b32_dpp v115, v96, v19 row_newbcast:11 row_mask:0xf bank_mask:0xf
s_waitcnt vmcnt(11)
v_mfma_f32_16x16x32_bf16 v[108:111], v[116:119], v[44:47], v[108:111]
s_bitcmp1_b32 s47, 2
s_cbranch_scc1 L_th392
s_waitcnt vmcnt(3)
L_th392:
s_waitcnt vmcnt(8)
buffer_load_dwordx4 v[44:47], v2, s[8:11], s45 offen offset:1024 nt
v_and_b32_dpp v116, v96, v16 row_newbcast:15 row_mask:0xf bank_mask:0xf
v_and_b32_dpp v117, v96, v17 row_newbcast:15 row_mask:0xf bank_mask:0xf
v_and_b32_dpp v118, v96, v18 row_newbcast:15 row_mask:0xf bank_mask:0xf
v_and_b32_dpp v119, v96, v19 row_newbcast:15 row_mask:0xf bank_mask:0xf
s_waitcnt vmcnt(11)
v_mfma_f32_16x16x32_bf16 v[108:111], v[112:115], v[48:51], v[108:111]
s_bitcmp1_b32 s47, 2
s_cbranch_scc1 L_th393
s_waitcnt vmcnt(3)
L_th393:
s_waitcnt vmcnt(8)
buffer_load_dwordx4 v[48:51], v2, s[8:11], s45 offen offset:2048 nt
v_and_b32_dpp v112, v97, v16 row_newbcast:0 row_mask:0xf bank_mask:0xf
v_and_b32_dpp v113, v97, v17 row_newbcast:0 row_mask:0xf bank_mask:0xf
v_and_b32_dpp v114, v97, v18 row_newbcast:0 row_mask:0xf bank_mask:0xf
v_and_b32_dpp v115, v97, v19 row_newbcast:0 row_mask:0xf bank_mask:0xf
s_waitcnt vmcnt(11)
v_mfma_f32_16x16x32_bf16 v[108:111], v[116:119], v[52:55], v[108:111]
s_bitcmp1_b32 s47, 2
s_cbranch_scc1 L_th394
s_waitcnt vmcnt(3)
L_th394:
s_waitcnt vmcnt(8)
buffer_load_dwordx4 v[52:55], v2, s[8:11], s45 offen offset:3072 nt
v_and_b32_dpp v116, v97, v16 row_newbcast:4 row_mask:0xf bank_mask:0xf
v_and_b32_dpp v117, v97, v17 row_newbcast:4 row_mask:0xf bank_mask:0xf
v_and_b32_dpp v118, v97, v18 row_newbcast:4 row_mask:0xf bank_mask:0xf
v_and_b32_dpp v119, v97, v19 row_newbcast:4 row_mask:0xf bank_mask:0xf
s_waitcnt vmcnt(11)
v_mfma_f32_16x16x32_bf16 v[108:111], v[112:115], v[56:59], v[108:111]
s_bitcmp1_b32 s47, 2
s_cbranch_scc1 L_th395
s_waitcnt vmcnt(3)
L_th395:
s_waitcnt vmcnt(8)
s_mov_b32 s45, 0x27000
buffer_load_dwordx4 v[56:59], v2, s[8:11], s45 offen offset:0 nt
v_and_b32_dpp v112, v97, v16 row_newbcast:8 row_mask:0xf bank_mask:0xf
v_and_b32_dpp v113, v97, v17 row_newbcast:8 row_mask:0xf bank_mask:0xf
v_and_b32_dpp v114, v97, v18 row_newbcast:8 row_mask:0xf bank_mask:0xf
v_and_b32_dpp v115, v97, v19 row_newbcast:8 row_mask:0xf bank_mask:0xf
s_waitcnt vmcnt(11)
v_mfma_f32_16x16x32_bf16 v[108:111], v[116:119], v[60:63], v[108:111]
s_bitcmp1_b32 s47, 2
s_cbranch_scc1 L_th396
s_waitcnt vmcnt(3)
L_th396:
s_waitcnt vmcnt(8)
buffer_load_dwordx4 v[60:63], v2, s[8:11], s45 offen offset:1024 nt
v_and_b32_dpp v116, v97, v16 row_newbcast:12 row_mask:0xf bank_mask:0xf
v_and_b32_dpp v117, v97, v17 row_newbcast:12 row_mask:0xf bank_mask:0xf
v_and_b32_dpp v118, v97, v18 row_newbcast:12 row_mask:0xf bank_mask:0xf
v_and_b32_dpp v119, v97, v19 row_newbcast:12 row_mask:0xf bank_mask:0xf
s_waitcnt vmcnt(11)
v_mfma_f32_16x16x32_bf16 v[108:111], v[112:115], v[64:67], v[108:111]
s_bitcmp1_b32 s47, 2
s_cbranch_scc1 L_th397
s_waitcnt vmcnt(3)
L_th397:
s_waitcnt vmcnt(8)
buffer_load_dwordx4 v[64:67], v2, s[8:11], s45 offen offset:2048 nt
v_and_b32_dpp v112, v97, v16 row_newbcast:1 row_mask:0xf bank_mask:0xf
v_and_b32_dpp v113, v97, v17 row_newbcast:1 row_mask:0xf bank_mask:0xf
v_and_b32_dpp v114, v97, v18 row_newbcast:1 row_mask:0xf bank_mask:0xf
v_and_b32_dpp v115, v97, v19 row_newbcast:1 row_mask:0xf bank_mask:0xf
s_waitcnt vmcnt(11)
v_mfma_f32_16x16x32_bf16 v[108:111], v[116:119], v[68:71], v[108:111]
s_bitcmp1_b32 s47, 2
s_cbranch_scc1 L_th398
s_waitcnt vmcnt(3)
L_th398:
s_waitcnt vmcnt(8)
buffer_load_dwordx4 v[68:71], v2, s[8:11], s45 offen offset:3072 nt
v_and_b32_dpp v116, v97, v16 row_newbcast:5 row_mask:0xf bank_mask:0xf
v_and_b32_dpp v117, v97, v17 row_newbcast:5 row_mask:0xf bank_mask:0xf
v_and_b32_dpp v118, v97, v18 row_newbcast:5 row_mask:0xf bank_mask:0xf
v_and_b32_dpp v119, v97, v19 row_newbcast:5 row_mask:0xf bank_mask:0xf
s_waitcnt vmcnt(11)
v_mfma_f32_16x16x32_bf16 v[108:111], v[112:115], v[24:27], v[108:111]
s_bitcmp1_b32 s47, 2
s_cbranch_scc1 L_th399
s_waitcnt vmcnt(3)
L_th399:
s_waitcnt vmcnt(8)
s_mov_b32 s45, 0x28000
buffer_load_dwordx4 v[24:27], v2, s[8:11], s45 offen offset:0 nt
v_and_b32_dpp v112, v97, v16 row_newbcast:9 row_mask:0xf bank_mask:0xf
v_and_b32_dpp v113, v97, v17 row_newbcast:9 row_mask:0xf bank_mask:0xf
v_and_b32_dpp v114, v97, v18 row_newbcast:9 row_mask:0xf bank_mask:0xf
v_and_b32_dpp v115, v97, v19 row_newbcast:9 row_mask:0xf bank_mask:0xf
s_waitcnt vmcnt(11)
v_mfma_f32_16x16x32_bf16 v[108:111], v[116:119], v[28:31], v[108:111]
s_bitcmp1_b32 s47, 2
s_cbranch_scc1 L_th400
s_waitcnt vmcnt(3)
L_th400:
s_waitcnt vmcnt(8)
buffer_load_dwordx4 v[28:31], v2, s[8:11], s45 offen offset:1024 nt
v_and_b32_dpp v116, v97, v16 row_newbcast:13 row_mask:0xf bank_mask:0xf
v_and_b32_dpp v117, v97, v17 row_newbcast:13 row_mask:0xf bank_mask:0xf
v_and_b32_dpp v118, v97, v18 row_newbcast:13 row_mask:0xf bank_mask:0xf
v_and_b32_dpp v119, v97, v19 row_newbcast:13 row_mask:0xf bank_mask:0xf
s_waitcnt vmcnt(11)
v_mfma_f32_16x16x32_bf16 v[108:111], v[112:115], v[32:35], v[108:111]
s_bitcmp1_b32 s47, 2
s_cbranch_scc1 L_th401
s_waitcnt vmcnt(3)
L_th401:
s_waitcnt vmcnt(8)
buffer_load_dwordx4 v[32:35], v2, s[8:11], s45 offen offset:2048 nt
v_and_b32_dpp v112, v97, v16 row_newbcast:2 row_mask:0xf bank_mask:0xf
v_and_b32_dpp v113, v97, v17 row_newbcast:2 row_mask:0xf bank_mask:0xf
v_and_b32_dpp v114, v97, v18 row_newbcast:2 row_mask:0xf bank_mask:0xf
v_and_b32_dpp v115, v97, v19 row_newbcast:2 row_mask:0xf bank_mask:0xf
s_waitcnt vmcnt(11)
v_mfma_f32_16x16x32_bf16 v[108:111], v[116:119], v[36:39], v[108:111]
s_bitcmp1_b32 s47, 2
s_cbranch_scc1 L_th402
s_waitcnt vmcnt(3)
L_th402:
s_waitcnt vmcnt(8)
buffer_load_dwordx4 v[36:39], v2, s[8:11], s45 offen offset:3072 nt
v_and_b32_dpp v116, v97, v16 row_newbcast:6 row_mask:0xf bank_mask:0xf
v_and_b32_dpp v117, v97, v17 row_newbcast:6 row_mask:0xf bank_mask:0xf
v_and_b32_dpp v118, v97, v18 row_newbcast:6 row_mask:0xf bank_mask:0xf
v_and_b32_dpp v119, v97, v19 row_newbcast:6 row_mask:0xf bank_mask:0xf
s_waitcnt vmcnt(11)
v_mfma_f32_16x16x32_bf16 v[108:111], v[112:115], v[40:43], v[108:111]
s_bitcmp1_b32 s47, 2
s_cbranch_scc1 L_th403
s_waitcnt vmcnt(3)
L_th403:
s_waitcnt vmcnt(8)
s_mov_b32 s45, 0x29000
buffer_load_dwordx4 v[40:43], v2, s[8:11], s45 offen offset:0 nt
v_and_b32_dpp v112, v97, v16 row_newbcast:10 row_mask:0xf bank_mask:0xf
v_and_b32_dpp v113, v97, v17 row_newbcast:10 row_mask:0xf bank_mask:0xf
v_and_b32_dpp v114, v97, v18 row_newbcast:10 row_mask:0xf bank_mask:0xf
v_and_b32_dpp v115, v97, v19 row_newbcast:10 row_mask:0xf bank_mask:0xf
s_waitcnt vmcnt(11)
v_mfma_f32_16x16x32_bf16 v[108:111], v[116:119], v[44:47], v[108:111]
s_bitcmp1_b32 s47, 2
s_cbranch_scc1 L_th404
s_waitcnt vmcnt(3)
L_th404:
s_waitcnt vmcnt(8)
buffer_load_dwordx4 v[44:47], v2, s[8:11], s45 offen offset:1024 nt
v_and_b32_dpp v116, v97, v16 row_newbcast:14 row_mask:0xf bank_mask:0xf
v_and_b32_dpp v117, v97, v17 row_newbcast:14 row_mask:0xf bank_mask:0xf
v_and_b32_dpp v118, v97, v18 row_newbcast:14 row_mask:0xf bank_mask:0xf
v_and_b32_dpp v119, v97, v19 row_newbcast:14 row_mask:0xf bank_mask:0xf
s_waitcnt vmcnt(11)
v_mfma_f32_16x16x32_bf16 v[108:111], v[112:115], v[48:51], v[108:111]
s_bitcmp1_b32 s47, 2
s_cbranch_scc1 L_th405
s_waitcnt vmcnt(3)
L_th405:
s_waitcnt vmcnt(8)
buffer_load_dwordx4 v[48:51], v2, s[8:11], s45 offen offset:2048 nt
v_and_b32_dpp v112, v97, v16 row_newbcast:3 row_mask:0xf bank_mask:0xf
v_and_b32_dpp v113, v97, v17 row_newbcast:3 row_mask:0xf bank_mask:0xf
v_and_b32_dpp v114, v97, v18 row_newbcast:3 row_mask:0xf bank_mask:0xf
v_and_b32_dpp v115, v97, v19 row_newbcast:3 row_mask:0xf bank_mask:0xf
s_waitcnt vmcnt(11)
v_mfma_f32_16x16x32_bf16 v[108:111], v[116:119], v[52:55], v[108:111]
s_bitcmp1_b32 s47, 2
s_cbranch_scc1 L_th406
s_waitcnt vmcnt(3)
L_th406:
s_waitcnt vmcnt(8)
buffer_load_dwordx4 v[52:55], v2, s[8:11], s45 offen offset:3072 nt
v_and_b32_dpp v116, v97, v16 row_newbcast:7 row_mask:0xf bank_mask:0xf
v_and_b32_dpp v117, v97, v17 row_newbcast:7 row_mask:0xf bank_mask:0xf
v_and_b32_dpp v118, v97, v18 row_newbcast:7 row_mask:0xf bank_mask:0xf
v_and_b32_dpp v119, v97, v19 row_newbcast:7 row_mask:0xf bank_mask:0xf
s_waitcnt vmcnt(11)
v_mfma_f32_16x16x32_bf16 v[108:111], v[112:115], v[56:59], v[108:111]
s_bitcmp1_b32 s47, 2
s_cbranch_scc1 L_th407
s_waitcnt vmcnt(3)
L_th407:
s_waitcnt vmcnt(8)
s_mov_b32 s45, 0x2a000
buffer_load_dwordx4 v[56:59], v2, s[8:11], s45 offen offset:0 nt
v_and_b32_dpp v112, v97, v16 row_newbcast:11 row_mask:0xf bank_mask:0xf
v_and_b32_dpp v113, v97, v17 row_newbcast:11 row_mask:0xf bank_mask:0xf
v_and_b32_dpp v114, v97, v18 row_newbcast:11 row_mask:0xf bank_mask:0xf
v_and_b32_dpp v115, v97, v19 row_newbcast:11 row_mask:0xf bank_mask:0xf
s_waitcnt vmcnt(11)
v_mfma_f32_16x16x32_bf16 v[108:111], v[116:119], v[60:63], v[108:111]
s_bitcmp1_b32 s47, 2
s_cbranch_scc1 L_th408
s_waitcnt vmcnt(3)
L_th408:
s_waitcnt vmcnt(8)
buffer_load_dwordx4 v[60:63], v2, s[8:11], s45 offen offset:1024 nt
v_and_b32_dpp v116, v97, v16 row_newbcast:15 row_mask:0xf bank_mask:0xf
v_and_b32_dpp v117, v97, v17 row_newbcast:15 row_mask:0xf bank_mask:0xf
v_and_b32_dpp v118, v97, v18 row_newbcast:15 row_mask:0xf bank_mask:0xf
v_and_b32_dpp v119, v97, v19 row_newbcast:15 row_mask:0xf bank_mask:0xf
s_waitcnt vmcnt(11)
v_mfma_f32_16x16x32_bf16 v[108:111], v[112:115], v[64:67], v[108:111]
s_bitcmp1_b32 s47, 2
s_cbranch_scc1 L_th409
s_waitcnt vmcnt(3)
L_th409:
s_waitcnt vmcnt(8)
buffer_load_dwordx4 v[64:67], v2, s[8:11], s45 offen offset:2048 nt
v_and_b32_dpp v112, v98, v16 row_newbcast:0 row_mask:0xf bank_mask:0xf
v_and_b32_dpp v113, v98, v17 row_newbcast:0 row_mask:0xf bank_mask:0xf
v_and_b32_dpp v114, v98, v18 row_newbcast:0 row_mask:0xf bank_mask:0xf
v_and_b32_dpp v115, v98, v19 row_newbcast:0 row_mask:0xf bank_mask:0xf
s_waitcnt vmcnt(11)
v_mfma_f32_16x16x32_bf16 v[108:111], v[116:119], v[68:71], v[108:111]
s_bitcmp1_b32 s47, 2
s_cbranch_scc1 L_th410
s_waitcnt vmcnt(3)
L_th410:
s_waitcnt vmcnt(8)
buffer_load_dwordx4 v[68:71], v2, s[8:11], s45 offen offset:3072 nt
v_and_b32_dpp v116, v98, v16 row_newbcast:4 row_mask:0xf bank_mask:0xf
v_and_b32_dpp v117, v98, v17 row_newbcast:4 row_mask:0xf bank_mask:0xf
v_and_b32_dpp v118, v98, v18 row_newbcast:4 row_mask:0xf bank_mask:0xf
v_and_b32_dpp v119, v98, v19 row_newbcast:4 row_mask:0xf bank_mask:0xf
s_waitcnt vmcnt(11)
v_mfma_f32_16x16x32_bf16 v[108:111], v[112:115], v[24:27], v[108:111]
s_bitcmp1_b32 s47, 2
s_cbranch_scc1 L_th411
s_waitcnt vmcnt(3)
L_th411:
s_waitcnt vmcnt(8)
s_mov_b32 s45, 0x2b000
buffer_load_dwordx4 v[24:27], v2, s[8:11], s45 offen offset:0 nt
v_and_b32_dpp v112, v98, v16 row_newbcast:8 row_mask:0xf bank_mask:0xf
v_and_b32_dpp v113, v98, v17 row_newbcast:8 row_mask:0xf bank_mask:0xf
v_and_b32_dpp v114, v98, v18 row_newbcast:8 row_mask:0xf bank_mask:0xf
v_and_b32_dpp v115, v98, v19 row_newbcast:8 row_mask:0xf bank_mask:0xf
s_waitcnt vmcnt(11)
v_mfma_f32_16x16x32_bf16 v[108:111], v[116:119], v[28:31], v[108:111]
s_bitcmp1_b32 s47, 2
s_cbranch_scc1 L_th412
s_waitcnt vmcnt(3)
L_th412:
s_waitcnt vmcnt(8)
buffer_load_dwordx4 v[28:31], v2, s[8:11], s45 offen offset:1024 nt
v_and_b32_dpp v116, v98, v16 row_newbcast:12 row_mask:0xf bank_mask:0xf
v_and_b32_dpp v117, v98, v17 row_newbcast:12 row_mask:0xf bank_mask:0xf
v_and_b32_dpp v118, v98, v18 row_newbcast:12 row_mask:0xf bank_mask:0xf
v_and_b32_dpp v119, v98, v19 row_newbcast:12 row_mask:0xf bank_mask:0xf
s_waitcnt vmcnt(11)
v_mfma_f32_16x16x32_bf16 v[108:111], v[112:115], v[32:35], v[108:111]
s_bitcmp1_b32 s47, 2
s_cbranch_scc1 L_th413
s_waitcnt vmcnt(3)
L_th413:
s_waitcnt vmcnt(8)
buffer_load_dwordx4 v[32:35], v2, s[8:11], s45 offen offset:2048 nt
v_and_b32_dpp v112, v98, v16 row_newbcast:1 row_mask:0xf bank_mask:0xf
v_and_b32_dpp v113, v98, v17 row_newbcast:1 row_mask:0xf bank_mask:0xf
v_and_b32_dpp v114, v98, v18 row_newbcast:1 row_mask:0xf bank_mask:0xf
v_and_b32_dpp v115, v98, v19 row_newbcast:1 row_mask:0xf bank_mask:0xf
s_waitcnt vmcnt(11)
v_mfma_f32_16x16x32_bf16 v[108:111], v[116:119], v[36:39], v[108:111]
s_bitcmp1_b32 s47, 2
s_cbranch_scc1 L_th414
s_waitcnt vmcnt(3)
L_th414:
s_waitcnt vmcnt(8)
buffer_load_dwordx4 v[36:39], v2, s[8:11], s45 offen offset:3072 nt
v_and_b32_dpp v116, v98, v16 row_newbcast:5 row_mask:0xf bank_mask:0xf
v_and_b32_dpp v117, v98, v17 row_newbcast:5 row_mask:0xf bank_mask:0xf
v_and_b32_dpp v118, v98, v18 row_newbcast:5 row_mask:0xf bank_mask:0xf
v_and_b32_dpp v119, v98, v19 row_newbcast:5 row_mask:0xf bank_mask:0xf
s_waitcnt vmcnt(11)
v_mfma_f32_16x16x32_bf16 v[108:111], v[112:115], v[40:43], v[108:111]
s_bitcmp1_b32 s47, 2
s_cbranch_scc1 L_th415
s_waitcnt vmcnt(3)
L_th415:
s_waitcnt vmcnt(8)
s_mov_b32 s45, 0x2c000
buffer_load_dwordx4 v[40:43], v2, s[8:11], s45 offen offset:0 nt
v_and_b32_dpp v112, v98, v16 row_newbcast:9 row_mask:0xf bank_mask:0xf
v_and_b32_dpp v113, v98, v17 row_newbcast:9 row_mask:0xf bank_mask:0xf
v_and_b32_dpp v114, v98, v18 row_newbcast:9 row_mask:0xf bank_mask:0xf
v_and_b32_dpp v115, v98, v19 row_newbcast:9 row_mask:0xf bank_mask:0xf
s_waitcnt vmcnt(11)
v_mfma_f32_16x16x32_bf16 v[108:111], v[116:119], v[44:47], v[108:111]
s_bitcmp1_b32 s47, 2
s_cbranch_scc1 L_th416
s_waitcnt vmcnt(3)
L_th416:
s_waitcnt vmcnt(8)
buffer_load_dwordx4 v[44:47], v2, s[8:11], s45 offen offset:1024 nt
v_and_b32_dpp v116, v98, v16 row_newbcast:13 row_mask:0xf bank_mask:0xf
v_and_b32_dpp v117, v98, v17 row_newbcast:13 row_mask:0xf bank_mask:0xf
v_and_b32_dpp v118, v98, v18 row_newbcast:13 row_mask:0xf bank_mask:0xf
v_and_b32_dpp v119, v98, v19 row_newbcast:13 row_mask:0xf bank_mask:0xf
s_waitcnt vmcnt(11)
v_mfma_f32_16x16x32_bf16 v[108:111], v[112:115], v[48:51], v[108:111]
s_bitcmp1_b32 s47, 2
s_cbranch_scc1 L_th417
s_waitcnt vmcnt(3)
L_th417:
s_waitcnt vmcnt(8)
buffer_load_dwordx4 v[48:51], v2, s[8:11], s45 offen offset:2048 nt
v_and_b32_dpp v112, v98, v16 row_newbcast:2 row_mask:0xf bank_mask:0xf
v_and_b32_dpp v113, v98, v17 row_newbcast:2 row_mask:0xf bank_mask:0xf
v_and_b32_dpp v114, v98, v18 row_newbcast:2 row_mask:0xf bank_mask:0xf
v_and_b32_dpp v115, v98, v19 row_newbcast:2 row_mask:0xf bank_mask:0xf
s_waitcnt vmcnt(11)
v_mfma_f32_16x16x32_bf16 v[108:111], v[116:119], v[52:55], v[108:111]
s_bitcmp1_b32 s47, 2
s_cbranch_scc1 L_th418
s_waitcnt vmcnt(3)
L_th418:
s_waitcnt vmcnt(8)
buffer_load_dwordx4 v[52:55], v2, s[8:11], s45 offen offset:3072 nt
v_and_b32_dpp v116, v98, v16 row_newbcast:6 row_mask:0xf bank_mask:0xf
v_and_b32_dpp v117, v98, v17 row_newbcast:6 row_mask:0xf bank_mask:0xf
v_and_b32_dpp v118, v98, v18 row_newbcast:6 row_mask:0xf bank_mask:0xf
v_and_b32_dpp v119, v98, v19 row_newbcast:6 row_mask:0xf bank_mask:0xf
s_waitcnt vmcnt(11)
v_mfma_f32_16x16x32_bf16 v[108:111], v[112:115], v[56:59], v[108:111]
s_bitcmp1_b32 s47, 2
s_cbranch_scc1 L_th419
s_waitcnt vmcnt(3)
L_th419:
s_waitcnt vmcnt(8)
s_mov_b32 s45, 0x2d000
buffer_load_dwordx4 v[56:59], v2, s[8:11], s45 offen offset:0 nt
v_and_b32_dpp v112, v98, v16 row_newbcast:10 row_mask:0xf bank_mask:0xf
v_and_b32_dpp v113, v98, v17 row_newbcast:10 row_mask:0xf bank_mask:0xf
v_and_b32_dpp v114, v98, v18 row_newbcast:10 row_mask:0xf bank_mask:0xf
v_and_b32_dpp v115, v98, v19 row_newbcast:10 row_mask:0xf bank_mask:0xf
s_waitcnt vmcnt(11)
v_mfma_f32_16x16x32_bf16 v[108:111], v[116:119], v[60:63], v[108:111]
s_bitcmp1_b32 s47, 2
s_cbranch_scc1 L_th420
s_waitcnt vmcnt(3)
L_th420:
s_waitcnt vmcnt(8)
buffer_load_dwordx4 v[60:63], v2, s[8:11], s45 offen offset:1024 nt
v_and_b32_dpp v116, v98, v16 row_newbcast:14 row_mask:0xf bank_mask:0xf
v_and_b32_dpp v117, v98, v17 row_newbcast:14 row_mask:0xf bank_mask:0xf
v_and_b32_dpp v118, v98, v18 row_newbcast:14 row_mask:0xf bank_mask:0xf
v_and_b32_dpp v119, v98, v19 row_newbcast:14 row_mask:0xf bank_mask:0xf
s_waitcnt vmcnt(11)
v_mfma_f32_16x16x32_bf16 v[108:111], v[112:115], v[64:67], v[108:111]
s_bitcmp1_b32 s47, 2
s_cbranch_scc1 L_th421
s_waitcnt vmcnt(3)
L_th421:
s_waitcnt vmcnt(8)
buffer_load_dwordx4 v[64:67], v2, s[8:11], s45 offen offset:2048 nt
v_and_b32_dpp v112, v98, v16 row_newbcast:3 row_mask:0xf bank_mask:0xf
v_and_b32_dpp v113, v98, v17 row_newbcast:3 row_mask:0xf bank_mask:0xf
v_and_b32_dpp v114, v98, v18 row_newbcast:3 row_mask:0xf bank_mask:0xf
v_and_b32_dpp v115, v98, v19 row_newbcast:3 row_mask:0xf bank_mask:0xf
s_waitcnt vmcnt(11)
v_mfma_f32_16x16x32_bf16 v[108:111], v[116:119], v[68:71], v[108:111]
s_bitcmp1_b32 s47, 2
s_cbranch_scc1 L_th422
s_waitcnt vmcnt(3)
L_th422:
s_waitcnt vmcnt(8)
buffer_load_dwordx4 v[68:71], v2, s[8:11], s45 offen offset:3072 nt
v_and_b32_dpp v116, v98, v16 row_newbcast:7 row_mask:0xf bank_mask:0xf
v_and_b32_dpp v117, v98, v17 row_newbcast:7 row_mask:0xf bank_mask:0xf
v_and_b32_dpp v118, v98, v18 row_newbcast:7 row_mask:0xf bank_mask:0xf
v_and_b32_dpp v119, v98, v19 row_newbcast:7 row_mask:0xf bank_mask:0xf
s_waitcnt vmcnt(11)
v_mfma_f32_16x16x32_bf16 v[108:111], v[112:115], v[24:27], v[108:111]
s_bitcmp1_b32 s47, 2
s_cbranch_scc1 L_th423
s_waitcnt vmcnt(3)
L_th423:
s_waitcnt vmcnt(8)
s_mov_b32 s45, 0x2e000
buffer_load_dwordx4 v[24:27], v2, s[8:11], s45 offen offset:0 nt
v_and_b32_dpp v112, v98, v16 row_newbcast:11 row_mask:0xf bank_mask:0xf
v_and_b32_dpp v113, v98, v17 row_newbcast:11 row_mask:0xf bank_mask:0xf
v_and_b32_dpp v114, v98, v18 row_newbcast:11 row_mask:0xf bank_mask:0xf
v_and_b32_dpp v115, v98, v19 row_newbcast:11 row_mask:0xf bank_mask:0xf
s_waitcnt vmcnt(11)
v_mfma_f32_16x16x32_bf16 v[108:111], v[116:119], v[28:31], v[108:111]
s_bitcmp1_b32 s47, 2
s_cbranch_scc1 L_th424
s_waitcnt vmcnt(3)
L_th424:
s_waitcnt vmcnt(8)
buffer_load_dwordx4 v[28:31], v2, s[8:11], s45 offen offset:1024 nt
v_and_b32_dpp v116, v98, v16 row_newbcast:15 row_mask:0xf bank_mask:0xf
v_and_b32_dpp v117, v98, v17 row_newbcast:15 row_mask:0xf bank_mask:0xf
v_and_b32_dpp v118, v98, v18 row_newbcast:15 row_mask:0xf bank_mask:0xf
v_and_b32_dpp v119, v98, v19 row_newbcast:15 row_mask:0xf bank_mask:0xf
s_waitcnt vmcnt(11)
v_mfma_f32_16x16x32_bf16 v[108:111], v[112:115], v[32:35], v[108:111]
s_bitcmp1_b32 s47, 2
s_cbranch_scc1 L_th425
s_waitcnt vmcnt(3)
L_th425:
s_waitcnt vmcnt(8)
buffer_load_dwordx4 v[32:35], v2, s[8:11], s45 offen offset:2048 nt
v_and_b32_dpp v112, v99, v16 row_newbcast:0 row_mask:0xf bank_mask:0xf
v_and_b32_dpp v113, v99, v17 row_newbcast:0 row_mask:0xf bank_mask:0xf
v_and_b32_dpp v114, v99, v18 row_newbcast:0 row_mask:0xf bank_mask:0xf
v_and_b32_dpp v115, v99, v19 row_newbcast:0 row_mask:0xf bank_mask:0xf
s_waitcnt vmcnt(11)
v_mfma_f32_16x16x32_bf16 v[108:111], v[116:119], v[36:39], v[108:111]
s_bitcmp1_b32 s47, 2
s_cbranch_scc1 L_th426
s_waitcnt vmcnt(3)
L_th426:
s_waitcnt vmcnt(8)
buffer_load_dwordx4 v[36:39], v2, s[8:11], s45 offen offset:3072 nt
v_and_b32_dpp v116, v99, v16 row_newbcast:4 row_mask:0xf bank_mask:0xf
v_and_b32_dpp v117, v99, v17 row_newbcast:4 row_mask:0xf bank_mask:0xf
v_and_b32_dpp v118, v99, v18 row_newbcast:4 row_mask:0xf bank_mask:0xf
v_and_b32_dpp v119, v99, v19 row_newbcast:4 row_mask:0xf bank_mask:0xf
s_waitcnt vmcnt(11)
v_mfma_f32_16x16x32_bf16 v[108:111], v[112:115], v[40:43], v[108:111]
s_bitcmp1_b32 s47, 2
s_cbranch_scc1 L_th427
s_waitcnt vmcnt(3)
L_th427:
s_waitcnt vmcnt(8)
s_mov_b32 s45, 0x2f000
buffer_load_dwordx4 v[40:43], v2, s[8:11], s45 offen offset:0 nt
v_and_b32_dpp v112, v99, v16 row_newbcast:8 row_mask:0xf bank_mask:0xf
v_and_b32_dpp v113, v99, v17 row_newbcast:8 row_mask:0xf bank_mask:0xf
v_and_b32_dpp v114, v99, v18 row_newbcast:8 row_mask:0xf bank_mask:0xf
v_and_b32_dpp v115, v99, v19 row_newbcast:8 row_mask:0xf bank_mask:0xf
s_waitcnt vmcnt(11)
v_mfma_f32_16x16x32_bf16 v[108:111], v[116:119], v[44:47], v[108:111]
s_bitcmp1_b32 s47, 2
s_cbranch_scc1 L_th428
s_waitcnt vmcnt(3)
L_th428:
s_waitcnt vmcnt(8)
buffer_load_dwordx4 v[44:47], v2, s[8:11], s45 offen offset:1024 nt
v_and_b32_dpp v116, v99, v16 row_newbcast:12 row_mask:0xf bank_mask:0xf
v_and_b32_dpp v117, v99, v17 row_newbcast:12 row_mask:0xf bank_mask:0xf
v_and_b32_dpp v118, v99, v18 row_newbcast:12 row_mask:0xf bank_mask:0xf
v_and_b32_dpp v119, v99, v19 row_newbcast:12 row_mask:0xf bank_mask:0xf
s_waitcnt vmcnt(11)
v_mfma_f32_16x16x32_bf16 v[108:111], v[112:115], v[48:51], v[108:111]
s_bitcmp1_b32 s47, 2
s_cbranch_scc1 L_th429
s_waitcnt vmcnt(3)
L_th429:
s_waitcnt vmcnt(8)
buffer_load_dwordx4 v[48:51], v2, s[8:11], s45 offen offset:2048 nt
v_and_b32_dpp v112, v99, v16 row_newbcast:1 row_mask:0xf bank_mask:0xf
v_and_b32_dpp v113, v99, v17 row_newbcast:1 row_mask:0xf bank_mask:0xf
v_and_b32_dpp v114, v99, v18 row_newbcast:1 row_mask:0xf bank_mask:0xf
v_and_b32_dpp v115, v99, v19 row_newbcast:1 row_mask:0xf bank_mask:0xf
s_waitcnt vmcnt(11)
v_mfma_f32_16x16x32_bf16 v[108:111], v[116:119], v[52:55], v[108:111]
s_bitcmp1_b32 s47, 2
s_cbranch_scc1 L_th430
s_waitcnt vmcnt(3)
L_th430:
s_waitcnt vmcnt(8)
buffer_load_dwordx4 v[52:55], v2, s[8:11], s45 offen offset:3072 nt
v_and_b32_dpp v116, v99, v16 row_newbcast:5 row_mask:0xf bank_mask:0xf
v_and_b32_dpp v117, v99, v17 row_newbcast:5 row_mask:0xf bank_mask:0xf
v_and_b32_dpp v118, v99, v18 row_newbcast:5 row_mask:0xf bank_mask:0xf
v_and_b32_dpp v119, v99, v19 row_newbcast:5 row_mask:0xf bank_mask:0xf
s_waitcnt vmcnt(11)
v_mfma_f32_16x16x32_bf16 v[108:111], v[112:115], v[56:59], v[108:111]
s_bitcmp1_b32 s47, 2
s_cbranch_scc1 L_th431
s_waitcnt vmcnt(3)
L_th431:
s_waitcnt vmcnt(8)
s_mov_b32 s45, 0x30000
buffer_load_dwordx4 v[56:59], v2, s[8:11], s45 offen offset:0 nt
v_and_b32_dpp v112, v99, v16 row_newbcast:9 row_mask:0xf bank_mask:0xf
v_and_b32_dpp v113, v99, v17 row_newbcast:9 row_mask:0xf bank_mask:0xf
v_and_b32_dpp v114, v99, v18 row_newbcast:9 row_mask:0xf bank_mask:0xf
v_and_b32_dpp v115, v99, v19 row_newbcast:9 row_mask:0xf bank_mask:0xf
s_waitcnt vmcnt(11)
v_mfma_f32_16x16x32_bf16 v[108:111], v[116:119], v[60:63], v[108:111]
s_bitcmp1_b32 s47, 2
s_cbranch_scc1 L_th432
s_waitcnt vmcnt(3)
L_th432:
s_waitcnt vmcnt(8)
buffer_load_dwordx4 v[60:63], v2, s[8:11], s45 offen offset:1024 nt
v_and_b32_dpp v116, v99, v16 row_newbcast:13 row_mask:0xf bank_mask:0xf
v_and_b32_dpp v117, v99, v17 row_newbcast:13 row_mask:0xf bank_mask:0xf
v_and_b32_dpp v118, v99, v18 row_newbcast:13 row_mask:0xf bank_mask:0xf
v_and_b32_dpp v119, v99, v19 row_newbcast:13 row_mask:0xf bank_mask:0xf
s_waitcnt vmcnt(11)
v_mfma_f32_16x16x32_bf16 v[108:111], v[112:115], v[64:67], v[108:111]
s_bitcmp1_b32 s47, 2
s_cbranch_scc1 L_th433
s_waitcnt vmcnt(3)
L_th433:
s_waitcnt vmcnt(8)
buffer_load_dwordx4 v[64:67], v2, s[8:11], s45 offen offset:2048 nt
v_and_b32_dpp v112, v99, v16 row_newbcast:2 row_mask:0xf bank_mask:0xf
v_and_b32_dpp v113, v99, v17 row_newbcast:2 row_mask:0xf bank_mask:0xf
v_and_b32_dpp v114, v99, v18 row_newbcast:2 row_mask:0xf bank_mask:0xf
v_and_b32_dpp v115, v99, v19 row_newbcast:2 row_mask:0xf bank_mask:0xf
s_waitcnt vmcnt(11)
v_mfma_f32_16x16x32_bf16 v[108:111], v[116:119], v[68:71], v[108:111]
s_bitcmp1_b32 s47, 2
s_cbranch_scc1 L_th434
s_waitcnt vmcnt(3)
L_th434:
s_waitcnt vmcnt(8)
buffer_load_dwordx4 v[68:71], v2, s[8:11], s45 offen offset:3072 nt
v_and_b32_dpp v116, v99, v16 row_newbcast:6 row_mask:0xf bank_mask:0xf
v_and_b32_dpp v117, v99, v17 row_newbcast:6 row_mask:0xf bank_mask:0xf
v_and_b32_dpp v118, v99, v18 row_newbcast:6 row_mask:0xf bank_mask:0xf
v_and_b32_dpp v119, v99, v19 row_newbcast:6 row_mask:0xf bank_mask:0xf
s_waitcnt vmcnt(11)
v_mfma_f32_16x16x32_bf16 v[108:111], v[112:115], v[24:27], v[108:111]
s_bitcmp1_b32 s47, 2
s_cbranch_scc1 L_th435
s_waitcnt vmcnt(3)
L_th435:
s_waitcnt vmcnt(8)
s_mov_b32 s45, 0x31000
buffer_load_dwordx4 v[24:27], v2, s[8:11], s45 offen offset:0 nt
v_and_b32_dpp v112, v99, v16 row_newbcast:10 row_mask:0xf bank_mask:0xf
v_and_b32_dpp v113, v99, v17 row_newbcast:10 row_mask:0xf bank_mask:0xf
v_and_b32_dpp v114, v99, v18 row_newbcast:10 row_mask:0xf bank_mask:0xf
v_and_b32_dpp v115, v99, v19 row_newbcast:10 row_mask:0xf bank_mask:0xf
s_waitcnt vmcnt(11)
v_mfma_f32_16x16x32_bf16 v[108:111], v[116:119], v[28:31], v[108:111]
s_bitcmp1_b32 s47, 2
s_cbranch_scc1 L_th436
s_waitcnt vmcnt(3)
L_th436:
s_waitcnt vmcnt(8)
buffer_load_dwordx4 v[28:31], v2, s[8:11], s45 offen offset:1024 nt
v_and_b32_dpp v116, v99, v16 row_newbcast:14 row_mask:0xf bank_mask:0xf
v_and_b32_dpp v117, v99, v17 row_newbcast:14 row_mask:0xf bank_mask:0xf
v_and_b32_dpp v118, v99, v18 row_newbcast:14 row_mask:0xf bank_mask:0xf
v_and_b32_dpp v119, v99, v19 row_newbcast:14 row_mask:0xf bank_mask:0xf
s_waitcnt vmcnt(11)
v_mfma_f32_16x16x32_bf16 v[108:111], v[112:115], v[32:35], v[108:111]
s_bitcmp1_b32 s47, 2
s_cbranch_scc1 L_th437
s_waitcnt vmcnt(3)
L_th437:
s_waitcnt vmcnt(8)
buffer_load_dwordx4 v[32:35], v2, s[8:11], s45 offen offset:2048 nt
v_and_b32_dpp v112, v99, v16 row_newbcast:3 row_mask:0xf bank_mask:0xf
v_and_b32_dpp v113, v99, v17 row_newbcast:3 row_mask:0xf bank_mask:0xf
v_and_b32_dpp v114, v99, v18 row_newbcast:3 row_mask:0xf bank_mask:0xf
v_and_b32_dpp v115, v99, v19 row_newbcast:3 row_mask:0xf bank_mask:0xf
s_waitcnt vmcnt(11)
v_mfma_f32_16x16x32_bf16 v[108:111], v[116:119], v[36:39], v[108:111]
s_bitcmp1_b32 s47, 2
s_cbranch_scc1 L_th438
s_waitcnt vmcnt(3)
L_th438:
s_waitcnt vmcnt(8)
buffer_load_dwordx4 v[36:39], v2, s[8:11], s45 offen offset:3072 nt
v_and_b32_dpp v116, v99, v16 row_newbcast:7 row_mask:0xf bank_mask:0xf
v_and_b32_dpp v117, v99, v17 row_newbcast:7 row_mask:0xf bank_mask:0xf
v_and_b32_dpp v118, v99, v18 row_newbcast:7 row_mask:0xf bank_mask:0xf
v_and_b32_dpp v119, v99, v19 row_newbcast:7 row_mask:0xf bank_mask:0xf
s_waitcnt vmcnt(11)
v_mfma_f32_16x16x32_bf16 v[108:111], v[112:115], v[40:43], v[108:111]
s_bitcmp1_b32 s47, 2
s_cbranch_scc1 L_th439
s_waitcnt vmcnt(3)
L_th439:
s_waitcnt vmcnt(8)
s_mov_b32 s45, 0x32000
buffer_load_dwordx4 v[40:43], v2, s[8:11], s45 offen offset:0 nt
v_and_b32_dpp v112, v99, v16 row_newbcast:11 row_mask:0xf bank_mask:0xf
v_and_b32_dpp v113, v99, v17 row_newbcast:11 row_mask:0xf bank_mask:0xf
v_and_b32_dpp v114, v99, v18 row_newbcast:11 row_mask:0xf bank_mask:0xf
v_and_b32_dpp v115, v99, v19 row_newbcast:11 row_mask:0xf bank_mask:0xf
s_waitcnt vmcnt(11)
v_mfma_f32_16x16x32_bf16 v[108:111], v[116:119], v[44:47], v[108:111]
s_bitcmp1_b32 s47, 2
s_cbranch_scc1 L_th440
s_waitcnt vmcnt(3)
L_th440:
s_waitcnt vmcnt(8)
buffer_load_dwordx4 v[44:47], v2, s[8:11], s45 offen offset:1024 nt
v_and_b32_dpp v116, v99, v16 row_newbcast:15 row_mask:0xf bank_mask:0xf
v_and_b32_dpp v117, v99, v17 row_newbcast:15 row_mask:0xf bank_mask:0xf
v_and_b32_dpp v118, v99, v18 row_newbcast:15 row_mask:0xf bank_mask:0xf
v_and_b32_dpp v119, v99, v19 row_newbcast:15 row_mask:0xf bank_mask:0xf
s_waitcnt vmcnt(11)
v_mfma_f32_16x16x32_bf16 v[108:111], v[112:115], v[48:51], v[108:111]
s_bitcmp1_b32 s47, 2
s_cbranch_scc1 L_th441
s_waitcnt vmcnt(3)
L_th441:
s_waitcnt vmcnt(8)
buffer_load_dwordx4 v[48:51], v2, s[8:11], s45 offen offset:2048 nt
v_and_b32_dpp v112, v100, v16 row_newbcast:0 row_mask:0xf bank_mask:0xf
v_and_b32_dpp v113, v100, v17 row_newbcast:0 row_mask:0xf bank_mask:0xf
v_and_b32_dpp v114, v100, v18 row_newbcast:0 row_mask:0xf bank_mask:0xf
v_and_b32_dpp v115, v100, v19 row_newbcast:0 row_mask:0xf bank_mask:0xf
s_waitcnt vmcnt(11)
v_mfma_f32_16x16x32_bf16 v[108:111], v[116:119], v[52:55], v[108:111]
s_bitcmp1_b32 s47, 2
s_cbranch_scc1 L_th442
s_waitcnt vmcnt(3)
L_th442:
s_waitcnt vmcnt(8)
buffer_load_dwordx4 v[52:55], v2, s[8:11], s45 offen offset:3072 nt
v_and_b32_dpp v116, v100, v16 row_newbcast:4 row_mask:0xf bank_mask:0xf
v_and_b32_dpp v117, v100, v17 row_newbcast:4 row_mask:0xf bank_mask:0xf
v_and_b32_dpp v118, v100, v18 row_newbcast:4 row_mask:0xf bank_mask:0xf
v_and_b32_dpp v119, v100, v19 row_newbcast:4 row_mask:0xf bank_mask:0xf
s_waitcnt vmcnt(11)
v_mfma_f32_16x16x32_bf16 v[108:111], v[112:115], v[56:59], v[108:111]
s_bitcmp1_b32 s47, 2
s_cbranch_scc1 L_th443
s_waitcnt vmcnt(3)
L_th443:
s_waitcnt vmcnt(8)
s_mov_b32 s45, 0x33000
buffer_load_dwordx4 v[56:59], v2, s[8:11], s45 offen offset:0 nt
v_and_b32_dpp v112, v100, v16 row_newbcast:8 row_mask:0xf bank_mask:0xf
v_and_b32_dpp v113, v100, v17 row_newbcast:8 row_mask:0xf bank_mask:0xf
v_and_b32_dpp v114, v100, v18 row_newbcast:8 row_mask:0xf bank_mask:0xf
v_and_b32_dpp v115, v100, v19 row_newbcast:8 row_mask:0xf bank_mask:0xf
s_waitcnt vmcnt(11)
v_mfma_f32_16x16x32_bf16 v[108:111], v[116:119], v[60:63], v[108:111]
s_bitcmp1_b32 s47, 2
s_cbranch_scc1 L_th444
s_waitcnt vmcnt(3)
L_th444:
s_waitcnt vmcnt(8)
buffer_load_dwordx4 v[60:63], v2, s[8:11], s45 offen offset:1024 nt
v_and_b32_dpp v116, v100, v16 row_newbcast:12 row_mask:0xf bank_mask:0xf
v_and_b32_dpp v117, v100, v17 row_newbcast:12 row_mask:0xf bank_mask:0xf
v_and_b32_dpp v118, v100, v18 row_newbcast:12 row_mask:0xf bank_mask:0xf
v_and_b32_dpp v119, v100, v19 row_newbcast:12 row_mask:0xf bank_mask:0xf
s_waitcnt vmcnt(11)
v_mfma_f32_16x16x32_bf16 v[108:111], v[112:115], v[64:67], v[108:111]
s_bitcmp1_b32 s47, 2
s_cbranch_scc1 L_th445
s_waitcnt vmcnt(3)
L_th445:
s_waitcnt vmcnt(8)
buffer_load_dwordx4 v[64:67], v2, s[8:11], s45 offen offset:2048 nt
v_and_b32_dpp v112, v100, v16 row_newbcast:1 row_mask:0xf bank_mask:0xf
v_and_b32_dpp v113, v100, v17 row_newbcast:1 row_mask:0xf bank_mask:0xf
v_and_b32_dpp v114, v100, v18 row_newbcast:1 row_mask:0xf bank_mask:0xf
v_and_b32_dpp v115, v100, v19 row_newbcast:1 row_mask:0xf bank_mask:0xf
s_waitcnt vmcnt(11)
v_mfma_f32_16x16x32_bf16 v[108:111], v[116:119], v[68:71], v[108:111]
s_bitcmp1_b32 s47, 2
s_cbranch_scc1 L_th446
s_waitcnt vmcnt(3)
L_th446:
s_waitcnt vmcnt(8)
buffer_load_dwordx4 v[68:71], v2, s[8:11], s45 offen offset:3072 nt
v_and_b32_dpp v116, v100, v16 row_newbcast:5 row_mask:0xf bank_mask:0xf
v_and_b32_dpp v117, v100, v17 row_newbcast:5 row_mask:0xf bank_mask:0xf
v_and_b32_dpp v118, v100, v18 row_newbcast:5 row_mask:0xf bank_mask:0xf
v_and_b32_dpp v119, v100, v19 row_newbcast:5 row_mask:0xf bank_mask:0xf
s_waitcnt vmcnt(11)
v_mfma_f32_16x16x32_bf16 v[108:111], v[112:115], v[24:27], v[108:111]
s_bitcmp1_b32 s47, 2
s_cbranch_scc1 L_th447
s_waitcnt vmcnt(3)
L_th447:
s_waitcnt vmcnt(8)
s_mov_b32 s45, 0x34000
buffer_load_dwordx4 v[24:27], v2, s[8:11], s45 offen offset:0 nt
v_and_b32_dpp v112, v100, v16 row_newbcast:9 row_mask:0xf bank_mask:0xf
v_and_b32_dpp v113, v100, v17 row_newbcast:9 row_mask:0xf bank_mask:0xf
v_and_b32_dpp v114, v100, v18 row_newbcast:9 row_mask:0xf bank_mask:0xf
v_and_b32_dpp v115, v100, v19 row_newbcast:9 row_mask:0xf bank_mask:0xf
s_waitcnt vmcnt(11)
v_mfma_f32_16x16x32_bf16 v[108:111], v[116:119], v[28:31], v[108:111]
s_bitcmp1_b32 s47, 2
s_cbranch_scc1 L_th448
s_waitcnt vmcnt(3)
L_th448:
s_waitcnt vmcnt(8)
buffer_load_dwordx4 v[28:31], v2, s[8:11], s45 offen offset:1024 nt
v_and_b32_dpp v116, v100, v16 row_newbcast:13 row_mask:0xf bank_mask:0xf
v_and_b32_dpp v117, v100, v17 row_newbcast:13 row_mask:0xf bank_mask:0xf
v_and_b32_dpp v118, v100, v18 row_newbcast:13 row_mask:0xf bank_mask:0xf
v_and_b32_dpp v119, v100, v19 row_newbcast:13 row_mask:0xf bank_mask:0xf
s_waitcnt vmcnt(11)
v_mfma_f32_16x16x32_bf16 v[108:111], v[112:115], v[32:35], v[108:111]
s_bitcmp1_b32 s47, 2
s_cbranch_scc1 L_th449
s_waitcnt vmcnt(3)
L_th449:
s_waitcnt vmcnt(8)
buffer_load_dwordx4 v[32:35], v2, s[8:11], s45 offen offset:2048 nt
v_and_b32_dpp v112, v100, v16 row_newbcast:2 row_mask:0xf bank_mask:0xf
v_and_b32_dpp v113, v100, v17 row_newbcast:2 row_mask:0xf bank_mask:0xf
v_and_b32_dpp v114, v100, v18 row_newbcast:2 row_mask:0xf bank_mask:0xf
v_and_b32_dpp v115, v100, v19 row_newbcast:2 row_mask:0xf bank_mask:0xf
s_waitcnt vmcnt(11)
v_mfma_f32_16x16x32_bf16 v[108:111], v[116:119], v[36:39], v[108:111]
s_bitcmp1_b32 s47, 2
s_cbranch_scc1 L_th450
s_waitcnt vmcnt(3)
L_th450:
s_waitcnt vmcnt(8)
buffer_load_dwordx4 v[36:39], v2, s[8:11], s45 offen offset:3072 nt
v_and_b32_dpp v116, v100, v16 row_newbcast:6 row_mask:0xf bank_mask:0xf
v_and_b32_dpp v117, v100, v17 row_newbcast:6 row_mask:0xf bank_mask:0xf
v_and_b32_dpp v118, v100, v18 row_newbcast:6 row_mask:0xf bank_mask:0xf
v_and_b32_dpp v119, v100, v19 row_newbcast:6 row_mask:0xf bank_mask:0xf
s_waitcnt vmcnt(11)
v_mfma_f32_16x16x32_bf16 v[108:111], v[112:115], v[40:43], v[108:111]
s_bitcmp1_b32 s47, 2
s_cbranch_scc1 L_th451
s_waitcnt vmcnt(3)
L_th451:
s_waitcnt vmcnt(8)
s_mov_b32 s45, 0x35000
buffer_load_dwordx4 v[40:43], v2, s[8:11], s45 offen offset:0 nt
v_and_b32_dpp v112, v100, v16 row_newbcast:10 row_mask:0xf bank_mask:0xf
v_and_b32_dpp v113, v100, v17 row_newbcast:10 row_mask:0xf bank_mask:0xf
v_and_b32_dpp v114, v100, v18 row_newbcast:10 row_mask:0xf bank_mask:0xf
v_and_b32_dpp v115, v100, v19 row_newbcast:10 row_mask:0xf bank_mask:0xf
s_waitcnt vmcnt(11)
v_mfma_f32_16x16x32_bf16 v[108:111], v[116:119], v[44:47], v[108:111]
s_bitcmp1_b32 s47, 2
s_cbranch_scc1 L_th452
s_waitcnt vmcnt(3)
L_th452:
s_waitcnt vmcnt(8)
buffer_load_dwordx4 v[44:47], v2, s[8:11], s45 offen offset:1024 nt
v_and_b32_dpp v116, v100, v16 row_newbcast:14 row_mask:0xf bank_mask:0xf
v_and_b32_dpp v117, v100, v17 row_newbcast:14 row_mask:0xf bank_mask:0xf
v_and_b32_dpp v118, v100, v18 row_newbcast:14 row_mask:0xf bank_mask:0xf
v_and_b32_dpp v119, v100, v19 row_newbcast:14 row_mask:0xf bank_mask:0xf
s_waitcnt vmcnt(11)
v_mfma_f32_16x16x32_bf16 v[108:111], v[112:115], v[48:51], v[108:111]
s_bitcmp1_b32 s47, 2
s_cbranch_scc1 L_th453
s_waitcnt vmcnt(3)
L_th453:
s_waitcnt vmcnt(8)
buffer_load_dwordx4 v[48:51], v2, s[8:11], s45 offen offset:2048 nt
v_and_b32_dpp v112, v100, v16 row_newbcast:3 row_mask:0xf bank_mask:0xf
v_and_b32_dpp v113, v100, v17 row_newbcast:3 row_mask:0xf bank_mask:0xf
v_and_b32_dpp v114, v100, v18 row_newbcast:3 row_mask:0xf bank_mask:0xf
v_and_b32_dpp v115, v100, v19 row_newbcast:3 row_mask:0xf bank_mask:0xf
s_waitcnt vmcnt(11)
v_mfma_f32_16x16x32_bf16 v[108:111], v[116:119], v[52:55], v[108:111]
s_bitcmp1_b32 s47, 2
s_cbranch_scc1 L_th454
s_waitcnt vmcnt(3)
L_th454:
s_waitcnt vmcnt(8)
buffer_load_dwordx4 v[52:55], v2, s[8:11], s45 offen offset:3072 nt
v_and_b32_dpp v116, v100, v16 row_newbcast:7 row_mask:0xf bank_mask:0xf
v_and_b32_dpp v117, v100, v17 row_newbcast:7 row_mask:0xf bank_mask:0xf
v_and_b32_dpp v118, v100, v18 row_newbcast:7 row_mask:0xf bank_mask:0xf
v_and_b32_dpp v119, v100, v19 row_newbcast:7 row_mask:0xf bank_mask:0xf
s_waitcnt vmcnt(11)
v_mfma_f32_16x16x32_bf16 v[108:111], v[112:115], v[56:59], v[108:111]
s_bitcmp1_b32 s47, 2
s_cbranch_scc1 L_th455
s_waitcnt vmcnt(3)
L_th455:
s_waitcnt vmcnt(8)
s_mov_b32 s45, 0x36000
buffer_load_dwordx4 v[56:59], v2, s[8:11], s45 offen offset:0 nt
v_and_b32_dpp v112, v100, v16 row_newbcast:11 row_mask:0xf bank_mask:0xf
v_and_b32_dpp v113, v100, v17 row_newbcast:11 row_mask:0xf bank_mask:0xf
v_and_b32_dpp v114, v100, v18 row_newbcast:11 row_mask:0xf bank_mask:0xf
v_and_b32_dpp v115, v100, v19 row_newbcast:11 row_mask:0xf bank_mask:0xf
s_waitcnt vmcnt(11)
v_mfma_f32_16x16x32_bf16 v[108:111], v[116:119], v[60:63], v[108:111]
s_bitcmp1_b32 s47, 2
s_cbranch_scc1 L_th456
s_waitcnt vmcnt(3)
L_th456:
s_waitcnt vmcnt(8)
buffer_load_dwordx4 v[60:63], v2, s[8:11], s45 offen offset:1024 nt
v_and_b32_dpp v116, v100, v16 row_newbcast:15 row_mask:0xf bank_mask:0xf
v_and_b32_dpp v117, v100, v17 row_newbcast:15 row_mask:0xf bank_mask:0xf
v_and_b32_dpp v118, v100, v18 row_newbcast:15 row_mask:0xf bank_mask:0xf
v_and_b32_dpp v119, v100, v19 row_newbcast:15 row_mask:0xf bank_mask:0xf
s_waitcnt vmcnt(11)
v_mfma_f32_16x16x32_bf16 v[108:111], v[112:115], v[64:67], v[108:111]
s_bitcmp1_b32 s47, 2
s_cbranch_scc1 L_th457
s_waitcnt vmcnt(3)
L_th457:
s_waitcnt vmcnt(8)
buffer_load_dwordx4 v[64:67], v2, s[8:11], s45 offen offset:2048 nt
v_and_b32_dpp v112, v101, v16 row_newbcast:0 row_mask:0xf bank_mask:0xf
v_and_b32_dpp v113, v101, v17 row_newbcast:0 row_mask:0xf bank_mask:0xf
v_and_b32_dpp v114, v101, v18 row_newbcast:0 row_mask:0xf bank_mask:0xf
v_and_b32_dpp v115, v101, v19 row_newbcast:0 row_mask:0xf bank_mask:0xf
s_waitcnt vmcnt(11)
v_mfma_f32_16x16x32_bf16 v[108:111], v[116:119], v[68:71], v[108:111]
s_bitcmp1_b32 s47, 2
s_cbranch_scc1 L_th458
s_waitcnt vmcnt(3)
L_th458:
s_waitcnt vmcnt(8)
buffer_load_dwordx4 v[68:71], v2, s[8:11], s45 offen offset:3072 nt
v_and_b32_dpp v116, v101, v16 row_newbcast:4 row_mask:0xf bank_mask:0xf
v_and_b32_dpp v117, v101, v17 row_newbcast:4 row_mask:0xf bank_mask:0xf
v_and_b32_dpp v118, v101, v18 row_newbcast:4 row_mask:0xf bank_mask:0xf
v_and_b32_dpp v119, v101, v19 row_newbcast:4 row_mask:0xf bank_mask:0xf
s_waitcnt vmcnt(11)
v_mfma_f32_16x16x32_bf16 v[108:111], v[112:115], v[24:27], v[108:111]
s_bitcmp1_b32 s47, 2
s_cbranch_scc1 L_th459
s_waitcnt vmcnt(3)
L_th459:
s_waitcnt vmcnt(8)
s_mov_b32 s45, 0x37000
buffer_load_dwordx4 v[24:27], v2, s[8:11], s45 offen offset:0 nt
v_and_b32_dpp v112, v101, v16 row_newbcast:8 row_mask:0xf bank_mask:0xf
v_and_b32_dpp v113, v101, v17 row_newbcast:8 row_mask:0xf bank_mask:0xf
v_and_b32_dpp v114, v101, v18 row_newbcast:8 row_mask:0xf bank_mask:0xf
v_and_b32_dpp v115, v101, v19 row_newbcast:8 row_mask:0xf bank_mask:0xf
s_waitcnt vmcnt(11)
v_mfma_f32_16x16x32_bf16 v[108:111], v[116:119], v[28:31], v[108:111]
s_bitcmp1_b32 s47, 2
s_cbranch_scc1 L_th460
s_waitcnt vmcnt(3)
L_th460:
s_waitcnt vmcnt(8)
buffer_load_dwordx4 v[28:31], v2, s[8:11], s45 offen offset:1024 nt
v_and_b32_dpp v116, v101, v16 row_newbcast:12 row_mask:0xf bank_mask:0xf
v_and_b32_dpp v117, v101, v17 row_newbcast:12 row_mask:0xf bank_mask:0xf
v_and_b32_dpp v118, v101, v18 row_newbcast:12 row_mask:0xf bank_mask:0xf
v_and_b32_dpp v119, v101, v19 row_newbcast:12 row_mask:0xf bank_mask:0xf
s_waitcnt vmcnt(11)
v_mfma_f32_16x16x32_bf16 v[108:111], v[112:115], v[32:35], v[108:111]
s_bitcmp1_b32 s47, 2
s_cbranch_scc1 L_th461
s_waitcnt vmcnt(3)
L_th461:
s_waitcnt vmcnt(8)
buffer_load_dwordx4 v[32:35], v2, s[8:11], s45 offen offset:2048 nt
v_and_b32_dpp v112, v101, v16 row_newbcast:1 row_mask:0xf bank_mask:0xf
v_and_b32_dpp v113, v101, v17 row_newbcast:1 row_mask:0xf bank_mask:0xf
v_and_b32_dpp v114, v101, v18 row_newbcast:1 row_mask:0xf bank_mask:0xf
v_and_b32_dpp v115, v101, v19 row_newbcast:1 row_mask:0xf bank_mask:0xf
s_waitcnt vmcnt(11)
v_mfma_f32_16x16x32_bf16 v[108:111], v[116:119], v[36:39], v[108:111]
s_bitcmp1_b32 s47, 2
s_cbranch_scc1 L_th462
s_waitcnt vmcnt(3)
L_th462:
s_waitcnt vmcnt(8)
buffer_load_dwordx4 v[36:39], v2, s[8:11], s45 offen offset:3072 nt
v_and_b32_dpp v116, v101, v16 row_newbcast:5 row_mask:0xf bank_mask:0xf
v_and_b32_dpp v117, v101, v17 row_newbcast:5 row_mask:0xf bank_mask:0xf
v_and_b32_dpp v118, v101, v18 row_newbcast:5 row_mask:0xf bank_mask:0xf
v_and_b32_dpp v119, v101, v19 row_newbcast:5 row_mask:0xf bank_mask:0xf
s_waitcnt vmcnt(11)
v_mfma_f32_16x16x32_bf16 v[108:111], v[112:115], v[40:43], v[108:111]
s_bitcmp1_b32 s47, 2
s_cbranch_scc1 L_th463
s_waitcnt vmcnt(3)
L_th463:
s_waitcnt vmcnt(8)
s_mov_b32 s45, 0x38000
buffer_load_dwordx4 v[40:43], v2, s[8:11], s45 offen offset:0 nt
v_and_b32_dpp v112, v101, v16 row_newbcast:9 row_mask:0xf bank_mask:0xf
v_and_b32_dpp v113, v101, v17 row_newbcast:9 row_mask:0xf bank_mask:0xf
v_and_b32_dpp v114, v101, v18 row_newbcast:9 row_mask:0xf bank_mask:0xf
v_and_b32_dpp v115, v101, v19 row_newbcast:9 row_mask:0xf bank_mask:0xf
s_waitcnt vmcnt(11)
v_mfma_f32_16x16x32_bf16 v[108:111], v[116:119], v[44:47], v[108:111]
s_bitcmp1_b32 s47, 2
s_cbranch_scc1 L_th464
s_waitcnt vmcnt(3)
L_th464:
s_waitcnt vmcnt(8)
buffer_load_dwordx4 v[44:47], v2, s[8:11], s45 offen offset:1024 nt
v_and_b32_dpp v116, v101, v16 row_newbcast:13 row_mask:0xf bank_mask:0xf
v_and_b32_dpp v117, v101, v17 row_newbcast:13 row_mask:0xf bank_mask:0xf
v_and_b32_dpp v118, v101, v18 row_newbcast:13 row_mask:0xf bank_mask:0xf
v_and_b32_dpp v119, v101, v19 row_newbcast:13 row_mask:0xf bank_mask:0xf
s_waitcnt vmcnt(11)
v_mfma_f32_16x16x32_bf16 v[108:111], v[112:115], v[48:51], v[108:111]
s_bitcmp1_b32 s47, 2
s_cbranch_scc1 L_th465
s_waitcnt vmcnt(3)
L_th465:
s_waitcnt vmcnt(8)
buffer_load_dwordx4 v[48:51], v2, s[8:11], s45 offen offset:2048 nt
v_and_b32_dpp v112, v101, v16 row_newbcast:2 row_mask:0xf bank_mask:0xf
v_and_b32_dpp v113, v101, v17 row_newbcast:2 row_mask:0xf bank_mask:0xf
v_and_b32_dpp v114, v101, v18 row_newbcast:2 row_mask:0xf bank_mask:0xf
v_and_b32_dpp v115, v101, v19 row_newbcast:2 row_mask:0xf bank_mask:0xf
s_waitcnt vmcnt(11)
v_mfma_f32_16x16x32_bf16 v[108:111], v[116:119], v[52:55], v[108:111]
s_bitcmp1_b32 s47, 2
s_cbranch_scc1 L_th466
s_waitcnt vmcnt(3)
L_th466:
s_waitcnt vmcnt(8)
buffer_load_dwordx4 v[52:55], v2, s[8:11], s45 offen offset:3072 nt
v_and_b32_dpp v116, v101, v16 row_newbcast:6 row_mask:0xf bank_mask:0xf
v_and_b32_dpp v117, v101, v17 row_newbcast:6 row_mask:0xf bank_mask:0xf
v_and_b32_dpp v118, v101, v18 row_newbcast:6 row_mask:0xf bank_mask:0xf
v_and_b32_dpp v119, v101, v19 row_newbcast:6 row_mask:0xf bank_mask:0xf
s_waitcnt vmcnt(11)
v_mfma_f32_16x16x32_bf16 v[108:111], v[112:115], v[56:59], v[108:111]
s_bitcmp1_b32 s47, 2
s_cbranch_scc1 L_th467
s_waitcnt vmcnt(3)
L_th467:
s_waitcnt vmcnt(8)
s_mov_b32 s45, 0x39000
buffer_load_dwordx4 v[56:59], v2, s[8:11], s45 offen offset:0 nt
v_and_b32_dpp v112, v101, v16 row_newbcast:10 row_mask:0xf bank_mask:0xf
v_and_b32_dpp v113, v101, v17 row_newbcast:10 row_mask:0xf bank_mask:0xf
v_and_b32_dpp v114, v101, v18 row_newbcast:10 row_mask:0xf bank_mask:0xf
v_and_b32_dpp v115, v101, v19 row_newbcast:10 row_mask:0xf bank_mask:0xf
s_waitcnt vmcnt(11)
v_mfma_f32_16x16x32_bf16 v[108:111], v[116:119], v[60:63], v[108:111]
s_bitcmp1_b32 s47, 2
s_cbranch_scc1 L_th468
s_waitcnt vmcnt(3)
L_th468:
s_waitcnt vmcnt(8)
buffer_load_dwordx4 v[60:63], v2, s[8:11], s45 offen offset:1024 nt
v_and_b32_dpp v116, v101, v16 row_newbcast:14 row_mask:0xf bank_mask:0xf
v_and_b32_dpp v117, v101, v17 row_newbcast:14 row_mask:0xf bank_mask:0xf
v_and_b32_dpp v118, v101, v18 row_newbcast:14 row_mask:0xf bank_mask:0xf
v_and_b32_dpp v119, v101, v19 row_newbcast:14 row_mask:0xf bank_mask:0xf
s_waitcnt vmcnt(11)
v_mfma_f32_16x16x32_bf16 v[108:111], v[112:115], v[64:67], v[108:111]
s_bitcmp1_b32 s47, 2
s_cbranch_scc1 L_th469
s_waitcnt vmcnt(3)
L_th469:
s_waitcnt vmcnt(8)
buffer_load_dwordx4 v[64:67], v2, s[8:11], s45 offen offset:2048 nt
v_and_b32_dpp v112, v101, v16 row_newbcast:3 row_mask:0xf bank_mask:0xf
v_and_b32_dpp v113, v101, v17 row_newbcast:3 row_mask:0xf bank_mask:0xf
v_and_b32_dpp v114, v101, v18 row_newbcast:3 row_mask:0xf bank_mask:0xf
v_and_b32_dpp v115, v101, v19 row_newbcast:3 row_mask:0xf bank_mask:0xf
s_waitcnt vmcnt(11)
v_mfma_f32_16x16x32_bf16 v[108:111], v[116:119], v[68:71], v[108:111]
s_bitcmp1_b32 s47, 2
s_cbranch_scc1 L_th470
s_waitcnt vmcnt(3)
L_th470:
s_waitcnt vmcnt(8)
buffer_load_dwordx4 v[68:71], v2, s[8:11], s45 offen offset:3072 nt
v_and_b32_dpp v116, v101, v16 row_newbcast:7 row_mask:0xf bank_mask:0xf
v_and_b32_dpp v117, v101, v17 row_newbcast:7 row_mask:0xf bank_mask:0xf
v_and_b32_dpp v118, v101, v18 row_newbcast:7 row_mask:0xf bank_mask:0xf
v_and_b32_dpp v119, v101, v19 row_newbcast:7 row_mask:0xf bank_mask:0xf
s_waitcnt vmcnt(11)
v_mfma_f32_16x16x32_bf16 v[108:111], v[112:115], v[24:27], v[108:111]
s_bitcmp1_b32 s47, 2
s_cbranch_scc1 L_th471
s_waitcnt vmcnt(3)
L_th471:
s_waitcnt vmcnt(8)
s_mov_b32 s45, 0x3a000
buffer_load_dwordx4 v[24:27], v2, s[8:11], s45 offen offset:0 nt
v_and_b32_dpp v112, v101, v16 row_newbcast:11 row_mask:0xf bank_mask:0xf
v_and_b32_dpp v113, v101, v17 row_newbcast:11 row_mask:0xf bank_mask:0xf
v_and_b32_dpp v114, v101, v18 row_newbcast:11 row_mask:0xf bank_mask:0xf
v_and_b32_dpp v115, v101, v19 row_newbcast:11 row_mask:0xf bank_mask:0xf
s_waitcnt vmcnt(11)
v_mfma_f32_16x16x32_bf16 v[108:111], v[116:119], v[28:31], v[108:111]
s_bitcmp1_b32 s47, 2
s_cbranch_scc1 L_th472
s_waitcnt vmcnt(3)
L_th472:
s_waitcnt vmcnt(8)
buffer_load_dwordx4 v[28:31], v2, s[8:11], s45 offen offset:1024 nt
v_and_b32_dpp v116, v101, v16 row_newbcast:15 row_mask:0xf bank_mask:0xf
v_and_b32_dpp v117, v101, v17 row_newbcast:15 row_mask:0xf bank_mask:0xf
v_and_b32_dpp v118, v101, v18 row_newbcast:15 row_mask:0xf bank_mask:0xf
v_and_b32_dpp v119, v101, v19 row_newbcast:15 row_mask:0xf bank_mask:0xf
s_waitcnt vmcnt(11)
v_mfma_f32_16x16x32_bf16 v[108:111], v[112:115], v[32:35], v[108:111]
s_bitcmp1_b32 s47, 2
s_cbranch_scc1 L_th473
s_waitcnt vmcnt(3)
L_th473:
s_waitcnt vmcnt(8)
buffer_load_dwordx4 v[32:35], v2, s[8:11], s45 offen offset:2048 nt
v_and_b32_dpp v112, v102, v16 row_newbcast:0 row_mask:0xf bank_mask:0xf
v_and_b32_dpp v113, v102, v17 row_newbcast:0 row_mask:0xf bank_mask:0xf
v_and_b32_dpp v114, v102, v18 row_newbcast:0 row_mask:0xf bank_mask:0xf
v_and_b32_dpp v115, v102, v19 row_newbcast:0 row_mask:0xf bank_mask:0xf
s_waitcnt vmcnt(11)
v_mfma_f32_16x16x32_bf16 v[108:111], v[116:119], v[36:39], v[108:111]
s_bitcmp1_b32 s47, 2
s_cbranch_scc1 L_th474
s_waitcnt vmcnt(3)
L_th474:
s_waitcnt vmcnt(8)
buffer_load_dwordx4 v[36:39], v2, s[8:11], s45 offen offset:3072 nt
v_and_b32_dpp v116, v102, v16 row_newbcast:4 row_mask:0xf bank_mask:0xf
v_and_b32_dpp v117, v102, v17 row_newbcast:4 row_mask:0xf bank_mask:0xf
v_and_b32_dpp v118, v102, v18 row_newbcast:4 row_mask:0xf bank_mask:0xf
v_and_b32_dpp v119, v102, v19 row_newbcast:4 row_mask:0xf bank_mask:0xf
s_waitcnt vmcnt(11)
v_mfma_f32_16x16x32_bf16 v[108:111], v[112:115], v[40:43], v[108:111]
s_bitcmp1_b32 s47, 2
s_cbranch_scc1 L_th475
s_waitcnt vmcnt(3)
L_th475:
s_waitcnt vmcnt(8)
s_mov_b32 s45, 0x3b000
buffer_load_dwordx4 v[40:43], v2, s[8:11], s45 offen offset:0 nt
v_and_b32_dpp v112, v102, v16 row_newbcast:8 row_mask:0xf bank_mask:0xf
v_and_b32_dpp v113, v102, v17 row_newbcast:8 row_mask:0xf bank_mask:0xf
v_and_b32_dpp v114, v102, v18 row_newbcast:8 row_mask:0xf bank_mask:0xf
v_and_b32_dpp v115, v102, v19 row_newbcast:8 row_mask:0xf bank_mask:0xf
s_waitcnt vmcnt(11)
v_mfma_f32_16x16x32_bf16 v[108:111], v[116:119], v[44:47], v[108:111]
s_bitcmp1_b32 s47, 2
s_cbranch_scc1 L_th476
s_waitcnt vmcnt(3)
L_th476:
s_waitcnt vmcnt(8)
buffer_load_dwordx4 v[44:47], v2, s[8:11], s45 offen offset:1024 nt
v_and_b32_dpp v116, v102, v16 row_newbcast:12 row_mask:0xf bank_mask:0xf
v_and_b32_dpp v117, v102, v17 row_newbcast:12 row_mask:0xf bank_mask:0xf
v_and_b32_dpp v118, v102, v18 row_newbcast:12 row_mask:0xf bank_mask:0xf
v_and_b32_dpp v119, v102, v19 row_newbcast:12 row_mask:0xf bank_mask:0xf
s_waitcnt vmcnt(11)
v_mfma_f32_16x16x32_bf16 v[108:111], v[112:115], v[48:51], v[108:111]
buffer_load_dwordx4 v[48:51], v2, s[8:11], s45 offen offset:2048 nt
v_and_b32_dpp v112, v102, v16 row_newbcast:1 row_mask:0xf bank_mask:0xf
v_and_b32_dpp v113, v102, v17 row_newbcast:1 row_mask:0xf bank_mask:0xf
v_and_b32_dpp v114, v102, v18 row_newbcast:1 row_mask:0xf bank_mask:0xf
v_and_b32_dpp v115, v102, v19 row_newbcast:1 row_mask:0xf bank_mask:0xf
s_waitcnt vmcnt(11)
v_mfma_f32_16x16x32_bf16 v[108:111], v[116:119], v[52:55], v[108:111]
buffer_load_dwordx4 v[52:55], v2, s[8:11], s45 offen offset:3072 nt
v_and_b32_dpp v116, v102, v16 row_newbcast:5 row_mask:0xf bank_mask:0xf
v_and_b32_dpp v117, v102, v17 row_newbcast:5 row_mask:0xf bank_mask:0xf
v_and_b32_dpp v118, v102, v18 row_newbcast:5 row_mask:0xf bank_mask:0xf
v_and_b32_dpp v119, v102, v19 row_newbcast:5 row_mask:0xf bank_mask:0xf
s_waitcnt vmcnt(11)
v_mfma_f32_16x16x32_bf16 v[108:111], v[112:115], v[56:59], v[108:111]
s_mov_b32 s45, 0x3c000
buffer_load_dwordx4 v[56:59], v2, s[8:11], s45 offen offset:0 nt
v_and_b32_dpp v112, v102, v16 row_newbcast:9 row_mask:0xf bank_mask:0xf
v_and_b32_dpp v113, v102, v17 row_newbcast:9 row_mask:0xf bank_mask:0xf
v_and_b32_dpp v114, v102, v18 row_newbcast:9 row_mask:0xf bank_mask:0xf
v_and_b32_dpp v115, v102, v19 row_newbcast:9 row_mask:0xf bank_mask:0xf
s_waitcnt vmcnt(11)
v_mfma_f32_16x16x32_bf16 v[108:111], v[116:119], v[60:63], v[108:111]
buffer_load_dwordx4 v[60:63], v2, s[8:11], s45 offen offset:1024 nt
v_and_b32_dpp v116, v102, v16 row_newbcast:13 row_mask:0xf bank_mask:0xf
v_and_b32_dpp v117, v102, v17 row_newbcast:13 row_mask:0xf bank_mask:0xf
v_and_b32_dpp v118, v102, v18 row_newbcast:13 row_mask:0xf bank_mask:0xf
v_and_b32_dpp v119, v102, v19 row_newbcast:13 row_mask:0xf bank_mask:0xf
s_waitcnt vmcnt(11)
v_mfma_f32_16x16x32_bf16 v[108:111], v[112:115], v[64:67], v[108:111]
buffer_load_dwordx4 v[64:67], v2, s[8:11], s45 offen offset:2048 nt
v_and_b32_dpp v112, v102, v16 row_newbcast:2 row_mask:0xf bank_mask:0xf
v_and_b32_dpp v113, v102, v17 row_newbcast:2 row_mask:0xf bank_mask:0xf
v_and_b32_dpp v114, v102, v18 row_newbcast:2 row_mask:0xf bank_mask:0xf
v_and_b32_dpp v115, v102, v19 row_newbcast:2 row_mask:0xf bank_mask:0xf
s_waitcnt vmcnt(11)
v_mfma_f32_16x16x32_bf16 v[108:111], v[116:119], v[68:71], v[108:111]
buffer_load_dwordx4 v[68:71], v2, s[8:11], s45 offen offset:3072 nt
v_and_b32_dpp v116, v102, v16 row_newbcast:6 row_mask:0xf bank_mask:0xf
v_and_b32_dpp v117, v102, v17 row_newbcast:6 row_mask:0xf bank_mask:0xf
v_and_b32_dpp v118, v102, v18 row_newbcast:6 row_mask:0xf bank_mask:0xf
v_and_b32_dpp v119, v102, v19 row_newbcast:6 row_mask:0xf bank_mask:0xf
s_waitcnt vmcnt(11)
v_mfma_f32_16x16x32_bf16 v[108:111], v[112:115], v[24:27], v[108:111]
s_mov_b32 s45, 0x3d000
buffer_load_dwordx4 v[24:27], v2, s[8:11], s45 offen offset:0 nt
v_and_b32_dpp v112, v102, v16 row_newbcast:10 row_mask:0xf bank_mask:0xf
v_and_b32_dpp v113, v102, v17 row_newbcast:10 row_mask:0xf bank_mask:0xf
v_and_b32_dpp v114, v102, v18 row_newbcast:10 row_mask:0xf bank_mask:0xf
v_and_b32_dpp v115, v102, v19 row_newbcast:10 row_mask:0xf bank_mask:0xf
s_waitcnt vmcnt(11)
v_mfma_f32_16x16x32_bf16 v[108:111], v[116:119], v[28:31], v[108:111]
buffer_load_dwordx4 v[28:31], v2, s[8:11], s45 offen offset:1024 nt
v_and_b32_dpp v116, v102, v16 row_newbcast:14 row_mask:0xf bank_mask:0xf
v_and_b32_dpp v117, v102, v17 row_newbcast:14 row_mask:0xf bank_mask:0xf
v_and_b32_dpp v118, v102, v18 row_newbcast:14 row_mask:0xf bank_mask:0xf
v_and_b32_dpp v119, v102, v19 row_newbcast:14 row_mask:0xf bank_mask:0xf
s_waitcnt vmcnt(11)
v_mfma_f32_16x16x32_bf16 v[108:111], v[112:115], v[32:35], v[108:111]
buffer_load_dwordx4 v[32:35], v2, s[8:11], s45 offen offset:2048 nt
v_and_b32_dpp v112, v102, v16 row_newbcast:3 row_mask:0xf bank_mask:0xf
v_and_b32_dpp v113, v102, v17 row_newbcast:3 row_mask:0xf bank_mask:0xf
v_and_b32_dpp v114, v102, v18 row_newbcast:3 row_mask:0xf bank_mask:0xf
v_and_b32_dpp v115, v102, v19 row_newbcast:3 row_mask:0xf bank_mask:0xf
s_waitcnt vmcnt(11)
v_mfma_f32_16x16x32_bf16 v[108:111], v[116:119], v[36:39], v[108:111]
buffer_load_dwordx4 v[36:39], v2, s[8:11], s45 offen offset:3072 nt
v_and_b32_dpp v116, v102, v16 row_newbcast:7 row_mask:0xf bank_mask:0xf
v_and_b32_dpp v117, v102, v17 row_newbcast:7 row_mask:0xf bank_mask:0xf
v_and_b32_dpp v118, v102, v18 row_newbcast:7 row_mask:0xf bank_mask:0xf
v_and_b32_dpp v119, v102, v19 row_newbcast:7 row_mask:0xf bank_mask:0xf
s_waitcnt vmcnt(11)
v_mfma_f32_16x16x32_bf16 v[108:111], v[112:115], v[40:43], v[108:111]
s_mov_b32 s45, 0x3e000
buffer_load_dwordx4 v[40:43], v2, s[8:11], s45 offen offset:0 nt
v_and_b32_dpp v112, v102, v16 row_newbcast:11 row_mask:0xf bank_mask:0xf
v_and_b32_dpp v113, v102, v17 row_newbcast:11 row_mask:0xf bank_mask:0xf
v_and_b32_dpp v114, v102, v18 row_newbcast:11 row_mask:0xf bank_mask:0xf
v_and_b32_dpp v115, v102, v19 row_newbcast:11 row_mask:0xf bank_mask:0xf
s_waitcnt vmcnt(11)
v_mfma_f32_16x16x32_bf16 v[108:111], v[116:119], v[44:47], v[108:111]
buffer_load_dwordx4 v[44:47], v2, s[8:11], s45 offen offset:1024 nt
v_and_b32_dpp v116, v102, v16 row_newbcast:15 row_mask:0xf bank_mask:0xf
v_and_b32_dpp v117, v102, v17 row_newbcast:15 row_mask:0xf bank_mask:0xf
v_and_b32_dpp v118, v102, v18 row_newbcast:15 row_mask:0xf bank_mask:0xf
v_and_b32_dpp v119, v102, v19 row_newbcast:15 row_mask:0xf bank_mask:0xf
s_waitcnt vmcnt(11)
v_mfma_f32_16x16x32_bf16 v[108:111], v[112:115], v[48:51], v[108:111]
buffer_load_dwordx4 v[48:51], v2, s[8:11], s45 offen offset:2048 nt
v_and_b32_dpp v112, v103, v16 row_newbcast:0 row_mask:0xf bank_mask:0xf
v_and_b32_dpp v113, v103, v17 row_newbcast:0 row_mask:0xf bank_mask:0xf
v_and_b32_dpp v114, v103, v18 row_newbcast:0 row_mask:0xf bank_mask:0xf
v_and_b32_dpp v115, v103, v19 row_newbcast:0 row_mask:0xf bank_mask:0xf
s_waitcnt vmcnt(11)
v_mfma_f32_16x16x32_bf16 v[108:111], v[116:119], v[52:55], v[108:111]
buffer_load_dwordx4 v[52:55], v2, s[8:11], s45 offen offset:3072 nt
v_and_b32_dpp v116, v103, v16 row_newbcast:4 row_mask:0xf bank_mask:0xf
v_and_b32_dpp v117, v103, v17 row_newbcast:4 row_mask:0xf bank_mask:0xf
v_and_b32_dpp v118, v103, v18 row_newbcast:4 row_mask:0xf bank_mask:0xf
v_and_b32_dpp v119, v103, v19 row_newbcast:4 row_mask:0xf bank_mask:0xf
s_waitcnt vmcnt(11)
v_mfma_f32_16x16x32_bf16 v[108:111], v[112:115], v[56:59], v[108:111]
s_mov_b32 s45, 0x3f000
buffer_load_dwordx4 v[56:59], v2, s[8:11], s45 offen offset:0 nt
v_and_b32_dpp v112, v103, v16 row_newbcast:8 row_mask:0xf bank_mask:0xf
v_and_b32_dpp v113, v103, v17 row_newbcast:8 row_mask:0xf bank_mask:0xf
v_and_b32_dpp v114, v103, v18 row_newbcast:8 row_mask:0xf bank_mask:0xf
v_and_b32_dpp v115, v103, v19 row_newbcast:8 row_mask:0xf bank_mask:0xf
s_waitcnt vmcnt(11)
v_mfma_f32_16x16x32_bf16 v[108:111], v[116:119], v[60:63], v[108:111]
buffer_load_dwordx4 v[60:63], v2, s[8:11], s45 offen offset:1024 nt
v_and_b32_dpp v116, v103, v16 row_newbcast:12 row_mask:0xf bank_mask:0xf
v_and_b32_dpp v117, v103, v17 row_newbcast:12 row_mask:0xf bank_mask:0xf
v_and_b32_dpp v118, v103, v18 row_newbcast:12 row_mask:0xf bank_mask:0xf
v_and_b32_dpp v119, v103, v19 row_newbcast:12 row_mask:0xf bank_mask:0xf
s_waitcnt vmcnt(11)
v_mfma_f32_16x16x32_bf16 v[108:111], v[112:115], v[64:67], v[108:111]
buffer_load_dwordx4 v[64:67], v2, s[8:11], s45 offen offset:2048 nt
v_and_b32_dpp v112, v103, v16 row_newbcast:1 row_mask:0xf bank_mask:0xf
v_and_b32_dpp v113, v103, v17 row_newbcast:1 row_mask:0xf bank_mask:0xf
v_and_b32_dpp v114, v103, v18 row_newbcast:1 row_mask:0xf bank_mask:0xf
v_and_b32_dpp v115, v103, v19 row_newbcast:1 row_mask:0xf bank_mask:0xf
s_waitcnt vmcnt(11)
v_mfma_f32_16x16x32_bf16 v[108:111], v[116:119], v[68:71], v[108:111]
buffer_load_dwordx4 v[68:71], v2, s[8:11], s45 offen offset:3072 nt
v_and_b32_dpp v116, v103, v16 row_newbcast:5 row_mask:0xf bank_mask:0xf
v_and_b32_dpp v117, v103, v17 row_newbcast:5 row_mask:0xf bank_mask:0xf
v_and_b32_dpp v118, v103, v18 row_newbcast:5 row_mask:0xf bank_mask:0xf
v_and_b32_dpp v119, v103, v19 row_newbcast:5 row_mask:0xf bank_mask:0xf
s_waitcnt vmcnt(11)
v_mfma_f32_16x16x32_bf16 v[108:111], v[112:115], v[24:27], v[108:111]
buffer_load_dwordx4 v[24:27], v5, s[16:19], 0 offen offset:0
v_and_b32_dpp v112, v103, v16 row_newbcast:9 row_mask:0xf bank_mask:0xf
v_and_b32_dpp v113, v103, v17 row_newbcast:9 row_mask:0xf bank_mask:0xf
v_and_b32_dpp v114, v103, v18 row_newbcast:9 row_mask:0xf bank_mask:0xf
v_and_b32_dpp v115, v103, v19 row_newbcast:9 row_mask:0xf bank_mask:0xf
s_waitcnt vmcnt(11)
v_mfma_f32_16x16x32_bf16 v[108:111], v[116:119], v[28:31], v[108:111]
s_mov_b32 s45, 0x1000
buffer_load_dwordx4 v[28:31], v5, s[16:19], s45 offen offset:0
v_and_b32_dpp v116, v103, v16 row_newbcast:13 row_mask:0xf bank_mask:0xf
v_and_b32_dpp v117, v103, v17 row_newbcast:13 row_mask:0xf bank_mask:0xf
v_and_b32_dpp v118, v103, v18 row_newbcast:13 row_mask:0xf bank_mask:0xf
v_and_b32_dpp v119, v103, v19 row_newbcast:13 row_mask:0xf bank_mask:0xf
s_waitcnt vmcnt(11)
v_mfma_f32_16x16x32_bf16 v[108:111], v[112:115], v[32:35], v[108:111]
s_mov_b32 s45, 0x2000
buffer_load_dwordx4 v[32:35], v5, s[16:19], s45 offen offset:0
v_and_b32_dpp v112, v103, v16 row_newbcast:2 row_mask:0xf bank_mask:0xf
v_and_b32_dpp v113, v103, v17 row_newbcast:2 row_mask:0xf bank_mask:0xf
v_and_b32_dpp v114, v103, v18 row_newbcast:2 row_mask:0xf bank_mask:0xf
v_and_b32_dpp v115, v103, v19 row_newbcast:2 row_mask:0xf bank_mask:0xf
s_waitcnt vmcnt(11)
v_mfma_f32_16x16x32_bf16 v[108:111], v[116:119], v[36:39], v[108:111]
s_mov_b32 s45, 0x3000
buffer_load_dwordx4 v[36:39], v5, s[16:19], s45 offen offset:0
v_and_b32_dpp v116, v103, v16 row_newbcast:6 row_mask:0xf bank_mask:0xf
v_and_b32_dpp v117, v103, v17 row_newbcast:6 row_mask:0xf bank_mask:0xf
v_and_b32_dpp v118, v103, v18 row_newbcast:6 row_mask:0xf bank_mask:0xf
v_and_b32_dpp v119, v103, v19 row_newbcast:6 row_mask:0xf bank_mask:0xf
s_waitcnt vmcnt(11)
v_mfma_f32_16x16x32_bf16 v[108:111], v[112:115], v[40:43], v[108:111]
s_mov_b32 s45, 0x4000
buffer_load_dwordx4 v[40:43], v5, s[16:19], s45 offen offset:0
v_and_b32_dpp v112, v103, v16 row_newbcast:10 row_mask:0xf bank_mask:0xf
v_and_b32_dpp v113, v103, v17 row_newbcast:10 row_mask:0xf bank_mask:0xf
v_and_b32_dpp v114, v103, v18 row_newbcast:10 row_mask:0xf bank_mask:0xf
v_and_b32_dpp v115, v103, v19 row_newbcast:10 row_mask:0xf bank_mask:0xf
s_waitcnt vmcnt(11)
v_mfma_f32_16x16x32_bf16 v[108:111], v[116:119], v[44:47], v[108:111]
s_mov_b32 s45, 0x5000
buffer_load_dwordx4 v[44:47], v5, s[16:19], s45 offen offset:0
v_and_b32_dpp v116, v103, v16 row_newbcast:14 row_mask:0xf bank_mask:0xf
v_and_b32_dpp v117, v103, v17 row_newbcast:14 row_mask:0xf bank_mask:0xf
v_and_b32_dpp v118, v103, v18 row_newbcast:14 row_mask:0xf bank_mask:0xf
v_and_b32_dpp v119, v103, v19 row_newbcast:14 row_mask:0xf bank_mask:0xf
s_waitcnt vmcnt(11)
v_mfma_f32_16x16x32_bf16 v[108:111], v[112:115], v[48:51], v[108:111]
s_mov_b32 s45, 0x6000
buffer_load_dwordx4 v[48:51], v5, s[16:19], s45 offen offset:0
v_and_b32_dpp v112, v103, v16 row_newbcast:3 row_mask:0xf bank_mask:0xf
v_and_b32_dpp v113, v103, v17 row_newbcast:3 row_mask:0xf bank_mask:0xf
v_and_b32_dpp v114, v103, v18 row_newbcast:3 row_mask:0xf bank_mask:0xf
v_and_b32_dpp v115, v103, v19 row_newbcast:3 row_mask:0xf bank_mask:0xf
s_waitcnt vmcnt(11)
v_mfma_f32_16x16x32_bf16 v[108:111], v[116:119], v[52:55], v[108:111]
s_mov_b32 s45, 0x7000
buffer_load_dwordx4 v[52:55], v5, s[16:19], s45 offen offset:0
v_and_b32_dpp v116, v103, v16 row_newbcast:7 row_mask:0xf bank_mask:0xf
v_and_b32_dpp v117, v103, v17 row_newbcast:7 row_mask:0xf bank_mask:0xf
v_and_b32_dpp v118, v103, v18 row_newbcast:7 row_mask:0xf bank_mask:0xf
v_and_b32_dpp v119, v103, v19 row_newbcast:7 row_mask:0xf bank_mask:0xf
s_waitcnt vmcnt(11)
v_mfma_f32_16x16x32_bf16 v[108:111], v[112:115], v[56:59], v[108:111]
s_mov_b32 s45, 0x8000
buffer_load_dwordx4 v[56:59], v5, s[16:19], s45 offen offset:0
v_and_b32_dpp v112, v103, v16 row_newbcast:11 row_mask:0xf bank_mask:0xf
v_and_b32_dpp v113, v103, v17 row_newbcast:11 row_mask:0xf bank_mask:0xf
v_and_b32_dpp v114, v103, v18 row_newbcast:11 row_mask:0xf bank_mask:0xf
v_and_b32_dpp v115, v103, v19 row_newbcast:11 row_mask:0xf bank_mask:0xf
s_waitcnt vmcnt(11)
v_mfma_f32_16x16x32_bf16 v[108:111], v[116:119], v[60:63], v[108:111]
s_mov_b32 s45, 0x9000
buffer_load_dwordx4 v[60:63], v5, s[16:19], s45 offen offset:0
v_and_b32_dpp v116, v103, v16 row_newbcast:15 row_mask:0xf bank_mask:0xf
v_and_b32_dpp v117, v103, v17 row_newbcast:15 row_mask:0xf bank_mask:0xf
v_and_b32_dpp v118, v103, v18 row_newbcast:15 row_mask:0xf bank_mask:0xf
v_and_b32_dpp v119, v103, v19 row_newbcast:15 row_mask:0xf bank_mask:0xf
s_waitcnt vmcnt(11)
v_mfma_f32_16x16x32_bf16 v[108:111], v[112:115], v[64:67], v[108:111]
s_mov_b32 s45, 0xa000
buffer_load_dwordx4 v[64:67], v5, s[16:19], s45 offen offset:0
s_nop 1
s_waitcnt vmcnt(11)
v_mfma_f32_16x16x32_bf16 v[108:111], v[116:119], v[68:71], v[108:111]
s_mov_b32 s45, 0xb000
buffer_load_dwordx4 v[68:71], v5, s[16:19], s45 offen offset:0
s_nop 7
s_mov_b32 exec_hi, 0
ds_write_b128 v11, v[108:111] offset:4096
s_mov_b32 exec_hi, -1
v_mov_b32 v15, s44
v_lshlrev_b32 v15, 3, v15
v_add_u32 v15, 0x26000, v15
ds_write_b64 v15, v[132:133]
s_waitcnt lgkmcnt(0)
s_barrier
v_mov_b32 v15, 0x26000
ds_read_b128 v[120:123], v15
ds_read_b128 v[124:127], v15 offset:16
ds_read_b32 v72, v9 offset:4096
ds_read_b32 v73, v9 offset:4352
ds_read_b32 v74, v9 offset:4608
ds_read_b32 v75, v9 offset:4864
ds_read_b32 v76, v9 offset:5120
ds_read_b32 v77, v9 offset:5376
ds_read_b32 v78, v9 offset:5632
ds_read_b32 v79, v9 offset:5888
s_waitcnt lgkmcnt(8)
v_max3_f32 v128, v120, v122, v124
v_max_f32 v128, v128, v126
v_sub_f32 v120, v120, v128
v_sub_f32 v122, v122, v128
v_sub_f32 v124, v124, v128
v_sub_f32 v126, v126, v128
v_exp_f32 v120, v120
v_exp_f32 v122, v122
v_exp_f32 v124, v124
v_exp_f32 v126, v126
s_nop 0
v_mul_f32 v128, v120, v121
v_fmac_f32 v128, v122, v123
v_fmac_f32 v128, v124, v125
v_fmac_f32 v128, v126, v127
v_rcp_f32 v128, v128
s_waitcnt lgkmcnt(0)
v_mul_f32 v130, v72, v120
v_fmac_f32 v130, v74, v122
v_fmac_f32 v130, v76, v124
v_fmac_f32 v130, v78, v126
v_mul_f32 v130, v130, v128
v_cvt_pk_bf16_f32 v88, v130, v130
v_mul_f32 v131, v73, v120
v_fmac_f32 v131, v75, v122
v_fmac_f32 v131, v77, v124
v_fmac_f32 v131, v79, v126
v_mul_f32 v131, v131, v128
v_cvt_pk_bf16_f32 v89, v131, v131
s_nop 1
v_and_b32_dpp v112, v88, v16 row_newbcast:0 row_mask:0xf bank_mask:0xf
v_and_b32_dpp v113, v88, v17 row_newbcast:0 row_mask:0xf bank_mask:0xf
v_and_b32_dpp v114, v88, v18 row_newbcast:0 row_mask:0xf bank_mask:0xf
v_and_b32_dpp v115, v88, v19 row_newbcast:0 row_mask:0xf bank_mask:0xf
v_and_b32_dpp v116, v88, v16 row_newbcast:1 row_mask:0xf bank_mask:0xf
v_and_b32_dpp v117, v88, v17 row_newbcast:1 row_mask:0xf bank_mask:0xf
v_and_b32_dpp v118, v88, v18 row_newbcast:1 row_mask:0xf bank_mask:0xf
v_and_b32_dpp v119, v88, v19 row_newbcast:1 row_mask:0xf bank_mask:0xf
s_waitcnt vmcnt(11)
v_mfma_f32_16x16x32_bf16 v[104:107], v[112:115], v[24:27], 0
s_mov_b32 s45, 0xc000
buffer_load_dwordx4 v[24:27], v5, s[16:19], s45 offen offset:0
v_and_b32_dpp v112, v88, v16 row_newbcast:2 row_mask:0xf bank_mask:0xf
v_and_b32_dpp v113, v88, v17 row_newbcast:2 row_mask:0xf bank_mask:0xf
v_and_b32_dpp v114, v88, v18 row_newbcast:2 row_mask:0xf bank_mask:0xf
v_and_b32_dpp v115, v88, v19 row_newbcast:2 row_mask:0xf bank_mask:0xf
s_waitcnt vmcnt(11)
v_mfma_f32_16x16x32_bf16 v[104:107], v[116:119], v[28:31], v[104:107]
s_mov_b32 s45, 0xd000
buffer_load_dwordx4 v[28:31], v5, s[16:19], s45 offen offset:0
v_and_b32_dpp v116, v88, v16 row_newbcast:3 row_mask:0xf bank_mask:0xf
v_and_b32_dpp v117, v88, v17 row_newbcast:3 row_mask:0xf bank_mask:0xf
v_and_b32_dpp v118, v88, v18 row_newbcast:3 row_mask:0xf bank_mask:0xf
v_and_b32_dpp v119, v88, v19 row_newbcast:3 row_mask:0xf bank_mask:0xf
s_waitcnt vmcnt(11)
v_mfma_f32_16x16x32_bf16 v[104:107], v[112:115], v[32:35], v[104:107]
s_mov_b32 s45, 0xe000
buffer_load_dwordx4 v[32:35], v5, s[16:19], s45 offen offset:0
v_and_b32_dpp v112, v88, v16 row_newbcast:4 row_mask:0xf bank_mask:0xf
v_and_b32_dpp v113, v88, v17 row_newbcast:4 row_mask:0xf bank_mask:0xf
v_and_b32_dpp v114, v88, v18 row_newbcast:4 row_mask:0xf bank_mask:0xf
v_and_b32_dpp v115, v88, v19 row_newbcast:4 row_mask:0xf bank_mask:0xf
s_waitcnt vmcnt(11)
v_mfma_f32_16x16x32_bf16 v[104:107], v[116:119], v[36:39], v[104:107]
s_mov_b32 s45, 0xf000
buffer_load_dwordx4 v[36:39], v5, s[16:19], s45 offen offset:0
v_and_b32_dpp v116, v88, v16 row_newbcast:5 row_mask:0xf bank_mask:0xf
v_and_b32_dpp v117, v88, v17 row_newbcast:5 row_mask:0xf bank_mask:0xf
v_and_b32_dpp v118, v88, v18 row_newbcast:5 row_mask:0xf bank_mask:0xf
v_and_b32_dpp v119, v88, v19 row_newbcast:5 row_mask:0xf bank_mask:0xf
s_waitcnt vmcnt(11)
v_mfma_f32_16x16x32_bf16 v[104:107], v[112:115], v[40:43], v[104:107]
s_mov_b32 s45, 0x10000
buffer_load_dwordx4 v[40:43], v5, s[16:19], s45 offen offset:0
v_and_b32_dpp v112, v88, v16 row_newbcast:6 row_mask:0xf bank_mask:0xf
v_and_b32_dpp v113, v88, v17 row_newbcast:6 row_mask:0xf bank_mask:0xf
v_and_b32_dpp v114, v88, v18 row_newbcast:6 row_mask:0xf bank_mask:0xf
v_and_b32_dpp v115, v88, v19 row_newbcast:6 row_mask:0xf bank_mask:0xf
s_waitcnt vmcnt(11)
v_mfma_f32_16x16x32_bf16 v[104:107], v[116:119], v[44:47], v[104:107]
s_mov_b32 s45, 0x11000
buffer_load_dwordx4 v[44:47], v5, s[16:19], s45 offen offset:0
v_and_b32_dpp v116, v88, v16 row_newbcast:7 row_mask:0xf bank_mask:0xf
v_and_b32_dpp v117, v88, v17 row_newbcast:7 row_mask:0xf bank_mask:0xf
v_and_b32_dpp v118, v88, v18 row_newbcast:7 row_mask:0xf bank_mask:0xf
v_and_b32_dpp v119, v88, v19 row_newbcast:7 row_mask:0xf bank_mask:0xf
s_waitcnt vmcnt(11)
v_mfma_f32_16x16x32_bf16 v[104:107], v[112:115], v[48:51], v[104:107]
s_mov_b32 s45, 0x12000
buffer_load_dwordx4 v[48:51], v5, s[16:19], s45 offen offset:0
v_and_b32_dpp v112, v88, v16 row_newbcast:8 row_mask:0xf bank_mask:0xf
v_and_b32_dpp v113, v88, v17 row_newbcast:8 row_mask:0xf bank_mask:0xf
v_and_b32_dpp v114, v88, v18 row_newbcast:8 row_mask:0xf bank_mask:0xf
v_and_b32_dpp v115, v88, v19 row_newbcast:8 row_mask:0xf bank_mask:0xf
s_waitcnt vmcnt(11)
v_mfma_f32_16x16x32_bf16 v[104:107], v[116:119], v[52:55], v[104:107]
s_mov_b32 s45, 0x13000
buffer_load_dwordx4 v[52:55], v5, s[16:19], s45 offen offset:0
v_and_b32_dpp v116, v88, v16 row_newbcast:9 row_mask:0xf bank_mask:0xf
v_and_b32_dpp v117, v88, v17 row_newbcast:9 row_mask:0xf bank_mask:0xf
v_and_b32_dpp v118, v88, v18 row_newbcast:9 row_mask:0xf bank_mask:0xf
v_and_b32_dpp v119, v88, v19 row_newbcast:9 row_mask:0xf bank_mask:0xf
s_waitcnt vmcnt(11)
v_mfma_f32_16x16x32_bf16 v[104:107], v[112:115], v[56:59], v[104:107]
s_mov_b32 s45, 0x14000
buffer_load_dwordx4 v[56:59], v5, s[16:19], s45 offen offset:0
v_and_b32_dpp v112, v88, v16 row_newbcast:10 row_mask:0xf bank_mask:0xf
v_and_b32_dpp v113, v88, v17 row_newbcast:10 row_mask:0xf bank_mask:0xf
v_and_b32_dpp v114, v88, v18 row_newbcast:10 row_mask:0xf bank_mask:0xf
v_and_b32_dpp v115, v88, v19 row_newbcast:10 row_mask:0xf bank_mask:0xf
s_waitcnt vmcnt(11)
v_mfma_f32_16x16x32_bf16 v[104:107], v[116:119], v[60:63], v[104:107]
s_mov_b32 s45, 0x15000
buffer_load_dwordx4 v[60:63], v5, s[16:19], s45 offen offset:0
v_and_b32_dpp v116, v88, v16 row_newbcast:11 row_mask:0xf bank_mask:0xf
v_and_b32_dpp v117, v88, v17 row_newbcast:11 row_mask:0xf bank_mask:0xf
v_and_b32_dpp v118, v88, v18 row_newbcast:11 row_mask:0xf bank_mask:0xf
v_and_b32_dpp v119, v88, v19 row_newbcast:11 row_mask:0xf bank_mask:0xf
s_waitcnt vmcnt(11)
v_mfma_f32_16x16x32_bf16 v[104:107], v[112:115], v[64:67], v[104:107]
s_mov_b32 s45, 0x16000
buffer_load_dwordx4 v[64:67], v5, s[16:19], s45 offen offset:0
v_and_b32_dpp v112, v88, v16 row_newbcast:12 row_mask:0xf bank_mask:0xf
v_and_b32_dpp v113, v88, v17 row_newbcast:12 row_mask:0xf bank_mask:0xf
v_and_b32_dpp v114, v88, v18 row_newbcast:12 row_mask:0xf bank_mask:0xf
v_and_b32_dpp v115, v88, v19 row_newbcast:12 row_mask:0xf bank_mask:0xf
s_waitcnt vmcnt(11)
v_mfma_f32_16x16x32_bf16 v[104:107], v[116:119], v[68:71], v[104:107]
s_mov_b32 s45, 0x17000
buffer_load_dwordx4 v[68:71], v5, s[16:19], s45 offen offset:0
v_and_b32_dpp v116, v88, v16 row_newbcast:13 row_mask:0xf bank_mask:0xf
v_and_b32_dpp v117, v88, v17 row_newbcast:13 row_mask:0xf bank_mask:0xf
v_and_b32_dpp v118, v88, v18 row_newbcast:13 row_mask:0xf bank_mask:0xf
v_and_b32_dpp v119, v88, v19 row_newbcast:13 row_mask:0xf bank_mask:0xf
s_waitcnt vmcnt(11)
v_mfma_f32_16x16x32_bf16 v[104:107], v[112:115], v[24:27], v[104:107]
s_mov_b32 s45, 0x18000
buffer_load_dwordx4 v[24:27], v5, s[16:19], s45 offen offset:0
v_and_b32_dpp v112, v88, v16 row_newbcast:14 row_mask:0xf bank_mask:0xf
v_and_b32_dpp v113, v88, v17 row_newbcast:14 row_mask:0xf bank_mask:0xf
v_and_b32_dpp v114, v88, v18 row_newbcast:14 row_mask:0xf bank_mask:0xf
v_and_b32_dpp v115, v88, v19 row_newbcast:14 row_mask:0xf bank_mask:0xf
s_waitcnt vmcnt(11)
v_mfma_f32_16x16x32_bf16 v[104:107], v[116:119], v[28:31], v[104:107]
s_mov_b32 s45, 0x19000
buffer_load_dwordx4 v[28:31], v5, s[16:19], s45 offen offset:0
v_and_b32_dpp v116, v88, v16 row_newbcast:15 row_mask:0xf bank_mask:0xf
v_and_b32_dpp v117, v88, v17 row_newbcast:15 row_mask:0xf bank_mask:0xf
v_and_b32_dpp v118, v88, v18 row_newbcast:15 row_mask:0xf bank_mask:0xf
v_and_b32_dpp v119, v88, v19 row_newbcast:15 row_mask:0xf bank_mask:0xf
s_waitcnt vmcnt(11)
v_mfma_f32_16x16x32_bf16 v[104:107], v[112:115], v[32:35], v[104:107]
s_mov_b32 s45, 0x1a000
buffer_load_dwordx4 v[32:35], v5, s[16:19], s45 offen offset:0
v_and_b32_dpp v112, v89, v16 row_newbcast:0 row_mask:0xf bank_mask:0xf
v_and_b32_dpp v113, v89, v17 row_newbcast:0 row_mask:0xf bank_mask:0xf
v_and_b32_dpp v114, v89, v18 row_newbcast:0 row_mask:0xf bank_mask:0xf
v_and_b32_dpp v115, v89, v19 row_newbcast:0 row_mask:0xf bank_mask:0xf
s_waitcnt vmcnt(11)
v_mfma_f32_16x16x32_bf16 v[104:107], v[116:119], v[36:39], v[104:107]
s_mov_b32 s45, 0x1b000
buffer_load_dwordx4 v[36:39], v5, s[16:19], s45 offen offset:0
v_and_b32_dpp v116, v89, v16 row_newbcast:1 row_mask:0xf bank_mask:0xf
v_and_b32_dpp v117, v89, v17 row_newbcast:1 row_mask:0xf bank_mask:0xf
v_and_b32_dpp v118, v89, v18 row_newbcast:1 row_mask:0xf bank_mask:0xf
v_and_b32_dpp v119, v89, v19 row_newbcast:1 row_mask:0xf bank_mask:0xf
s_waitcnt vmcnt(11)
v_mfma_f32_16x16x32_bf16 v[104:107], v[112:115], v[40:43], v[104:107]
s_mov_b32 s45, 0x1c000
buffer_load_dwordx4 v[40:43], v5, s[16:19], s45 offen offset:0
v_and_b32_dpp v112, v89, v16 row_newbcast:2 row_mask:0xf bank_mask:0xf
v_and_b32_dpp v113, v89, v17 row_newbcast:2 row_mask:0xf bank_mask:0xf
v_and_b32_dpp v114, v89, v18 row_newbcast:2 row_mask:0xf bank_mask:0xf
v_and_b32_dpp v115, v89, v19 row_newbcast:2 row_mask:0xf bank_mask:0xf
s_waitcnt vmcnt(11)
v_mfma_f32_16x16x32_bf16 v[104:107], v[116:119], v[44:47], v[104:107]
s_mov_b32 s45, 0x1d000
buffer_load_dwordx4 v[44:47], v5, s[16:19], s45 offen offset:0
v_and_b32_dpp v116, v89, v16 row_newbcast:3 row_mask:0xf bank_mask:0xf
v_and_b32_dpp v117, v89, v17 row_newbcast:3 row_mask:0xf bank_mask:0xf
v_and_b32_dpp v118, v89, v18 row_newbcast:3 row_mask:0xf bank_mask:0xf
v_and_b32_dpp v119, v89, v19 row_newbcast:3 row_mask:0xf bank_mask:0xf
s_waitcnt vmcnt(11)
v_mfma_f32_16x16x32_bf16 v[104:107], v[112:115], v[48:51], v[104:107]
s_mov_b32 s45, 0x1e000
buffer_load_dwordx4 v[48:51], v5, s[16:19], s45 offen offset:0
v_and_b32_dpp v112, v89, v16 row_newbcast:4 row_mask:0xf bank_mask:0xf
v_and_b32_dpp v113, v89, v17 row_newbcast:4 row_mask:0xf bank_mask:0xf
v_and_b32_dpp v114, v89, v18 row_newbcast:4 row_mask:0xf bank_mask:0xf
v_and_b32_dpp v115, v89, v19 row_newbcast:4 row_mask:0xf bank_mask:0xf
s_waitcnt vmcnt(11)
v_mfma_f32_16x16x32_bf16 v[104:107], v[116:119], v[52:55], v[104:107]
s_mov_b32 s45, 0x1f000
buffer_load_dwordx4 v[52:55], v5, s[16:19], s45 offen offset:0
v_and_b32_dpp v116, v89, v16 row_newbcast:5 row_mask:0xf bank_mask:0xf
v_and_b32_dpp v117, v89, v17 row_newbcast:5 row_mask:0xf bank_mask:0xf
v_and_b32_dpp v118, v89, v18 row_newbcast:5 row_mask:0xf bank_mask:0xf
v_and_b32_dpp v119, v89, v19 row_newbcast:5 row_mask:0xf bank_mask:0xf
s_waitcnt vmcnt(11)
v_mfma_f32_16x16x32_bf16 v[104:107], v[112:115], v[56:59], v[104:107]
v_and_b32_dpp v112, v89, v16 row_newbcast:6 row_mask:0xf bank_mask:0xf
v_and_b32_dpp v113, v89, v17 row_newbcast:6 row_mask:0xf bank_mask:0xf
v_and_b32_dpp v114, v89, v18 row_newbcast:6 row_mask:0xf bank_mask:0xf
v_and_b32_dpp v115, v89, v19 row_newbcast:6 row_mask:0xf bank_mask:0xf
s_waitcnt vmcnt(10)
v_mfma_f32_16x16x32_bf16 v[104:107], v[116:119], v[60:63], v[104:107]
v_and_b32_dpp v116, v89, v16 row_newbcast:7 row_mask:0xf bank_mask:0xf
v_and_b32_dpp v117, v89, v17 row_newbcast:7 row_mask:0xf bank_mask:0xf
v_and_b32_dpp v118, v89, v18 row_newbcast:7 row_mask:0xf bank_mask:0xf
v_and_b32_dpp v119, v89, v19 row_newbcast:7 row_mask:0xf bank_mask:0xf
s_waitcnt vmcnt(9)
v_mfma_f32_16x16x32_bf16 v[104:107], v[112:115], v[64:67], v[104:107]
v_and_b32_dpp v112, v89, v16 row_newbcast:8 row_mask:0xf bank_mask:0xf
v_and_b32_dpp v113, v89, v17 row_newbcast:8 row_mask:0xf bank_mask:0xf
v_and_b32_dpp v114, v89, v18 row_newbcast:8 row_mask:0xf bank_mask:0xf
v_and_b32_dpp v115, v89, v19 row_newbcast:8 row_mask:0xf bank_mask:0xf
s_waitcnt vmcnt(8)
v_mfma_f32_16x16x32_bf16 v[104:107], v[116:119], v[68:71], v[104:107]
v_and_b32_dpp v116, v89, v16 row_newbcast:9 row_mask:0xf bank_mask:0xf
v_and_b32_dpp v117, v89, v17 row_newbcast:9 row_mask:0xf bank_mask:0xf
v_and_b32_dpp v118, v89, v18 row_newbcast:9 row_mask:0xf bank_mask:0xf
v_and_b32_dpp v119, v89, v19 row_newbcast:9 row_mask:0xf bank_mask:0xf
s_waitcnt vmcnt(7)
v_mfma_f32_16x16x32_bf16 v[104:107], v[112:115], v[24:27], v[104:107]
v_and_b32_dpp v112, v89, v16 row_newbcast:10 row_mask:0xf bank_mask:0xf
v_and_b32_dpp v113, v89, v17 row_newbcast:10 row_mask:0xf bank_mask:0xf
v_and_b32_dpp v114, v89, v18 row_newbcast:10 row_mask:0xf bank_mask:0xf
v_and_b32_dpp v115, v89, v19 row_newbcast:10 row_mask:0xf bank_mask:0xf
s_waitcnt vmcnt(6)
v_mfma_f32_16x16x32_bf16 v[104:107], v[116:119], v[28:31], v[104:107]
v_and_b32_dpp v116, v89, v16 row_newbcast:11 row_mask:0xf bank_mask:0xf
v_and_b32_dpp v117, v89, v17 row_newbcast:11 row_mask:0xf bank_mask:0xf
v_and_b32_dpp v118, v89, v18 row_newbcast:11 row_mask:0xf bank_mask:0xf
v_and_b32_dpp v119, v89, v19 row_newbcast:11 row_mask:0xf bank_mask:0xf
s_waitcnt vmcnt(5)
v_mfma_f32_16x16x32_bf16 v[104:107], v[112:115], v[32:35], v[104:107]
v_and_b32_dpp v112, v89, v16 row_newbcast:12 row_mask:0xf bank_mask:0xf
v_and_b32_dpp v113, v89, v17 row_newbcast:12 row_mask:0xf bank_mask:0xf
v_and_b32_dpp v114, v89, v18 row_newbcast:12 row_mask:0xf bank_mask:0xf
v_and_b32_dpp v115, v89, v19 row_newbcast:12 row_mask:0xf bank_mask:0xf
s_waitcnt vmcnt(4)
v_mfma_f32_16x16x32_bf16 v[104:107], v[116:119], v[36:39], v[104:107]
v_and_b32_dpp v116, v89, v16 row_newbcast:13 row_mask:0xf bank_mask:0xf
v_and_b32_dpp v117, v89, v17 row_newbcast:13 row_mask:0xf bank_mask:0xf
v_and_b32_dpp v118, v89, v18 row_newbcast:13 row_mask:0xf bank_mask:0xf
v_and_b32_dpp v119, v89, v19 row_newbcast:13 row_mask:0xf bank_mask:0xf
s_waitcnt vmcnt(3)
v_mfma_f32_16x16x32_bf16 v[104:107], v[112:115], v[40:43], v[104:107]
v_and_b32_dpp v112, v89, v16 row_newbcast:14 row_mask:0xf bank_mask:0xf
v_and_b32_dpp v113, v89, v17 row_newbcast:14 row_mask:0xf bank_mask:0xf
v_and_b32_dpp v114, v89, v18 row_newbcast:14 row_mask:0xf bank_mask:0xf
v_and_b32_dpp v115, v89, v19 row_newbcast:14 row_mask:0xf bank_mask:0xf
s_waitcnt vmcnt(2)
v_mfma_f32_16x16x32_bf16 v[104:107], v[116:119], v[44:47], v[104:107]
v_and_b32_dpp v116, v89, v16 row_newbcast:15 row_mask:0xf bank_mask:0xf
v_and_b32_dpp v117, v89, v17 row_newbcast:15 row_mask:0xf bank_mask:0xf
v_and_b32_dpp v118, v89, v18 row_newbcast:15 row_mask:0xf bank_mask:0xf
v_and_b32_dpp v119, v89, v19 row_newbcast:15 row_mask:0xf bank_mask:0xf
s_waitcnt vmcnt(1)
v_mfma_f32_16x16x32_bf16 v[104:107], v[112:115], v[48:51], v[104:107]
s_nop 1
s_waitcnt vmcnt(0)
v_mfma_f32_16x16x32_bf16 v[104:107], v[116:119], v[52:55], v[104:107]
s_nop 7
s_mov_b32 s54, 0xfffffffe
v_min_u32 v104, s54, v104
v_min_u32 v105, s54, v105
v_min_u32 v106, s54, v106
v_min_u32 v107, s54, v107
s_mov_b32 s45, 0x20000
v_add_u32 v15, s56, v6
buffer_store_dwordx4 v[104:107], v15, s[28:31], s45 offen sc1
buffer_load_dwordx4 v[56:59], v4, s[20:23], 0 offen offset:0
s_mov_b32 s45, 0x3000
buffer_load_dwordx4 v[60:63], v4, s[20:23], s45 offen offset:2048
s_mov_b32 s45, 0x7000
buffer_load_dwordx4 v[64:67], v4, s[20:23], s45 offen offset:0
s_mov_b32 s45, 0xa000
buffer_load_dwordx4 v[68:71], v4, s[20:23], s45 offen offset:2048
s_mov_b32 s45, 0xe000
buffer_load_dwordx4 v[24:27], v4, s[20:23], s45 offen offset:0
s_mov_b32 s45, 0x11000
buffer_load_dwordx4 v[28:31], v4, s[20:23], s45 offen offset:2048
s_mov_b32 s45, 0x15000
buffer_load_dwordx4 v[32:35], v4, s[20:23], s45 offen offset:0
s_mov_b32 s45, 0x18000
buffer_load_dwordx4 v[36:39], v4, s[20:23], s45 offen offset:2048
s_mov_b32 s45, 0x1c000
buffer_load_dwordx4 v[40:43], v4, s[20:23], s45 offen offset:0
s_mov_b32 s45, 0x1f000
buffer_load_dwordx4 v[44:47], v4, s[20:23], s45 offen offset:2048
s_mov_b32 s45, 0x23000
buffer_load_dwordx4 v[48:51], v4, s[20:23], s45 offen offset:0
s_mov_b32 s45, 0x26000
buffer_load_dwordx4 v[52:55], v4, s[20:23], s45 offen offset:2048
s_cmp_lg_u32 s44, 0
s_cbranch_scc1 L_skip6
s_mov_b32 s57, 0
v_lshlrev_b32 v120, 11, v0
v_add_u32 v120, 0x207fc, v120
s_mov_b32 exec_lo, 0xffffffff
s_mov_b32 exec_hi, 0
L_poll6:
buffer_load_dword v122, v120, s[28:31], 0 offen sc1
s_waitcnt vmcnt(0)
v_cmp_eq_u32 vcc, -1, v122
s_add_u32 s57, s57, 1
s_nop 3
s_and_b64 exec, exec, vcc
s_cbranch_scc0 L_done6
s_cmp_ge_u32 s57, 0x40000
s_cbranch_scc1 L_done6
s_sleep 4
s_branch L_poll6
L_done6:
s_mov_b64 exec, -1
L_skip6:
s_barrier
s_mov_b32 s57, 0
L_g7:
s_mov_b32 s45, 0x20000
buffer_load_dwordx4 v[72:75], v7, s[28:31], s45 offen sc1
s_mov_b32 s45, 0x21000
buffer_load_dwordx4 v[76:79], v7, s[28:31], s45 offen sc1
s_mov_b32 s45, 0x22000
buffer_load_dwordx4 v[80:83], v7, s[28:31], s45 offen sc1
s_mov_b32 s45, 0x23000
buffer_load_dwordx4 v[84:87], v7, s[28:31], s45 offen sc1
s_mov_b32 s45, 0x24000
buffer_load_dwordx4 v[88:91], v7, s[28:31], s45 offen sc1
s_mov_b32 s45, 0x25000
buffer_load_dwordx4 v[92:95], v7, s[28:31], s45 offen sc1
s_mov_b32 s45, 0x26000
buffer_load_dwordx4 v[96:99], v7, s[28:31], s45 offen sc1
s_mov_b32 s45, 0x27000
buffer_load_dwordx4 v[100:103], v7, s[28:31], s45 offen sc1
s_mov_b32 s45, 0x28000
buffer_load_dwordx4 v[104:107], v7, s[28:31], s45 offen sc1
s_mov_b32 s45, 0x29000
buffer_load_dwordx4 v[108:111], v7, s[28:31], s45 offen sc1
s_mov_b32 s45, 0x2a000
buffer_load_dwordx4 v[112:115], v7, s[28:31], s45 offen sc1
s_mov_b32 s45, 0x2b000
buffer_load_dwordx4 v[116:119], v7, s[28:31], s45 offen sc1
s_mov_b32 s45, 0x2c000
buffer_load_dwordx4 v[120:123], v7, s[28:31], s45 offen sc1
s_mov_b32 s45, 0x2d000
buffer_load_dwordx4 v[124:127], v7, s[28:31], s45 offen sc1
s_mov_b32 s45, 0x2e000
buffer_load_dwordx4 v[128:131], v7, s[28:31], s45 offen sc1
s_mov_b32 s45, 0x2f000
buffer_load_dwordx4 v[132:135], v7, s[28:31], s45 offen sc1
s_waitcnt vmcnt(15)
v_max3_u32 v15, v72, v73, v74
v_max_u32 v15, v15, v75
s_waitcnt vmcnt(14)
v_max3_u32 v15, v15, v76, v77
v_max3_u32 v15, v15, v78, v79
v_add_f32 v72, v72, v76
v_add_f32 v73, v73, v77
v_add_f32 v74, v74, v78
v_add_f32 v75, v75, v79
s_waitcnt vmcnt(13)
v_max3_u32 v15, v15, v80, v81
v_max3_u32 v15, v15, v82, v83
v_add_f32 v72, v72, v80
v_add_f32 v73, v73, v81
v_add_f32 v74, v74, v82
v_add_f32 v75, v75, v83
s_waitcnt vmcnt(12)
v_max3_u32 v15, v15, v84, v85
v_max3_u32 v15, v15, v86, v87
v_add_f32 v72, v72, v84
v_add_f32 v73, v73, v85
v_add_f32 v74, v74, v86
v_add_f32 v75, v75, v87
s_waitcnt vmcnt(11)
v_max3_u32 v15, v15, v88, v89
v_max3_u32 v15, v15, v90, v91
v_add_f32 v72, v72, v88
v_add_f32 v73, v73, v89
v_add_f32 v74, v74, v90
v_add_f32 v75, v75, v91
s_waitcnt vmcnt(10)
v_max3_u32 v15, v15, v92, v93
v_max3_u32 v15, v15, v94, v95
v_add_f32 v72, v72, v92
v_add_f32 v73, v73, v93
v_add_f32 v74, v74, v94
v_add_f32 v75, v75, v95
s_waitcnt vmcnt(9)
v_max3_u32 v15, v15, v96, v97
v_max3_u32 v15, v15, v98, v99
v_add_f32 v72, v72, v96
v_add_f32 v73, v73, v97
v_add_f32 v74, v74, v98
v_add_f32 v75, v75, v99
s_waitcnt vmcnt(8)
v_max3_u32 v15, v15, v100, v101
v_max3_u32 v15, v15, v102, v103
v_add_f32 v72, v72, v100
v_add_f32 v73, v73, v101
v_add_f32 v74, v74, v102
v_add_f32 v75, v75, v103
s_waitcnt vmcnt(7)
v_max3_u32 v15, v15, v104, v105
v_max3_u32 v15, v15, v106, v107
v_add_f32 v72, v72, v104
v_add_f32 v73, v73, v105
v_add_f32 v74, v74, v106
v_add_f32 v75, v75, v107
s_waitcnt vmcnt(6)
v_max3_u32 v15, v15, v108, v109
v_max3_u32 v15, v15, v110, v111
v_add_f32 v72, v72, v108
v_add_f32 v73, v73, v109
v_add_f32 v74, v74, v110
v_add_f32 v75, v75, v111
s_waitcnt vmcnt(5)
v_max3_u32 v15, v15, v112, v113
v_max3_u32 v15, v15, v114, v115
v_add_f32 v72, v72, v112
v_add_f32 v73, v73, v113
v_add_f32 v74, v74, v114
v_add_f32 v75, v75, v115
s_waitcnt vmcnt(4)
v_max3_u32 v15, v15, v116, v117
v_max3_u32 v15, v15, v118, v119
v_add_f32 v72, v72, v116
v_add_f32 v73, v73, v117
v_add_f32 v74, v74, v118
v_add_f32 v75, v75, v119
s_waitcnt vmcnt(3)
v_max3_u32 v15, v15, v120, v121
v_max3_u32 v15, v15, v122, v123
v_add_f32 v72, v72, v120
v_add_f32 v73, v73, v121
v_add_f32 v74, v74, v122
v_add_f32 v75, v75, v123
s_waitcnt vmcnt(2)
v_max3_u32 v15, v15, v124, v125
v_max3_u32 v15, v15, v126, v127
v_add_f32 v72, v72, v124
v_add_f32 v73, v73, v125
v_add_f32 v74, v74, v126
v_add_f32 v75, v75, v127
s_waitcnt vmcnt(1)
v_max3_u32 v15, v15, v128, v129
v_max3_u32 v15, v15, v130, v131
v_add_f32 v72, v72, v128
v_add_f32 v73, v73, v129
v_add_f32 v74, v74, v130
v_add_f32 v75, v75, v131
s_waitcnt vmcnt(0)
v_max3_u32 v15, v15, v132, v133
v_max3_u32 v15, v15, v134, v135
v_add_f32 v72, v72, v132
v_add_f32 v73, v73, v133
v_add_f32 v74, v74, v134
v_add_f32 v75, v75, v135
v_cmp_eq_u32 vcc, -1, v15
s_add_u32 s57, s57, 1
s_nop 3
s_cbranch_vccz L_gd7
s_cmp_ge_u32 s57, 0x40000
s_cbranch_scc1 L_gd7
s_sleep 2
s_branch L_g7
L_gd7:
v_mov_b32 v76, v72
v_mov_b32 v77, v73
v_mov_b32 v78, v74
v_mov_b32 v79, v75
s_nop 1
v_permlane32_swap_b32 v72, v76
v_permlane32_swap_b32 v73, v77
v_permlane32_swap_b32 v74, v78
v_permlane32_swap_b32 v75, v79
s_nop 0
v_add_f32 v72, v72, v76
v_add_f32 v73, v73, v77
v_add_f32 v74, v74, v78
v_add_f32 v75, v75, v79
v_cvt_pk_bf16_f32 v76, v72, v73
v_lshlrev_b32 v72, 16, v76
v_and_b32 v73, 0xffff0000, v76
v_cvt_pk_bf16_f32 v76, v74, v75
v_lshlrev_b32 v74, 16, v76
v_and_b32 v75, 0xffff0000, v76
v_add_f32 v20, v20, v72
v_add_f32 v21, v21, v73
v_add_f32 v22, v22, v74
v_add_f32 v23, v23, v75
v_cvt_pk_bf16_f32 v76, v20, v21
v_lshlrev_b32 v20, 16, v76
v_and_b32 v21, 0xffff0000, v76
v_cvt_pk_bf16_f32 v76, v22, v23
v_lshlrev_b32 v22, 16, v76
v_and_b32 v23, 0xffff0000, v76
ds_write_b128 v12, v[20:23] offset:0
s_waitcnt lgkmcnt(0)
s_barrier
ds_read_b128 v[120:123], v14 offset:0
ds_read_b128 v[124:127], v14 offset:16
ds_read_b32 v132, v10 offset:0
ds_read_b32 v133, v10 offset:256
s_waitcnt lgkmcnt(2)
v_add_f32 v128, v120, v121
v_add_f32 v128, v128, v122
v_add_f32 v128, v128, v123
v_add_f32 v128, v128, v124
v_add_f32 v128, v128, v125
v_add_f32 v128, v128, v126
v_add_f32 v128, v128, v127
s_nop 1
v_add_f32_dpp v128, v128, v128 row_ror:8 row_mask:0xf bank_mask:0xf
s_nop 1
v_add_f32_dpp v128, v128, v128 row_ror:4 row_mask:0xf bank_mask:0xf
s_nop 1
v_add_f32_dpp v128, v128, v128 row_ror:2 row_mask:0xf bank_mask:0xf
s_nop 1
v_add_f32_dpp v128, v128, v128 row_ror:1 row_mask:0xf bank_mask:0xf
v_mov_b32 v129, v128
s_nop 1
v_permlane16_swap_b32 v128, v129
s_nop 0
v_add_f32 v128, v128, v129
v_mov_b32 v129, v128
s_nop 1
v_permlane32_swap_b32 v128, v129
s_nop 0
v_add_f32 v128, v128, v129
v_mul_f32 v128, 0x3b000000, v128
v_sub_f32 v120, v120, v128
v_sub_f32 v121, v121, v128
v_sub_f32 v122, v122, v128
v_sub_f32 v123, v123, v128
v_sub_f32 v124, v124, v128
v_sub_f32 v125, v125, v128
v_sub_f32 v126, v126, v128
v_sub_f32 v127, v127, v128
v_mul_f32 v130, v120, v120
v_fmac_f32 v130, v121, v121
v_fmac_f32 v130, v122, v122
v_fmac_f32 v130, v123, v123
v_fmac_f32 v130, v124, v124
v_fmac_f32 v130, v125, v125
v_fmac_f32 v130, v126, v126
v_fmac_f32 v130, v127, v127
s_nop 1
v_add_f32_dpp v130, v130, v130 row_ror:8 row_mask:0xf bank_mask:0xf
s_nop 1
v_add_f32_dpp v130, v130, v130 row_ror:4 row_mask:0xf bank_mask:0xf
s_nop 1
v_add_f32_dpp v130, v130, v130 row_ror:2 row_mask:0xf bank_mask:0xf
s_nop 1
v_add_f32_dpp v130, v130, v130 row_ror:1 row_mask:0xf bank_mask:0xf
v_mov_b32 v129, v130
s_nop 1
v_permlane16_swap_b32 v130, v129
s_nop 0
v_add_f32 v130, v130, v129
v_mov_b32 v129, v130
s_nop 1
v_permlane32_swap_b32 v130, v129
s_nop 0
v_add_f32 v130, v130, v129
v_mov_b32 v129, 0x3727c5ac
v_fmac_f32 v129, 0x3b000000, v130
v_rsq_f32 v130, v129
s_waitcnt lgkmcnt(0)
v_sub_f32 v132, v132, v128
v_mul_f32 v132, v132, v130
v_cvt_pk_bf16_f32 v88, v132, v132
v_sub_f32 v133, v133, v128
v_mul_f32 v133, v133, v130
v_cvt_pk_bf16_f32 v89, v133, v133
s_nop 1
v_and_b32_dpp v112, v88, v16 row_newbcast:0 row_mask:0xf bank_mask:0xf
v_and_b32_dpp v113, v88, v17 row_newbcast:0 row_mask:0xf bank_mask:0xf
v_and_b32_dpp v114, v88, v18 row_newbcast:0 row_mask:0xf bank_mask:0xf
v_and_b32_dpp v115, v88, v19 row_newbcast:0 row_mask:0xf bank_mask:0xf
v_and_b32_dpp v116, v88, v16 row_newbcast:1 row_mask:0xf bank_mask:0xf
v_and_b32_dpp v117, v88, v17 row_newbcast:1 row_mask:0xf bank_mask:0xf
v_and_b32_dpp v118, v88, v18 row_newbcast:1 row_mask:0xf bank_mask:0xf
v_and_b32_dpp v119, v88, v19 row_newbcast:1 row_mask:0xf bank_mask:0xf
v_mfma_f32_16x16x32_bf16 v[104:107], v[112:115], v[56:59], 0
s_mov_b32 s45, 0x2a000
buffer_load_dwordx4 v[56:59], v4, s[20:23], s45 offen offset:0
v_and_b32_dpp v112, v88, v16 row_newbcast:2 row_mask:0xf bank_mask:0xf
v_and_b32_dpp v113, v88, v17 row_newbcast:2 row_mask:0xf bank_mask:0xf
v_and_b32_dpp v114, v88, v18 row_newbcast:2 row_mask:0xf bank_mask:0xf
v_and_b32_dpp v115, v88, v19 row_newbcast:2 row_mask:0xf bank_mask:0xf
v_mfma_f32_16x16x32_bf16 v[104:107], v[116:119], v[60:63], v[104:107]
s_mov_b32 s45, 0x2d000
buffer_load_dwordx4 v[60:63], v4, s[20:23], s45 offen offset:2048
v_and_b32_dpp v116, v88, v16 row_newbcast:3 row_mask:0xf bank_mask:0xf
v_and_b32_dpp v117, v88, v17 row_newbcast:3 row_mask:0xf bank_mask:0xf
v_and_b32_dpp v118, v88, v18 row_newbcast:3 row_mask:0xf bank_mask:0xf
v_and_b32_dpp v119, v88, v19 row_newbcast:3 row_mask:0xf bank_mask:0xf
v_mfma_f32_16x16x32_bf16 v[104:107], v[112:115], v[64:67], v[104:107]
s_mov_b32 s45, 0x31000
buffer_load_dwordx4 v[64:67], v4, s[20:23], s45 offen offset:0
v_and_b32_dpp v112, v88, v16 row_newbcast:4 row_mask:0xf bank_mask:0xf
v_and_b32_dpp v113, v88, v17 row_newbcast:4 row_mask:0xf bank_mask:0xf
v_and_b32_dpp v114, v88, v18 row_newbcast:4 row_mask:0xf bank_mask:0xf
v_and_b32_dpp v115, v88, v19 row_newbcast:4 row_mask:0xf bank_mask:0xf
v_mfma_f32_16x16x32_bf16 v[104:107], v[116:119], v[68:71], v[104:107]
s_mov_b32 s45, 0x34000
buffer_load_dwordx4 v[68:71], v4, s[20:23], s45 offen offset:2048
v_and_b32_dpp v116, v88, v16 row_newbcast:5 row_mask:0xf bank_mask:0xf
v_and_b32_dpp v117, v88, v17 row_newbcast:5 row_mask:0xf bank_mask:0xf
v_and_b32_dpp v118, v88, v18 row_newbcast:5 row_mask:0xf bank_mask:0xf
v_and_b32_dpp v119, v88, v19 row_newbcast:5 row_mask:0xf bank_mask:0xf
v_mfma_f32_16x16x32_bf16 v[104:107], v[112:115], v[24:27], v[104:107]
s_mov_b32 s45, 0x38000
buffer_load_dwordx4 v[24:27], v4, s[20:23], s45 offen offset:0
v_and_b32_dpp v112, v88, v16 row_newbcast:6 row_mask:0xf bank_mask:0xf
v_and_b32_dpp v113, v88, v17 row_newbcast:6 row_mask:0xf bank_mask:0xf
v_and_b32_dpp v114, v88, v18 row_newbcast:6 row_mask:0xf bank_mask:0xf
v_and_b32_dpp v115, v88, v19 row_newbcast:6 row_mask:0xf bank_mask:0xf
v_mfma_f32_16x16x32_bf16 v[104:107], v[116:119], v[28:31], v[104:107]
s_mov_b32 s45, 0x3b000
buffer_load_dwordx4 v[28:31], v4, s[20:23], s45 offen offset:2048
v_and_b32_dpp v116, v88, v16 row_newbcast:7 row_mask:0xf bank_mask:0xf
v_and_b32_dpp v117, v88, v17 row_newbcast:7 row_mask:0xf bank_mask:0xf
v_and_b32_dpp v118, v88, v18 row_newbcast:7 row_mask:0xf bank_mask:0xf
v_and_b32_dpp v119, v88, v19 row_newbcast:7 row_mask:0xf bank_mask:0xf
v_mfma_f32_16x16x32_bf16 v[104:107], v[112:115], v[32:35], v[104:107]
s_mov_b32 s45, 0x3f000
buffer_load_dwordx4 v[32:35], v4, s[20:23], s45 offen offset:0
v_and_b32_dpp v112, v88, v16 row_newbcast:8 row_mask:0xf bank_mask:0xf
v_and_b32_dpp v113, v88, v17 row_newbcast:8 row_mask:0xf bank_mask:0xf
v_and_b32_dpp v114, v88, v18 row_newbcast:8 row_mask:0xf bank_mask:0xf
v_and_b32_dpp v115, v88, v19 row_newbcast:8 row_mask:0xf bank_mask:0xf
v_mfma_f32_16x16x32_bf16 v[104:107], v[116:119], v[36:39], v[104:107]
s_mov_b32 s45, 0x42000
buffer_load_dwordx4 v[36:39], v4, s[20:23], s45 offen offset:2048
v_and_b32_dpp v116, v88, v16 row_newbcast:9 row_mask:0xf bank_mask:0xf
v_and_b32_dpp v117, v88, v17 row_newbcast:9 row_mask:0xf bank_mask:0xf
v_and_b32_dpp v118, v88, v18 row_newbcast:9 row_mask:0xf bank_mask:0xf
v_and_b32_dpp v119, v88, v19 row_newbcast:9 row_mask:0xf bank_mask:0xf
v_mfma_f32_16x16x32_bf16 v[104:107], v[112:115], v[40:43], v[104:107]
s_mov_b32 s45, 0x46000
buffer_load_dwordx4 v[40:43], v4, s[20:23], s45 offen offset:0
v_and_b32_dpp v112, v88, v16 row_newbcast:10 row_mask:0xf bank_mask:0xf
v_and_b32_dpp v113, v88, v17 row_newbcast:10 row_mask:0xf bank_mask:0xf
v_and_b32_dpp v114, v88, v18 row_newbcast:10 row_mask:0xf bank_mask:0xf
v_and_b32_dpp v115, v88, v19 row_newbcast:10 row_mask:0xf bank_mask:0xf
v_mfma_f32_16x16x32_bf16 v[104:107], v[116:119], v[44:47], v[104:107]
s_mov_b32 s45, 0x49000
buffer_load_dwordx4 v[44:47], v4, s[20:23], s45 offen offset:2048
v_and_b32_dpp v116, v88, v16 row_newbcast:11 row_mask:0xf bank_mask:0xf
v_and_b32_dpp v117, v88, v17 row_newbcast:11 row_mask:0xf bank_mask:0xf
v_and_b32_dpp v118, v88, v18 row_newbcast:11 row_mask:0xf bank_mask:0xf
v_and_b32_dpp v119, v88, v19 row_newbcast:11 row_mask:0xf bank_mask:0xf
v_mfma_f32_16x16x32_bf16 v[104:107], v[112:115], v[48:51], v[104:107]
s_mov_b32 s45, 0x4d000
buffer_load_dwordx4 v[48:51], v4, s[20:23], s45 offen offset:0
v_and_b32_dpp v112, v88, v16 row_newbcast:12 row_mask:0xf bank_mask:0xf
v_and_b32_dpp v113, v88, v17 row_newbcast:12 row_mask:0xf bank_mask:0xf
v_and_b32_dpp v114, v88, v18 row_newbcast:12 row_mask:0xf bank_mask:0xf
v_and_b32_dpp v115, v88, v19 row_newbcast:12 row_mask:0xf bank_mask:0xf
v_mfma_f32_16x16x32_bf16 v[104:107], v[116:119], v[52:55], v[104:107]
s_mov_b32 s45, 0x50000
buffer_load_dwordx4 v[52:55], v4, s[20:23], s45 offen offset:2048
v_and_b32_dpp v116, v88, v16 row_newbcast:13 row_mask:0xf bank_mask:0xf
v_and_b32_dpp v117, v88, v17 row_newbcast:13 row_mask:0xf bank_mask:0xf
v_and_b32_dpp v118, v88, v18 row_newbcast:13 row_mask:0xf bank_mask:0xf
v_and_b32_dpp v119, v88, v19 row_newbcast:13 row_mask:0xf bank_mask:0xf
s_waitcnt vmcnt(11)
v_mfma_f32_16x16x32_bf16 v[104:107], v[112:115], v[56:59], v[104:107]
s_mov_b32 s45, 0x54000
buffer_load_dwordx4 v[56:59], v4, s[20:23], s45 offen offset:0
v_and_b32_dpp v112, v88, v16 row_newbcast:14 row_mask:0xf bank_mask:0xf
v_and_b32_dpp v113, v88, v17 row_newbcast:14 row_mask:0xf bank_mask:0xf
v_and_b32_dpp v114, v88, v18 row_newbcast:14 row_mask:0xf bank_mask:0xf
v_and_b32_dpp v115, v88, v19 row_newbcast:14 row_mask:0xf bank_mask:0xf
s_waitcnt vmcnt(11)
v_mfma_f32_16x16x32_bf16 v[104:107], v[116:119], v[60:63], v[104:107]
s_mov_b32 s45, 0x57000
buffer_load_dwordx4 v[60:63], v4, s[20:23], s45 offen offset:2048
v_and_b32_dpp v116, v88, v16 row_newbcast:15 row_mask:0xf bank_mask:0xf
v_and_b32_dpp v117, v88, v17 row_newbcast:15 row_mask:0xf bank_mask:0xf
v_and_b32_dpp v118, v88, v18 row_newbcast:15 row_mask:0xf bank_mask:0xf
v_and_b32_dpp v119, v88, v19 row_newbcast:15 row_mask:0xf bank_mask:0xf
s_waitcnt vmcnt(11)
v_mfma_f32_16x16x32_bf16 v[104:107], v[112:115], v[64:67], v[104:107]
s_mov_b32 s45, 0x5b000
buffer_load_dwordx4 v[64:67], v4, s[20:23], s45 offen offset:0
v_and_b32_dpp v112, v89, v16 row_newbcast:0 row_mask:0xf bank_mask:0xf
v_and_b32_dpp v113, v89, v17 row_newbcast:0 row_mask:0xf bank_mask:0xf
v_and_b32_dpp v114, v89, v18 row_newbcast:0 row_mask:0xf bank_mask:0xf
v_and_b32_dpp v115, v89, v19 row_newbcast:0 row_mask:0xf bank_mask:0xf
s_waitcnt vmcnt(11)
v_mfma_f32_16x16x32_bf16 v[104:107], v[116:119], v[68:71], v[104:107]
s_mov_b32 s45, 0x5e000
buffer_load_dwordx4 v[68:71], v4, s[20:23], s45 offen offset:2048
v_and_b32_dpp v116, v89, v16 row_newbcast:1 row_mask:0xf bank_mask:0xf
v_and_b32_dpp v117, v89, v17 row_newbcast:1 row_mask:0xf bank_mask:0xf
v_and_b32_dpp v118, v89, v18 row_newbcast:1 row_mask:0xf bank_mask:0xf
v_and_b32_dpp v119, v89, v19 row_newbcast:1 row_mask:0xf bank_mask:0xf
s_waitcnt vmcnt(11)
v_mfma_f32_16x16x32_bf16 v[104:107], v[112:115], v[24:27], v[104:107]
s_mov_b32 s45, 0x62000
buffer_load_dwordx4 v[24:27], v4, s[20:23], s45 offen offset:0
v_and_b32_dpp v112, v89, v16 row_newbcast:2 row_mask:0xf bank_mask:0xf
v_and_b32_dpp v113, v89, v17 row_newbcast:2 row_mask:0xf bank_mask:0xf
v_and_b32_dpp v114, v89, v18 row_newbcast:2 row_mask:0xf bank_mask:0xf
v_and_b32_dpp v115, v89, v19 row_newbcast:2 row_mask:0xf bank_mask:0xf
s_waitcnt vmcnt(11)
v_mfma_f32_16x16x32_bf16 v[104:107], v[116:119], v[28:31], v[104:107]
s_mov_b32 s45, 0x65000
buffer_load_dwordx4 v[28:31], v4, s[20:23], s45 offen offset:2048
v_and_b32_dpp v116, v89, v16 row_newbcast:3 row_mask:0xf bank_mask:0xf
v_and_b32_dpp v117, v89, v17 row_newbcast:3 row_mask:0xf bank_mask:0xf
v_and_b32_dpp v118, v89, v18 row_newbcast:3 row_mask:0xf bank_mask:0xf
v_and_b32_dpp v119, v89, v19 row_newbcast:3 row_mask:0xf bank_mask:0xf
s_waitcnt vmcnt(11)
v_mfma_f32_16x16x32_bf16 v[104:107], v[112:115], v[32:35], v[104:107]
s_mov_b32 s45, 0x69000
buffer_load_dwordx4 v[32:35], v4, s[20:23], s45 offen offset:0
v_and_b32_dpp v112, v89, v16 row_newbcast:4 row_mask:0xf bank_mask:0xf
v_and_b32_dpp v113, v89, v17 row_newbcast:4 row_mask:0xf bank_mask:0xf
v_and_b32_dpp v114, v89, v18 row_newbcast:4 row_mask:0xf bank_mask:0xf
v_and_b32_dpp v115, v89, v19 row_newbcast:4 row_mask:0xf bank_mask:0xf
s_waitcnt vmcnt(11)
v_mfma_f32_16x16x32_bf16 v[104:107], v[116:119], v[36:39], v[104:107]
s_mov_b32 s45, 0x6c000
buffer_load_dwordx4 v[36:39], v4, s[20:23], s45 offen offset:2048
v_and_b32_dpp v116, v89, v16 row_newbcast:5 row_mask:0xf bank_mask:0xf
v_and_b32_dpp v117, v89, v17 row_newbcast:5 row_mask:0xf bank_mask:0xf
v_and_b32_dpp v118, v89, v18 row_newbcast:5 row_mask:0xf bank_mask:0xf
v_and_b32_dpp v119, v89, v19 row_newbcast:5 row_mask:0xf bank_mask:0xf
s_waitcnt vmcnt(11)
v_mfma_f32_16x16x32_bf16 v[104:107], v[112:115], v[40:43], v[104:107]
buffer_load_dwordx4 v[40:43], v5, s[24:27], 0 offen offset:0
v_and_b32_dpp v112, v89, v16 row_newbcast:6 row_mask:0xf bank_mask:0xf
v_and_b32_dpp v113, v89, v17 row_newbcast:6 row_mask:0xf bank_mask:0xf
v_and_b32_dpp v114, v89, v18 row_newbcast:6 row_mask:0xf bank_mask:0xf
v_and_b32_dpp v115, v89, v19 row_newbcast:6 row_mask:0xf bank_mask:0xf
s_waitcnt vmcnt(11)
v_mfma_f32_16x16x32_bf16 v[104:107], v[116:119], v[44:47], v[104:107]
s_mov_b32 s45, 0x1000
buffer_load_dwordx4 v[44:47], v5, s[24:27], s45 offen offset:0
v_and_b32_dpp v116, v89, v16 row_newbcast:7 row_mask:0xf bank_mask:0xf
v_and_b32_dpp v117, v89, v17 row_newbcast:7 row_mask:0xf bank_mask:0xf
v_and_b32_dpp v118, v89, v18 row_newbcast:7 row_mask:0xf bank_mask:0xf
v_and_b32_dpp v119, v89, v19 row_newbcast:7 row_mask:0xf bank_mask:0xf
s_waitcnt vmcnt(11)
v_mfma_f32_16x16x32_bf16 v[104:107], v[112:115], v[48:51], v[104:107]
s_mov_b32 s45, 0x2000
buffer_load_dwordx4 v[48:51], v5, s[24:27], s45 offen offset:0
v_and_b32_dpp v112, v89, v16 row_newbcast:8 row_mask:0xf bank_mask:0xf
v_and_b32_dpp v113, v89, v17 row_newbcast:8 row_mask:0xf bank_mask:0xf
v_and_b32_dpp v114, v89, v18 row_newbcast:8 row_mask:0xf bank_mask:0xf
v_and_b32_dpp v115, v89, v19 row_newbcast:8 row_mask:0xf bank_mask:0xf
s_waitcnt vmcnt(11)
v_mfma_f32_16x16x32_bf16 v[104:107], v[116:119], v[52:55], v[104:107]
s_mov_b32 s45, 0x3000
buffer_load_dwordx4 v[52:55], v5, s[24:27], s45 offen offset:0
v_and_b32_dpp v116, v89, v16 row_newbcast:9 row_mask:0xf bank_mask:0xf
v_and_b32_dpp v117, v89, v17 row_newbcast:9 row_mask:0xf bank_mask:0xf
v_and_b32_dpp v118, v89, v18 row_newbcast:9 row_mask:0xf bank_mask:0xf
v_and_b32_dpp v119, v89, v19 row_newbcast:9 row_mask:0xf bank_mask:0xf
s_waitcnt vmcnt(11)
v_mfma_f32_16x16x32_bf16 v[104:107], v[112:115], v[56:59], v[104:107]
s_mov_b32 s45, 0x4000
buffer_load_dwordx4 v[56:59], v5, s[24:27], s45 offen offset:0
v_and_b32_dpp v112, v89, v16 row_newbcast:10 row_mask:0xf bank_mask:0xf
v_and_b32_dpp v113, v89, v17 row_newbcast:10 row_mask:0xf bank_mask:0xf
v_and_b32_dpp v114, v89, v18 row_newbcast:10 row_mask:0xf bank_mask:0xf
v_and_b32_dpp v115, v89, v19 row_newbcast:10 row_mask:0xf bank_mask:0xf
s_waitcnt vmcnt(11)
v_mfma_f32_16x16x32_bf16 v[104:107], v[116:119], v[60:63], v[104:107]
s_mov_b32 s45, 0x5000
buffer_load_dwordx4 v[60:63], v5, s[24:27], s45 offen offset:0
v_and_b32_dpp v116, v89, v16 row_newbcast:11 row_mask:0xf bank_mask:0xf
v_and_b32_dpp v117, v89, v17 row_newbcast:11 row_mask:0xf bank_mask:0xf
v_and_b32_dpp v118, v89, v18 row_newbcast:11 row_mask:0xf bank_mask:0xf
v_and_b32_dpp v119, v89, v19 row_newbcast:11 row_mask:0xf bank_mask:0xf
s_waitcnt vmcnt(11)
v_mfma_f32_16x16x32_bf16 v[104:107], v[112:115], v[64:67], v[104:107]
s_mov_b32 s45, 0x6000
buffer_load_dwordx4 v[64:67], v5, s[24:27], s45 offen offset:0
v_and_b32_dpp v112, v89, v16 row_newbcast:12 row_mask:0xf bank_mask:0xf
v_and_b32_dpp v113, v89, v17 row_newbcast:12 row_mask:0xf bank_mask:0xf
v_and_b32_dpp v114, v89, v18 row_newbcast:12 row_mask:0xf bank_mask:0xf
v_and_b32_dpp v115, v89, v19 row_newbcast:12 row_mask:0xf bank_mask:0xf
s_waitcnt vmcnt(11)
v_mfma_f32_16x16x32_bf16 v[104:107], v[116:119], v[68:71], v[104:107]
s_mov_b32 s45, 0x7000
buffer_load_dwordx4 v[68:71], v5, s[24:27], s45 offen offset:0
v_and_b32_dpp v116, v89, v16 row_newbcast:13 row_mask:0xf bank_mask:0xf
v_and_b32_dpp v117, v89, v17 row_newbcast:13 row_mask:0xf bank_mask:0xf
v_and_b32_dpp v118, v89, v18 row_newbcast:13 row_mask:0xf bank_mask:0xf
v_and_b32_dpp v119, v89, v19 row_newbcast:13 row_mask:0xf bank_mask:0xf
s_waitcnt vmcnt(11)
v_mfma_f32_16x16x32_bf16 v[104:107], v[112:115], v[24:27], v[104:107]
s_mov_b32 s45, 0x8000
buffer_load_dwordx4 v[24:27], v5, s[24:27], s45 offen offset:0
v_and_b32_dpp v112, v89, v16 row_newbcast:14 row_mask:0xf bank_mask:0xf
v_and_b32_dpp v113, v89, v17 row_newbcast:14 row_mask:0xf bank_mask:0xf
v_and_b32_dpp v114, v89, v18 row_newbcast:14 row_mask:0xf bank_mask:0xf
v_and_b32_dpp v115, v89, v19 row_newbcast:14 row_mask:0xf bank_mask:0xf
s_waitcnt vmcnt(11)
v_mfma_f32_16x16x32_bf16 v[104:107], v[116:119], v[28:31], v[104:107]
s_mov_b32 s45, 0x9000
buffer_load_dwordx4 v[28:31], v5, s[24:27], s45 offen offset:0
v_and_b32_dpp v116, v89, v16 row_newbcast:15 row_mask:0xf bank_mask:0xf
v_and_b32_dpp v117, v89, v17 row_newbcast:15 row_mask:0xf bank_mask:0xf
v_and_b32_dpp v118, v89, v18 row_newbcast:15 row_mask:0xf bank_mask:0xf
v_and_b32_dpp v119, v89, v19 row_newbcast:15 row_mask:0xf bank_mask:0xf
s_waitcnt vmcnt(11)
v_mfma_f32_16x16x32_bf16 v[104:107], v[112:115], v[32:35], v[104:107]
s_mov_b32 s45, 0xa000
buffer_load_dwordx4 v[32:35], v5, s[24:27], s45 offen offset:0
s_nop 1
s_waitcnt vmcnt(11)
v_mfma_f32_16x16x32_bf16 v[104:107], v[116:119], v[36:39], v[104:107]
s_mov_b32 s45, 0xb000
buffer_load_dwordx4 v[36:39], v5, s[24:27], s45 offen offset:0
s_nop 7
s_mov_b32 exec_hi, 0
ds_write_b128 v11, v[104:107] offset:6144
s_mov_b32 exec_hi, -1
s_waitcnt lgkmcnt(0)
s_barrier
ds_read_b32 v120, v9 offset:6144
ds_read_b32 v121, v9 offset:6400
ds_read_b32 v122, v9 offset:6656
ds_read_b32 v123, v9 offset:6912
ds_read_b32 v124, v9 offset:7168
ds_read_b32 v125, v9 offset:7424
ds_read_b32 v126, v9 offset:7680
ds_read_b32 v127, v9 offset:7936
s_waitcnt lgkmcnt(0)
v_add_f32 v120, v120, v122
v_add_f32 v120, v120, v124
v_add_f32 v120, v120, v126
v_add_f32 v121, v121, v123
v_add_f32 v121, v121, v125
v_add_f32 v121, v121, v127
v_cvt_pk_bf16_f32 v122, v120, v121
v_lshlrev_b32 v120, 16, v122
v_and_b32 v121, 0xffff0000, v122
v_mul_f32 v124, 0xbfb8aa3b, v120
v_mul_f32 v125, 0xbfb8aa3b, v121
v_exp_f32 v124, v124
v_exp_f32 v125, v125
s_nop 0
v_add_f32 v124, 1.0, v124
v_add_f32 v125, 1.0, v125
v_rcp_f32 v124, v124
v_rcp_f32 v125, v125
s_nop 0
v_mul_f32 v120, v120, v124
v_cvt_pk_bf16_f32 v88, v120, v120
v_mul_f32 v121, v121, v125
v_cvt_pk_bf16_f32 v89, v121, v121
s_nop 1
v_and_b32_dpp v112, v88, v16 row_newbcast:0 row_mask:0xf bank_mask:0xf
v_and_b32_dpp v113, v88, v17 row_newbcast:0 row_mask:0xf bank_mask:0xf
v_and_b32_dpp v114, v88, v18 row_newbcast:0 row_mask:0xf bank_mask:0xf
v_and_b32_dpp v115, v88, v19 row_newbcast:0 row_mask:0xf bank_mask:0xf
v_and_b32_dpp v116, v88, v16 row_newbcast:1 row_mask:0xf bank_mask:0xf
v_and_b32_dpp v117, v88, v17 row_newbcast:1 row_mask:0xf bank_mask:0xf
v_and_b32_dpp v118, v88, v18 row_newbcast:1 row_mask:0xf bank_mask:0xf
v_and_b32_dpp v119, v88, v19 row_newbcast:1 row_mask:0xf bank_mask:0xf
s_waitcnt vmcnt(11)
v_mfma_f32_16x16x32_bf16 v[104:107], v[112:115], v[40:43], 0
s_mov_b32 s45, 0xc000
buffer_load_dwordx4 v[40:43], v5, s[24:27], s45 offen offset:0
v_and_b32_dpp v112, v88, v16 row_newbcast:2 row_mask:0xf bank_mask:0xf
v_and_b32_dpp v113, v88, v17 row_newbcast:2 row_mask:0xf bank_mask:0xf
v_and_b32_dpp v114, v88, v18 row_newbcast:2 row_mask:0xf bank_mask:0xf
v_and_b32_dpp v115, v88, v19 row_newbcast:2 row_mask:0xf bank_mask:0xf
s_waitcnt vmcnt(11)
v_mfma_f32_16x16x32_bf16 v[104:107], v[116:119], v[44:47], v[104:107]
s_mov_b32 s45, 0xd000
buffer_load_dwordx4 v[44:47], v5, s[24:27], s45 offen offset:0
v_and_b32_dpp v116, v88, v16 row_newbcast:3 row_mask:0xf bank_mask:0xf
v_and_b32_dpp v117, v88, v17 row_newbcast:3 row_mask:0xf bank_mask:0xf
v_and_b32_dpp v118, v88, v18 row_newbcast:3 row_mask:0xf bank_mask:0xf
v_and_b32_dpp v119, v88, v19 row_newbcast:3 row_mask:0xf bank_mask:0xf
s_waitcnt vmcnt(11)
v_mfma_f32_16x16x32_bf16 v[104:107], v[112:115], v[48:51], v[104:107]
s_mov_b32 s45, 0xe000
buffer_load_dwordx4 v[48:51], v5, s[24:27], s45 offen offset:0
v_and_b32_dpp v112, v88, v16 row_newbcast:4 row_mask:0xf bank_mask:0xf
v_and_b32_dpp v113, v88, v17 row_newbcast:4 row_mask:0xf bank_mask:0xf
v_and_b32_dpp v114, v88, v18 row_newbcast:4 row_mask:0xf bank_mask:0xf
v_and_b32_dpp v115, v88, v19 row_newbcast:4 row_mask:0xf bank_mask:0xf
s_waitcnt vmcnt(11)
v_mfma_f32_16x16x32_bf16 v[104:107], v[116:119], v[52:55], v[104:107]
s_mov_b32 s45, 0xf000
buffer_load_dwordx4 v[52:55], v5, s[24:27], s45 offen offset:0
v_and_b32_dpp v116, v88, v16 row_newbcast:5 row_mask:0xf bank_mask:0xf
v_and_b32_dpp v117, v88, v17 row_newbcast:5 row_mask:0xf bank_mask:0xf
v_and_b32_dpp v118, v88, v18 row_newbcast:5 row_mask:0xf bank_mask:0xf
v_and_b32_dpp v119, v88, v19 row_newbcast:5 row_mask:0xf bank_mask:0xf
s_waitcnt vmcnt(11)
v_mfma_f32_16x16x32_bf16 v[104:107], v[112:115], v[56:59], v[104:107]
s_mov_b32 s45, 0x10000
buffer_load_dwordx4 v[56:59], v5, s[24:27], s45 offen offset:0
v_and_b32_dpp v112, v88, v16 row_newbcast:6 row_mask:0xf bank_mask:0xf
v_and_b32_dpp v113, v88, v17 row_newbcast:6 row_mask:0xf bank_mask:0xf
v_and_b32_dpp v114, v88, v18 row_newbcast:6 row_mask:0xf bank_mask:0xf
v_and_b32_dpp v115, v88, v19 row_newbcast:6 row_mask:0xf bank_mask:0xf
s_waitcnt vmcnt(11)
v_mfma_f32_16x16x32_bf16 v[104:107], v[116:119], v[60:63], v[104:107]
s_mov_b32 s45, 0x11000
buffer_load_dwordx4 v[60:63], v5, s[24:27], s45 offen offset:0
v_and_b32_dpp v116, v88, v16 row_newbcast:7 row_mask:0xf bank_mask:0xf
v_and_b32_dpp v117, v88, v17 row_newbcast:7 row_mask:0xf bank_mask:0xf
v_and_b32_dpp v118, v88, v18 row_newbcast:7 row_mask:0xf bank_mask:0xf
v_and_b32_dpp v119, v88, v19 row_newbcast:7 row_mask:0xf bank_mask:0xf
s_waitcnt vmcnt(11)
v_mfma_f32_16x16x32_bf16 v[104:107], v[112:115], v[64:67], v[104:107]
s_mov_b32 s45, 0x12000
buffer_load_dwordx4 v[64:67], v5, s[24:27], s45 offen offset:0
v_and_b32_dpp v112, v88, v16 row_newbcast:8 row_mask:0xf bank_mask:0xf
v_and_b32_dpp v113, v88, v17 row_newbcast:8 row_mask:0xf bank_mask:0xf
v_and_b32_dpp v114, v88, v18 row_newbcast:8 row_mask:0xf bank_mask:0xf
v_and_b32_dpp v115, v88, v19 row_newbcast:8 row_mask:0xf bank_mask:0xf
s_waitcnt vmcnt(11)
v_mfma_f32_16x16x32_bf16 v[104:107], v[116:119], v[68:71], v[104:107]
s_mov_b32 s45, 0x13000
buffer_load_dwordx4 v[68:71], v5, s[24:27], s45 offen offset:0
v_and_b32_dpp v116, v88, v16 row_newbcast:9 row_mask:0xf bank_mask:0xf
v_and_b32_dpp v117, v88, v17 row_newbcast:9 row_mask:0xf bank_mask:0xf
v_and_b32_dpp v118, v88, v18 row_newbcast:9 row_mask:0xf bank_mask:0xf
v_and_b32_dpp v119, v88, v19 row_newbcast:9 row_mask:0xf bank_mask:0xf
s_waitcnt vmcnt(11)
v_mfma_f32_16x16x32_bf16 v[104:107], v[112:115], v[24:27], v[104:107]
s_mov_b32 s45, 0x14000
buffer_load_dwordx4 v[24:27], v5, s[24:27], s45 offen offset:0
v_and_b32_dpp v112, v88, v16 row_newbcast:10 row_mask:0xf bank_mask:0xf
v_and_b32_dpp v113, v88, v17 row_newbcast:10 row_mask:0xf bank_mask:0xf
v_and_b32_dpp v114, v88, v18 row_newbcast:10 row_mask:0xf bank_mask:0xf
v_and_b32_dpp v115, v88, v19 row_newbcast:10 row_mask:0xf bank_mask:0xf
s_waitcnt vmcnt(11)
v_mfma_f32_16x16x32_bf16 v[104:107], v[116:119], v[28:31], v[104:107]
s_mov_b32 s45, 0x15000
buffer_load_dwordx4 v[28:31], v5, s[24:27], s45 offen offset:0
v_and_b32_dpp v116, v88, v16 row_newbcast:11 row_mask:0xf bank_mask:0xf
v_and_b32_dpp v117, v88, v17 row_newbcast:11 row_mask:0xf bank_mask:0xf
v_and_b32_dpp v118, v88, v18 row_newbcast:11 row_mask:0xf bank_mask:0xf
v_and_b32_dpp v119, v88, v19 row_newbcast:11 row_mask:0xf bank_mask:0xf
s_waitcnt vmcnt(11)
v_mfma_f32_16x16x32_bf16 v[104:107], v[112:115], v[32:35], v[104:107]
s_mov_b32 s45, 0x16000
buffer_load_dwordx4 v[32:35], v5, s[24:27], s45 offen offset:0
v_and_b32_dpp v112, v88, v16 row_newbcast:12 row_mask:0xf bank_mask:0xf
v_and_b32_dpp v113, v88, v17 row_newbcast:12 row_mask:0xf bank_mask:0xf
v_and_b32_dpp v114, v88, v18 row_newbcast:12 row_mask:0xf bank_mask:0xf
v_and_b32_dpp v115, v88, v19 row_newbcast:12 row_mask:0xf bank_mask:0xf
s_waitcnt vmcnt(11)
v_mfma_f32_16x16x32_bf16 v[104:107], v[116:119], v[36:39], v[104:107]
s_mov_b32 s45, 0x17000
buffer_load_dwordx4 v[36:39], v5, s[24:27], s45 offen offset:0
v_and_b32_dpp v116, v88, v16 row_newbcast:13 row_mask:0xf bank_mask:0xf
v_and_b32_dpp v117, v88, v17 row_newbcast:13 row_mask:0xf bank_mask:0xf
v_and_b32_dpp v118, v88, v18 row_newbcast:13 row_mask:0xf bank_mask:0xf
v_and_b32_dpp v119, v88, v19 row_newbcast:13 row_mask:0xf bank_mask:0xf
s_waitcnt vmcnt(11)
v_mfma_f32_16x16x32_bf16 v[104:107], v[112:115], v[40:43], v[104:107]
s_mov_b32 s45, 0x18000
buffer_load_dwordx4 v[40:43], v5, s[24:27], s45 offen offset:0
v_and_b32_dpp v112, v88, v16 row_newbcast:14 row_mask:0xf bank_mask:0xf
v_and_b32_dpp v113, v88, v17 row_newbcast:14 row_mask:0xf bank_mask:0xf
v_and_b32_dpp v114, v88, v18 row_newbcast:14 row_mask:0xf bank_mask:0xf
v_and_b32_dpp v115, v88, v19 row_newbcast:14 row_mask:0xf bank_mask:0xf
s_waitcnt vmcnt(11)
v_mfma_f32_16x16x32_bf16 v[104:107], v[116:119], v[44:47], v[104:107]
s_mov_b32 s45, 0x19000
buffer_load_dwordx4 v[44:47], v5, s[24:27], s45 offen offset:0
v_and_b32_dpp v116, v88, v16 row_newbcast:15 row_mask:0xf bank_mask:0xf
v_and_b32_dpp v117, v88, v17 row_newbcast:15 row_mask:0xf bank_mask:0xf
v_and_b32_dpp v118, v88, v18 row_newbcast:15 row_mask:0xf bank_mask:0xf
v_and_b32_dpp v119, v88, v19 row_newbcast:15 row_mask:0xf bank_mask:0xf
s_waitcnt vmcnt(11)
v_mfma_f32_16x16x32_bf16 v[104:107], v[112:115], v[48:51], v[104:107]
s_mov_b32 s45, 0x1a000
buffer_load_dwordx4 v[48:51], v5, s[24:27], s45 offen offset:0
v_and_b32_dpp v112, v89, v16 row_newbcast:0 row_mask:0xf bank_mask:0xf
v_and_b32_dpp v113, v89, v17 row_newbcast:0 row_mask:0xf bank_mask:0xf
v_and_b32_dpp v114, v89, v18 row_newbcast:0 row_mask:0xf bank_mask:0xf
v_and_b32_dpp v115, v89, v19 row_newbcast:0 row_mask:0xf bank_mask:0xf
s_waitcnt vmcnt(11)
v_mfma_f32_16x16x32_bf16 v[104:107], v[116:119], v[52:55], v[104:107]
s_mov_b32 s45, 0x1b000
buffer_load_dwordx4 v[52:55], v5, s[24:27], s45 offen offset:0
v_and_b32_dpp v116, v89, v16 row_newbcast:1 row_mask:0xf bank_mask:0xf
v_and_b32_dpp v117, v89, v17 row_newbcast:1 row_mask:0xf bank_mask:0xf
v_and_b32_dpp v118, v89, v18 row_newbcast:1 row_mask:0xf bank_mask:0xf
v_and_b32_dpp v119, v89, v19 row_newbcast:1 row_mask:0xf bank_mask:0xf
s_waitcnt vmcnt(11)
v_mfma_f32_16x16x32_bf16 v[104:107], v[112:115], v[56:59], v[104:107]
s_mov_b32 s45, 0x1c000
buffer_load_dwordx4 v[56:59], v5, s[24:27], s45 offen offset:0
v_and_b32_dpp v112, v89, v16 row_newbcast:2 row_mask:0xf bank_mask:0xf
v_and_b32_dpp v113, v89, v17 row_newbcast:2 row_mask:0xf bank_mask:0xf
v_and_b32_dpp v114, v89, v18 row_newbcast:2 row_mask:0xf bank_mask:0xf
v_and_b32_dpp v115, v89, v19 row_newbcast:2 row_mask:0xf bank_mask:0xf
s_waitcnt vmcnt(11)
v_mfma_f32_16x16x32_bf16 v[104:107], v[116:119], v[60:63], v[104:107]
s_mov_b32 s45, 0x1d000
buffer_load_dwordx4 v[60:63], v5, s[24:27], s45 offen offset:0
v_and_b32_dpp v116, v89, v16 row_newbcast:3 row_mask:0xf bank_mask:0xf
v_and_b32_dpp v117, v89, v17 row_newbcast:3 row_mask:0xf bank_mask:0xf
v_and_b32_dpp v118, v89, v18 row_newbcast:3 row_mask:0xf bank_mask:0xf
v_and_b32_dpp v119, v89, v19 row_newbcast:3 row_mask:0xf bank_mask:0xf
s_waitcnt vmcnt(11)
v_mfma_f32_16x16x32_bf16 v[104:107], v[112:115], v[64:67], v[104:107]
s_mov_b32 s45, 0x1e000
buffer_load_dwordx4 v[64:67], v5, s[24:27], s45 offen offset:0
v_and_b32_dpp v112, v89, v16 row_newbcast:4 row_mask:0xf bank_mask:0xf
v_and_b32_dpp v113, v89, v17 row_newbcast:4 row_mask:0xf bank_mask:0xf
v_and_b32_dpp v114, v89, v18 row_newbcast:4 row_mask:0xf bank_mask:0xf
v_and_b32_dpp v115, v89, v19 row_newbcast:4 row_mask:0xf bank_mask:0xf
s_waitcnt vmcnt(11)
v_mfma_f32_16x16x32_bf16 v[104:107], v[116:119], v[68:71], v[104:107]
s_mov_b32 s45, 0x1f000
buffer_load_dwordx4 v[68:71], v5, s[24:27], s45 offen offset:0
v_and_b32_dpp v116, v89, v16 row_newbcast:5 row_mask:0xf bank_mask:0xf
v_and_b32_dpp v117, v89, v17 row_newbcast:5 row_mask:0xf bank_mask:0xf
v_and_b32_dpp v118, v89, v18 row_newbcast:5 row_mask:0xf bank_mask:0xf
v_and_b32_dpp v119, v89, v19 row_newbcast:5 row_mask:0xf bank_mask:0xf
s_waitcnt vmcnt(11)
v_mfma_f32_16x16x32_bf16 v[104:107], v[112:115], v[24:27], v[104:107]
v_and_b32_dpp v112, v89, v16 row_newbcast:6 row_mask:0xf bank_mask:0xf
v_and_b32_dpp v113, v89, v17 row_newbcast:6 row_mask:0xf bank_mask:0xf
v_and_b32_dpp v114, v89, v18 row_newbcast:6 row_mask:0xf bank_mask:0xf
v_and_b32_dpp v115, v89, v19 row_newbcast:6 row_mask:0xf bank_mask:0xf
s_waitcnt vmcnt(10)
v_mfma_f32_16x16x32_bf16 v[104:107], v[116:119], v[28:31], v[104:107]
v_and_b32_dpp v116, v89, v16 row_newbcast:7 row_mask:0xf bank_mask:0xf
v_and_b32_dpp v117, v89, v17 row_newbcast:7 row_mask:0xf bank_mask:0xf
v_and_b32_dpp v118, v89, v18 row_newbcast:7 row_mask:0xf bank_mask:0xf
v_and_b32_dpp v119, v89, v19 row_newbcast:7 row_mask:0xf bank_mask:0xf
s_waitcnt vmcnt(9)
v_mfma_f32_16x16x32_bf16 v[104:107], v[112:115], v[32:35], v[104:107]
v_and_b32_dpp v112, v89, v16 row_newbcast:8 row_mask:0xf bank_mask:0xf
v_and_b32_dpp v113, v89, v17 row_newbcast:8 row_mask:0xf bank_mask:0xf
v_and_b32_dpp v114, v89, v18 row_newbcast:8 row_mask:0xf bank_mask:0xf
v_and_b32_dpp v115, v89, v19 row_newbcast:8 row_mask:0xf bank_mask:0xf
s_waitcnt vmcnt(8)
v_mfma_f32_16x16x32_bf16 v[104:107], v[116:119], v[36:39], v[104:107]
v_and_b32_dpp v116, v89, v16 row_newbcast:9 row_mask:0xf bank_mask:0xf
v_and_b32_dpp v117, v89, v17 row_newbcast:9 row_mask:0xf bank_mask:0xf
v_and_b32_dpp v118, v89, v18 row_newbcast:9 row_mask:0xf bank_mask:0xf
v_and_b32_dpp v119, v89, v19 row_newbcast:9 row_mask:0xf bank_mask:0xf
s_waitcnt vmcnt(7)
v_mfma_f32_16x16x32_bf16 v[104:107], v[112:115], v[40:43], v[104:107]
v_and_b32_dpp v112, v89, v16 row_newbcast:10 row_mask:0xf bank_mask:0xf
v_and_b32_dpp v113, v89, v17 row_newbcast:10 row_mask:0xf bank_mask:0xf
v_and_b32_dpp v114, v89, v18 row_newbcast:10 row_mask:0xf bank_mask:0xf
v_and_b32_dpp v115, v89, v19 row_newbcast:10 row_mask:0xf bank_mask:0xf
s_waitcnt vmcnt(6)
v_mfma_f32_16x16x32_bf16 v[104:107], v[116:119], v[44:47], v[104:107]
v_and_b32_dpp v116, v89, v16 row_newbcast:11 row_mask:0xf bank_mask:0xf
v_and_b32_dpp v117, v89, v17 row_newbcast:11 row_mask:0xf bank_mask:0xf
v_and_b32_dpp v118, v89, v18 row_newbcast:11 row_mask:0xf bank_mask:0xf
v_and_b32_dpp v119, v89, v19 row_newbcast:11 row_mask:0xf bank_mask:0xf
s_waitcnt vmcnt(5)
v_mfma_f32_16x16x32_bf16 v[104:107], v[112:115], v[48:51], v[104:107]
v_and_b32_dpp v112, v89, v16 row_newbcast:12 row_mask:0xf bank_mask:0xf
v_and_b32_dpp v113, v89, v17 row_newbcast:12 row_mask:0xf bank_mask:0xf
v_and_b32_dpp v114, v89, v18 row_newbcast:12 row_mask:0xf bank_mask:0xf
v_and_b32_dpp v115, v89, v19 row_newbcast:12 row_mask:0xf bank_mask:0xf
s_waitcnt vmcnt(4)
v_mfma_f32_16x16x32_bf16 v[104:107], v[116:119], v[52:55], v[104:107]
v_and_b32_dpp v116, v89, v16 row_newbcast:13 row_mask:0xf bank_mask:0xf
v_and_b32_dpp v117, v89, v17 row_newbcast:13 row_mask:0xf bank_mask:0xf
v_and_b32_dpp v118, v89, v18 row_newbcast:13 row_mask:0xf bank_mask:0xf
v_and_b32_dpp v119, v89, v19 row_newbcast:13 row_mask:0xf bank_mask:0xf
s_waitcnt vmcnt(3)
v_mfma_f32_16x16x32_bf16 v[104:107], v[112:115], v[56:59], v[104:107]
v_and_b32_dpp v112, v89, v16 row_newbcast:14 row_mask:0xf bank_mask:0xf
v_and_b32_dpp v113, v89, v17 row_newbcast:14 row_mask:0xf bank_mask:0xf
v_and_b32_dpp v114, v89, v18 row_newbcast:14 row_mask:0xf bank_mask:0xf
v_and_b32_dpp v115, v89, v19 row_newbcast:14 row_mask:0xf bank_mask:0xf
s_waitcnt vmcnt(2)
v_mfma_f32_16x16x32_bf16 v[104:107], v[116:119], v[60:63], v[104:107]
v_and_b32_dpp v116, v89, v16 row_newbcast:15 row_mask:0xf bank_mask:0xf
v_and_b32_dpp v117, v89, v17 row_newbcast:15 row_mask:0xf bank_mask:0xf
v_and_b32_dpp v118, v89, v18 row_newbcast:15 row_mask:0xf bank_mask:0xf
v_and_b32_dpp v119, v89, v19 row_newbcast:15 row_mask:0xf bank_mask:0xf
s_waitcnt vmcnt(1)
v_mfma_f32_16x16x32_bf16 v[104:107], v[112:115], v[64:67], v[104:107]
s_nop 1
s_waitcnt vmcnt(0)
v_mfma_f32_16x16x32_bf16 v[104:107], v[116:119], v[68:71], v[104:107]
s_nop 7
s_mov_b32 s54, 0xfffffffe
v_min_u32 v104, s54, v104
v_min_u32 v105, s54, v105
v_min_u32 v106, s54, v106
v_min_u32 v107, s54, v107
s_mov_b32 s45, 0x30000
v_add_u32 v15, s56, v6
buffer_store_dwordx4 v[104:107], v15, s[28:31], s45 offen sc1
s_cmp_lg_u32 s46, 31
s_cbranch_scc1 L_end
s_cmp_lg_u32 s44, 0
s_cbranch_scc1 L_skip8
s_mov_b32 s57, 0
v_lshlrev_b32 v120, 11, v0
v_add_u32 v120, 0x307fc, v120
s_mov_b32 exec_lo, 0x3fff
s_mov_b32 exec_hi, 0
L_poll8:
buffer_load_dword v122, v120, s[28:31], 0 offen sc1
s_waitcnt vmcnt(0)
v_cmp_eq_u32 vcc, -1, v122
s_add_u32 s57, s57, 1
s_nop 3
s_and_b64 exec, exec, vcc
s_cbranch_scc0 L_done8
s_cmp_ge_u32 s57, 0x40000
s_cbranch_scc1 L_done8
s_sleep 4
s_branch L_poll8
L_done8:
s_mov_b64 exec, -1
L_skip8:
s_barrier
s_mov_b32 s57, 0
L_g9:
s_mov_b32 s45, 0x30000
buffer_load_dwordx4 v[72:75], v7, s[28:31], s45 offen sc1
s_mov_b32 s45, 0x31000
buffer_load_dwordx4 v[76:79], v7, s[28:31], s45 offen sc1
s_mov_b32 s45, 0x32000
buffer_load_dwordx4 v[80:83], v7, s[28:31], s45 offen sc1
s_mov_b32 s45, 0x33000
buffer_load_dwordx4 v[84:87], v7, s[28:31], s45 offen sc1
s_mov_b32 s45, 0x34000
buffer_load_dwordx4 v[88:91], v7, s[28:31], s45 offen sc1
s_mov_b32 s45, 0x35000
buffer_load_dwordx4 v[92:95], v7, s[28:31], s45 offen sc1
s_mov_b32 s45, 0x36000
buffer_load_dwordx4 v[96:99], v7, s[28:31], s45 offen sc1
s_waitcnt vmcnt(6)
v_max3_u32 v15, v72, v73, v74
v_max_u32 v15, v15, v75
s_waitcnt vmcnt(5)
v_max3_u32 v15, v15, v76, v77
v_max3_u32 v15, v15, v78, v79
v_add_f32 v72, v72, v76
v_add_f32 v73, v73, v77
v_add_f32 v74, v74, v78
v_add_f32 v75, v75, v79
s_waitcnt vmcnt(4)
v_max3_u32 v15, v15, v80, v81
v_max3_u32 v15, v15, v82, v83
v_add_f32 v72, v72, v80
v_add_f32 v73, v73, v81
v_add_f32 v74, v74, v82
v_add_f32 v75, v75, v83
s_waitcnt vmcnt(3)
v_max3_u32 v15, v15, v84, v85
v_max3_u32 v15, v15, v86, v87
v_add_f32 v72, v72, v84
v_add_f32 v73, v73, v85
v_add_f32 v74, v74, v86
v_add_f32 v75, v75, v87
s_waitcnt vmcnt(2)
v_max3_u32 v15, v15, v88, v89
v_max3_u32 v15, v15, v90, v91
v_add_f32 v72, v72, v88
v_add_f32 v73, v73, v89
v_add_f32 v74, v74, v90
v_add_f32 v75, v75, v91
s_waitcnt vmcnt(1)
v_max3_u32 v15, v15, v92, v93
v_max3_u32 v15, v15, v94, v95
v_add_f32 v72, v72, v92
v_add_f32 v73, v73, v93
v_add_f32 v74, v74, v94
v_add_f32 v75, v75, v95
s_waitcnt vmcnt(0)
v_max3_u32 v15, v15, v96, v97
v_max3_u32 v15, v15, v98, v99
v_add_f32 v72, v72, v96
v_add_f32 v73, v73, v97
v_add_f32 v74, v74, v98
v_add_f32 v75, v75, v99
v_cmp_eq_u32 vcc, -1, v15
s_add_u32 s57, s57, 1
s_nop 3
s_cbranch_vccz L_gd9
s_cmp_ge_u32 s57, 0x40000
s_cbranch_scc1 L_gd9
s_sleep 2
s_branch L_g9
L_gd9:
v_mov_b32 v76, v72
v_mov_b32 v77, v73
v_mov_b32 v78, v74
v_mov_b32 v79, v75
s_nop 1
v_permlane32_swap_b32 v72, v76
v_permlane32_swap_b32 v73, v77
v_permlane32_swap_b32 v74, v78
v_permlane32_swap_b32 v75, v79
s_nop 0
v_add_f32 v72, v72, v76
v_add_f32 v73, v73, v77
v_add_f32 v74, v74, v78
v_add_f32 v75, v75, v79
v_cvt_pk_bf16_f32 v76, v72, v73
v_lshlrev_b32 v72, 16, v76
v_and_b32 v73, 0xffff0000, v76
v_cvt_pk_bf16_f32 v76, v74, v75
v_lshlrev_b32 v74, 16, v76
v_and_b32 v75, 0xffff0000, v76
v_add_f32 v20, v20, v72
v_add_f32 v21, v21, v73
v_add_f32 v22, v22, v74
v_add_f32 v23, v23, v75
v_cvt_pk_bf16_f32 v76, v20, v21
v_lshlrev_b32 v20, 16, v76
v_and_b32 v21, 0xffff0000, v76
v_cvt_pk_bf16_f32 v76, v22, v23
v_lshlrev_b32 v22, 16, v76
v_and_b32 v23, 0xffff0000, v76
v_cvt_pk_bf16_f32 v120, v20, v21
v_cvt_pk_bf16_f32 v121, v22, v23
v_subrev_u32 v122, 0x24000, v12
v_lshrrev_b32 v122, 1, v122
s_mov_b32 exec_hi, 0
buffer_store_dwordx2 v[120:121], v122, s[40:43], 0 offen
s_waitcnt vmcnt(0)
L_end:
s_endpgm
.section .rodata,"a"
.p2align 6
.amdhsa_kernel interleave_layers__mha_block_cached__dense_activation_silu__decode_kernel
  .amdhsa_next_free_vgpr 512
  .amdhsa_next_free_sgpr 102
  .amdhsa_accum_offset 256
  .amdhsa_group_segment_fixed_size 0
  .amdhsa_kernarg_size 88
  .amdhsa_user_sgpr_count 2
  .amdhsa_user_sgpr_kernarg_segment_ptr 1
  .amdhsa_system_sgpr_workgroup_id_x 1
.end_amdhsa_kernel
```
